```python
import torch

def _softmax(x, axis=-1):
    return torch.softmax(x, dim=axis)
def _gelu(x):
    return torch.nn.functional.gelu(x, approximate="tanh")
def _silu(x):
    return torch.nn.functional.silu(x)
def _sigmoid(x):
    return torch.sigmoid(x)
def _layernorm(x, axis=-1, eps=1e-5):
    m = x.mean(dim=axis, keepdim=True)
    v = x.var(dim=axis, keepdim=True, unbiased=False)
    return (x - m) / torch.sqrt(v + eps)
def _scatter_add(tgt, idx, src, axis=0):
    return tgt.clone().index_add_(axis, idx, src)
def _segment_sum(src, seg, n):
    out = torch.zeros((n,) + src.shape[1:], dtype=src.dtype)
    return out.index_add_(0, seg, src)
def _pad(x, pw):
    flat = tuple(v for pair in reversed(pw) for v in pair)
    return torch.nn.functional.pad(x, flat)

kernel_name = 'concat_heads__mha_block_cached__gqa_block_cached__near_ridge'

def setup_inputs():

    _w = (lambda a: (lambda t: t.to(torch.bfloat16) if t.is_floating_point() else t)(torch.as_tensor(a)))
    def _A_setup():
        B, Sq, D = 8, 144, 448
        H, Sk, Dh = 16, 512, 256
        return {
            "x": _w((lambda *s: torch.randn(*s, dtype=torch.bfloat16) * 0.8)(B, Sq, D)),
            "k_cache": _w((lambda *s: torch.randn(*s, dtype=torch.bfloat16) * 0.8)(B, H, Sk, Dh)),
            "v_cache": _w((lambda *s: torch.randn(*s, dtype=torch.bfloat16) * 0.05)(B, H, Sk, Dh)),
            "wq": _w((lambda *s: torch.randn(*s, dtype=torch.bfloat16) * 0.8)(D, H * Dh) * (D ** -0.5)),
            "wo": _w((lambda *s: torch.randn(*s, dtype=torch.bfloat16) * 0.05)(H * Dh, D) * ((H * Dh) ** -0.5)),
        }
    _A_in = _A_setup()

    def _B_setup():
        B, Sq, D = 8, 144, 448
        Hq, Hkv, Sk, Dh = 16, 16, 512, 256
        assert Hq % Hkv == 0, (Hq, Hkv)
        return {
            "x": _w((lambda *s: torch.randn(*s, dtype=torch.bfloat16) * 0.8)(B, Sq, D)),
            "k_cache": _w((lambda *s: torch.randn(*s, dtype=torch.bfloat16) * 0.8)(B, Hkv, Sk, Dh)),
            "v_cache": _w((lambda *s: torch.randn(*s, dtype=torch.bfloat16) * 0.05)(B, Hkv, Sk, Dh)),
            "wq": _w((lambda *s: torch.randn(*s, dtype=torch.bfloat16) * 0.8)(D, Hq * Dh) * (D ** -0.5)),
            "wo": _w((lambda *s: torch.randn(*s, dtype=torch.bfloat16) * 0.05)(Hq * Dh, D) * ((Hq * Dh) ** -0.5)),
        }
    _B_in = _B_setup()

    return {
        "A_x": _A_in["x"],
        "A_k_cache": _A_in["k_cache"],
        "A_v_cache": _A_in["v_cache"],
        "A_wq": _A_in["wq"],
        "A_wo": _A_in["wo"],
        "B_x": _B_in["x"],
        "B_k_cache": _B_in["k_cache"],
        "B_v_cache": _B_in["v_cache"],
        "B_wq": _B_in["wq"],
        "B_wo": _B_in["wo"],
    }

def reference(A_x, A_k_cache, A_v_cache, A_wq, A_wo, B_x, B_k_cache, B_v_cache, B_wq, B_wo):
    def _A_ref(x, k_cache, v_cache, wq, wo):
        B, Sq, D = x.shape
        H, Dh = 16, 256
        q = (lambda x, *d: x.permute(*d))((x @ wq).reshape(B, Sq, H, Dh), 0, 2, 1, 3)
        scores = torch.einsum("bhqd,bhkd->bhqk", q, k_cache) * (Dh ** -0.5)
        p = _softmax(scores, axis=-1)
        o = torch.einsum("bhqk,bhkd->bhqd", p, v_cache)
        return (lambda x, *d: x.permute(*d))(o, 0, 2, 1, 3).reshape(B, Sq, H * Dh) @ wo

    def _B_ref(x, k_cache, v_cache, wq, wo):
        B, Sq, D = x.shape
        Hq, Dh = 16, 256
        Hkv = k_cache.shape[1]
        rep = Hq // Hkv
        q = (lambda x, *d: x.permute(*d))((x @ wq).reshape(B, Sq, Hq, Dh), 0, 2, 1, 3)
        k = (lambda x, n, axis: torch.repeat_interleave(x, n, dim=axis))(k_cache, rep, axis=1)
        v = (lambda x, n, axis: torch.repeat_interleave(x, n, dim=axis))(v_cache, rep, axis=1)
        scores = torch.einsum("bhqd,bhkd->bhqk", q, k) * (Dh ** -0.5)
        p = _softmax(scores, axis=-1)
        o = torch.einsum("bhqk,bhkd->bhqd", p, v)
        return (lambda x, *d: x.permute(*d))(o, 0, 2, 1, 3).reshape(B, Sq, Hq * Dh) @ wo

    a = _A_ref(A_x, A_k_cache, A_v_cache, A_wq, A_wo)
    b = _B_ref(B_x, B_k_cache, B_v_cache, B_wq, B_wo)
    return torch.concatenate([a, b], axis=-1)
```

```asm
; @launch kernel=attn_kernel grid=(256,1,1) block=(256,1,1) lds=163840
; @launch kernel=reduce_kernel grid=(504,1,1) block=(256,1,1) lds=0
.amdgcn_target "amdgcn-amd-amdhsa--gfx950"
.text
    .globl attn_kernel
    .p2align 8
    .type attn_kernel,@function
attn_kernel:
    s_cmp_ge_u32 s2, 256
    s_cbranch_scc1 L1_end
    s_and_b32 s3, s2, 7
    s_lshr_b32 s4, s2, 3
    s_lshr_b32 s5, s3, 2
    s_and_b32 s6, s3, 3
    s_lshl_b32 s6, s6, 2
    s_and_b32 s7, s4, 3
    s_add_u32 s6, s6, s7
    s_lshr_b32 s7, s4, 2
    s_mul_i32 s8, s5, 40
    s_add_u32 s10, s0, s8
    s_addc_u32 s11, s1, 0
    s_load_dwordx8 s[12:19], s[10:11], 0
    s_load_dwordx2 s[52:53], s[10:11], 32
    s_load_dwordx2 s[20:21], s[0:1], 96
    v_lshrrev_b32 v1, 6, v0
    s_nop 0
    v_readfirstlane_b32 s9, v1
    v_and_b32 v0, 63, v0
    s_waitcnt lgkmcnt(0)
    s_mul_i32 s22, s7, 129024
    s_add_u32 s24, s12, s22
    s_addc_u32 s25, s13, 0
    s_mov_b32 s26, 129024
    s_mov_b32 s27, 0x20000
    s_lshl_b32 s23, s7, 4
    s_add_u32 s23, s23, s6
    s_lshl_b32 s22, s23, 18
    s_add_u32 s28, s14, s22
    s_addc_u32 s29, s15, 0
    s_mov_b32 s30, 262144
    s_mov_b32 s31, 0x20000
    s_add_u32 s32, s16, s22
    s_addc_u32 s33, s17, 0
    s_mov_b32 s34, 262144
    s_mov_b32 s35, 0x20000
    s_lshl_b32 s22, s6, 9
    s_add_u32 s36, s18, s22
    s_addc_u32 s37, s19, 0
    s_sub_u32 s38, 3670016, s22
    s_mov_b32 s39, 0x20000
    s_lshl_b32 s22, s5, 7
    s_add_u32 s22, s22, s23
    s_mul_i32 s22, s22, 129024
    s_add_u32 s40, s20, s22
    s_addc_u32 s41, s21, 0
    s_mov_b32 s42, 129024
    s_mov_b32 s43, 0x20000
    s_mul_i32 s22, s6, 229376
    s_add_u32 s64, s52, s22
    s_addc_u32 s65, s53, 0
    s_mov_b32 s66, 229376
    s_mov_b32 s67, 0x20000
    s_cmp_eq_u32 s9, 3
    s_cbranch_scc1 L1_loader
    v_and_b32 v1, 15, v0
    v_lshrrev_b32 v2, 4, v0
    v_lshrrev_b32 v3, 2, v1
    v_and_b32 v16, 3, v0
    s_mul_i32 s44, s9, 48
    v_add_u32 v17, s44, v1
    v_mul_u32_u24 v17, 896, v17
    v_lshl_add_u32 v18, v2, 4, v17
    v_add_u32 v19, 14336, v18
    v_add_u32 v20, 14336, v19
    buffer_load_dwordx4 a[0:3], v18, s[24:27], 0 offen offset:0
    buffer_load_dwordx4 a[56:59], v19, s[24:27], 0 offen offset:0
    buffer_load_dwordx4 a[112:115], v20, s[24:27], 0 offen offset:0
    buffer_load_dwordx4 a[4:7], v18, s[24:27], 0 offen offset:64
    buffer_load_dwordx4 a[60:63], v19, s[24:27], 0 offen offset:64
    buffer_load_dwordx4 a[116:119], v20, s[24:27], 0 offen offset:64
    buffer_load_dwordx4 a[8:11], v18, s[24:27], 0 offen offset:128
    buffer_load_dwordx4 a[64:67], v19, s[24:27], 0 offen offset:128
    buffer_load_dwordx4 a[120:123], v20, s[24:27], 0 offen offset:128
    buffer_load_dwordx4 a[12:15], v18, s[24:27], 0 offen offset:192
    buffer_load_dwordx4 a[68:71], v19, s[24:27], 0 offen offset:192
    buffer_load_dwordx4 a[124:127], v20, s[24:27], 0 offen offset:192
    buffer_load_dwordx4 a[16:19], v18, s[24:27], 0 offen offset:256
    buffer_load_dwordx4 a[72:75], v19, s[24:27], 0 offen offset:256
    buffer_load_dwordx4 a[128:131], v20, s[24:27], 0 offen offset:256
    buffer_load_dwordx4 a[20:23], v18, s[24:27], 0 offen offset:320
    buffer_load_dwordx4 a[76:79], v19, s[24:27], 0 offen offset:320
    buffer_load_dwordx4 a[132:135], v20, s[24:27], 0 offen offset:320
    buffer_load_dwordx4 a[24:27], v18, s[24:27], 0 offen offset:384
    buffer_load_dwordx4 a[80:83], v19, s[24:27], 0 offen offset:384
    buffer_load_dwordx4 a[136:139], v20, s[24:27], 0 offen offset:384
    s_lshr_b32 s48, s2, 4
    s_add_u32 s48, s48, s2
    v_lshrrev_b32 v30, 5, v0
    v_and_b32 v31, 31, v0
    v_add_u32 v32, 0, v30
    v_xor_b32 v32, v32, v31
    v_lshlrev_b32 v32, 4, v32
    v_lshl_add_u32 v40, v30, 9, v32
    v_add_u32 v32, 2, v30
    v_xor_b32 v32, v32, v31
    v_lshlrev_b32 v32, 4, v32
    v_lshl_add_u32 v41, v30, 9, v32
    v_add_u32 v32, 4, v30
    v_xor_b32 v32, v32, v31
    v_lshlrev_b32 v32, 4, v32
    v_lshl_add_u32 v42, v30, 9, v32
    v_add_u32 v32, 6, v30
    v_xor_b32 v32, v32, v31
    v_lshlrev_b32 v32, 4, v32
    v_lshl_add_u32 v43, v30, 9, v32
    v_add_u32 v32, 8, v30
    v_xor_b32 v32, v32, v31
    v_lshlrev_b32 v32, 4, v32
    v_lshl_add_u32 v44, v30, 9, v32
    v_add_u32 v32, 10, v30
    v_xor_b32 v32, v32, v31
    v_lshlrev_b32 v32, 4, v32
    v_lshl_add_u32 v45, v30, 9, v32
    v_add_u32 v32, 12, v30
    v_xor_b32 v32, v32, v31
    v_lshlrev_b32 v32, 4, v32
    v_lshl_add_u32 v46, v30, 9, v32
    v_add_u32 v32, 14, v30
    v_xor_b32 v32, v32, v31
    v_lshlrev_b32 v32, 4, v32
    v_lshl_add_u32 v47, v30, 9, v32
    s_lshl_b32 s50, s9, 1
    s_add_u32 s49, s48, s50
    s_add_u32 s49, s49, 0
    s_and_b32 s49, s49, 15
    s_lshl_b32 s49, s49, 14
    s_add_u32 s51, s50, 4
    s_lshl_b32 s51, s51, 14
    s_add_u32 s47, s51, 0
    s_mov_b32 m0, s47
    s_add_u32 s47, s49, 0
    buffer_load_dwordx4 v40, s[28:31], s47 offen nt lds
    s_add_u32 s47, s51, 1024
    s_mov_b32 m0, s47
    s_add_u32 s47, s49, 1024
    buffer_load_dwordx4 v41, s[28:31], s47 offen nt lds
    s_add_u32 s47, s51, 2048
    s_mov_b32 m0, s47
    s_add_u32 s47, s49, 2048
    buffer_load_dwordx4 v40, s[28:31], s47 offen nt lds
    s_add_u32 s47, s51, 3072
    s_mov_b32 m0, s47
    s_add_u32 s47, s49, 3072
    buffer_load_dwordx4 v41, s[28:31], s47 offen nt lds
    s_add_u32 s47, s51, 4096
    s_mov_b32 m0, s47
    s_add_u32 s47, s49, 4096
    buffer_load_dwordx4 v42, s[28:31], s47 offen nt lds
    s_add_u32 s47, s51, 5120
    s_mov_b32 m0, s47
    s_add_u32 s47, s49, 5120
    buffer_load_dwordx4 v43, s[28:31], s47 offen nt lds
    s_add_u32 s47, s51, 6144
    s_mov_b32 m0, s47
    s_add_u32 s47, s49, 6144
    buffer_load_dwordx4 v42, s[28:31], s47 offen nt lds
    s_add_u32 s47, s51, 7168
    s_mov_b32 m0, s47
    s_add_u32 s47, s49, 7168
    buffer_load_dwordx4 v43, s[28:31], s47 offen nt lds
    s_add_u32 s47, s51, 8192
    s_mov_b32 m0, s47
    s_add_u32 s47, s49, 8192
    buffer_load_dwordx4 v44, s[28:31], s47 offen nt lds
    s_add_u32 s47, s51, 9216
    s_mov_b32 m0, s47
    s_add_u32 s47, s49, 9216
    buffer_load_dwordx4 v45, s[28:31], s47 offen nt lds
    s_add_u32 s47, s51, 10240
    s_mov_b32 m0, s47
    s_add_u32 s47, s49, 10240
    buffer_load_dwordx4 v44, s[28:31], s47 offen nt lds
    s_add_u32 s47, s51, 11264
    s_mov_b32 m0, s47
    s_add_u32 s47, s49, 11264
    buffer_load_dwordx4 v45, s[28:31], s47 offen nt lds
    s_add_u32 s47, s51, 12288
    s_mov_b32 m0, s47
    s_add_u32 s47, s49, 12288
    buffer_load_dwordx4 v46, s[28:31], s47 offen nt lds
    s_add_u32 s47, s51, 13312
    s_mov_b32 m0, s47
    s_add_u32 s47, s49, 13312
    buffer_load_dwordx4 v47, s[28:31], s47 offen nt lds
    s_add_u32 s47, s51, 14336
    s_mov_b32 m0, s47
    s_add_u32 s47, s49, 14336
    buffer_load_dwordx4 v46, s[28:31], s47 offen nt lds
    s_add_u32 s47, s51, 15360
    s_mov_b32 m0, s47
    s_add_u32 s47, s49, 15360
    buffer_load_dwordx4 v47, s[28:31], s47 offen nt lds
    s_add_u32 s49, s48, s50
    s_add_u32 s49, s49, 1
    s_and_b32 s49, s49, 15
    s_lshl_b32 s49, s49, 14
    s_add_u32 s51, s50, 5
    s_lshl_b32 s51, s51, 14
    s_add_u32 s47, s51, 0
    s_mov_b32 m0, s47
    s_add_u32 s47, s49, 0
    buffer_load_dwordx4 v40, s[28:31], s47 offen nt lds
    s_add_u32 s47, s51, 1024
    s_mov_b32 m0, s47
    s_add_u32 s47, s49, 1024
    buffer_load_dwordx4 v41, s[28:31], s47 offen nt lds
    s_add_u32 s47, s51, 2048
    s_mov_b32 m0, s47
    s_add_u32 s47, s49, 2048
    buffer_load_dwordx4 v40, s[28:31], s47 offen nt lds
    s_add_u32 s47, s51, 3072
    s_mov_b32 m0, s47
    s_add_u32 s47, s49, 3072
    buffer_load_dwordx4 v41, s[28:31], s47 offen nt lds
    s_add_u32 s47, s51, 4096
    s_mov_b32 m0, s47
    s_add_u32 s47, s49, 4096
    buffer_load_dwordx4 v42, s[28:31], s47 offen nt lds
    s_add_u32 s47, s51, 5120
    s_mov_b32 m0, s47
    s_add_u32 s47, s49, 5120
    buffer_load_dwordx4 v43, s[28:31], s47 offen nt lds
    s_add_u32 s47, s51, 6144
    s_mov_b32 m0, s47
    s_add_u32 s47, s49, 6144
    buffer_load_dwordx4 v42, s[28:31], s47 offen nt lds
    s_add_u32 s47, s51, 7168
    s_mov_b32 m0, s47
    s_add_u32 s47, s49, 7168
    buffer_load_dwordx4 v43, s[28:31], s47 offen nt lds
    s_add_u32 s47, s51, 8192
    s_mov_b32 m0, s47
    s_add_u32 s47, s49, 8192
    buffer_load_dwordx4 v44, s[28:31], s47 offen nt lds
    s_add_u32 s47, s51, 9216
    s_mov_b32 m0, s47
    s_add_u32 s47, s49, 9216
    buffer_load_dwordx4 v45, s[28:31], s47 offen nt lds
    s_add_u32 s47, s51, 10240
    s_mov_b32 m0, s47
    s_add_u32 s47, s49, 10240
    buffer_load_dwordx4 v44, s[28:31], s47 offen nt lds
    s_add_u32 s47, s51, 11264
    s_mov_b32 m0, s47
    s_add_u32 s47, s49, 11264
    buffer_load_dwordx4 v45, s[28:31], s47 offen nt lds
    s_add_u32 s47, s51, 12288
    s_mov_b32 m0, s47
    s_add_u32 s47, s49, 12288
    buffer_load_dwordx4 v46, s[28:31], s47 offen nt lds
    s_add_u32 s47, s51, 13312
    s_mov_b32 m0, s47
    s_add_u32 s47, s49, 13312
    buffer_load_dwordx4 v47, s[28:31], s47 offen nt lds
    s_add_u32 s47, s51, 14336
    s_mov_b32 m0, s47
    s_add_u32 s47, s49, 14336
    buffer_load_dwordx4 v46, s[28:31], s47 offen nt lds
    s_add_u32 s47, s51, 15360
    s_mov_b32 m0, s47
    s_add_u32 s47, s49, 15360
    buffer_load_dwordx4 v47, s[28:31], s47 offen nt lds
    v_lshl_add_u32 v21, v2, 3, v3
    v_lshlrev_b32 v21, 9, v21
    v_lshl_add_u32 v21, v16, 4, v21
    v_xor_b32 v22, 0, v3
    v_lshl_add_u32 v4, v22, 6, v21
    v_xor_b32 v22, 1, v3
    v_lshl_add_u32 v5, v22, 6, v21
    v_xor_b32 v22, 2, v3
    v_lshl_add_u32 v6, v22, 6, v21
    v_xor_b32 v22, 3, v3
    v_lshl_add_u32 v7, v22, 6, v21
    v_lshl_add_u32 v21, v3, 3, v16
    v_lshlrev_b32 v21, 9, v21
    v_xor_b32 v22, v2, v16
    v_lshl_add_u32 v21, v22, 4, v21
    v_xor_b32 v22, 0, v3
    v_lshl_add_u32 v8, v22, 6, v21
    v_xor_b32 v22, 1, v3
    v_lshl_add_u32 v9, v22, 6, v21
    v_xor_b32 v22, 2, v3
    v_lshl_add_u32 v10, v22, 6, v21
    v_xor_b32 v22, 3, v3
    v_lshl_add_u32 v11, v22, 6, v21
    v_lshl_add_u32 v21, v2, 3, v3
    v_lshlrev_b32 v21, 6, v21
    v_lshl_add_u32 v12, v16, 4, v21
    v_mov_b32 v21, 0x3f803f80
    v_accvgpr_write_b32 a240, v21
    v_mov_b32 v21, 0x3f803f80
    v_accvgpr_write_b32 a241, v21
    v_mov_b32 v21, 0x3f803f80
    v_accvgpr_write_b32 a242, v21
    v_mov_b32 v21, 0x3f803f80
    v_accvgpr_write_b32 a243, v21
    v_xor_b32 v58, 16, v0
    v_lshlrev_b32 v58, 2, v58
    v_xor_b32 v59, 32, v0
    v_lshlrev_b32 v59, 2, v59
    s_waitcnt vmcnt(50)
    s_barrier
    v_add_u32 v60, 0, v4
    v_add_u32 v61, 0, v5
    v_add_u32 v62, 0, v6
    v_add_u32 v63, 0, v7
    ds_read_b64_tr_b16 a[192:193], v60 offset:0
    ds_read_b64_tr_b16 a[194:195], v60 offset:2048
    ds_read_b64_tr_b16 a[196:197], v60 offset:8
    ds_read_b64_tr_b16 a[198:199], v60 offset:2056
    ds_read_b64_tr_b16 a[200:201], v61 offset:0
    ds_read_b64_tr_b16 a[202:203], v61 offset:2048
    ds_read_b64_tr_b16 a[204:205], v61 offset:8
    ds_read_b64_tr_b16 a[206:207], v61 offset:2056
    ds_read_b64_tr_b16 a[208:209], v62 offset:0
    ds_read_b64_tr_b16 a[210:211], v62 offset:2048
    ds_read_b64_tr_b16 a[212:213], v62 offset:8
    ds_read_b64_tr_b16 a[214:215], v62 offset:2056
    s_waitcnt lgkmcnt(10)
    v_mfma_f32_16x16x32_bf16 v[64:67], a[192:195], a[0:3], 0
    v_mfma_f32_16x16x32_bf16 v[68:71], a[192:195], a[56:59], 0
    v_mfma_f32_16x16x32_bf16 v[72:75], a[192:195], a[112:115], 0
    ds_read_b64_tr_b16 a[216:217], v63 offset:0
    ds_read_b64_tr_b16 a[218:219], v63 offset:2048
    s_waitcnt lgkmcnt(10)
    v_mfma_f32_16x16x32_bf16 v[76:79], a[196:199], a[0:3], 0
    v_mfma_f32_16x16x32_bf16 v[80:83], a[196:199], a[56:59], 0
    v_mfma_f32_16x16x32_bf16 v[84:87], a[196:199], a[112:115], 0
    ds_read_b64_tr_b16 a[220:221], v63 offset:8
    ds_read_b64_tr_b16 a[222:223], v63 offset:2056
    s_waitcnt lgkmcnt(10)
    v_mfma_f32_16x16x32_bf16 v[88:91], a[200:203], a[0:3], 0
    v_mfma_f32_16x16x32_bf16 v[92:95], a[200:203], a[56:59], 0
    v_mfma_f32_16x16x32_bf16 v[96:99], a[200:203], a[112:115], 0
    ds_read_b64_tr_b16 a[224:225], v60 offset:256
    ds_read_b64_tr_b16 a[226:227], v60 offset:2304
    s_waitcnt lgkmcnt(10)
    v_mfma_f32_16x16x32_bf16 v[100:103], a[204:207], a[0:3], 0
    v_mfma_f32_16x16x32_bf16 v[104:107], a[204:207], a[56:59], 0
    v_mfma_f32_16x16x32_bf16 v[108:111], a[204:207], a[112:115], 0
    ds_read_b64_tr_b16 a[228:229], v60 offset:264
    ds_read_b64_tr_b16 a[230:231], v60 offset:2312
    s_waitcnt lgkmcnt(10)
    v_mfma_f32_16x16x32_bf16 v[112:115], a[208:211], a[0:3], 0
    v_mfma_f32_16x16x32_bf16 v[116:119], a[208:211], a[56:59], 0
    v_mfma_f32_16x16x32_bf16 v[120:123], a[208:211], a[112:115], 0
    ds_read_b64_tr_b16 a[232:233], v61 offset:256
    ds_read_b64_tr_b16 a[234:235], v61 offset:2304
    s_waitcnt lgkmcnt(10)
    v_mfma_f32_16x16x32_bf16 v[124:127], a[212:215], a[0:3], 0
    v_mfma_f32_16x16x32_bf16 v[128:131], a[212:215], a[56:59], 0
    v_mfma_f32_16x16x32_bf16 v[132:135], a[212:215], a[112:115], 0
    ds_read_b64_tr_b16 a[236:237], v61 offset:264
    ds_read_b64_tr_b16 a[238:239], v61 offset:2312
    s_waitcnt lgkmcnt(10)
    v_mfma_f32_16x16x32_bf16 v[136:139], a[216:219], a[0:3], 0
    v_mfma_f32_16x16x32_bf16 v[140:143], a[216:219], a[56:59], 0
    v_mfma_f32_16x16x32_bf16 v[144:147], a[216:219], a[112:115], 0
    ds_read_b64_tr_b16 a[192:193], v62 offset:256
    ds_read_b64_tr_b16 a[194:195], v62 offset:2304
    s_waitcnt lgkmcnt(10)
    v_mfma_f32_16x16x32_bf16 v[148:151], a[220:223], a[0:3], 0
    v_mfma_f32_16x16x32_bf16 v[152:155], a[220:223], a[56:59], 0
    v_mfma_f32_16x16x32_bf16 v[156:159], a[220:223], a[112:115], 0
    ds_read_b64_tr_b16 a[196:197], v62 offset:264
    ds_read_b64_tr_b16 a[198:199], v62 offset:2312
    s_waitcnt lgkmcnt(10)
    v_mfma_f32_16x16x32_bf16 v[160:163], a[224:227], a[0:3], 0
    v_mfma_f32_16x16x32_bf16 v[164:167], a[224:227], a[56:59], 0
    v_mfma_f32_16x16x32_bf16 v[168:171], a[224:227], a[112:115], 0
    ds_read_b64_tr_b16 a[200:201], v63 offset:256
    ds_read_b64_tr_b16 a[202:203], v63 offset:2304
    s_waitcnt lgkmcnt(10)
    v_mfma_f32_16x16x32_bf16 v[172:175], a[228:231], a[0:3], 0
    v_mfma_f32_16x16x32_bf16 v[176:179], a[228:231], a[56:59], 0
    v_mfma_f32_16x16x32_bf16 v[180:183], a[228:231], a[112:115], 0
    ds_read_b64_tr_b16 a[204:205], v63 offset:264
    ds_read_b64_tr_b16 a[206:207], v63 offset:2312
    s_waitcnt lgkmcnt(10)
    v_mfma_f32_16x16x32_bf16 v[184:187], a[232:235], a[0:3], 0
    v_mfma_f32_16x16x32_bf16 v[188:191], a[232:235], a[56:59], 0
    v_mfma_f32_16x16x32_bf16 v[192:195], a[232:235], a[112:115], 0
    s_barrier
    v_add_u32 v60, 16384, v4
    v_add_u32 v61, 16384, v5
    v_add_u32 v62, 16384, v6
    v_add_u32 v63, 16384, v7
    ds_read_b64_tr_b16 a[208:209], v60 offset:0
    ds_read_b64_tr_b16 a[210:211], v60 offset:2048
    s_waitcnt lgkmcnt(10)
    v_mfma_f32_16x16x32_bf16 v[196:199], a[236:239], a[0:3], 0
    v_mfma_f32_16x16x32_bf16 v[200:203], a[236:239], a[56:59], 0
    v_mfma_f32_16x16x32_bf16 v[204:207], a[236:239], a[112:115], 0
    ds_read_b64_tr_b16 a[212:213], v60 offset:8
    ds_read_b64_tr_b16 a[214:215], v60 offset:2056
    s_waitcnt lgkmcnt(10)
    v_mfma_f32_16x16x32_bf16 v[208:211], a[192:195], a[0:3], 0
    v_mfma_f32_16x16x32_bf16 v[212:215], a[192:195], a[56:59], 0
    v_mfma_f32_16x16x32_bf16 v[216:219], a[192:195], a[112:115], 0
    ds_read_b64_tr_b16 a[216:217], v61 offset:0
    ds_read_b64_tr_b16 a[218:219], v61 offset:2048
    s_waitcnt lgkmcnt(10)
    v_mfma_f32_16x16x32_bf16 v[220:223], a[196:199], a[0:3], 0
    v_mfma_f32_16x16x32_bf16 v[224:227], a[196:199], a[56:59], 0
    v_mfma_f32_16x16x32_bf16 v[228:231], a[196:199], a[112:115], 0
    ds_read_b64_tr_b16 a[220:221], v61 offset:8
    ds_read_b64_tr_b16 a[222:223], v61 offset:2056
    s_waitcnt lgkmcnt(10)
    v_mfma_f32_16x16x32_bf16 v[232:235], a[200:203], a[0:3], 0
    v_mfma_f32_16x16x32_bf16 v[236:239], a[200:203], a[56:59], 0
    v_mfma_f32_16x16x32_bf16 v[240:243], a[200:203], a[112:115], 0
    ds_read_b64_tr_b16 a[224:225], v62 offset:0
    ds_read_b64_tr_b16 a[226:227], v62 offset:2048
    s_waitcnt lgkmcnt(10)
    v_mfma_f32_16x16x32_bf16 v[244:247], a[204:207], a[0:3], 0
    v_mfma_f32_16x16x32_bf16 v[248:251], a[204:207], a[56:59], 0
    v_mfma_f32_16x16x32_bf16 v[252:255], a[204:207], a[112:115], 0
    s_waitcnt vmcnt(47)
    ds_read_b64_tr_b16 a[228:229], v62 offset:8
    ds_read_b64_tr_b16 a[230:231], v62 offset:2056
    s_waitcnt lgkmcnt(10)
    v_mfma_f32_16x16x32_bf16 v[64:67], a[208:211], a[4:7], v[64:67]
    v_mfma_f32_16x16x32_bf16 v[68:71], a[208:211], a[60:63], v[68:71]
    v_mfma_f32_16x16x32_bf16 v[72:75], a[208:211], a[116:119], v[72:75]
    ds_read_b64_tr_b16 a[232:233], v63 offset:0
    ds_read_b64_tr_b16 a[234:235], v63 offset:2048
    s_waitcnt lgkmcnt(10)
    v_mfma_f32_16x16x32_bf16 v[76:79], a[212:215], a[4:7], v[76:79]
    v_mfma_f32_16x16x32_bf16 v[80:83], a[212:215], a[60:63], v[80:83]
    v_mfma_f32_16x16x32_bf16 v[84:87], a[212:215], a[116:119], v[84:87]
    ds_read_b64_tr_b16 a[236:237], v63 offset:8
    ds_read_b64_tr_b16 a[238:239], v63 offset:2056
    s_waitcnt lgkmcnt(10)
    v_mfma_f32_16x16x32_bf16 v[88:91], a[216:219], a[4:7], v[88:91]
    v_mfma_f32_16x16x32_bf16 v[92:95], a[216:219], a[60:63], v[92:95]
    v_mfma_f32_16x16x32_bf16 v[96:99], a[216:219], a[116:119], v[96:99]
    ds_read_b64_tr_b16 a[192:193], v60 offset:256
    ds_read_b64_tr_b16 a[194:195], v60 offset:2304
    s_waitcnt lgkmcnt(10)
    v_mfma_f32_16x16x32_bf16 v[100:103], a[220:223], a[4:7], v[100:103]
    v_mfma_f32_16x16x32_bf16 v[104:107], a[220:223], a[60:63], v[104:107]
    v_mfma_f32_16x16x32_bf16 v[108:111], a[220:223], a[116:119], v[108:111]
    ds_read_b64_tr_b16 a[196:197], v60 offset:264
    ds_read_b64_tr_b16 a[198:199], v60 offset:2312
    s_waitcnt lgkmcnt(10)
    v_mfma_f32_16x16x32_bf16 v[112:115], a[224:227], a[4:7], v[112:115]
    v_mfma_f32_16x16x32_bf16 v[116:119], a[224:227], a[60:63], v[116:119]
    v_mfma_f32_16x16x32_bf16 v[120:123], a[224:227], a[116:119], v[120:123]
    ds_read_b64_tr_b16 a[200:201], v61 offset:256
    ds_read_b64_tr_b16 a[202:203], v61 offset:2304
    s_waitcnt lgkmcnt(10)
    v_mfma_f32_16x16x32_bf16 v[124:127], a[228:231], a[4:7], v[124:127]
    v_mfma_f32_16x16x32_bf16 v[128:131], a[228:231], a[60:63], v[128:131]
    v_mfma_f32_16x16x32_bf16 v[132:135], a[228:231], a[116:119], v[132:135]
    ds_read_b64_tr_b16 a[204:205], v61 offset:264
    ds_read_b64_tr_b16 a[206:207], v61 offset:2312
    s_waitcnt lgkmcnt(10)
    v_mfma_f32_16x16x32_bf16 v[136:139], a[232:235], a[4:7], v[136:139]
    v_mfma_f32_16x16x32_bf16 v[140:143], a[232:235], a[60:63], v[140:143]
    v_mfma_f32_16x16x32_bf16 v[144:147], a[232:235], a[116:119], v[144:147]
    ds_read_b64_tr_b16 a[208:209], v62 offset:256
    ds_read_b64_tr_b16 a[210:211], v62 offset:2304
    s_waitcnt lgkmcnt(10)
    v_mfma_f32_16x16x32_bf16 v[148:151], a[236:239], a[4:7], v[148:151]
    v_mfma_f32_16x16x32_bf16 v[152:155], a[236:239], a[60:63], v[152:155]
    v_mfma_f32_16x16x32_bf16 v[156:159], a[236:239], a[116:119], v[156:159]
    ds_read_b64_tr_b16 a[212:213], v62 offset:264
    ds_read_b64_tr_b16 a[214:215], v62 offset:2312
    s_waitcnt lgkmcnt(10)
    v_mfma_f32_16x16x32_bf16 v[160:163], a[192:195], a[4:7], v[160:163]
    v_mfma_f32_16x16x32_bf16 v[164:167], a[192:195], a[60:63], v[164:167]
    v_mfma_f32_16x16x32_bf16 v[168:171], a[192:195], a[116:119], v[168:171]
    ds_read_b64_tr_b16 a[216:217], v63 offset:256
    ds_read_b64_tr_b16 a[218:219], v63 offset:2304
    s_waitcnt lgkmcnt(10)
    v_mfma_f32_16x16x32_bf16 v[172:175], a[196:199], a[4:7], v[172:175]
    v_mfma_f32_16x16x32_bf16 v[176:179], a[196:199], a[60:63], v[176:179]
    v_mfma_f32_16x16x32_bf16 v[180:183], a[196:199], a[116:119], v[180:183]
    ds_read_b64_tr_b16 a[220:221], v63 offset:264
    ds_read_b64_tr_b16 a[222:223], v63 offset:2312
    s_waitcnt lgkmcnt(10)
    v_mfma_f32_16x16x32_bf16 v[184:187], a[200:203], a[4:7], v[184:187]
    v_mfma_f32_16x16x32_bf16 v[188:191], a[200:203], a[60:63], v[188:191]
    v_mfma_f32_16x16x32_bf16 v[192:195], a[200:203], a[116:119], v[192:195]
    s_barrier
    v_add_u32 v60, 32768, v4
    v_add_u32 v61, 32768, v5
    v_add_u32 v62, 32768, v6
    v_add_u32 v63, 32768, v7
    ds_read_b64_tr_b16 a[224:225], v60 offset:0
    ds_read_b64_tr_b16 a[226:227], v60 offset:2048
    s_waitcnt lgkmcnt(10)
    v_mfma_f32_16x16x32_bf16 v[196:199], a[204:207], a[4:7], v[196:199]
    v_mfma_f32_16x16x32_bf16 v[200:203], a[204:207], a[60:63], v[200:203]
    v_mfma_f32_16x16x32_bf16 v[204:207], a[204:207], a[116:119], v[204:207]
    ds_read_b64_tr_b16 a[228:229], v60 offset:8
    ds_read_b64_tr_b16 a[230:231], v60 offset:2056
    s_waitcnt lgkmcnt(10)
    v_mfma_f32_16x16x32_bf16 v[208:211], a[208:211], a[4:7], v[208:211]
    v_mfma_f32_16x16x32_bf16 v[212:215], a[208:211], a[60:63], v[212:215]
    v_mfma_f32_16x16x32_bf16 v[216:219], a[208:211], a[116:119], v[216:219]
    ds_read_b64_tr_b16 a[232:233], v61 offset:0
    ds_read_b64_tr_b16 a[234:235], v61 offset:2048
    s_waitcnt lgkmcnt(10)
    v_mfma_f32_16x16x32_bf16 v[220:223], a[212:215], a[4:7], v[220:223]
    v_mfma_f32_16x16x32_bf16 v[224:227], a[212:215], a[60:63], v[224:227]
    v_mfma_f32_16x16x32_bf16 v[228:231], a[212:215], a[116:119], v[228:231]
    ds_read_b64_tr_b16 a[236:237], v61 offset:8
    ds_read_b64_tr_b16 a[238:239], v61 offset:2056
    s_waitcnt lgkmcnt(10)
    v_mfma_f32_16x16x32_bf16 v[232:235], a[216:219], a[4:7], v[232:235]
    v_mfma_f32_16x16x32_bf16 v[236:239], a[216:219], a[60:63], v[236:239]
    v_mfma_f32_16x16x32_bf16 v[240:243], a[216:219], a[116:119], v[240:243]
    ds_read_b64_tr_b16 a[192:193], v62 offset:0
    ds_read_b64_tr_b16 a[194:195], v62 offset:2048
    s_waitcnt lgkmcnt(10)
    v_mfma_f32_16x16x32_bf16 v[244:247], a[220:223], a[4:7], v[244:247]
    v_mfma_f32_16x16x32_bf16 v[248:251], a[220:223], a[60:63], v[248:251]
    v_mfma_f32_16x16x32_bf16 v[252:255], a[220:223], a[116:119], v[252:255]
    s_waitcnt vmcnt(44)
    ds_read_b64_tr_b16 a[196:197], v62 offset:8
    ds_read_b64_tr_b16 a[198:199], v62 offset:2056
    s_waitcnt lgkmcnt(10)
    v_mfma_f32_16x16x32_bf16 v[64:67], a[224:227], a[8:11], v[64:67]
    v_mfma_f32_16x16x32_bf16 v[68:71], a[224:227], a[64:67], v[68:71]
    v_mfma_f32_16x16x32_bf16 v[72:75], a[224:227], a[120:123], v[72:75]
    ds_read_b64_tr_b16 a[200:201], v63 offset:0
    ds_read_b64_tr_b16 a[202:203], v63 offset:2048
    s_waitcnt lgkmcnt(10)
    v_mfma_f32_16x16x32_bf16 v[76:79], a[228:231], a[8:11], v[76:79]
    v_mfma_f32_16x16x32_bf16 v[80:83], a[228:231], a[64:67], v[80:83]
    v_mfma_f32_16x16x32_bf16 v[84:87], a[228:231], a[120:123], v[84:87]
    ds_read_b64_tr_b16 a[204:205], v63 offset:8
    ds_read_b64_tr_b16 a[206:207], v63 offset:2056
    s_waitcnt lgkmcnt(10)
    v_mfma_f32_16x16x32_bf16 v[88:91], a[232:235], a[8:11], v[88:91]
    v_mfma_f32_16x16x32_bf16 v[92:95], a[232:235], a[64:67], v[92:95]
    v_mfma_f32_16x16x32_bf16 v[96:99], a[232:235], a[120:123], v[96:99]
    ds_read_b64_tr_b16 a[208:209], v60 offset:256
    ds_read_b64_tr_b16 a[210:211], v60 offset:2304
    s_waitcnt lgkmcnt(10)
    v_mfma_f32_16x16x32_bf16 v[100:103], a[236:239], a[8:11], v[100:103]
    v_mfma_f32_16x16x32_bf16 v[104:107], a[236:239], a[64:67], v[104:107]
    v_mfma_f32_16x16x32_bf16 v[108:111], a[236:239], a[120:123], v[108:111]
    ds_read_b64_tr_b16 a[212:213], v60 offset:264
    ds_read_b64_tr_b16 a[214:215], v60 offset:2312
    s_waitcnt lgkmcnt(10)
    v_mfma_f32_16x16x32_bf16 v[112:115], a[192:195], a[8:11], v[112:115]
    v_mfma_f32_16x16x32_bf16 v[116:119], a[192:195], a[64:67], v[116:119]
    v_mfma_f32_16x16x32_bf16 v[120:123], a[192:195], a[120:123], v[120:123]
    ds_read_b64_tr_b16 a[216:217], v61 offset:256
    ds_read_b64_tr_b16 a[218:219], v61 offset:2304
    s_waitcnt lgkmcnt(10)
    v_mfma_f32_16x16x32_bf16 v[124:127], a[196:199], a[8:11], v[124:127]
    v_mfma_f32_16x16x32_bf16 v[128:131], a[196:199], a[64:67], v[128:131]
    v_mfma_f32_16x16x32_bf16 v[132:135], a[196:199], a[120:123], v[132:135]
    ds_read_b64_tr_b16 a[220:221], v61 offset:264
    ds_read_b64_tr_b16 a[222:223], v61 offset:2312
    s_waitcnt lgkmcnt(10)
    v_mfma_f32_16x16x32_bf16 v[136:139], a[200:203], a[8:11], v[136:139]
    v_mfma_f32_16x16x32_bf16 v[140:143], a[200:203], a[64:67], v[140:143]
    v_mfma_f32_16x16x32_bf16 v[144:147], a[200:203], a[120:123], v[144:147]
    ds_read_b64_tr_b16 a[224:225], v62 offset:256
    ds_read_b64_tr_b16 a[226:227], v62 offset:2304
    s_waitcnt lgkmcnt(10)
    v_mfma_f32_16x16x32_bf16 v[148:151], a[204:207], a[8:11], v[148:151]
    v_mfma_f32_16x16x32_bf16 v[152:155], a[204:207], a[64:67], v[152:155]
    v_mfma_f32_16x16x32_bf16 v[156:159], a[204:207], a[120:123], v[156:159]
    ds_read_b64_tr_b16 a[228:229], v62 offset:264
    ds_read_b64_tr_b16 a[230:231], v62 offset:2312
    s_waitcnt lgkmcnt(10)
    v_mfma_f32_16x16x32_bf16 v[160:163], a[208:211], a[8:11], v[160:163]
    v_mfma_f32_16x16x32_bf16 v[164:167], a[208:211], a[64:67], v[164:167]
    v_mfma_f32_16x16x32_bf16 v[168:171], a[208:211], a[120:123], v[168:171]
    ds_read_b64_tr_b16 a[232:233], v63 offset:256
    ds_read_b64_tr_b16 a[234:235], v63 offset:2304
    s_waitcnt lgkmcnt(10)
    v_mfma_f32_16x16x32_bf16 v[172:175], a[212:215], a[8:11], v[172:175]
    v_mfma_f32_16x16x32_bf16 v[176:179], a[212:215], a[64:67], v[176:179]
    v_mfma_f32_16x16x32_bf16 v[180:183], a[212:215], a[120:123], v[180:183]
    ds_read_b64_tr_b16 a[236:237], v63 offset:264
    ds_read_b64_tr_b16 a[238:239], v63 offset:2312
    s_waitcnt lgkmcnt(10)
    v_mfma_f32_16x16x32_bf16 v[184:187], a[216:219], a[8:11], v[184:187]
    v_mfma_f32_16x16x32_bf16 v[188:191], a[216:219], a[64:67], v[188:191]
    v_mfma_f32_16x16x32_bf16 v[192:195], a[216:219], a[120:123], v[192:195]
    s_barrier
    v_add_u32 v60, 49152, v4
    v_add_u32 v61, 49152, v5
    v_add_u32 v62, 49152, v6
    v_add_u32 v63, 49152, v7
    ds_read_b64_tr_b16 a[192:193], v60 offset:0
    ds_read_b64_tr_b16 a[194:195], v60 offset:2048
    s_waitcnt lgkmcnt(10)
    v_mfma_f32_16x16x32_bf16 v[196:199], a[220:223], a[8:11], v[196:199]
    v_mfma_f32_16x16x32_bf16 v[200:203], a[220:223], a[64:67], v[200:203]
    v_mfma_f32_16x16x32_bf16 v[204:207], a[220:223], a[120:123], v[204:207]
    ds_read_b64_tr_b16 a[196:197], v60 offset:8
    ds_read_b64_tr_b16 a[198:199], v60 offset:2056
    s_waitcnt lgkmcnt(10)
    v_mfma_f32_16x16x32_bf16 v[208:211], a[224:227], a[8:11], v[208:211]
    v_mfma_f32_16x16x32_bf16 v[212:215], a[224:227], a[64:67], v[212:215]
    v_mfma_f32_16x16x32_bf16 v[216:219], a[224:227], a[120:123], v[216:219]
    ds_read_b64_tr_b16 a[200:201], v61 offset:0
    ds_read_b64_tr_b16 a[202:203], v61 offset:2048
    s_waitcnt lgkmcnt(10)
    v_mfma_f32_16x16x32_bf16 v[220:223], a[228:231], a[8:11], v[220:223]
    v_mfma_f32_16x16x32_bf16 v[224:227], a[228:231], a[64:67], v[224:227]
    v_mfma_f32_16x16x32_bf16 v[228:231], a[228:231], a[120:123], v[228:231]
    ds_read_b64_tr_b16 a[204:205], v61 offset:8
    ds_read_b64_tr_b16 a[206:207], v61 offset:2056
    s_waitcnt lgkmcnt(10)
    v_mfma_f32_16x16x32_bf16 v[232:235], a[232:235], a[8:11], v[232:235]
    v_mfma_f32_16x16x32_bf16 v[236:239], a[232:235], a[64:67], v[236:239]
    v_mfma_f32_16x16x32_bf16 v[240:243], a[232:235], a[120:123], v[240:243]
    ds_read_b64_tr_b16 a[208:209], v62 offset:0
    ds_read_b64_tr_b16 a[210:211], v62 offset:2048
    s_waitcnt lgkmcnt(10)
    v_mfma_f32_16x16x32_bf16 v[244:247], a[236:239], a[8:11], v[244:247]
    v_mfma_f32_16x16x32_bf16 v[248:251], a[236:239], a[64:67], v[248:251]
    v_mfma_f32_16x16x32_bf16 v[252:255], a[236:239], a[120:123], v[252:255]
    s_waitcnt vmcnt(41)
    buffer_load_dwordx4 a[28:31], v18, s[24:27], 0 offen offset:448
    buffer_load_dwordx4 a[84:87], v19, s[24:27], 0 offen offset:448
    buffer_load_dwordx4 a[140:143], v20, s[24:27], 0 offen offset:448
    buffer_load_dwordx4 a[32:35], v18, s[24:27], 0 offen offset:512
    buffer_load_dwordx4 a[88:91], v19, s[24:27], 0 offen offset:512
    buffer_load_dwordx4 a[144:147], v20, s[24:27], 0 offen offset:512
    buffer_load_dwordx4 a[36:39], v18, s[24:27], 0 offen offset:576
    buffer_load_dwordx4 a[92:95], v19, s[24:27], 0 offen offset:576
    buffer_load_dwordx4 a[148:151], v20, s[24:27], 0 offen offset:576
    buffer_load_dwordx4 a[40:43], v18, s[24:27], 0 offen offset:640
    buffer_load_dwordx4 a[96:99], v19, s[24:27], 0 offen offset:640
    buffer_load_dwordx4 a[152:155], v20, s[24:27], 0 offen offset:640
    buffer_load_dwordx4 a[44:47], v18, s[24:27], 0 offen offset:704
    buffer_load_dwordx4 a[100:103], v19, s[24:27], 0 offen offset:704
    buffer_load_dwordx4 a[156:159], v20, s[24:27], 0 offen offset:704
    buffer_load_dwordx4 a[48:51], v18, s[24:27], 0 offen offset:768
    buffer_load_dwordx4 a[104:107], v19, s[24:27], 0 offen offset:768
    buffer_load_dwordx4 a[160:163], v20, s[24:27], 0 offen offset:768
    buffer_load_dwordx4 a[52:55], v18, s[24:27], 0 offen offset:832
    buffer_load_dwordx4 a[108:111], v19, s[24:27], 0 offen offset:832
    buffer_load_dwordx4 a[164:167], v20, s[24:27], 0 offen offset:832
    ds_read_b64_tr_b16 a[212:213], v62 offset:8
    ds_read_b64_tr_b16 a[214:215], v62 offset:2056
    s_waitcnt lgkmcnt(10)
    v_mfma_f32_16x16x32_bf16 v[64:67], a[192:195], a[12:15], v[64:67]
    v_mfma_f32_16x16x32_bf16 v[68:71], a[192:195], a[68:71], v[68:71]
    v_mfma_f32_16x16x32_bf16 v[72:75], a[192:195], a[124:127], v[72:75]
    ds_read_b64_tr_b16 a[216:217], v63 offset:0
    ds_read_b64_tr_b16 a[218:219], v63 offset:2048
    s_waitcnt lgkmcnt(10)
    v_mfma_f32_16x16x32_bf16 v[76:79], a[196:199], a[12:15], v[76:79]
    v_mfma_f32_16x16x32_bf16 v[80:83], a[196:199], a[68:71], v[80:83]
    v_mfma_f32_16x16x32_bf16 v[84:87], a[196:199], a[124:127], v[84:87]
    ds_read_b64_tr_b16 a[220:221], v63 offset:8
    ds_read_b64_tr_b16 a[222:223], v63 offset:2056
    s_waitcnt lgkmcnt(10)
    v_mfma_f32_16x16x32_bf16 v[88:91], a[200:203], a[12:15], v[88:91]
    v_mfma_f32_16x16x32_bf16 v[92:95], a[200:203], a[68:71], v[92:95]
    v_mfma_f32_16x16x32_bf16 v[96:99], a[200:203], a[124:127], v[96:99]
    ds_read_b64_tr_b16 a[224:225], v60 offset:256
    ds_read_b64_tr_b16 a[226:227], v60 offset:2304
    s_waitcnt lgkmcnt(10)
    v_mfma_f32_16x16x32_bf16 v[100:103], a[204:207], a[12:15], v[100:103]
    v_mfma_f32_16x16x32_bf16 v[104:107], a[204:207], a[68:71], v[104:107]
    v_mfma_f32_16x16x32_bf16 v[108:111], a[204:207], a[124:127], v[108:111]
    ds_read_b64_tr_b16 a[228:229], v60 offset:264
    ds_read_b64_tr_b16 a[230:231], v60 offset:2312
    s_waitcnt lgkmcnt(10)
    v_mfma_f32_16x16x32_bf16 v[112:115], a[208:211], a[12:15], v[112:115]
    v_mfma_f32_16x16x32_bf16 v[116:119], a[208:211], a[68:71], v[116:119]
    v_mfma_f32_16x16x32_bf16 v[120:123], a[208:211], a[124:127], v[120:123]
    ds_read_b64_tr_b16 a[232:233], v61 offset:256
    ds_read_b64_tr_b16 a[234:235], v61 offset:2304
    s_waitcnt lgkmcnt(10)
    v_mfma_f32_16x16x32_bf16 v[124:127], a[212:215], a[12:15], v[124:127]
    v_mfma_f32_16x16x32_bf16 v[128:131], a[212:215], a[68:71], v[128:131]
    v_mfma_f32_16x16x32_bf16 v[132:135], a[212:215], a[124:127], v[132:135]
    ds_read_b64_tr_b16 a[236:237], v61 offset:264
    ds_read_b64_tr_b16 a[238:239], v61 offset:2312
    s_waitcnt lgkmcnt(10)
    v_mfma_f32_16x16x32_bf16 v[136:139], a[216:219], a[12:15], v[136:139]
    v_mfma_f32_16x16x32_bf16 v[140:143], a[216:219], a[68:71], v[140:143]
    v_mfma_f32_16x16x32_bf16 v[144:147], a[216:219], a[124:127], v[144:147]
    ds_read_b64_tr_b16 a[192:193], v62 offset:256
    ds_read_b64_tr_b16 a[194:195], v62 offset:2304
    s_waitcnt lgkmcnt(10)
    v_mfma_f32_16x16x32_bf16 v[148:151], a[220:223], a[12:15], v[148:151]
    v_mfma_f32_16x16x32_bf16 v[152:155], a[220:223], a[68:71], v[152:155]
    v_mfma_f32_16x16x32_bf16 v[156:159], a[220:223], a[124:127], v[156:159]
    ds_read_b64_tr_b16 a[196:197], v62 offset:264
    ds_read_b64_tr_b16 a[198:199], v62 offset:2312
    s_waitcnt lgkmcnt(10)
    v_mfma_f32_16x16x32_bf16 v[160:163], a[224:227], a[12:15], v[160:163]
    v_mfma_f32_16x16x32_bf16 v[164:167], a[224:227], a[68:71], v[164:167]
    v_mfma_f32_16x16x32_bf16 v[168:171], a[224:227], a[124:127], v[168:171]
    ds_read_b64_tr_b16 a[200:201], v63 offset:256
    ds_read_b64_tr_b16 a[202:203], v63 offset:2304
    s_waitcnt lgkmcnt(10)
    v_mfma_f32_16x16x32_bf16 v[172:175], a[228:231], a[12:15], v[172:175]
    v_mfma_f32_16x16x32_bf16 v[176:179], a[228:231], a[68:71], v[176:179]
    v_mfma_f32_16x16x32_bf16 v[180:183], a[228:231], a[124:127], v[180:183]
    ds_read_b64_tr_b16 a[204:205], v63 offset:264
    ds_read_b64_tr_b16 a[206:207], v63 offset:2312
    s_waitcnt lgkmcnt(10)
    v_mfma_f32_16x16x32_bf16 v[184:187], a[232:235], a[12:15], v[184:187]
    v_mfma_f32_16x16x32_bf16 v[188:191], a[232:235], a[68:71], v[188:191]
    v_mfma_f32_16x16x32_bf16 v[192:195], a[232:235], a[124:127], v[192:195]
    s_barrier
    v_add_u32 v60, 0, v4
    v_add_u32 v61, 0, v5
    v_add_u32 v62, 0, v6
    v_add_u32 v63, 0, v7
    ds_read_b64_tr_b16 a[208:209], v60 offset:0
    ds_read_b64_tr_b16 a[210:211], v60 offset:2048
    s_waitcnt lgkmcnt(10)
    v_mfma_f32_16x16x32_bf16 v[196:199], a[236:239], a[12:15], v[196:199]
    v_mfma_f32_16x16x32_bf16 v[200:203], a[236:239], a[68:71], v[200:203]
    v_mfma_f32_16x16x32_bf16 v[204:207], a[236:239], a[124:127], v[204:207]
    ds_read_b64_tr_b16 a[212:213], v60 offset:8
    ds_read_b64_tr_b16 a[214:215], v60 offset:2056
    s_waitcnt lgkmcnt(10)
    v_mfma_f32_16x16x32_bf16 v[208:211], a[192:195], a[12:15], v[208:211]
    v_mfma_f32_16x16x32_bf16 v[212:215], a[192:195], a[68:71], v[212:215]
    v_mfma_f32_16x16x32_bf16 v[216:219], a[192:195], a[124:127], v[216:219]
    ds_read_b64_tr_b16 a[216:217], v61 offset:0
    ds_read_b64_tr_b16 a[218:219], v61 offset:2048
    s_waitcnt lgkmcnt(10)
    v_mfma_f32_16x16x32_bf16 v[220:223], a[196:199], a[12:15], v[220:223]
    v_mfma_f32_16x16x32_bf16 v[224:227], a[196:199], a[68:71], v[224:227]
    v_mfma_f32_16x16x32_bf16 v[228:231], a[196:199], a[124:127], v[228:231]
    ds_read_b64_tr_b16 a[220:221], v61 offset:8
    ds_read_b64_tr_b16 a[222:223], v61 offset:2056
    s_waitcnt lgkmcnt(10)
    v_mfma_f32_16x16x32_bf16 v[232:235], a[200:203], a[12:15], v[232:235]
    v_mfma_f32_16x16x32_bf16 v[236:239], a[200:203], a[68:71], v[236:239]
    v_mfma_f32_16x16x32_bf16 v[240:243], a[200:203], a[124:127], v[240:243]
    ds_read_b64_tr_b16 a[224:225], v62 offset:0
    ds_read_b64_tr_b16 a[226:227], v62 offset:2048
    s_waitcnt lgkmcnt(10)
    v_mfma_f32_16x16x32_bf16 v[244:247], a[204:207], a[12:15], v[244:247]
    v_mfma_f32_16x16x32_bf16 v[248:251], a[204:207], a[68:71], v[248:251]
    v_mfma_f32_16x16x32_bf16 v[252:255], a[204:207], a[124:127], v[252:255]
    s_waitcnt vmcnt(59)
    ds_read_b64_tr_b16 a[228:229], v62 offset:8
    ds_read_b64_tr_b16 a[230:231], v62 offset:2056
    s_waitcnt lgkmcnt(10)
    v_mfma_f32_16x16x32_bf16 v[64:67], a[208:211], a[16:19], v[64:67]
    v_mfma_f32_16x16x32_bf16 v[68:71], a[208:211], a[72:75], v[68:71]
    v_mfma_f32_16x16x32_bf16 v[72:75], a[208:211], a[128:131], v[72:75]
    ds_read_b64_tr_b16 a[232:233], v63 offset:0
    ds_read_b64_tr_b16 a[234:235], v63 offset:2048
    s_waitcnt lgkmcnt(10)
    v_mfma_f32_16x16x32_bf16 v[76:79], a[212:215], a[16:19], v[76:79]
    v_mfma_f32_16x16x32_bf16 v[80:83], a[212:215], a[72:75], v[80:83]
    v_mfma_f32_16x16x32_bf16 v[84:87], a[212:215], a[128:131], v[84:87]
    ds_read_b64_tr_b16 a[236:237], v63 offset:8
    ds_read_b64_tr_b16 a[238:239], v63 offset:2056
    s_waitcnt lgkmcnt(10)
    v_mfma_f32_16x16x32_bf16 v[88:91], a[216:219], a[16:19], v[88:91]
    v_mfma_f32_16x16x32_bf16 v[92:95], a[216:219], a[72:75], v[92:95]
    v_mfma_f32_16x16x32_bf16 v[96:99], a[216:219], a[128:131], v[96:99]
    ds_read_b64_tr_b16 a[192:193], v60 offset:256
    ds_read_b64_tr_b16 a[194:195], v60 offset:2304
    s_waitcnt lgkmcnt(10)
    v_mfma_f32_16x16x32_bf16 v[100:103], a[220:223], a[16:19], v[100:103]
    v_mfma_f32_16x16x32_bf16 v[104:107], a[220:223], a[72:75], v[104:107]
    v_mfma_f32_16x16x32_bf16 v[108:111], a[220:223], a[128:131], v[108:111]
    ds_read_b64_tr_b16 a[196:197], v60 offset:264
    ds_read_b64_tr_b16 a[198:199], v60 offset:2312
    s_waitcnt lgkmcnt(10)
    v_mfma_f32_16x16x32_bf16 v[112:115], a[224:227], a[16:19], v[112:115]
    v_mfma_f32_16x16x32_bf16 v[116:119], a[224:227], a[72:75], v[116:119]
    v_mfma_f32_16x16x32_bf16 v[120:123], a[224:227], a[128:131], v[120:123]
    ds_read_b64_tr_b16 a[200:201], v61 offset:256
    ds_read_b64_tr_b16 a[202:203], v61 offset:2304
    s_waitcnt lgkmcnt(10)
    v_mfma_f32_16x16x32_bf16 v[124:127], a[228:231], a[16:19], v[124:127]
    v_mfma_f32_16x16x32_bf16 v[128:131], a[228:231], a[72:75], v[128:131]
    v_mfma_f32_16x16x32_bf16 v[132:135], a[228:231], a[128:131], v[132:135]
    ds_read_b64_tr_b16 a[204:205], v61 offset:264
    ds_read_b64_tr_b16 a[206:207], v61 offset:2312
    s_waitcnt lgkmcnt(10)
    v_mfma_f32_16x16x32_bf16 v[136:139], a[232:235], a[16:19], v[136:139]
    v_mfma_f32_16x16x32_bf16 v[140:143], a[232:235], a[72:75], v[140:143]
    v_mfma_f32_16x16x32_bf16 v[144:147], a[232:235], a[128:131], v[144:147]
    ds_read_b64_tr_b16 a[208:209], v62 offset:256
    ds_read_b64_tr_b16 a[210:211], v62 offset:2304
    s_waitcnt lgkmcnt(10)
    v_mfma_f32_16x16x32_bf16 v[148:151], a[236:239], a[16:19], v[148:151]
    v_mfma_f32_16x16x32_bf16 v[152:155], a[236:239], a[72:75], v[152:155]
    v_mfma_f32_16x16x32_bf16 v[156:159], a[236:239], a[128:131], v[156:159]
    ds_read_b64_tr_b16 a[212:213], v62 offset:264
    ds_read_b64_tr_b16 a[214:215], v62 offset:2312
    s_waitcnt lgkmcnt(10)
    v_mfma_f32_16x16x32_bf16 v[160:163], a[192:195], a[16:19], v[160:163]
    v_mfma_f32_16x16x32_bf16 v[164:167], a[192:195], a[72:75], v[164:167]
    v_mfma_f32_16x16x32_bf16 v[168:171], a[192:195], a[128:131], v[168:171]
    ds_read_b64_tr_b16 a[216:217], v63 offset:256
    ds_read_b64_tr_b16 a[218:219], v63 offset:2304
    s_waitcnt lgkmcnt(10)
    v_mfma_f32_16x16x32_bf16 v[172:175], a[196:199], a[16:19], v[172:175]
    v_mfma_f32_16x16x32_bf16 v[176:179], a[196:199], a[72:75], v[176:179]
    v_mfma_f32_16x16x32_bf16 v[180:183], a[196:199], a[128:131], v[180:183]
    ds_read_b64_tr_b16 a[220:221], v63 offset:264
    ds_read_b64_tr_b16 a[222:223], v63 offset:2312
    s_waitcnt lgkmcnt(10)
    v_mfma_f32_16x16x32_bf16 v[184:187], a[200:203], a[16:19], v[184:187]
    v_mfma_f32_16x16x32_bf16 v[188:191], a[200:203], a[72:75], v[188:191]
    v_mfma_f32_16x16x32_bf16 v[192:195], a[200:203], a[128:131], v[192:195]
    s_barrier
    v_add_u32 v60, 16384, v4
    v_add_u32 v61, 16384, v5
    v_add_u32 v62, 16384, v6
    v_add_u32 v63, 16384, v7
    ds_read_b64_tr_b16 a[224:225], v60 offset:0
    ds_read_b64_tr_b16 a[226:227], v60 offset:2048
    s_waitcnt lgkmcnt(10)
    v_mfma_f32_16x16x32_bf16 v[196:199], a[204:207], a[16:19], v[196:199]
    v_mfma_f32_16x16x32_bf16 v[200:203], a[204:207], a[72:75], v[200:203]
    v_mfma_f32_16x16x32_bf16 v[204:207], a[204:207], a[128:131], v[204:207]
    ds_read_b64_tr_b16 a[228:229], v60 offset:8
    ds_read_b64_tr_b16 a[230:231], v60 offset:2056
    s_waitcnt lgkmcnt(10)
    v_mfma_f32_16x16x32_bf16 v[208:211], a[208:211], a[16:19], v[208:211]
    v_mfma_f32_16x16x32_bf16 v[212:215], a[208:211], a[72:75], v[212:215]
    v_mfma_f32_16x16x32_bf16 v[216:219], a[208:211], a[128:131], v[216:219]
    ds_read_b64_tr_b16 a[232:233], v61 offset:0
    ds_read_b64_tr_b16 a[234:235], v61 offset:2048
    s_waitcnt lgkmcnt(10)
    v_mfma_f32_16x16x32_bf16 v[220:223], a[212:215], a[16:19], v[220:223]
    v_mfma_f32_16x16x32_bf16 v[224:227], a[212:215], a[72:75], v[224:227]
    v_mfma_f32_16x16x32_bf16 v[228:231], a[212:215], a[128:131], v[228:231]
    ds_read_b64_tr_b16 a[236:237], v61 offset:8
    ds_read_b64_tr_b16 a[238:239], v61 offset:2056
    s_waitcnt lgkmcnt(10)
    v_mfma_f32_16x16x32_bf16 v[232:235], a[216:219], a[16:19], v[232:235]
    v_mfma_f32_16x16x32_bf16 v[236:239], a[216:219], a[72:75], v[236:239]
    v_mfma_f32_16x16x32_bf16 v[240:243], a[216:219], a[128:131], v[240:243]
    ds_read_b64_tr_b16 a[192:193], v62 offset:0
    ds_read_b64_tr_b16 a[194:195], v62 offset:2048
    s_waitcnt lgkmcnt(10)
    v_mfma_f32_16x16x32_bf16 v[244:247], a[220:223], a[16:19], v[244:247]
    v_mfma_f32_16x16x32_bf16 v[248:251], a[220:223], a[72:75], v[248:251]
    v_mfma_f32_16x16x32_bf16 v[252:255], a[220:223], a[128:131], v[252:255]
    s_waitcnt vmcnt(56)
    ds_read_b64_tr_b16 a[196:197], v62 offset:8
    ds_read_b64_tr_b16 a[198:199], v62 offset:2056
    s_waitcnt lgkmcnt(10)
    v_mfma_f32_16x16x32_bf16 v[64:67], a[224:227], a[20:23], v[64:67]
    v_mfma_f32_16x16x32_bf16 v[68:71], a[224:227], a[76:79], v[68:71]
    v_mfma_f32_16x16x32_bf16 v[72:75], a[224:227], a[132:135], v[72:75]
    ds_read_b64_tr_b16 a[200:201], v63 offset:0
    ds_read_b64_tr_b16 a[202:203], v63 offset:2048
    s_waitcnt lgkmcnt(10)
    v_mfma_f32_16x16x32_bf16 v[76:79], a[228:231], a[20:23], v[76:79]
    v_mfma_f32_16x16x32_bf16 v[80:83], a[228:231], a[76:79], v[80:83]
    v_mfma_f32_16x16x32_bf16 v[84:87], a[228:231], a[132:135], v[84:87]
    ds_read_b64_tr_b16 a[204:205], v63 offset:8
    ds_read_b64_tr_b16 a[206:207], v63 offset:2056
    s_waitcnt lgkmcnt(10)
    v_mfma_f32_16x16x32_bf16 v[88:91], a[232:235], a[20:23], v[88:91]
    v_mfma_f32_16x16x32_bf16 v[92:95], a[232:235], a[76:79], v[92:95]
    v_mfma_f32_16x16x32_bf16 v[96:99], a[232:235], a[132:135], v[96:99]
    ds_read_b64_tr_b16 a[208:209], v60 offset:256
    ds_read_b64_tr_b16 a[210:211], v60 offset:2304
    s_waitcnt lgkmcnt(10)
    v_mfma_f32_16x16x32_bf16 v[100:103], a[236:239], a[20:23], v[100:103]
    v_mfma_f32_16x16x32_bf16 v[104:107], a[236:239], a[76:79], v[104:107]
    v_mfma_f32_16x16x32_bf16 v[108:111], a[236:239], a[132:135], v[108:111]
    ds_read_b64_tr_b16 a[212:213], v60 offset:264
    ds_read_b64_tr_b16 a[214:215], v60 offset:2312
    s_waitcnt lgkmcnt(10)
    v_mfma_f32_16x16x32_bf16 v[112:115], a[192:195], a[20:23], v[112:115]
    v_mfma_f32_16x16x32_bf16 v[116:119], a[192:195], a[76:79], v[116:119]
    v_mfma_f32_16x16x32_bf16 v[120:123], a[192:195], a[132:135], v[120:123]
    ds_read_b64_tr_b16 a[216:217], v61 offset:256
    ds_read_b64_tr_b16 a[218:219], v61 offset:2304
    s_waitcnt lgkmcnt(10)
    v_mfma_f32_16x16x32_bf16 v[124:127], a[196:199], a[20:23], v[124:127]
    v_mfma_f32_16x16x32_bf16 v[128:131], a[196:199], a[76:79], v[128:131]
    v_mfma_f32_16x16x32_bf16 v[132:135], a[196:199], a[132:135], v[132:135]
    ds_read_b64_tr_b16 a[220:221], v61 offset:264
    ds_read_b64_tr_b16 a[222:223], v61 offset:2312
    s_waitcnt lgkmcnt(10)
    v_mfma_f32_16x16x32_bf16 v[136:139], a[200:203], a[20:23], v[136:139]
    v_mfma_f32_16x16x32_bf16 v[140:143], a[200:203], a[76:79], v[140:143]
    v_mfma_f32_16x16x32_bf16 v[144:147], a[200:203], a[132:135], v[144:147]
    ds_read_b64_tr_b16 a[224:225], v62 offset:256
    ds_read_b64_tr_b16 a[226:227], v62 offset:2304
    s_waitcnt lgkmcnt(10)
    v_mfma_f32_16x16x32_bf16 v[148:151], a[204:207], a[20:23], v[148:151]
    v_mfma_f32_16x16x32_bf16 v[152:155], a[204:207], a[76:79], v[152:155]
    v_mfma_f32_16x16x32_bf16 v[156:159], a[204:207], a[132:135], v[156:159]
    ds_read_b64_tr_b16 a[228:229], v62 offset:264
    ds_read_b64_tr_b16 a[230:231], v62 offset:2312
    s_waitcnt lgkmcnt(10)
    v_mfma_f32_16x16x32_bf16 v[160:163], a[208:211], a[20:23], v[160:163]
    v_mfma_f32_16x16x32_bf16 v[164:167], a[208:211], a[76:79], v[164:167]
    v_mfma_f32_16x16x32_bf16 v[168:171], a[208:211], a[132:135], v[168:171]
    ds_read_b64_tr_b16 a[232:233], v63 offset:256
    ds_read_b64_tr_b16 a[234:235], v63 offset:2304
    s_waitcnt lgkmcnt(10)
    v_mfma_f32_16x16x32_bf16 v[172:175], a[212:215], a[20:23], v[172:175]
    v_mfma_f32_16x16x32_bf16 v[176:179], a[212:215], a[76:79], v[176:179]
    v_mfma_f32_16x16x32_bf16 v[180:183], a[212:215], a[132:135], v[180:183]
    ds_read_b64_tr_b16 a[236:237], v63 offset:264
    ds_read_b64_tr_b16 a[238:239], v63 offset:2312
    s_waitcnt lgkmcnt(10)
    v_mfma_f32_16x16x32_bf16 v[184:187], a[216:219], a[20:23], v[184:187]
    v_mfma_f32_16x16x32_bf16 v[188:191], a[216:219], a[76:79], v[188:191]
    v_mfma_f32_16x16x32_bf16 v[192:195], a[216:219], a[132:135], v[192:195]
    s_barrier
    v_add_u32 v60, 32768, v4
    v_add_u32 v61, 32768, v5
    v_add_u32 v62, 32768, v6
    v_add_u32 v63, 32768, v7
    ds_read_b64_tr_b16 a[192:193], v60 offset:0
    ds_read_b64_tr_b16 a[194:195], v60 offset:2048
    s_waitcnt lgkmcnt(10)
    v_mfma_f32_16x16x32_bf16 v[196:199], a[220:223], a[20:23], v[196:199]
    v_mfma_f32_16x16x32_bf16 v[200:203], a[220:223], a[76:79], v[200:203]
    v_mfma_f32_16x16x32_bf16 v[204:207], a[220:223], a[132:135], v[204:207]
    ds_read_b64_tr_b16 a[196:197], v60 offset:8
    ds_read_b64_tr_b16 a[198:199], v60 offset:2056
    s_waitcnt lgkmcnt(10)
    v_mfma_f32_16x16x32_bf16 v[208:211], a[224:227], a[20:23], v[208:211]
    v_mfma_f32_16x16x32_bf16 v[212:215], a[224:227], a[76:79], v[212:215]
    v_mfma_f32_16x16x32_bf16 v[216:219], a[224:227], a[132:135], v[216:219]
    ds_read_b64_tr_b16 a[200:201], v61 offset:0
    ds_read_b64_tr_b16 a[202:203], v61 offset:2048
    s_waitcnt lgkmcnt(10)
    v_mfma_f32_16x16x32_bf16 v[220:223], a[228:231], a[20:23], v[220:223]
    v_mfma_f32_16x16x32_bf16 v[224:227], a[228:231], a[76:79], v[224:227]
    v_mfma_f32_16x16x32_bf16 v[228:231], a[228:231], a[132:135], v[228:231]
    ds_read_b64_tr_b16 a[204:205], v61 offset:8
    ds_read_b64_tr_b16 a[206:207], v61 offset:2056
    s_waitcnt lgkmcnt(10)
    v_mfma_f32_16x16x32_bf16 v[232:235], a[232:235], a[20:23], v[232:235]
    v_mfma_f32_16x16x32_bf16 v[236:239], a[232:235], a[76:79], v[236:239]
    v_mfma_f32_16x16x32_bf16 v[240:243], a[232:235], a[132:135], v[240:243]
    ds_read_b64_tr_b16 a[208:209], v62 offset:0
    ds_read_b64_tr_b16 a[210:211], v62 offset:2048
    s_waitcnt lgkmcnt(10)
    v_mfma_f32_16x16x32_bf16 v[244:247], a[236:239], a[20:23], v[244:247]
    v_mfma_f32_16x16x32_bf16 v[248:251], a[236:239], a[76:79], v[248:251]
    v_mfma_f32_16x16x32_bf16 v[252:255], a[236:239], a[132:135], v[252:255]
    s_waitcnt vmcnt(53)
    ds_read_b64_tr_b16 a[212:213], v62 offset:8
    ds_read_b64_tr_b16 a[214:215], v62 offset:2056
    s_waitcnt lgkmcnt(10)
    v_mfma_f32_16x16x32_bf16 v[64:67], a[192:195], a[24:27], v[64:67]
    v_mfma_f32_16x16x32_bf16 v[68:71], a[192:195], a[80:83], v[68:71]
    v_mfma_f32_16x16x32_bf16 v[72:75], a[192:195], a[136:139], v[72:75]
    ds_read_b64_tr_b16 a[216:217], v63 offset:0
    ds_read_b64_tr_b16 a[218:219], v63 offset:2048
    s_waitcnt lgkmcnt(10)
    v_mfma_f32_16x16x32_bf16 v[76:79], a[196:199], a[24:27], v[76:79]
    v_mfma_f32_16x16x32_bf16 v[80:83], a[196:199], a[80:83], v[80:83]
    v_mfma_f32_16x16x32_bf16 v[84:87], a[196:199], a[136:139], v[84:87]
    ds_read_b64_tr_b16 a[220:221], v63 offset:8
    ds_read_b64_tr_b16 a[222:223], v63 offset:2056
    s_waitcnt lgkmcnt(10)
    v_mfma_f32_16x16x32_bf16 v[88:91], a[200:203], a[24:27], v[88:91]
    v_mfma_f32_16x16x32_bf16 v[92:95], a[200:203], a[80:83], v[92:95]
    v_mfma_f32_16x16x32_bf16 v[96:99], a[200:203], a[136:139], v[96:99]
    ds_read_b64_tr_b16 a[224:225], v60 offset:256
    ds_read_b64_tr_b16 a[226:227], v60 offset:2304
    s_waitcnt lgkmcnt(10)
    v_mfma_f32_16x16x32_bf16 v[100:103], a[204:207], a[24:27], v[100:103]
    v_mfma_f32_16x16x32_bf16 v[104:107], a[204:207], a[80:83], v[104:107]
    v_mfma_f32_16x16x32_bf16 v[108:111], a[204:207], a[136:139], v[108:111]
    ds_read_b64_tr_b16 a[228:229], v60 offset:264
    ds_read_b64_tr_b16 a[230:231], v60 offset:2312
    s_waitcnt lgkmcnt(10)
    v_mfma_f32_16x16x32_bf16 v[112:115], a[208:211], a[24:27], v[112:115]
    v_mfma_f32_16x16x32_bf16 v[116:119], a[208:211], a[80:83], v[116:119]
    v_mfma_f32_16x16x32_bf16 v[120:123], a[208:211], a[136:139], v[120:123]
    ds_read_b64_tr_b16 a[232:233], v61 offset:256
    ds_read_b64_tr_b16 a[234:235], v61 offset:2304
    s_waitcnt lgkmcnt(10)
    v_mfma_f32_16x16x32_bf16 v[124:127], a[212:215], a[24:27], v[124:127]
    v_mfma_f32_16x16x32_bf16 v[128:131], a[212:215], a[80:83], v[128:131]
    v_mfma_f32_16x16x32_bf16 v[132:135], a[212:215], a[136:139], v[132:135]
    ds_read_b64_tr_b16 a[236:237], v61 offset:264
    ds_read_b64_tr_b16 a[238:239], v61 offset:2312
    s_waitcnt lgkmcnt(10)
    v_mfma_f32_16x16x32_bf16 v[136:139], a[216:219], a[24:27], v[136:139]
    v_mfma_f32_16x16x32_bf16 v[140:143], a[216:219], a[80:83], v[140:143]
    v_mfma_f32_16x16x32_bf16 v[144:147], a[216:219], a[136:139], v[144:147]
    ds_read_b64_tr_b16 a[192:193], v62 offset:256
    ds_read_b64_tr_b16 a[194:195], v62 offset:2304
    s_waitcnt lgkmcnt(10)
    v_mfma_f32_16x16x32_bf16 v[148:151], a[220:223], a[24:27], v[148:151]
    v_mfma_f32_16x16x32_bf16 v[152:155], a[220:223], a[80:83], v[152:155]
    v_mfma_f32_16x16x32_bf16 v[156:159], a[220:223], a[136:139], v[156:159]
    ds_read_b64_tr_b16 a[196:197], v62 offset:264
    ds_read_b64_tr_b16 a[198:199], v62 offset:2312
    s_waitcnt lgkmcnt(10)
    v_mfma_f32_16x16x32_bf16 v[160:163], a[224:227], a[24:27], v[160:163]
    v_mfma_f32_16x16x32_bf16 v[164:167], a[224:227], a[80:83], v[164:167]
    v_mfma_f32_16x16x32_bf16 v[168:171], a[224:227], a[136:139], v[168:171]
    ds_read_b64_tr_b16 a[200:201], v63 offset:256
    ds_read_b64_tr_b16 a[202:203], v63 offset:2304
    s_waitcnt lgkmcnt(10)
    v_mfma_f32_16x16x32_bf16 v[172:175], a[228:231], a[24:27], v[172:175]
    v_mfma_f32_16x16x32_bf16 v[176:179], a[228:231], a[80:83], v[176:179]
    v_mfma_f32_16x16x32_bf16 v[180:183], a[228:231], a[136:139], v[180:183]
    ds_read_b64_tr_b16 a[204:205], v63 offset:264
    ds_read_b64_tr_b16 a[206:207], v63 offset:2312
    s_waitcnt lgkmcnt(10)
    v_mfma_f32_16x16x32_bf16 v[184:187], a[232:235], a[24:27], v[184:187]
    v_mfma_f32_16x16x32_bf16 v[188:191], a[232:235], a[80:83], v[188:191]
    v_mfma_f32_16x16x32_bf16 v[192:195], a[232:235], a[136:139], v[192:195]
    s_barrier
    v_add_u32 v60, 49152, v4
    v_add_u32 v61, 49152, v5
    v_add_u32 v62, 49152, v6
    v_add_u32 v63, 49152, v7
    ds_read_b64_tr_b16 a[208:209], v60 offset:0
    ds_read_b64_tr_b16 a[210:211], v60 offset:2048
    s_waitcnt lgkmcnt(10)
    v_mfma_f32_16x16x32_bf16 v[196:199], a[236:239], a[24:27], v[196:199]
    v_mfma_f32_16x16x32_bf16 v[200:203], a[236:239], a[80:83], v[200:203]
    v_mfma_f32_16x16x32_bf16 v[204:207], a[236:239], a[136:139], v[204:207]
    ds_read_b64_tr_b16 a[212:213], v60 offset:8
    ds_read_b64_tr_b16 a[214:215], v60 offset:2056
    s_waitcnt lgkmcnt(10)
    v_mfma_f32_16x16x32_bf16 v[208:211], a[192:195], a[24:27], v[208:211]
    v_mfma_f32_16x16x32_bf16 v[212:215], a[192:195], a[80:83], v[212:215]
    v_mfma_f32_16x16x32_bf16 v[216:219], a[192:195], a[136:139], v[216:219]
    ds_read_b64_tr_b16 a[216:217], v61 offset:0
    ds_read_b64_tr_b16 a[218:219], v61 offset:2048
    s_waitcnt lgkmcnt(10)
    v_mfma_f32_16x16x32_bf16 v[220:223], a[196:199], a[24:27], v[220:223]
    v_mfma_f32_16x16x32_bf16 v[224:227], a[196:199], a[80:83], v[224:227]
    v_mfma_f32_16x16x32_bf16 v[228:231], a[196:199], a[136:139], v[228:231]
    ds_read_b64_tr_b16 a[220:221], v61 offset:8
    ds_read_b64_tr_b16 a[222:223], v61 offset:2056
    s_waitcnt lgkmcnt(10)
    v_mfma_f32_16x16x32_bf16 v[232:235], a[200:203], a[24:27], v[232:235]
    v_mfma_f32_16x16x32_bf16 v[236:239], a[200:203], a[80:83], v[236:239]
    v_mfma_f32_16x16x32_bf16 v[240:243], a[200:203], a[136:139], v[240:243]
    ds_read_b64_tr_b16 a[224:225], v62 offset:0
    ds_read_b64_tr_b16 a[226:227], v62 offset:2048
    s_waitcnt lgkmcnt(10)
    v_mfma_f32_16x16x32_bf16 v[244:247], a[204:207], a[24:27], v[244:247]
    v_mfma_f32_16x16x32_bf16 v[248:251], a[204:207], a[80:83], v[248:251]
    v_mfma_f32_16x16x32_bf16 v[252:255], a[204:207], a[136:139], v[252:255]
    s_waitcnt vmcnt(18)
    ds_read_b64_tr_b16 a[228:229], v62 offset:8
    ds_read_b64_tr_b16 a[230:231], v62 offset:2056
    s_waitcnt lgkmcnt(10)
    v_mfma_f32_16x16x32_bf16 v[64:67], a[208:211], a[28:31], v[64:67]
    v_mfma_f32_16x16x32_bf16 v[68:71], a[208:211], a[84:87], v[68:71]
    v_mfma_f32_16x16x32_bf16 v[72:75], a[208:211], a[140:143], v[72:75]
    ds_read_b64_tr_b16 a[232:233], v63 offset:0
    ds_read_b64_tr_b16 a[234:235], v63 offset:2048
    s_waitcnt lgkmcnt(10)
    v_mfma_f32_16x16x32_bf16 v[76:79], a[212:215], a[28:31], v[76:79]
    v_mfma_f32_16x16x32_bf16 v[80:83], a[212:215], a[84:87], v[80:83]
    v_mfma_f32_16x16x32_bf16 v[84:87], a[212:215], a[140:143], v[84:87]
    ds_read_b64_tr_b16 a[236:237], v63 offset:8
    ds_read_b64_tr_b16 a[238:239], v63 offset:2056
    s_waitcnt lgkmcnt(10)
    v_mfma_f32_16x16x32_bf16 v[88:91], a[216:219], a[28:31], v[88:91]
    v_mfma_f32_16x16x32_bf16 v[92:95], a[216:219], a[84:87], v[92:95]
    v_mfma_f32_16x16x32_bf16 v[96:99], a[216:219], a[140:143], v[96:99]
    ds_read_b64_tr_b16 a[192:193], v60 offset:256
    ds_read_b64_tr_b16 a[194:195], v60 offset:2304
    s_waitcnt lgkmcnt(10)
    v_mfma_f32_16x16x32_bf16 v[100:103], a[220:223], a[28:31], v[100:103]
    v_mfma_f32_16x16x32_bf16 v[104:107], a[220:223], a[84:87], v[104:107]
    v_mfma_f32_16x16x32_bf16 v[108:111], a[220:223], a[140:143], v[108:111]
    ds_read_b64_tr_b16 a[196:197], v60 offset:264
    ds_read_b64_tr_b16 a[198:199], v60 offset:2312
    s_waitcnt lgkmcnt(10)
    v_mfma_f32_16x16x32_bf16 v[112:115], a[224:227], a[28:31], v[112:115]
    v_mfma_f32_16x16x32_bf16 v[116:119], a[224:227], a[84:87], v[116:119]
    v_mfma_f32_16x16x32_bf16 v[120:123], a[224:227], a[140:143], v[120:123]
    ds_read_b64_tr_b16 a[200:201], v61 offset:256
    ds_read_b64_tr_b16 a[202:203], v61 offset:2304
    s_waitcnt lgkmcnt(10)
    v_mfma_f32_16x16x32_bf16 v[124:127], a[228:231], a[28:31], v[124:127]
    v_mfma_f32_16x16x32_bf16 v[128:131], a[228:231], a[84:87], v[128:131]
    v_mfma_f32_16x16x32_bf16 v[132:135], a[228:231], a[140:143], v[132:135]
    ds_read_b64_tr_b16 a[204:205], v61 offset:264
    ds_read_b64_tr_b16 a[206:207], v61 offset:2312
    s_waitcnt lgkmcnt(10)
    v_mfma_f32_16x16x32_bf16 v[136:139], a[232:235], a[28:31], v[136:139]
    v_mfma_f32_16x16x32_bf16 v[140:143], a[232:235], a[84:87], v[140:143]
    v_mfma_f32_16x16x32_bf16 v[144:147], a[232:235], a[140:143], v[144:147]
    ds_read_b64_tr_b16 a[208:209], v62 offset:256
    ds_read_b64_tr_b16 a[210:211], v62 offset:2304
    s_waitcnt lgkmcnt(10)
    v_mfma_f32_16x16x32_bf16 v[148:151], a[236:239], a[28:31], v[148:151]
    v_mfma_f32_16x16x32_bf16 v[152:155], a[236:239], a[84:87], v[152:155]
    v_mfma_f32_16x16x32_bf16 v[156:159], a[236:239], a[140:143], v[156:159]
    ds_read_b64_tr_b16 a[212:213], v62 offset:264
    ds_read_b64_tr_b16 a[214:215], v62 offset:2312
    s_waitcnt lgkmcnt(10)
    v_mfma_f32_16x16x32_bf16 v[160:163], a[192:195], a[28:31], v[160:163]
    v_mfma_f32_16x16x32_bf16 v[164:167], a[192:195], a[84:87], v[164:167]
    v_mfma_f32_16x16x32_bf16 v[168:171], a[192:195], a[140:143], v[168:171]
    ds_read_b64_tr_b16 a[216:217], v63 offset:256
    ds_read_b64_tr_b16 a[218:219], v63 offset:2304
    s_waitcnt lgkmcnt(10)
    v_mfma_f32_16x16x32_bf16 v[172:175], a[196:199], a[28:31], v[172:175]
    v_mfma_f32_16x16x32_bf16 v[176:179], a[196:199], a[84:87], v[176:179]
    v_mfma_f32_16x16x32_bf16 v[180:183], a[196:199], a[140:143], v[180:183]
    ds_read_b64_tr_b16 a[220:221], v63 offset:264
    ds_read_b64_tr_b16 a[222:223], v63 offset:2312
    s_waitcnt lgkmcnt(10)
    v_mfma_f32_16x16x32_bf16 v[184:187], a[200:203], a[28:31], v[184:187]
    v_mfma_f32_16x16x32_bf16 v[188:191], a[200:203], a[84:87], v[188:191]
    v_mfma_f32_16x16x32_bf16 v[192:195], a[200:203], a[140:143], v[192:195]
    s_barrier
    v_add_u32 v60, 0, v4
    v_add_u32 v61, 0, v5
    v_add_u32 v62, 0, v6
    v_add_u32 v63, 0, v7
    ds_read_b64_tr_b16 a[224:225], v60 offset:0
    ds_read_b64_tr_b16 a[226:227], v60 offset:2048
    s_waitcnt lgkmcnt(10)
    v_mfma_f32_16x16x32_bf16 v[196:199], a[204:207], a[28:31], v[196:199]
    v_mfma_f32_16x16x32_bf16 v[200:203], a[204:207], a[84:87], v[200:203]
    v_mfma_f32_16x16x32_bf16 v[204:207], a[204:207], a[140:143], v[204:207]
    ds_read_b64_tr_b16 a[228:229], v60 offset:8
    ds_read_b64_tr_b16 a[230:231], v60 offset:2056
    s_waitcnt lgkmcnt(10)
    v_mfma_f32_16x16x32_bf16 v[208:211], a[208:211], a[28:31], v[208:211]
    v_mfma_f32_16x16x32_bf16 v[212:215], a[208:211], a[84:87], v[212:215]
    v_mfma_f32_16x16x32_bf16 v[216:219], a[208:211], a[140:143], v[216:219]
    ds_read_b64_tr_b16 a[232:233], v61 offset:0
    ds_read_b64_tr_b16 a[234:235], v61 offset:2048
    s_waitcnt lgkmcnt(10)
    v_mfma_f32_16x16x32_bf16 v[220:223], a[212:215], a[28:31], v[220:223]
    v_mfma_f32_16x16x32_bf16 v[224:227], a[212:215], a[84:87], v[224:227]
    v_mfma_f32_16x16x32_bf16 v[228:231], a[212:215], a[140:143], v[228:231]
    ds_read_b64_tr_b16 a[236:237], v61 offset:8
    ds_read_b64_tr_b16 a[238:239], v61 offset:2056
    s_waitcnt lgkmcnt(10)
    v_mfma_f32_16x16x32_bf16 v[232:235], a[216:219], a[28:31], v[232:235]
    v_mfma_f32_16x16x32_bf16 v[236:239], a[216:219], a[84:87], v[236:239]
    v_mfma_f32_16x16x32_bf16 v[240:243], a[216:219], a[140:143], v[240:243]
    ds_read_b64_tr_b16 a[192:193], v62 offset:0
    ds_read_b64_tr_b16 a[194:195], v62 offset:2048
    s_waitcnt lgkmcnt(10)
    v_mfma_f32_16x16x32_bf16 v[244:247], a[220:223], a[28:31], v[244:247]
    v_mfma_f32_16x16x32_bf16 v[248:251], a[220:223], a[84:87], v[248:251]
    v_mfma_f32_16x16x32_bf16 v[252:255], a[220:223], a[140:143], v[252:255]
    s_waitcnt vmcnt(15)
    ds_read_b64_tr_b16 a[196:197], v62 offset:8
    ds_read_b64_tr_b16 a[198:199], v62 offset:2056
    s_waitcnt lgkmcnt(10)
    v_mfma_f32_16x16x32_bf16 v[64:67], a[224:227], a[32:35], v[64:67]
    v_mfma_f32_16x16x32_bf16 v[68:71], a[224:227], a[88:91], v[68:71]
    v_mfma_f32_16x16x32_bf16 v[72:75], a[224:227], a[144:147], v[72:75]
    ds_read_b64_tr_b16 a[200:201], v63 offset:0
    ds_read_b64_tr_b16 a[202:203], v63 offset:2048
    s_waitcnt lgkmcnt(10)
    v_mfma_f32_16x16x32_bf16 v[76:79], a[228:231], a[32:35], v[76:79]
    v_mfma_f32_16x16x32_bf16 v[80:83], a[228:231], a[88:91], v[80:83]
    v_mfma_f32_16x16x32_bf16 v[84:87], a[228:231], a[144:147], v[84:87]
    ds_read_b64_tr_b16 a[204:205], v63 offset:8
    ds_read_b64_tr_b16 a[206:207], v63 offset:2056
    s_waitcnt lgkmcnt(10)
    v_mfma_f32_16x16x32_bf16 v[88:91], a[232:235], a[32:35], v[88:91]
    v_mfma_f32_16x16x32_bf16 v[92:95], a[232:235], a[88:91], v[92:95]
    v_mfma_f32_16x16x32_bf16 v[96:99], a[232:235], a[144:147], v[96:99]
    ds_read_b64_tr_b16 a[208:209], v60 offset:256
    ds_read_b64_tr_b16 a[210:211], v60 offset:2304
    s_waitcnt lgkmcnt(10)
    v_mfma_f32_16x16x32_bf16 v[100:103], a[236:239], a[32:35], v[100:103]
    v_mfma_f32_16x16x32_bf16 v[104:107], a[236:239], a[88:91], v[104:107]
    v_mfma_f32_16x16x32_bf16 v[108:111], a[236:239], a[144:147], v[108:111]
    ds_read_b64_tr_b16 a[212:213], v60 offset:264
    ds_read_b64_tr_b16 a[214:215], v60 offset:2312
    s_waitcnt lgkmcnt(10)
    v_mfma_f32_16x16x32_bf16 v[112:115], a[192:195], a[32:35], v[112:115]
    v_mfma_f32_16x16x32_bf16 v[116:119], a[192:195], a[88:91], v[116:119]
    v_mfma_f32_16x16x32_bf16 v[120:123], a[192:195], a[144:147], v[120:123]
    ds_read_b64_tr_b16 a[216:217], v61 offset:256
    ds_read_b64_tr_b16 a[218:219], v61 offset:2304
    s_waitcnt lgkmcnt(10)
    v_mfma_f32_16x16x32_bf16 v[124:127], a[196:199], a[32:35], v[124:127]
    v_mfma_f32_16x16x32_bf16 v[128:131], a[196:199], a[88:91], v[128:131]
    v_mfma_f32_16x16x32_bf16 v[132:135], a[196:199], a[144:147], v[132:135]
    ds_read_b64_tr_b16 a[220:221], v61 offset:264
    ds_read_b64_tr_b16 a[222:223], v61 offset:2312
    s_waitcnt lgkmcnt(10)
    v_mfma_f32_16x16x32_bf16 v[136:139], a[200:203], a[32:35], v[136:139]
    v_mfma_f32_16x16x32_bf16 v[140:143], a[200:203], a[88:91], v[140:143]
    v_mfma_f32_16x16x32_bf16 v[144:147], a[200:203], a[144:147], v[144:147]
    ds_read_b64_tr_b16 a[224:225], v62 offset:256
    ds_read_b64_tr_b16 a[226:227], v62 offset:2304
    s_waitcnt lgkmcnt(10)
    v_mfma_f32_16x16x32_bf16 v[148:151], a[204:207], a[32:35], v[148:151]
    v_mfma_f32_16x16x32_bf16 v[152:155], a[204:207], a[88:91], v[152:155]
    v_mfma_f32_16x16x32_bf16 v[156:159], a[204:207], a[144:147], v[156:159]
    ds_read_b64_tr_b16 a[228:229], v62 offset:264
    ds_read_b64_tr_b16 a[230:231], v62 offset:2312
    s_waitcnt lgkmcnt(10)
    v_mfma_f32_16x16x32_bf16 v[160:163], a[208:211], a[32:35], v[160:163]
    v_mfma_f32_16x16x32_bf16 v[164:167], a[208:211], a[88:91], v[164:167]
    v_mfma_f32_16x16x32_bf16 v[168:171], a[208:211], a[144:147], v[168:171]
    ds_read_b64_tr_b16 a[232:233], v63 offset:256
    ds_read_b64_tr_b16 a[234:235], v63 offset:2304
    s_waitcnt lgkmcnt(10)
    v_mfma_f32_16x16x32_bf16 v[172:175], a[212:215], a[32:35], v[172:175]
    v_mfma_f32_16x16x32_bf16 v[176:179], a[212:215], a[88:91], v[176:179]
    v_mfma_f32_16x16x32_bf16 v[180:183], a[212:215], a[144:147], v[180:183]
    ds_read_b64_tr_b16 a[236:237], v63 offset:264
    ds_read_b64_tr_b16 a[238:239], v63 offset:2312
    s_waitcnt lgkmcnt(10)
    v_mfma_f32_16x16x32_bf16 v[184:187], a[216:219], a[32:35], v[184:187]
    v_mfma_f32_16x16x32_bf16 v[188:191], a[216:219], a[88:91], v[188:191]
    v_mfma_f32_16x16x32_bf16 v[192:195], a[216:219], a[144:147], v[192:195]
    s_barrier
    v_add_u32 v60, 16384, v4
    v_add_u32 v61, 16384, v5
    v_add_u32 v62, 16384, v6
    v_add_u32 v63, 16384, v7
    ds_read_b64_tr_b16 a[192:193], v60 offset:0
    ds_read_b64_tr_b16 a[194:195], v60 offset:2048
    s_waitcnt lgkmcnt(10)
    v_mfma_f32_16x16x32_bf16 v[196:199], a[220:223], a[32:35], v[196:199]
    v_mfma_f32_16x16x32_bf16 v[200:203], a[220:223], a[88:91], v[200:203]
    v_mfma_f32_16x16x32_bf16 v[204:207], a[220:223], a[144:147], v[204:207]
    ds_read_b64_tr_b16 a[196:197], v60 offset:8
    ds_read_b64_tr_b16 a[198:199], v60 offset:2056
    s_waitcnt lgkmcnt(10)
    v_mfma_f32_16x16x32_bf16 v[208:211], a[224:227], a[32:35], v[208:211]
    v_mfma_f32_16x16x32_bf16 v[212:215], a[224:227], a[88:91], v[212:215]
    v_mfma_f32_16x16x32_bf16 v[216:219], a[224:227], a[144:147], v[216:219]
    ds_read_b64_tr_b16 a[200:201], v61 offset:0
    ds_read_b64_tr_b16 a[202:203], v61 offset:2048
    s_waitcnt lgkmcnt(10)
    v_mfma_f32_16x16x32_bf16 v[220:223], a[228:231], a[32:35], v[220:223]
    v_mfma_f32_16x16x32_bf16 v[224:227], a[228:231], a[88:91], v[224:227]
    v_mfma_f32_16x16x32_bf16 v[228:231], a[228:231], a[144:147], v[228:231]
    ds_read_b64_tr_b16 a[204:205], v61 offset:8
    ds_read_b64_tr_b16 a[206:207], v61 offset:2056
    s_waitcnt lgkmcnt(10)
    v_mfma_f32_16x16x32_bf16 v[232:235], a[232:235], a[32:35], v[232:235]
    v_mfma_f32_16x16x32_bf16 v[236:239], a[232:235], a[88:91], v[236:239]
    v_mfma_f32_16x16x32_bf16 v[240:243], a[232:235], a[144:147], v[240:243]
    ds_read_b64_tr_b16 a[208:209], v62 offset:0
    ds_read_b64_tr_b16 a[210:211], v62 offset:2048
    s_waitcnt lgkmcnt(10)
    v_mfma_f32_16x16x32_bf16 v[244:247], a[236:239], a[32:35], v[244:247]
    v_mfma_f32_16x16x32_bf16 v[248:251], a[236:239], a[88:91], v[248:251]
    v_mfma_f32_16x16x32_bf16 v[252:255], a[236:239], a[144:147], v[252:255]
    s_waitcnt vmcnt(12)
    ds_read_b64_tr_b16 a[212:213], v62 offset:8
    ds_read_b64_tr_b16 a[214:215], v62 offset:2056
    s_waitcnt lgkmcnt(10)
    v_mfma_f32_16x16x32_bf16 v[64:67], a[192:195], a[36:39], v[64:67]
    v_mfma_f32_16x16x32_bf16 v[68:71], a[192:195], a[92:95], v[68:71]
    v_mfma_f32_16x16x32_bf16 v[72:75], a[192:195], a[148:151], v[72:75]
    ds_read_b64_tr_b16 a[216:217], v63 offset:0
    ds_read_b64_tr_b16 a[218:219], v63 offset:2048
    s_waitcnt lgkmcnt(10)
    v_mfma_f32_16x16x32_bf16 v[76:79], a[196:199], a[36:39], v[76:79]
    v_mfma_f32_16x16x32_bf16 v[80:83], a[196:199], a[92:95], v[80:83]
    v_mfma_f32_16x16x32_bf16 v[84:87], a[196:199], a[148:151], v[84:87]
    ds_read_b64_tr_b16 a[220:221], v63 offset:8
    ds_read_b64_tr_b16 a[222:223], v63 offset:2056
    s_waitcnt lgkmcnt(10)
    v_mfma_f32_16x16x32_bf16 v[88:91], a[200:203], a[36:39], v[88:91]
    v_mfma_f32_16x16x32_bf16 v[92:95], a[200:203], a[92:95], v[92:95]
    v_mfma_f32_16x16x32_bf16 v[96:99], a[200:203], a[148:151], v[96:99]
    ds_read_b64_tr_b16 a[224:225], v60 offset:256
    ds_read_b64_tr_b16 a[226:227], v60 offset:2304
    s_waitcnt lgkmcnt(10)
    v_mfma_f32_16x16x32_bf16 v[100:103], a[204:207], a[36:39], v[100:103]
    v_mfma_f32_16x16x32_bf16 v[104:107], a[204:207], a[92:95], v[104:107]
    v_mfma_f32_16x16x32_bf16 v[108:111], a[204:207], a[148:151], v[108:111]
    ds_read_b64_tr_b16 a[228:229], v60 offset:264
    ds_read_b64_tr_b16 a[230:231], v60 offset:2312
    s_waitcnt lgkmcnt(10)
    v_mfma_f32_16x16x32_bf16 v[112:115], a[208:211], a[36:39], v[112:115]
    v_mfma_f32_16x16x32_bf16 v[116:119], a[208:211], a[92:95], v[116:119]
    v_mfma_f32_16x16x32_bf16 v[120:123], a[208:211], a[148:151], v[120:123]
    ds_read_b64_tr_b16 a[232:233], v61 offset:256
    ds_read_b64_tr_b16 a[234:235], v61 offset:2304
    s_waitcnt lgkmcnt(10)
    v_mfma_f32_16x16x32_bf16 v[124:127], a[212:215], a[36:39], v[124:127]
    v_mfma_f32_16x16x32_bf16 v[128:131], a[212:215], a[92:95], v[128:131]
    v_mfma_f32_16x16x32_bf16 v[132:135], a[212:215], a[148:151], v[132:135]
    ds_read_b64_tr_b16 a[236:237], v61 offset:264
    ds_read_b64_tr_b16 a[238:239], v61 offset:2312
    s_waitcnt lgkmcnt(10)
    v_mfma_f32_16x16x32_bf16 v[136:139], a[216:219], a[36:39], v[136:139]
    v_mfma_f32_16x16x32_bf16 v[140:143], a[216:219], a[92:95], v[140:143]
    v_mfma_f32_16x16x32_bf16 v[144:147], a[216:219], a[148:151], v[144:147]
    ds_read_b64_tr_b16 a[192:193], v62 offset:256
    ds_read_b64_tr_b16 a[194:195], v62 offset:2304
    s_waitcnt lgkmcnt(10)
    v_mfma_f32_16x16x32_bf16 v[148:151], a[220:223], a[36:39], v[148:151]
    v_mfma_f32_16x16x32_bf16 v[152:155], a[220:223], a[92:95], v[152:155]
    v_mfma_f32_16x16x32_bf16 v[156:159], a[220:223], a[148:151], v[156:159]
    ds_read_b64_tr_b16 a[196:197], v62 offset:264
    ds_read_b64_tr_b16 a[198:199], v62 offset:2312
    s_waitcnt lgkmcnt(10)
    v_mfma_f32_16x16x32_bf16 v[160:163], a[224:227], a[36:39], v[160:163]
    v_mfma_f32_16x16x32_bf16 v[164:167], a[224:227], a[92:95], v[164:167]
    v_mfma_f32_16x16x32_bf16 v[168:171], a[224:227], a[148:151], v[168:171]
    ds_read_b64_tr_b16 a[200:201], v63 offset:256
    ds_read_b64_tr_b16 a[202:203], v63 offset:2304
    s_waitcnt lgkmcnt(10)
    v_mfma_f32_16x16x32_bf16 v[172:175], a[228:231], a[36:39], v[172:175]
    v_mfma_f32_16x16x32_bf16 v[176:179], a[228:231], a[92:95], v[176:179]
    v_mfma_f32_16x16x32_bf16 v[180:183], a[228:231], a[148:151], v[180:183]
    ds_read_b64_tr_b16 a[204:205], v63 offset:264
    ds_read_b64_tr_b16 a[206:207], v63 offset:2312
    s_waitcnt lgkmcnt(10)
    v_mfma_f32_16x16x32_bf16 v[184:187], a[232:235], a[36:39], v[184:187]
    v_mfma_f32_16x16x32_bf16 v[188:191], a[232:235], a[92:95], v[188:191]
    v_mfma_f32_16x16x32_bf16 v[192:195], a[232:235], a[148:151], v[192:195]
    s_barrier
    v_add_u32 v60, 32768, v4
    v_add_u32 v61, 32768, v5
    v_add_u32 v62, 32768, v6
    v_add_u32 v63, 32768, v7
    ds_read_b64_tr_b16 a[208:209], v60 offset:0
    ds_read_b64_tr_b16 a[210:211], v60 offset:2048
    s_waitcnt lgkmcnt(10)
    v_mfma_f32_16x16x32_bf16 v[196:199], a[236:239], a[36:39], v[196:199]
    v_mfma_f32_16x16x32_bf16 v[200:203], a[236:239], a[92:95], v[200:203]
    v_mfma_f32_16x16x32_bf16 v[204:207], a[236:239], a[148:151], v[204:207]
    ds_read_b64_tr_b16 a[212:213], v60 offset:8
    ds_read_b64_tr_b16 a[214:215], v60 offset:2056
    s_waitcnt lgkmcnt(10)
    v_mfma_f32_16x16x32_bf16 v[208:211], a[192:195], a[36:39], v[208:211]
    v_mfma_f32_16x16x32_bf16 v[212:215], a[192:195], a[92:95], v[212:215]
    v_mfma_f32_16x16x32_bf16 v[216:219], a[192:195], a[148:151], v[216:219]
    ds_read_b64_tr_b16 a[216:217], v61 offset:0
    ds_read_b64_tr_b16 a[218:219], v61 offset:2048
    s_waitcnt lgkmcnt(10)
    v_mfma_f32_16x16x32_bf16 v[220:223], a[196:199], a[36:39], v[220:223]
    v_mfma_f32_16x16x32_bf16 v[224:227], a[196:199], a[92:95], v[224:227]
    v_mfma_f32_16x16x32_bf16 v[228:231], a[196:199], a[148:151], v[228:231]
    ds_read_b64_tr_b16 a[220:221], v61 offset:8
    ds_read_b64_tr_b16 a[222:223], v61 offset:2056
    s_waitcnt lgkmcnt(10)
    v_mfma_f32_16x16x32_bf16 v[232:235], a[200:203], a[36:39], v[232:235]
    v_mfma_f32_16x16x32_bf16 v[236:239], a[200:203], a[92:95], v[236:239]
    v_mfma_f32_16x16x32_bf16 v[240:243], a[200:203], a[148:151], v[240:243]
    ds_read_b64_tr_b16 a[224:225], v62 offset:0
    ds_read_b64_tr_b16 a[226:227], v62 offset:2048
    s_waitcnt lgkmcnt(10)
    v_mfma_f32_16x16x32_bf16 v[244:247], a[204:207], a[36:39], v[244:247]
    v_mfma_f32_16x16x32_bf16 v[248:251], a[204:207], a[92:95], v[248:251]
    v_mfma_f32_16x16x32_bf16 v[252:255], a[204:207], a[148:151], v[252:255]
    s_waitcnt vmcnt(9)
    ds_read_b64_tr_b16 a[228:229], v62 offset:8
    ds_read_b64_tr_b16 a[230:231], v62 offset:2056
    s_waitcnt lgkmcnt(10)
    v_mfma_f32_16x16x32_bf16 v[64:67], a[208:211], a[40:43], v[64:67]
    v_mfma_f32_16x16x32_bf16 v[68:71], a[208:211], a[96:99], v[68:71]
    v_mfma_f32_16x16x32_bf16 v[72:75], a[208:211], a[152:155], v[72:75]
    ds_read_b64_tr_b16 a[232:233], v63 offset:0
    ds_read_b64_tr_b16 a[234:235], v63 offset:2048
    s_waitcnt lgkmcnt(10)
    v_mfma_f32_16x16x32_bf16 v[76:79], a[212:215], a[40:43], v[76:79]
    v_mfma_f32_16x16x32_bf16 v[80:83], a[212:215], a[96:99], v[80:83]
    v_mfma_f32_16x16x32_bf16 v[84:87], a[212:215], a[152:155], v[84:87]
    ds_read_b64_tr_b16 a[236:237], v63 offset:8
    ds_read_b64_tr_b16 a[238:239], v63 offset:2056
    s_waitcnt lgkmcnt(10)
    v_mfma_f32_16x16x32_bf16 v[88:91], a[216:219], a[40:43], v[88:91]
    v_mfma_f32_16x16x32_bf16 v[92:95], a[216:219], a[96:99], v[92:95]
    v_mfma_f32_16x16x32_bf16 v[96:99], a[216:219], a[152:155], v[96:99]
    ds_read_b64_tr_b16 a[192:193], v60 offset:256
    ds_read_b64_tr_b16 a[194:195], v60 offset:2304
    s_waitcnt lgkmcnt(10)
    v_mfma_f32_16x16x32_bf16 v[100:103], a[220:223], a[40:43], v[100:103]
    v_mfma_f32_16x16x32_bf16 v[104:107], a[220:223], a[96:99], v[104:107]
    v_mfma_f32_16x16x32_bf16 v[108:111], a[220:223], a[152:155], v[108:111]
    ds_read_b64_tr_b16 a[196:197], v60 offset:264
    ds_read_b64_tr_b16 a[198:199], v60 offset:2312
    s_waitcnt lgkmcnt(10)
    v_mfma_f32_16x16x32_bf16 v[112:115], a[224:227], a[40:43], v[112:115]
    v_mfma_f32_16x16x32_bf16 v[116:119], a[224:227], a[96:99], v[116:119]
    v_mfma_f32_16x16x32_bf16 v[120:123], a[224:227], a[152:155], v[120:123]
    ds_read_b64_tr_b16 a[200:201], v61 offset:256
    ds_read_b64_tr_b16 a[202:203], v61 offset:2304
    s_waitcnt lgkmcnt(10)
    v_mfma_f32_16x16x32_bf16 v[124:127], a[228:231], a[40:43], v[124:127]
    v_mfma_f32_16x16x32_bf16 v[128:131], a[228:231], a[96:99], v[128:131]
    v_mfma_f32_16x16x32_bf16 v[132:135], a[228:231], a[152:155], v[132:135]
    ds_read_b64_tr_b16 a[204:205], v61 offset:264
    ds_read_b64_tr_b16 a[206:207], v61 offset:2312
    s_waitcnt lgkmcnt(10)
    v_mfma_f32_16x16x32_bf16 v[136:139], a[232:235], a[40:43], v[136:139]
    v_mfma_f32_16x16x32_bf16 v[140:143], a[232:235], a[96:99], v[140:143]
    v_mfma_f32_16x16x32_bf16 v[144:147], a[232:235], a[152:155], v[144:147]
    ds_read_b64_tr_b16 a[208:209], v62 offset:256
    ds_read_b64_tr_b16 a[210:211], v62 offset:2304
    s_waitcnt lgkmcnt(10)
    v_mfma_f32_16x16x32_bf16 v[148:151], a[236:239], a[40:43], v[148:151]
    v_mfma_f32_16x16x32_bf16 v[152:155], a[236:239], a[96:99], v[152:155]
    v_mfma_f32_16x16x32_bf16 v[156:159], a[236:239], a[152:155], v[156:159]
    ds_read_b64_tr_b16 a[212:213], v62 offset:264
    ds_read_b64_tr_b16 a[214:215], v62 offset:2312
    s_waitcnt lgkmcnt(10)
    v_mfma_f32_16x16x32_bf16 v[160:163], a[192:195], a[40:43], v[160:163]
    v_mfma_f32_16x16x32_bf16 v[164:167], a[192:195], a[96:99], v[164:167]
    v_mfma_f32_16x16x32_bf16 v[168:171], a[192:195], a[152:155], v[168:171]
    ds_read_b64_tr_b16 a[216:217], v63 offset:256
    ds_read_b64_tr_b16 a[218:219], v63 offset:2304
    s_waitcnt lgkmcnt(10)
    v_mfma_f32_16x16x32_bf16 v[172:175], a[196:199], a[40:43], v[172:175]
    v_mfma_f32_16x16x32_bf16 v[176:179], a[196:199], a[96:99], v[176:179]
    v_mfma_f32_16x16x32_bf16 v[180:183], a[196:199], a[152:155], v[180:183]
    ds_read_b64_tr_b16 a[220:221], v63 offset:264
    ds_read_b64_tr_b16 a[222:223], v63 offset:2312
    s_waitcnt lgkmcnt(10)
    v_mfma_f32_16x16x32_bf16 v[184:187], a[200:203], a[40:43], v[184:187]
    v_mfma_f32_16x16x32_bf16 v[188:191], a[200:203], a[96:99], v[188:191]
    v_mfma_f32_16x16x32_bf16 v[192:195], a[200:203], a[152:155], v[192:195]
    s_barrier
    v_add_u32 v60, 49152, v4
    v_add_u32 v61, 49152, v5
    v_add_u32 v62, 49152, v6
    v_add_u32 v63, 49152, v7
    ds_read_b64_tr_b16 a[224:225], v60 offset:0
    ds_read_b64_tr_b16 a[226:227], v60 offset:2048
    s_waitcnt lgkmcnt(10)
    v_mfma_f32_16x16x32_bf16 v[196:199], a[204:207], a[40:43], v[196:199]
    v_mfma_f32_16x16x32_bf16 v[200:203], a[204:207], a[96:99], v[200:203]
    v_mfma_f32_16x16x32_bf16 v[204:207], a[204:207], a[152:155], v[204:207]
    ds_read_b64_tr_b16 a[228:229], v60 offset:8
    ds_read_b64_tr_b16 a[230:231], v60 offset:2056
    s_waitcnt lgkmcnt(10)
    v_mfma_f32_16x16x32_bf16 v[208:211], a[208:211], a[40:43], v[208:211]
    v_mfma_f32_16x16x32_bf16 v[212:215], a[208:211], a[96:99], v[212:215]
    v_mfma_f32_16x16x32_bf16 v[216:219], a[208:211], a[152:155], v[216:219]
    ds_read_b64_tr_b16 a[232:233], v61 offset:0
    ds_read_b64_tr_b16 a[234:235], v61 offset:2048
    s_waitcnt lgkmcnt(10)
    v_mfma_f32_16x16x32_bf16 v[220:223], a[212:215], a[40:43], v[220:223]
    v_mfma_f32_16x16x32_bf16 v[224:227], a[212:215], a[96:99], v[224:227]
    v_mfma_f32_16x16x32_bf16 v[228:231], a[212:215], a[152:155], v[228:231]
    ds_read_b64_tr_b16 a[236:237], v61 offset:8
    ds_read_b64_tr_b16 a[238:239], v61 offset:2056
    s_waitcnt lgkmcnt(10)
    v_mfma_f32_16x16x32_bf16 v[232:235], a[216:219], a[40:43], v[232:235]
    v_mfma_f32_16x16x32_bf16 v[236:239], a[216:219], a[96:99], v[236:239]
    v_mfma_f32_16x16x32_bf16 v[240:243], a[216:219], a[152:155], v[240:243]
    ds_read_b64_tr_b16 a[192:193], v62 offset:0
    ds_read_b64_tr_b16 a[194:195], v62 offset:2048
    s_waitcnt lgkmcnt(10)
    v_mfma_f32_16x16x32_bf16 v[244:247], a[220:223], a[40:43], v[244:247]
    v_mfma_f32_16x16x32_bf16 v[248:251], a[220:223], a[96:99], v[248:251]
    v_mfma_f32_16x16x32_bf16 v[252:255], a[220:223], a[152:155], v[252:255]
    s_waitcnt vmcnt(6)
    ds_read_b64_tr_b16 a[196:197], v62 offset:8
    ds_read_b64_tr_b16 a[198:199], v62 offset:2056
    s_waitcnt lgkmcnt(10)
    v_mfma_f32_16x16x32_bf16 v[64:67], a[224:227], a[44:47], v[64:67]
    v_mfma_f32_16x16x32_bf16 v[68:71], a[224:227], a[100:103], v[68:71]
    v_mfma_f32_16x16x32_bf16 v[72:75], a[224:227], a[156:159], v[72:75]
    ds_read_b64_tr_b16 a[200:201], v63 offset:0
    ds_read_b64_tr_b16 a[202:203], v63 offset:2048
    s_waitcnt lgkmcnt(10)
    v_mfma_f32_16x16x32_bf16 v[76:79], a[228:231], a[44:47], v[76:79]
    v_mfma_f32_16x16x32_bf16 v[80:83], a[228:231], a[100:103], v[80:83]
    v_mfma_f32_16x16x32_bf16 v[84:87], a[228:231], a[156:159], v[84:87]
    ds_read_b64_tr_b16 a[204:205], v63 offset:8
    ds_read_b64_tr_b16 a[206:207], v63 offset:2056
    s_waitcnt lgkmcnt(10)
    v_mfma_f32_16x16x32_bf16 v[88:91], a[232:235], a[44:47], v[88:91]
    v_mfma_f32_16x16x32_bf16 v[92:95], a[232:235], a[100:103], v[92:95]
    v_mfma_f32_16x16x32_bf16 v[96:99], a[232:235], a[156:159], v[96:99]
    ds_read_b64_tr_b16 a[208:209], v60 offset:256
    ds_read_b64_tr_b16 a[210:211], v60 offset:2304
    s_waitcnt lgkmcnt(10)
    v_mfma_f32_16x16x32_bf16 v[100:103], a[236:239], a[44:47], v[100:103]
    v_mfma_f32_16x16x32_bf16 v[104:107], a[236:239], a[100:103], v[104:107]
    v_mfma_f32_16x16x32_bf16 v[108:111], a[236:239], a[156:159], v[108:111]
    ds_read_b64_tr_b16 a[212:213], v60 offset:264
    ds_read_b64_tr_b16 a[214:215], v60 offset:2312
    s_waitcnt lgkmcnt(10)
    v_mfma_f32_16x16x32_bf16 v[112:115], a[192:195], a[44:47], v[112:115]
    v_mfma_f32_16x16x32_bf16 v[116:119], a[192:195], a[100:103], v[116:119]
    v_mfma_f32_16x16x32_bf16 v[120:123], a[192:195], a[156:159], v[120:123]
    ds_read_b64_tr_b16 a[216:217], v61 offset:256
    ds_read_b64_tr_b16 a[218:219], v61 offset:2304
    s_waitcnt lgkmcnt(10)
    v_mfma_f32_16x16x32_bf16 v[124:127], a[196:199], a[44:47], v[124:127]
    v_mfma_f32_16x16x32_bf16 v[128:131], a[196:199], a[100:103], v[128:131]
    v_mfma_f32_16x16x32_bf16 v[132:135], a[196:199], a[156:159], v[132:135]
    ds_read_b64_tr_b16 a[220:221], v61 offset:264
    ds_read_b64_tr_b16 a[222:223], v61 offset:2312
    s_waitcnt lgkmcnt(10)
    v_mfma_f32_16x16x32_bf16 v[136:139], a[200:203], a[44:47], v[136:139]
    v_mfma_f32_16x16x32_bf16 v[140:143], a[200:203], a[100:103], v[140:143]
    v_mfma_f32_16x16x32_bf16 v[144:147], a[200:203], a[156:159], v[144:147]
    ds_read_b64_tr_b16 a[224:225], v62 offset:256
    ds_read_b64_tr_b16 a[226:227], v62 offset:2304
    s_waitcnt lgkmcnt(10)
    v_mfma_f32_16x16x32_bf16 v[148:151], a[204:207], a[44:47], v[148:151]
    v_mfma_f32_16x16x32_bf16 v[152:155], a[204:207], a[100:103], v[152:155]
    v_mfma_f32_16x16x32_bf16 v[156:159], a[204:207], a[156:159], v[156:159]
    ds_read_b64_tr_b16 a[228:229], v62 offset:264
    ds_read_b64_tr_b16 a[230:231], v62 offset:2312
    s_waitcnt lgkmcnt(10)
    v_mfma_f32_16x16x32_bf16 v[160:163], a[208:211], a[44:47], v[160:163]
    v_mfma_f32_16x16x32_bf16 v[164:167], a[208:211], a[100:103], v[164:167]
    v_mfma_f32_16x16x32_bf16 v[168:171], a[208:211], a[156:159], v[168:171]
    ds_read_b64_tr_b16 a[232:233], v63 offset:256
    ds_read_b64_tr_b16 a[234:235], v63 offset:2304
    s_waitcnt lgkmcnt(10)
    v_mfma_f32_16x16x32_bf16 v[172:175], a[212:215], a[44:47], v[172:175]
    v_mfma_f32_16x16x32_bf16 v[176:179], a[212:215], a[100:103], v[176:179]
    v_mfma_f32_16x16x32_bf16 v[180:183], a[212:215], a[156:159], v[180:183]
    ds_read_b64_tr_b16 a[236:237], v63 offset:264
    ds_read_b64_tr_b16 a[238:239], v63 offset:2312
    s_waitcnt lgkmcnt(10)
    v_mfma_f32_16x16x32_bf16 v[184:187], a[216:219], a[44:47], v[184:187]
    v_mfma_f32_16x16x32_bf16 v[188:191], a[216:219], a[100:103], v[188:191]
    v_mfma_f32_16x16x32_bf16 v[192:195], a[216:219], a[156:159], v[192:195]
    s_barrier
    v_add_u32 v60, 0, v4
    v_add_u32 v61, 0, v5
    v_add_u32 v62, 0, v6
    v_add_u32 v63, 0, v7
    ds_read_b64_tr_b16 a[192:193], v60 offset:0
    ds_read_b64_tr_b16 a[194:195], v60 offset:2048
    s_waitcnt lgkmcnt(10)
    v_mfma_f32_16x16x32_bf16 v[196:199], a[220:223], a[44:47], v[196:199]
    v_mfma_f32_16x16x32_bf16 v[200:203], a[220:223], a[100:103], v[200:203]
    v_mfma_f32_16x16x32_bf16 v[204:207], a[220:223], a[156:159], v[204:207]
    ds_read_b64_tr_b16 a[196:197], v60 offset:8
    ds_read_b64_tr_b16 a[198:199], v60 offset:2056
    s_waitcnt lgkmcnt(10)
    v_mfma_f32_16x16x32_bf16 v[208:211], a[224:227], a[44:47], v[208:211]
    v_mfma_f32_16x16x32_bf16 v[212:215], a[224:227], a[100:103], v[212:215]
    v_mfma_f32_16x16x32_bf16 v[216:219], a[224:227], a[156:159], v[216:219]
    ds_read_b64_tr_b16 a[200:201], v61 offset:0
    ds_read_b64_tr_b16 a[202:203], v61 offset:2048
    s_waitcnt lgkmcnt(10)
    v_mfma_f32_16x16x32_bf16 v[220:223], a[228:231], a[44:47], v[220:223]
    v_mfma_f32_16x16x32_bf16 v[224:227], a[228:231], a[100:103], v[224:227]
    v_mfma_f32_16x16x32_bf16 v[228:231], a[228:231], a[156:159], v[228:231]
    ds_read_b64_tr_b16 a[204:205], v61 offset:8
    ds_read_b64_tr_b16 a[206:207], v61 offset:2056
    s_waitcnt lgkmcnt(10)
    v_mfma_f32_16x16x32_bf16 v[232:235], a[232:235], a[44:47], v[232:235]
    v_mfma_f32_16x16x32_bf16 v[236:239], a[232:235], a[100:103], v[236:239]
    v_mfma_f32_16x16x32_bf16 v[240:243], a[232:235], a[156:159], v[240:243]
    ds_read_b64_tr_b16 a[208:209], v62 offset:0
    ds_read_b64_tr_b16 a[210:211], v62 offset:2048
    s_waitcnt lgkmcnt(10)
    v_mfma_f32_16x16x32_bf16 v[244:247], a[236:239], a[44:47], v[244:247]
    v_mfma_f32_16x16x32_bf16 v[248:251], a[236:239], a[100:103], v[248:251]
    v_mfma_f32_16x16x32_bf16 v[252:255], a[236:239], a[156:159], v[252:255]
    s_waitcnt vmcnt(3)
    ds_read_b64_tr_b16 a[212:213], v62 offset:8
    ds_read_b64_tr_b16 a[214:215], v62 offset:2056
    s_waitcnt lgkmcnt(10)
    v_mfma_f32_16x16x32_bf16 v[64:67], a[192:195], a[48:51], v[64:67]
    v_mfma_f32_16x16x32_bf16 v[68:71], a[192:195], a[104:107], v[68:71]
    v_mfma_f32_16x16x32_bf16 v[72:75], a[192:195], a[160:163], v[72:75]
    ds_read_b64_tr_b16 a[216:217], v63 offset:0
    ds_read_b64_tr_b16 a[218:219], v63 offset:2048
    s_waitcnt lgkmcnt(10)
    v_mfma_f32_16x16x32_bf16 v[76:79], a[196:199], a[48:51], v[76:79]
    v_mfma_f32_16x16x32_bf16 v[80:83], a[196:199], a[104:107], v[80:83]
    v_mfma_f32_16x16x32_bf16 v[84:87], a[196:199], a[160:163], v[84:87]
    ds_read_b64_tr_b16 a[220:221], v63 offset:8
    ds_read_b64_tr_b16 a[222:223], v63 offset:2056
    s_waitcnt lgkmcnt(10)
    v_mfma_f32_16x16x32_bf16 v[88:91], a[200:203], a[48:51], v[88:91]
    v_mfma_f32_16x16x32_bf16 v[92:95], a[200:203], a[104:107], v[92:95]
    v_mfma_f32_16x16x32_bf16 v[96:99], a[200:203], a[160:163], v[96:99]
    ds_read_b64_tr_b16 a[224:225], v60 offset:256
    ds_read_b64_tr_b16 a[226:227], v60 offset:2304
    s_waitcnt lgkmcnt(10)
    v_mfma_f32_16x16x32_bf16 v[100:103], a[204:207], a[48:51], v[100:103]
    v_mfma_f32_16x16x32_bf16 v[104:107], a[204:207], a[104:107], v[104:107]
    v_mfma_f32_16x16x32_bf16 v[108:111], a[204:207], a[160:163], v[108:111]
    ds_read_b64_tr_b16 a[228:229], v60 offset:264
    ds_read_b64_tr_b16 a[230:231], v60 offset:2312
    s_waitcnt lgkmcnt(10)
    v_mfma_f32_16x16x32_bf16 v[112:115], a[208:211], a[48:51], v[112:115]
    v_mfma_f32_16x16x32_bf16 v[116:119], a[208:211], a[104:107], v[116:119]
    v_mfma_f32_16x16x32_bf16 v[120:123], a[208:211], a[160:163], v[120:123]
    ds_read_b64_tr_b16 a[232:233], v61 offset:256
    ds_read_b64_tr_b16 a[234:235], v61 offset:2304
    s_waitcnt lgkmcnt(10)
    v_mfma_f32_16x16x32_bf16 v[124:127], a[212:215], a[48:51], v[124:127]
    v_mfma_f32_16x16x32_bf16 v[128:131], a[212:215], a[104:107], v[128:131]
    v_mfma_f32_16x16x32_bf16 v[132:135], a[212:215], a[160:163], v[132:135]
    ds_read_b64_tr_b16 a[236:237], v61 offset:264
    ds_read_b64_tr_b16 a[238:239], v61 offset:2312
    s_waitcnt lgkmcnt(10)
    v_mfma_f32_16x16x32_bf16 v[136:139], a[216:219], a[48:51], v[136:139]
    v_mfma_f32_16x16x32_bf16 v[140:143], a[216:219], a[104:107], v[140:143]
    v_mfma_f32_16x16x32_bf16 v[144:147], a[216:219], a[160:163], v[144:147]
    ds_read_b64_tr_b16 a[192:193], v62 offset:256
    ds_read_b64_tr_b16 a[194:195], v62 offset:2304
    s_waitcnt lgkmcnt(10)
    v_mfma_f32_16x16x32_bf16 v[148:151], a[220:223], a[48:51], v[148:151]
    v_mfma_f32_16x16x32_bf16 v[152:155], a[220:223], a[104:107], v[152:155]
    v_mfma_f32_16x16x32_bf16 v[156:159], a[220:223], a[160:163], v[156:159]
    ds_read_b64_tr_b16 a[196:197], v62 offset:264
    ds_read_b64_tr_b16 a[198:199], v62 offset:2312
    s_waitcnt lgkmcnt(10)
    v_mfma_f32_16x16x32_bf16 v[160:163], a[224:227], a[48:51], v[160:163]
    v_mfma_f32_16x16x32_bf16 v[164:167], a[224:227], a[104:107], v[164:167]
    v_mfma_f32_16x16x32_bf16 v[168:171], a[224:227], a[160:163], v[168:171]
    ds_read_b64_tr_b16 a[200:201], v63 offset:256
    ds_read_b64_tr_b16 a[202:203], v63 offset:2304
    s_waitcnt lgkmcnt(10)
    v_mfma_f32_16x16x32_bf16 v[172:175], a[228:231], a[48:51], v[172:175]
    v_mfma_f32_16x16x32_bf16 v[176:179], a[228:231], a[104:107], v[176:179]
    v_mfma_f32_16x16x32_bf16 v[180:183], a[228:231], a[160:163], v[180:183]
    ds_read_b64_tr_b16 a[204:205], v63 offset:264
    ds_read_b64_tr_b16 a[206:207], v63 offset:2312
    s_waitcnt lgkmcnt(10)
    v_mfma_f32_16x16x32_bf16 v[184:187], a[232:235], a[48:51], v[184:187]
    v_mfma_f32_16x16x32_bf16 v[188:191], a[232:235], a[104:107], v[188:191]
    v_mfma_f32_16x16x32_bf16 v[192:195], a[232:235], a[160:163], v[192:195]
    s_barrier
    v_add_u32 v60, 16384, v4
    v_add_u32 v61, 16384, v5
    v_add_u32 v62, 16384, v6
    v_add_u32 v63, 16384, v7
    ds_read_b64_tr_b16 a[208:209], v60 offset:0
    ds_read_b64_tr_b16 a[210:211], v60 offset:2048
    s_waitcnt lgkmcnt(10)
    v_mfma_f32_16x16x32_bf16 v[196:199], a[236:239], a[48:51], v[196:199]
    v_mfma_f32_16x16x32_bf16 v[200:203], a[236:239], a[104:107], v[200:203]
    v_mfma_f32_16x16x32_bf16 v[204:207], a[236:239], a[160:163], v[204:207]
    ds_read_b64_tr_b16 a[212:213], v60 offset:8
    ds_read_b64_tr_b16 a[214:215], v60 offset:2056
    s_waitcnt lgkmcnt(10)
    v_mfma_f32_16x16x32_bf16 v[208:211], a[192:195], a[48:51], v[208:211]
    v_mfma_f32_16x16x32_bf16 v[212:215], a[192:195], a[104:107], v[212:215]
    v_mfma_f32_16x16x32_bf16 v[216:219], a[192:195], a[160:163], v[216:219]
    ds_read_b64_tr_b16 a[216:217], v61 offset:0
    ds_read_b64_tr_b16 a[218:219], v61 offset:2048
    s_waitcnt lgkmcnt(10)
    v_mfma_f32_16x16x32_bf16 v[220:223], a[196:199], a[48:51], v[220:223]
    v_mfma_f32_16x16x32_bf16 v[224:227], a[196:199], a[104:107], v[224:227]
    v_mfma_f32_16x16x32_bf16 v[228:231], a[196:199], a[160:163], v[228:231]
    ds_read_b64_tr_b16 a[220:221], v61 offset:8
    ds_read_b64_tr_b16 a[222:223], v61 offset:2056
    s_waitcnt lgkmcnt(10)
    v_mfma_f32_16x16x32_bf16 v[232:235], a[200:203], a[48:51], v[232:235]
    v_mfma_f32_16x16x32_bf16 v[236:239], a[200:203], a[104:107], v[236:239]
    v_mfma_f32_16x16x32_bf16 v[240:243], a[200:203], a[160:163], v[240:243]
    ds_read_b64_tr_b16 a[224:225], v62 offset:0
    ds_read_b64_tr_b16 a[226:227], v62 offset:2048
    s_waitcnt lgkmcnt(10)
    v_mfma_f32_16x16x32_bf16 v[244:247], a[204:207], a[48:51], v[244:247]
    v_mfma_f32_16x16x32_bf16 v[248:251], a[204:207], a[104:107], v[248:251]
    v_mfma_f32_16x16x32_bf16 v[252:255], a[204:207], a[160:163], v[252:255]
    s_waitcnt vmcnt(0)
    ds_read_b64_tr_b16 a[228:229], v62 offset:8
    ds_read_b64_tr_b16 a[230:231], v62 offset:2056
    s_waitcnt lgkmcnt(10)
    v_mfma_f32_16x16x32_bf16 v[64:67], a[208:211], a[52:55], v[64:67]
    v_mfma_f32_16x16x32_bf16 v[68:71], a[208:211], a[108:111], v[68:71]
    v_mfma_f32_16x16x32_bf16 v[72:75], a[208:211], a[164:167], v[72:75]
    ds_read_b64_tr_b16 a[232:233], v63 offset:0
    ds_read_b64_tr_b16 a[234:235], v63 offset:2048
    s_waitcnt lgkmcnt(10)
    v_mfma_f32_16x16x32_bf16 v[76:79], a[212:215], a[52:55], v[76:79]
    v_mfma_f32_16x16x32_bf16 v[80:83], a[212:215], a[108:111], v[80:83]
    v_mfma_f32_16x16x32_bf16 v[84:87], a[212:215], a[164:167], v[84:87]
    ds_read_b64_tr_b16 a[236:237], v63 offset:8
    ds_read_b64_tr_b16 a[238:239], v63 offset:2056
    s_waitcnt lgkmcnt(10)
    v_mfma_f32_16x16x32_bf16 v[88:91], a[216:219], a[52:55], v[88:91]
    v_mfma_f32_16x16x32_bf16 v[92:95], a[216:219], a[108:111], v[92:95]
    v_mfma_f32_16x16x32_bf16 v[96:99], a[216:219], a[164:167], v[96:99]
    ds_read_b64_tr_b16 a[192:193], v60 offset:256
    ds_read_b64_tr_b16 a[194:195], v60 offset:2304
    s_waitcnt lgkmcnt(10)
    v_mfma_f32_16x16x32_bf16 v[100:103], a[220:223], a[52:55], v[100:103]
    v_mfma_f32_16x16x32_bf16 v[104:107], a[220:223], a[108:111], v[104:107]
    v_mfma_f32_16x16x32_bf16 v[108:111], a[220:223], a[164:167], v[108:111]
    ds_read_b64_tr_b16 a[196:197], v60 offset:264
    ds_read_b64_tr_b16 a[198:199], v60 offset:2312
    s_waitcnt lgkmcnt(10)
    v_mfma_f32_16x16x32_bf16 v[112:115], a[224:227], a[52:55], v[112:115]
    v_mfma_f32_16x16x32_bf16 v[116:119], a[224:227], a[108:111], v[116:119]
    v_mfma_f32_16x16x32_bf16 v[120:123], a[224:227], a[164:167], v[120:123]
    ds_read_b64_tr_b16 a[200:201], v61 offset:256
    ds_read_b64_tr_b16 a[202:203], v61 offset:2304
    s_waitcnt lgkmcnt(10)
    v_mfma_f32_16x16x32_bf16 v[124:127], a[228:231], a[52:55], v[124:127]
    v_mfma_f32_16x16x32_bf16 v[128:131], a[228:231], a[108:111], v[128:131]
    v_mfma_f32_16x16x32_bf16 v[132:135], a[228:231], a[164:167], v[132:135]
    ds_read_b64_tr_b16 a[204:205], v61 offset:264
    ds_read_b64_tr_b16 a[206:207], v61 offset:2312
    s_waitcnt lgkmcnt(10)
    v_mfma_f32_16x16x32_bf16 v[136:139], a[232:235], a[52:55], v[136:139]
    v_mfma_f32_16x16x32_bf16 v[140:143], a[232:235], a[108:111], v[140:143]
    v_mfma_f32_16x16x32_bf16 v[144:147], a[232:235], a[164:167], v[144:147]
    ds_read_b64_tr_b16 a[208:209], v62 offset:256
    ds_read_b64_tr_b16 a[210:211], v62 offset:2304
    s_waitcnt lgkmcnt(10)
    v_mfma_f32_16x16x32_bf16 v[148:151], a[236:239], a[52:55], v[148:151]
    v_mfma_f32_16x16x32_bf16 v[152:155], a[236:239], a[108:111], v[152:155]
    v_mfma_f32_16x16x32_bf16 v[156:159], a[236:239], a[164:167], v[156:159]
    ds_read_b64_tr_b16 a[212:213], v62 offset:264
    ds_read_b64_tr_b16 a[214:215], v62 offset:2312
    s_waitcnt lgkmcnt(10)
    v_mfma_f32_16x16x32_bf16 v[160:163], a[192:195], a[52:55], v[160:163]
    v_mfma_f32_16x16x32_bf16 v[164:167], a[192:195], a[108:111], v[164:167]
    v_mfma_f32_16x16x32_bf16 v[168:171], a[192:195], a[164:167], v[168:171]
    ds_read_b64_tr_b16 a[216:217], v63 offset:256
    ds_read_b64_tr_b16 a[218:219], v63 offset:2304
    s_waitcnt lgkmcnt(10)
    v_mfma_f32_16x16x32_bf16 v[172:175], a[196:199], a[52:55], v[172:175]
    v_mfma_f32_16x16x32_bf16 v[176:179], a[196:199], a[108:111], v[176:179]
    v_mfma_f32_16x16x32_bf16 v[180:183], a[196:199], a[164:167], v[180:183]
    ds_read_b64_tr_b16 a[220:221], v63 offset:264
    ds_read_b64_tr_b16 a[222:223], v63 offset:2312
    s_waitcnt lgkmcnt(10)
    v_mfma_f32_16x16x32_bf16 v[184:187], a[200:203], a[52:55], v[184:187]
    v_mfma_f32_16x16x32_bf16 v[188:191], a[200:203], a[108:111], v[188:191]
    v_mfma_f32_16x16x32_bf16 v[192:195], a[200:203], a[164:167], v[192:195]
    s_barrier
    v_add_u32 v60, 65536, v8
    v_add_u32 v61, 65536, v9
    v_add_u32 v62, 65536, v10
    v_add_u32 v63, 65536, v11
    ds_read_b128 a[224:227], v60 offset:0
    s_waitcnt lgkmcnt(9)
    v_mfma_f32_16x16x32_bf16 v[196:199], a[204:207], a[52:55], v[196:199]
    v_mfma_f32_16x16x32_bf16 v[200:203], a[204:207], a[108:111], v[200:203]
    v_mfma_f32_16x16x32_bf16 v[204:207], a[204:207], a[164:167], v[204:207]
    ds_read_b128 a[228:231], v61 offset:0
    s_waitcnt lgkmcnt(8)
    v_mfma_f32_16x16x32_bf16 v[208:211], a[208:211], a[52:55], v[208:211]
    v_mfma_f32_16x16x32_bf16 v[212:215], a[208:211], a[108:111], v[212:215]
    v_mfma_f32_16x16x32_bf16 v[216:219], a[208:211], a[164:167], v[216:219]
    ds_read_b128 a[232:235], v62 offset:0
    s_waitcnt lgkmcnt(7)
    v_mfma_f32_16x16x32_bf16 v[220:223], a[212:215], a[52:55], v[220:223]
    v_mfma_f32_16x16x32_bf16 v[224:227], a[212:215], a[108:111], v[224:227]
    v_mfma_f32_16x16x32_bf16 v[228:231], a[212:215], a[164:167], v[228:231]
    ds_read_b128 a[236:239], v63 offset:0
    s_waitcnt lgkmcnt(6)
    v_mfma_f32_16x16x32_bf16 v[232:235], a[216:219], a[52:55], v[232:235]
    v_mfma_f32_16x16x32_bf16 v[236:239], a[216:219], a[108:111], v[236:239]
    v_mfma_f32_16x16x32_bf16 v[240:243], a[216:219], a[164:167], v[240:243]
    ds_read_b128 a[192:195], v60 offset:256
    s_waitcnt lgkmcnt(5)
    v_mfma_f32_16x16x32_bf16 v[244:247], a[220:223], a[52:55], v[244:247]
    v_mfma_f32_16x16x32_bf16 v[248:251], a[220:223], a[108:111], v[248:251]
    v_mfma_f32_16x16x32_bf16 v[252:255], a[220:223], a[164:167], v[252:255]
    s_nop 7
    s_nop 1
    v_cvt_pk_bf16_f32 v16, v64, v65
    v_cvt_pk_bf16_f32 v17, v66, v67
    v_cvt_pk_bf16_f32 v18, v76, v77
    v_cvt_pk_bf16_f32 v19, v78, v79
    v_accvgpr_write_b32 a0, v16
    v_accvgpr_write_b32 a1, v17
    v_accvgpr_write_b32 a2, v18
    v_accvgpr_write_b32 a3, v19
    v_cvt_pk_bf16_f32 v16, v68, v69
    v_cvt_pk_bf16_f32 v17, v70, v71
    v_cvt_pk_bf16_f32 v18, v80, v81
    v_cvt_pk_bf16_f32 v19, v82, v83
    v_accvgpr_write_b32 a32, v16
    v_accvgpr_write_b32 a33, v17
    v_accvgpr_write_b32 a34, v18
    v_accvgpr_write_b32 a35, v19
    v_cvt_pk_bf16_f32 v16, v72, v73
    v_cvt_pk_bf16_f32 v17, v74, v75
    v_cvt_pk_bf16_f32 v18, v84, v85
    v_cvt_pk_bf16_f32 v19, v86, v87
    v_accvgpr_write_b32 a64, v16
    v_accvgpr_write_b32 a65, v17
    v_accvgpr_write_b32 a66, v18
    v_accvgpr_write_b32 a67, v19
    v_cvt_pk_bf16_f32 v16, v88, v89
    v_cvt_pk_bf16_f32 v17, v90, v91
    v_cvt_pk_bf16_f32 v18, v100, v101
    v_cvt_pk_bf16_f32 v19, v102, v103
    v_accvgpr_write_b32 a4, v16
    v_accvgpr_write_b32 a5, v17
    v_accvgpr_write_b32 a6, v18
    v_accvgpr_write_b32 a7, v19
    v_cvt_pk_bf16_f32 v16, v92, v93
    v_cvt_pk_bf16_f32 v17, v94, v95
    v_cvt_pk_bf16_f32 v18, v104, v105
    v_cvt_pk_bf16_f32 v19, v106, v107
    v_accvgpr_write_b32 a36, v16
    v_accvgpr_write_b32 a37, v17
    v_accvgpr_write_b32 a38, v18
    v_accvgpr_write_b32 a39, v19
    v_cvt_pk_bf16_f32 v16, v96, v97
    v_cvt_pk_bf16_f32 v17, v98, v99
    v_cvt_pk_bf16_f32 v18, v108, v109
    v_cvt_pk_bf16_f32 v19, v110, v111
    v_accvgpr_write_b32 a68, v16
    v_accvgpr_write_b32 a69, v17
    v_accvgpr_write_b32 a70, v18
    v_accvgpr_write_b32 a71, v19
    v_cvt_pk_bf16_f32 v16, v112, v113
    v_cvt_pk_bf16_f32 v17, v114, v115
    v_cvt_pk_bf16_f32 v18, v124, v125
    v_cvt_pk_bf16_f32 v19, v126, v127
    v_accvgpr_write_b32 a8, v16
    v_accvgpr_write_b32 a9, v17
    v_accvgpr_write_b32 a10, v18
    v_accvgpr_write_b32 a11, v19
    v_cvt_pk_bf16_f32 v16, v116, v117
    v_cvt_pk_bf16_f32 v17, v118, v119
    v_cvt_pk_bf16_f32 v18, v128, v129
    v_cvt_pk_bf16_f32 v19, v130, v131
    v_accvgpr_write_b32 a40, v16
    v_accvgpr_write_b32 a41, v17
    v_accvgpr_write_b32 a42, v18
    v_accvgpr_write_b32 a43, v19
    v_cvt_pk_bf16_f32 v16, v120, v121
    v_cvt_pk_bf16_f32 v17, v122, v123
    v_cvt_pk_bf16_f32 v18, v132, v133
    v_cvt_pk_bf16_f32 v19, v134, v135
    v_accvgpr_write_b32 a72, v16
    v_accvgpr_write_b32 a73, v17
    v_accvgpr_write_b32 a74, v18
    v_accvgpr_write_b32 a75, v19
    v_cvt_pk_bf16_f32 v16, v136, v137
    v_cvt_pk_bf16_f32 v17, v138, v139
    v_cvt_pk_bf16_f32 v18, v148, v149
    v_cvt_pk_bf16_f32 v19, v150, v151
    v_accvgpr_write_b32 a12, v16
    v_accvgpr_write_b32 a13, v17
    v_accvgpr_write_b32 a14, v18
    v_accvgpr_write_b32 a15, v19
    v_cvt_pk_bf16_f32 v16, v140, v141
    v_cvt_pk_bf16_f32 v17, v142, v143
    v_cvt_pk_bf16_f32 v18, v152, v153
    v_cvt_pk_bf16_f32 v19, v154, v155
    v_accvgpr_write_b32 a44, v16
    v_accvgpr_write_b32 a45, v17
    v_accvgpr_write_b32 a46, v18
    v_accvgpr_write_b32 a47, v19
    v_cvt_pk_bf16_f32 v16, v144, v145
    v_cvt_pk_bf16_f32 v17, v146, v147
    v_cvt_pk_bf16_f32 v18, v156, v157
    v_cvt_pk_bf16_f32 v19, v158, v159
    v_accvgpr_write_b32 a76, v16
    v_accvgpr_write_b32 a77, v17
    v_accvgpr_write_b32 a78, v18
    v_accvgpr_write_b32 a79, v19
    v_cvt_pk_bf16_f32 v16, v160, v161
    v_cvt_pk_bf16_f32 v17, v162, v163
    v_cvt_pk_bf16_f32 v18, v172, v173
    v_cvt_pk_bf16_f32 v19, v174, v175
    v_accvgpr_write_b32 a16, v16
    v_accvgpr_write_b32 a17, v17
    v_accvgpr_write_b32 a18, v18
    v_accvgpr_write_b32 a19, v19
    v_cvt_pk_bf16_f32 v16, v164, v165
    v_cvt_pk_bf16_f32 v17, v166, v167
    v_cvt_pk_bf16_f32 v18, v176, v177
    v_cvt_pk_bf16_f32 v19, v178, v179
    v_accvgpr_write_b32 a48, v16
    v_accvgpr_write_b32 a49, v17
    v_accvgpr_write_b32 a50, v18
    v_accvgpr_write_b32 a51, v19
    v_cvt_pk_bf16_f32 v16, v168, v169
    v_cvt_pk_bf16_f32 v17, v170, v171
    v_cvt_pk_bf16_f32 v18, v180, v181
    v_cvt_pk_bf16_f32 v19, v182, v183
    v_accvgpr_write_b32 a80, v16
    v_accvgpr_write_b32 a81, v17
    v_accvgpr_write_b32 a82, v18
    v_accvgpr_write_b32 a83, v19
    v_cvt_pk_bf16_f32 v16, v184, v185
    v_cvt_pk_bf16_f32 v17, v186, v187
    v_cvt_pk_bf16_f32 v18, v196, v197
    v_cvt_pk_bf16_f32 v19, v198, v199
    v_accvgpr_write_b32 a20, v16
    v_accvgpr_write_b32 a21, v17
    v_accvgpr_write_b32 a22, v18
    v_accvgpr_write_b32 a23, v19
    v_cvt_pk_bf16_f32 v16, v188, v189
    v_cvt_pk_bf16_f32 v17, v190, v191
    v_cvt_pk_bf16_f32 v18, v200, v201
    v_cvt_pk_bf16_f32 v19, v202, v203
    v_accvgpr_write_b32 a52, v16
    v_accvgpr_write_b32 a53, v17
    v_accvgpr_write_b32 a54, v18
    v_accvgpr_write_b32 a55, v19
    v_cvt_pk_bf16_f32 v16, v192, v193
    v_cvt_pk_bf16_f32 v17, v194, v195
    v_cvt_pk_bf16_f32 v18, v204, v205
    v_cvt_pk_bf16_f32 v19, v206, v207
    v_accvgpr_write_b32 a84, v16
    v_accvgpr_write_b32 a85, v17
    v_accvgpr_write_b32 a86, v18
    v_accvgpr_write_b32 a87, v19
    v_cvt_pk_bf16_f32 v16, v208, v209
    v_cvt_pk_bf16_f32 v17, v210, v211
    v_cvt_pk_bf16_f32 v18, v220, v221
    v_cvt_pk_bf16_f32 v19, v222, v223
    v_accvgpr_write_b32 a24, v16
    v_accvgpr_write_b32 a25, v17
    v_accvgpr_write_b32 a26, v18
    v_accvgpr_write_b32 a27, v19
    v_cvt_pk_bf16_f32 v16, v212, v213
    v_cvt_pk_bf16_f32 v17, v214, v215
    v_cvt_pk_bf16_f32 v18, v224, v225
    v_cvt_pk_bf16_f32 v19, v226, v227
    v_accvgpr_write_b32 a56, v16
    v_accvgpr_write_b32 a57, v17
    v_accvgpr_write_b32 a58, v18
    v_accvgpr_write_b32 a59, v19
    v_cvt_pk_bf16_f32 v16, v216, v217
    v_cvt_pk_bf16_f32 v17, v218, v219
    v_cvt_pk_bf16_f32 v18, v228, v229
    v_cvt_pk_bf16_f32 v19, v230, v231
    v_accvgpr_write_b32 a88, v16
    v_accvgpr_write_b32 a89, v17
    v_accvgpr_write_b32 a90, v18
    v_accvgpr_write_b32 a91, v19
    v_cvt_pk_bf16_f32 v16, v232, v233
    v_cvt_pk_bf16_f32 v17, v234, v235
    v_cvt_pk_bf16_f32 v18, v244, v245
    v_cvt_pk_bf16_f32 v19, v246, v247
    v_accvgpr_write_b32 a28, v16
    v_accvgpr_write_b32 a29, v17
    v_accvgpr_write_b32 a30, v18
    v_accvgpr_write_b32 a31, v19
    v_cvt_pk_bf16_f32 v16, v236, v237
    v_cvt_pk_bf16_f32 v17, v238, v239
    v_cvt_pk_bf16_f32 v18, v248, v249
    v_cvt_pk_bf16_f32 v19, v250, v251
    v_accvgpr_write_b32 a60, v16
    v_accvgpr_write_b32 a61, v17
    v_accvgpr_write_b32 a62, v18
    v_accvgpr_write_b32 a63, v19
    v_cvt_pk_bf16_f32 v16, v240, v241
    v_cvt_pk_bf16_f32 v17, v242, v243
    v_cvt_pk_bf16_f32 v18, v252, v253
    v_cvt_pk_bf16_f32 v19, v254, v255
    v_accvgpr_write_b32 a92, v16
    v_accvgpr_write_b32 a93, v17
    v_accvgpr_write_b32 a94, v18
    v_accvgpr_write_b32 a95, v19
    v_mov_b32 v52, 0xff800000
    v_mov_b32 v53, 0xff800000
    v_mov_b32 v54, 0xff800000
    ds_read_b128 a[196:199], v61 offset:256
    s_waitcnt lgkmcnt(5)
    v_mfma_f32_16x16x32_bf16 v[16:19], a[224:227], a[0:3], 0
    v_mfma_f32_16x16x32_bf16 v[20:23], a[224:227], a[32:35], 0
    v_mfma_f32_16x16x32_bf16 v[24:27], a[224:227], a[64:67], 0
    ds_read_b128 a[200:203], v62 offset:256
    s_waitcnt lgkmcnt(5)
    v_mfma_f32_16x16x32_bf16 v[16:19], a[228:231], a[4:7], v[16:19]
    v_mfma_f32_16x16x32_bf16 v[20:23], a[228:231], a[36:39], v[20:23]
    v_mfma_f32_16x16x32_bf16 v[24:27], a[228:231], a[68:71], v[24:27]
    ds_read_b128 a[204:207], v63 offset:256
    s_waitcnt lgkmcnt(5)
    v_mfma_f32_16x16x32_bf16 v[16:19], a[232:235], a[8:11], v[16:19]
    v_mfma_f32_16x16x32_bf16 v[20:23], a[232:235], a[40:43], v[20:23]
    v_mfma_f32_16x16x32_bf16 v[24:27], a[232:235], a[72:75], v[24:27]
    ds_read_b128 a[208:211], v60 offset:2048
    s_waitcnt lgkmcnt(5)
    v_mfma_f32_16x16x32_bf16 v[16:19], a[236:239], a[12:15], v[16:19]
    v_mfma_f32_16x16x32_bf16 v[20:23], a[236:239], a[44:47], v[20:23]
    v_mfma_f32_16x16x32_bf16 v[24:27], a[236:239], a[76:79], v[24:27]
    ds_read_b128 a[212:215], v61 offset:2048
    s_waitcnt lgkmcnt(5)
    v_mfma_f32_16x16x32_bf16 v[16:19], a[192:195], a[16:19], v[16:19]
    v_mfma_f32_16x16x32_bf16 v[20:23], a[192:195], a[48:51], v[20:23]
    v_mfma_f32_16x16x32_bf16 v[24:27], a[192:195], a[80:83], v[24:27]
    ds_read_b128 a[216:219], v62 offset:2048
    s_waitcnt lgkmcnt(5)
    v_mfma_f32_16x16x32_bf16 v[16:19], a[196:199], a[20:23], v[16:19]
    v_mfma_f32_16x16x32_bf16 v[20:23], a[196:199], a[52:55], v[20:23]
    v_mfma_f32_16x16x32_bf16 v[24:27], a[196:199], a[84:87], v[24:27]
    ds_read_b128 a[220:223], v63 offset:2048
    s_waitcnt lgkmcnt(5)
    v_mfma_f32_16x16x32_bf16 v[16:19], a[200:203], a[24:27], v[16:19]
    v_mfma_f32_16x16x32_bf16 v[20:23], a[200:203], a[56:59], v[20:23]
    v_mfma_f32_16x16x32_bf16 v[24:27], a[200:203], a[88:91], v[24:27]
    ds_read_b128 a[224:227], v60 offset:2304
    s_waitcnt lgkmcnt(5)
    v_mfma_f32_16x16x32_bf16 v[16:19], a[204:207], a[28:31], v[16:19]
    v_mfma_f32_16x16x32_bf16 v[20:23], a[204:207], a[60:63], v[20:23]
    v_mfma_f32_16x16x32_bf16 v[24:27], a[204:207], a[92:95], v[24:27]
    ds_read_b128 a[228:231], v61 offset:2304
    s_waitcnt lgkmcnt(5)
    v_mfma_f32_16x16x32_bf16 v[28:31], a[208:211], a[0:3], 0
    v_mfma_f32_16x16x32_bf16 v[32:35], a[208:211], a[32:35], 0
    v_mfma_f32_16x16x32_bf16 v[36:39], a[208:211], a[64:67], 0
    ds_read_b128 a[232:235], v62 offset:2304
    s_waitcnt lgkmcnt(5)
    v_mfma_f32_16x16x32_bf16 v[28:31], a[212:215], a[4:7], v[28:31]
    v_mfma_f32_16x16x32_bf16 v[32:35], a[212:215], a[36:39], v[32:35]
    v_mfma_f32_16x16x32_bf16 v[36:39], a[212:215], a[68:71], v[36:39]
    ds_read_b128 a[236:239], v63 offset:2304
    s_waitcnt lgkmcnt(5)
    v_mfma_f32_16x16x32_bf16 v[28:31], a[216:219], a[8:11], v[28:31]
    v_mfma_f32_16x16x32_bf16 v[32:35], a[216:219], a[40:43], v[32:35]
    v_mfma_f32_16x16x32_bf16 v[36:39], a[216:219], a[72:75], v[36:39]
    s_barrier
    v_add_u32 v60, 81920, v8
    v_add_u32 v61, 81920, v9
    v_add_u32 v62, 81920, v10
    v_add_u32 v63, 81920, v11
    ds_read_b128 a[192:195], v60 offset:0
    s_waitcnt lgkmcnt(5)
    v_mfma_f32_16x16x32_bf16 v[28:31], a[220:223], a[12:15], v[28:31]
    v_max3_f32 v52, v52, v16, v17
    v_mfma_f32_16x16x32_bf16 v[32:35], a[220:223], a[44:47], v[32:35]
    v_cvt_pk_bf16_f32 v64, v16, v17
    v_mfma_f32_16x16x32_bf16 v[36:39], a[220:223], a[76:79], v[36:39]
    v_max3_f32 v52, v52, v18, v19
    ds_read_b128 a[196:199], v61 offset:0
    s_waitcnt lgkmcnt(5)
    v_mfma_f32_16x16x32_bf16 v[28:31], a[224:227], a[16:19], v[28:31]
    v_cvt_pk_bf16_f32 v65, v18, v19
    v_mfma_f32_16x16x32_bf16 v[32:35], a[224:227], a[48:51], v[32:35]
    v_max3_f32 v53, v53, v20, v21
    v_mfma_f32_16x16x32_bf16 v[36:39], a[224:227], a[80:83], v[36:39]
    v_cvt_pk_bf16_f32 v68, v20, v21
    ds_read_b128 a[200:203], v62 offset:0
    s_waitcnt lgkmcnt(5)
    v_mfma_f32_16x16x32_bf16 v[28:31], a[228:231], a[20:23], v[28:31]
    v_max3_f32 v53, v53, v22, v23
    v_mfma_f32_16x16x32_bf16 v[32:35], a[228:231], a[52:55], v[32:35]
    v_cvt_pk_bf16_f32 v69, v22, v23
    v_mfma_f32_16x16x32_bf16 v[36:39], a[228:231], a[84:87], v[36:39]
    v_max3_f32 v54, v54, v24, v25
    ds_read_b128 a[204:207], v63 offset:0
    s_waitcnt lgkmcnt(5)
    v_mfma_f32_16x16x32_bf16 v[28:31], a[232:235], a[24:27], v[28:31]
    v_cvt_pk_bf16_f32 v72, v24, v25
    v_mfma_f32_16x16x32_bf16 v[32:35], a[232:235], a[56:59], v[32:35]
    v_max3_f32 v54, v54, v26, v27
    v_mfma_f32_16x16x32_bf16 v[36:39], a[232:235], a[88:91], v[36:39]
    v_cvt_pk_bf16_f32 v73, v26, v27
    ds_read_b128 a[208:211], v60 offset:256
    s_waitcnt lgkmcnt(5)
    v_mfma_f32_16x16x32_bf16 v[28:31], a[236:239], a[28:31], v[28:31]
    v_mfma_f32_16x16x32_bf16 v[32:35], a[236:239], a[60:63], v[32:35]
    v_mfma_f32_16x16x32_bf16 v[36:39], a[236:239], a[92:95], v[36:39]
    ds_read_b128 a[212:215], v61 offset:256
    s_waitcnt lgkmcnt(5)
    v_mfma_f32_16x16x32_bf16 v[16:19], a[192:195], a[0:3], 0
    v_mfma_f32_16x16x32_bf16 v[20:23], a[192:195], a[32:35], 0
    v_mfma_f32_16x16x32_bf16 v[24:27], a[192:195], a[64:67], 0
    ds_read_b128 a[216:219], v62 offset:256
    s_waitcnt lgkmcnt(5)
    v_mfma_f32_16x16x32_bf16 v[16:19], a[196:199], a[4:7], v[16:19]
    v_mfma_f32_16x16x32_bf16 v[20:23], a[196:199], a[36:39], v[20:23]
    v_mfma_f32_16x16x32_bf16 v[24:27], a[196:199], a[68:71], v[24:27]
    ds_read_b128 a[220:223], v63 offset:256
    s_waitcnt lgkmcnt(5)
    v_mfma_f32_16x16x32_bf16 v[16:19], a[200:203], a[8:11], v[16:19]
    v_mfma_f32_16x16x32_bf16 v[20:23], a[200:203], a[40:43], v[20:23]
    v_mfma_f32_16x16x32_bf16 v[24:27], a[200:203], a[72:75], v[24:27]
    ds_read_b128 a[224:227], v60 offset:2048
    s_waitcnt lgkmcnt(5)
    v_mfma_f32_16x16x32_bf16 v[16:19], a[204:207], a[12:15], v[16:19]
    v_max3_f32 v52, v52, v28, v29
    v_mfma_f32_16x16x32_bf16 v[20:23], a[204:207], a[44:47], v[20:23]
    v_cvt_pk_bf16_f32 v66, v28, v29
    v_mfma_f32_16x16x32_bf16 v[24:27], a[204:207], a[76:79], v[24:27]
    v_max3_f32 v52, v52, v30, v31
    ds_read_b128 a[228:231], v61 offset:2048
    s_waitcnt lgkmcnt(5)
    v_mfma_f32_16x16x32_bf16 v[16:19], a[208:211], a[16:19], v[16:19]
    v_cvt_pk_bf16_f32 v67, v30, v31
    v_mfma_f32_16x16x32_bf16 v[20:23], a[208:211], a[48:51], v[20:23]
    v_max3_f32 v53, v53, v32, v33
    v_mfma_f32_16x16x32_bf16 v[24:27], a[208:211], a[80:83], v[24:27]
    v_cvt_pk_bf16_f32 v70, v32, v33
    ds_read_b128 a[232:235], v62 offset:2048
    s_waitcnt lgkmcnt(5)
    v_mfma_f32_16x16x32_bf16 v[16:19], a[212:215], a[20:23], v[16:19]
    v_max3_f32 v53, v53, v34, v35
    v_mfma_f32_16x16x32_bf16 v[20:23], a[212:215], a[52:55], v[20:23]
    v_cvt_pk_bf16_f32 v71, v34, v35
    v_mfma_f32_16x16x32_bf16 v[24:27], a[212:215], a[84:87], v[24:27]
    v_max3_f32 v54, v54, v36, v37
    ds_read_b128 a[236:239], v63 offset:2048
    s_waitcnt lgkmcnt(5)
    v_mfma_f32_16x16x32_bf16 v[16:19], a[216:219], a[24:27], v[16:19]
    v_cvt_pk_bf16_f32 v74, v36, v37
    v_mfma_f32_16x16x32_bf16 v[20:23], a[216:219], a[56:59], v[20:23]
    v_max3_f32 v54, v54, v38, v39
    v_mfma_f32_16x16x32_bf16 v[24:27], a[216:219], a[88:91], v[24:27]
    v_cvt_pk_bf16_f32 v75, v38, v39
    ds_read_b128 a[192:195], v60 offset:2304
    s_waitcnt lgkmcnt(5)
    v_mfma_f32_16x16x32_bf16 v[16:19], a[220:223], a[28:31], v[16:19]
    v_mfma_f32_16x16x32_bf16 v[20:23], a[220:223], a[60:63], v[20:23]
    v_mfma_f32_16x16x32_bf16 v[24:27], a[220:223], a[92:95], v[24:27]
    ds_read_b128 a[196:199], v61 offset:2304
    s_waitcnt lgkmcnt(5)
    v_mfma_f32_16x16x32_bf16 v[28:31], a[224:227], a[0:3], 0
    v_mfma_f32_16x16x32_bf16 v[32:35], a[224:227], a[32:35], 0
    v_mfma_f32_16x16x32_bf16 v[36:39], a[224:227], a[64:67], 0
    ds_read_b128 a[200:203], v62 offset:2304
    s_waitcnt lgkmcnt(5)
    v_mfma_f32_16x16x32_bf16 v[28:31], a[228:231], a[4:7], v[28:31]
    v_mfma_f32_16x16x32_bf16 v[32:35], a[228:231], a[36:39], v[32:35]
    v_mfma_f32_16x16x32_bf16 v[36:39], a[228:231], a[68:71], v[36:39]
    ds_read_b128 a[204:207], v63 offset:2304
    s_waitcnt lgkmcnt(5)
    v_mfma_f32_16x16x32_bf16 v[28:31], a[232:235], a[8:11], v[28:31]
    v_mfma_f32_16x16x32_bf16 v[32:35], a[232:235], a[40:43], v[32:35]
    v_mfma_f32_16x16x32_bf16 v[36:39], a[232:235], a[72:75], v[36:39]
    s_barrier
    v_add_u32 v60, 98304, v8
    v_add_u32 v61, 98304, v9
    v_add_u32 v62, 98304, v10
    v_add_u32 v63, 98304, v11
    ds_read_b128 a[208:211], v60 offset:0
    s_waitcnt lgkmcnt(5)
    v_mfma_f32_16x16x32_bf16 v[28:31], a[236:239], a[12:15], v[28:31]
    v_max3_f32 v52, v52, v16, v17
    v_mfma_f32_16x16x32_bf16 v[32:35], a[236:239], a[44:47], v[32:35]
    v_cvt_pk_bf16_f32 v76, v16, v17
    v_mfma_f32_16x16x32_bf16 v[36:39], a[236:239], a[76:79], v[36:39]
    v_max3_f32 v52, v52, v18, v19
    ds_read_b128 a[212:215], v61 offset:0
    s_waitcnt lgkmcnt(5)
    v_mfma_f32_16x16x32_bf16 v[28:31], a[192:195], a[16:19], v[28:31]
    v_cvt_pk_bf16_f32 v77, v18, v19
    v_mfma_f32_16x16x32_bf16 v[32:35], a[192:195], a[48:51], v[32:35]
    v_max3_f32 v53, v53, v20, v21
    v_mfma_f32_16x16x32_bf16 v[36:39], a[192:195], a[80:83], v[36:39]
    v_cvt_pk_bf16_f32 v80, v20, v21
    ds_read_b128 a[216:219], v62 offset:0
    s_waitcnt lgkmcnt(5)
    v_mfma_f32_16x16x32_bf16 v[28:31], a[196:199], a[20:23], v[28:31]
    v_max3_f32 v53, v53, v22, v23
    v_mfma_f32_16x16x32_bf16 v[32:35], a[196:199], a[52:55], v[32:35]
    v_cvt_pk_bf16_f32 v81, v22, v23
    v_mfma_f32_16x16x32_bf16 v[36:39], a[196:199], a[84:87], v[36:39]
    v_max3_f32 v54, v54, v24, v25
    ds_read_b128 a[220:223], v63 offset:0
    s_waitcnt lgkmcnt(5)
    v_mfma_f32_16x16x32_bf16 v[28:31], a[200:203], a[24:27], v[28:31]
    v_cvt_pk_bf16_f32 v84, v24, v25
    v_mfma_f32_16x16x32_bf16 v[32:35], a[200:203], a[56:59], v[32:35]
    v_max3_f32 v54, v54, v26, v27
    v_mfma_f32_16x16x32_bf16 v[36:39], a[200:203], a[88:91], v[36:39]
    v_cvt_pk_bf16_f32 v85, v26, v27
    ds_read_b128 a[224:227], v60 offset:256
    s_waitcnt lgkmcnt(5)
    v_mfma_f32_16x16x32_bf16 v[28:31], a[204:207], a[28:31], v[28:31]
    v_mfma_f32_16x16x32_bf16 v[32:35], a[204:207], a[60:63], v[32:35]
    v_mfma_f32_16x16x32_bf16 v[36:39], a[204:207], a[92:95], v[36:39]
    ds_read_b128 a[228:231], v61 offset:256
    s_waitcnt lgkmcnt(5)
    v_mfma_f32_16x16x32_bf16 v[16:19], a[208:211], a[0:3], 0
    v_mfma_f32_16x16x32_bf16 v[20:23], a[208:211], a[32:35], 0
    v_mfma_f32_16x16x32_bf16 v[24:27], a[208:211], a[64:67], 0
    ds_read_b128 a[232:235], v62 offset:256
    s_waitcnt lgkmcnt(5)
    v_mfma_f32_16x16x32_bf16 v[16:19], a[212:215], a[4:7], v[16:19]
    v_mfma_f32_16x16x32_bf16 v[20:23], a[212:215], a[36:39], v[20:23]
    v_mfma_f32_16x16x32_bf16 v[24:27], a[212:215], a[68:71], v[24:27]
    ds_read_b128 a[236:239], v63 offset:256
    s_waitcnt lgkmcnt(5)
    v_mfma_f32_16x16x32_bf16 v[16:19], a[216:219], a[8:11], v[16:19]
    v_mfma_f32_16x16x32_bf16 v[20:23], a[216:219], a[40:43], v[20:23]
    v_mfma_f32_16x16x32_bf16 v[24:27], a[216:219], a[72:75], v[24:27]
    ds_read_b128 a[192:195], v60 offset:2048
    s_waitcnt lgkmcnt(5)
    v_mfma_f32_16x16x32_bf16 v[16:19], a[220:223], a[12:15], v[16:19]
    v_max3_f32 v52, v52, v28, v29
    v_mfma_f32_16x16x32_bf16 v[20:23], a[220:223], a[44:47], v[20:23]
    v_cvt_pk_bf16_f32 v78, v28, v29
    v_mfma_f32_16x16x32_bf16 v[24:27], a[220:223], a[76:79], v[24:27]
    v_max3_f32 v52, v52, v30, v31
    ds_read_b128 a[196:199], v61 offset:2048
    s_waitcnt lgkmcnt(5)
    v_mfma_f32_16x16x32_bf16 v[16:19], a[224:227], a[16:19], v[16:19]
    v_cvt_pk_bf16_f32 v79, v30, v31
    v_mfma_f32_16x16x32_bf16 v[20:23], a[224:227], a[48:51], v[20:23]
    v_max3_f32 v53, v53, v32, v33
    v_mfma_f32_16x16x32_bf16 v[24:27], a[224:227], a[80:83], v[24:27]
    v_cvt_pk_bf16_f32 v82, v32, v33
    ds_read_b128 a[200:203], v62 offset:2048
    s_waitcnt lgkmcnt(5)
    v_mfma_f32_16x16x32_bf16 v[16:19], a[228:231], a[20:23], v[16:19]
    v_max3_f32 v53, v53, v34, v35
    v_mfma_f32_16x16x32_bf16 v[20:23], a[228:231], a[52:55], v[20:23]
    v_cvt_pk_bf16_f32 v83, v34, v35
    v_mfma_f32_16x16x32_bf16 v[24:27], a[228:231], a[84:87], v[24:27]
    v_max3_f32 v54, v54, v36, v37
    ds_read_b128 a[204:207], v63 offset:2048
    s_waitcnt lgkmcnt(5)
    v_mfma_f32_16x16x32_bf16 v[16:19], a[232:235], a[24:27], v[16:19]
    v_cvt_pk_bf16_f32 v86, v36, v37
    v_mfma_f32_16x16x32_bf16 v[20:23], a[232:235], a[56:59], v[20:23]
    v_max3_f32 v54, v54, v38, v39
    v_mfma_f32_16x16x32_bf16 v[24:27], a[232:235], a[88:91], v[24:27]
    v_cvt_pk_bf16_f32 v87, v38, v39
    ds_read_b128 a[208:211], v60 offset:2304
    s_waitcnt lgkmcnt(5)
    v_mfma_f32_16x16x32_bf16 v[16:19], a[236:239], a[28:31], v[16:19]
    v_mfma_f32_16x16x32_bf16 v[20:23], a[236:239], a[60:63], v[20:23]
    v_mfma_f32_16x16x32_bf16 v[24:27], a[236:239], a[92:95], v[24:27]
    ds_read_b128 a[212:215], v61 offset:2304
    s_waitcnt lgkmcnt(5)
    v_mfma_f32_16x16x32_bf16 v[28:31], a[192:195], a[0:3], 0
    v_mfma_f32_16x16x32_bf16 v[32:35], a[192:195], a[32:35], 0
    v_mfma_f32_16x16x32_bf16 v[36:39], a[192:195], a[64:67], 0
    ds_read_b128 a[216:219], v62 offset:2304
    s_waitcnt lgkmcnt(5)
    v_mfma_f32_16x16x32_bf16 v[28:31], a[196:199], a[4:7], v[28:31]
    v_mfma_f32_16x16x32_bf16 v[32:35], a[196:199], a[36:39], v[32:35]
    v_mfma_f32_16x16x32_bf16 v[36:39], a[196:199], a[68:71], v[36:39]
    ds_read_b128 a[220:223], v63 offset:2304
    s_waitcnt lgkmcnt(5)
    v_mfma_f32_16x16x32_bf16 v[28:31], a[200:203], a[8:11], v[28:31]
    v_mfma_f32_16x16x32_bf16 v[32:35], a[200:203], a[40:43], v[32:35]
    v_mfma_f32_16x16x32_bf16 v[36:39], a[200:203], a[72:75], v[36:39]
    s_barrier
    v_add_u32 v60, 114688, v8
    v_add_u32 v61, 114688, v9
    v_add_u32 v62, 114688, v10
    v_add_u32 v63, 114688, v11
    ds_read_b128 a[224:227], v60 offset:0
    s_waitcnt lgkmcnt(5)
    v_mfma_f32_16x16x32_bf16 v[28:31], a[204:207], a[12:15], v[28:31]
    v_max3_f32 v52, v52, v16, v17
    v_mfma_f32_16x16x32_bf16 v[32:35], a[204:207], a[44:47], v[32:35]
    v_cvt_pk_bf16_f32 v88, v16, v17
    v_mfma_f32_16x16x32_bf16 v[36:39], a[204:207], a[76:79], v[36:39]
    v_max3_f32 v52, v52, v18, v19
    ds_read_b128 a[228:231], v61 offset:0
    s_waitcnt lgkmcnt(5)
    v_mfma_f32_16x16x32_bf16 v[28:31], a[208:211], a[16:19], v[28:31]
    v_cvt_pk_bf16_f32 v89, v18, v19
    v_mfma_f32_16x16x32_bf16 v[32:35], a[208:211], a[48:51], v[32:35]
    v_max3_f32 v53, v53, v20, v21
    v_mfma_f32_16x16x32_bf16 v[36:39], a[208:211], a[80:83], v[36:39]
    v_cvt_pk_bf16_f32 v92, v20, v21
    ds_read_b128 a[232:235], v62 offset:0
    s_waitcnt lgkmcnt(5)
    v_mfma_f32_16x16x32_bf16 v[28:31], a[212:215], a[20:23], v[28:31]
    v_max3_f32 v53, v53, v22, v23
    v_mfma_f32_16x16x32_bf16 v[32:35], a[212:215], a[52:55], v[32:35]
    v_cvt_pk_bf16_f32 v93, v22, v23
    v_mfma_f32_16x16x32_bf16 v[36:39], a[212:215], a[84:87], v[36:39]
    v_max3_f32 v54, v54, v24, v25
    ds_read_b128 a[236:239], v63 offset:0
    s_waitcnt lgkmcnt(5)
    v_mfma_f32_16x16x32_bf16 v[28:31], a[216:219], a[24:27], v[28:31]
    v_cvt_pk_bf16_f32 v96, v24, v25
    v_mfma_f32_16x16x32_bf16 v[32:35], a[216:219], a[56:59], v[32:35]
    v_max3_f32 v54, v54, v26, v27
    v_mfma_f32_16x16x32_bf16 v[36:39], a[216:219], a[88:91], v[36:39]
    v_cvt_pk_bf16_f32 v97, v26, v27
    ds_read_b128 a[192:195], v60 offset:256
    s_waitcnt lgkmcnt(5)
    v_mfma_f32_16x16x32_bf16 v[28:31], a[220:223], a[28:31], v[28:31]
    v_mfma_f32_16x16x32_bf16 v[32:35], a[220:223], a[60:63], v[32:35]
    v_mfma_f32_16x16x32_bf16 v[36:39], a[220:223], a[92:95], v[36:39]
    ds_read_b128 a[196:199], v61 offset:256
    s_waitcnt lgkmcnt(5)
    v_mfma_f32_16x16x32_bf16 v[16:19], a[224:227], a[0:3], 0
    v_mfma_f32_16x16x32_bf16 v[20:23], a[224:227], a[32:35], 0
    v_mfma_f32_16x16x32_bf16 v[24:27], a[224:227], a[64:67], 0
    ds_read_b128 a[200:203], v62 offset:256
    s_waitcnt lgkmcnt(5)
    v_mfma_f32_16x16x32_bf16 v[16:19], a[228:231], a[4:7], v[16:19]
    v_mfma_f32_16x16x32_bf16 v[20:23], a[228:231], a[36:39], v[20:23]
    v_mfma_f32_16x16x32_bf16 v[24:27], a[228:231], a[68:71], v[24:27]
    ds_read_b128 a[204:207], v63 offset:256
    s_waitcnt lgkmcnt(5)
    v_mfma_f32_16x16x32_bf16 v[16:19], a[232:235], a[8:11], v[16:19]
    v_mfma_f32_16x16x32_bf16 v[20:23], a[232:235], a[40:43], v[20:23]
    v_mfma_f32_16x16x32_bf16 v[24:27], a[232:235], a[72:75], v[24:27]
    ds_read_b128 a[208:211], v60 offset:2048
    s_waitcnt lgkmcnt(5)
    v_mfma_f32_16x16x32_bf16 v[16:19], a[236:239], a[12:15], v[16:19]
    v_max3_f32 v52, v52, v28, v29
    v_mfma_f32_16x16x32_bf16 v[20:23], a[236:239], a[44:47], v[20:23]
    v_cvt_pk_bf16_f32 v90, v28, v29
    v_mfma_f32_16x16x32_bf16 v[24:27], a[236:239], a[76:79], v[24:27]
    v_max3_f32 v52, v52, v30, v31
    ds_read_b128 a[212:215], v61 offset:2048
    s_waitcnt lgkmcnt(5)
    v_mfma_f32_16x16x32_bf16 v[16:19], a[192:195], a[16:19], v[16:19]
    v_cvt_pk_bf16_f32 v91, v30, v31
    v_mfma_f32_16x16x32_bf16 v[20:23], a[192:195], a[48:51], v[20:23]
    v_max3_f32 v53, v53, v32, v33
    v_mfma_f32_16x16x32_bf16 v[24:27], a[192:195], a[80:83], v[24:27]
    v_cvt_pk_bf16_f32 v94, v32, v33
    ds_read_b128 a[216:219], v62 offset:2048
    s_waitcnt lgkmcnt(5)
    v_mfma_f32_16x16x32_bf16 v[16:19], a[196:199], a[20:23], v[16:19]
    v_max3_f32 v53, v53, v34, v35
    v_mfma_f32_16x16x32_bf16 v[20:23], a[196:199], a[52:55], v[20:23]
    v_cvt_pk_bf16_f32 v95, v34, v35
    v_mfma_f32_16x16x32_bf16 v[24:27], a[196:199], a[84:87], v[24:27]
    v_max3_f32 v54, v54, v36, v37
    ds_read_b128 a[220:223], v63 offset:2048
    s_waitcnt lgkmcnt(5)
    v_mfma_f32_16x16x32_bf16 v[16:19], a[200:203], a[24:27], v[16:19]
    v_cvt_pk_bf16_f32 v98, v36, v37
    v_mfma_f32_16x16x32_bf16 v[20:23], a[200:203], a[56:59], v[20:23]
    v_max3_f32 v54, v54, v38, v39
    v_mfma_f32_16x16x32_bf16 v[24:27], a[200:203], a[88:91], v[24:27]
    v_cvt_pk_bf16_f32 v99, v38, v39
    ds_read_b128 a[224:227], v60 offset:2304
    s_waitcnt lgkmcnt(5)
    v_mfma_f32_16x16x32_bf16 v[16:19], a[204:207], a[28:31], v[16:19]
    v_mfma_f32_16x16x32_bf16 v[20:23], a[204:207], a[60:63], v[20:23]
    v_mfma_f32_16x16x32_bf16 v[24:27], a[204:207], a[92:95], v[24:27]
    ds_read_b128 a[228:231], v61 offset:2304
    s_waitcnt lgkmcnt(5)
    v_mfma_f32_16x16x32_bf16 v[28:31], a[208:211], a[0:3], 0
    v_mfma_f32_16x16x32_bf16 v[32:35], a[208:211], a[32:35], 0
    v_mfma_f32_16x16x32_bf16 v[36:39], a[208:211], a[64:67], 0
    ds_read_b128 a[232:235], v62 offset:2304
    s_waitcnt lgkmcnt(5)
    v_mfma_f32_16x16x32_bf16 v[28:31], a[212:215], a[4:7], v[28:31]
    v_mfma_f32_16x16x32_bf16 v[32:35], a[212:215], a[36:39], v[32:35]
    v_mfma_f32_16x16x32_bf16 v[36:39], a[212:215], a[68:71], v[36:39]
    ds_read_b128 a[236:239], v63 offset:2304
    s_waitcnt lgkmcnt(5)
    v_mfma_f32_16x16x32_bf16 v[28:31], a[216:219], a[8:11], v[28:31]
    v_mfma_f32_16x16x32_bf16 v[32:35], a[216:219], a[40:43], v[32:35]
    v_mfma_f32_16x16x32_bf16 v[36:39], a[216:219], a[72:75], v[36:39]
    s_barrier
    v_add_u32 v60, 131072, v8
    v_add_u32 v61, 131072, v9
    v_add_u32 v62, 131072, v10
    v_add_u32 v63, 131072, v11
    ds_read_b128 a[192:195], v60 offset:0
    s_waitcnt lgkmcnt(5)
    v_mfma_f32_16x16x32_bf16 v[28:31], a[220:223], a[12:15], v[28:31]
    v_max3_f32 v52, v52, v16, v17
    v_mfma_f32_16x16x32_bf16 v[32:35], a[220:223], a[44:47], v[32:35]
    v_cvt_pk_bf16_f32 v100, v16, v17
    v_mfma_f32_16x16x32_bf16 v[36:39], a[220:223], a[76:79], v[36:39]
    v_max3_f32 v52, v52, v18, v19
    ds_read_b128 a[196:199], v61 offset:0
    s_waitcnt lgkmcnt(5)
    v_mfma_f32_16x16x32_bf16 v[28:31], a[224:227], a[16:19], v[28:31]
    v_cvt_pk_bf16_f32 v101, v18, v19
    v_mfma_f32_16x16x32_bf16 v[32:35], a[224:227], a[48:51], v[32:35]
    v_max3_f32 v53, v53, v20, v21
    v_mfma_f32_16x16x32_bf16 v[36:39], a[224:227], a[80:83], v[36:39]
    v_cvt_pk_bf16_f32 v104, v20, v21
    ds_read_b128 a[200:203], v62 offset:0
    s_waitcnt lgkmcnt(5)
    v_mfma_f32_16x16x32_bf16 v[28:31], a[228:231], a[20:23], v[28:31]
    v_max3_f32 v53, v53, v22, v23
    v_mfma_f32_16x16x32_bf16 v[32:35], a[228:231], a[52:55], v[32:35]
    v_cvt_pk_bf16_f32 v105, v22, v23
    v_mfma_f32_16x16x32_bf16 v[36:39], a[228:231], a[84:87], v[36:39]
    v_max3_f32 v54, v54, v24, v25
    ds_read_b128 a[204:207], v63 offset:0
    s_waitcnt lgkmcnt(5)
    v_mfma_f32_16x16x32_bf16 v[28:31], a[232:235], a[24:27], v[28:31]
    v_cvt_pk_bf16_f32 v108, v24, v25
    v_mfma_f32_16x16x32_bf16 v[32:35], a[232:235], a[56:59], v[32:35]
    v_max3_f32 v54, v54, v26, v27
    v_mfma_f32_16x16x32_bf16 v[36:39], a[232:235], a[88:91], v[36:39]
    v_cvt_pk_bf16_f32 v109, v26, v27
    ds_read_b128 a[208:211], v60 offset:256
    s_waitcnt lgkmcnt(5)
    v_mfma_f32_16x16x32_bf16 v[28:31], a[236:239], a[28:31], v[28:31]
    v_mfma_f32_16x16x32_bf16 v[32:35], a[236:239], a[60:63], v[32:35]
    v_mfma_f32_16x16x32_bf16 v[36:39], a[236:239], a[92:95], v[36:39]
    ds_read_b128 a[212:215], v61 offset:256
    s_waitcnt lgkmcnt(5)
    v_mfma_f32_16x16x32_bf16 v[16:19], a[192:195], a[0:3], 0
    v_mfma_f32_16x16x32_bf16 v[20:23], a[192:195], a[32:35], 0
    v_mfma_f32_16x16x32_bf16 v[24:27], a[192:195], a[64:67], 0
    ds_read_b128 a[216:219], v62 offset:256
    s_waitcnt lgkmcnt(5)
    v_mfma_f32_16x16x32_bf16 v[16:19], a[196:199], a[4:7], v[16:19]
    v_mfma_f32_16x16x32_bf16 v[20:23], a[196:199], a[36:39], v[20:23]
    v_mfma_f32_16x16x32_bf16 v[24:27], a[196:199], a[68:71], v[24:27]
    ds_read_b128 a[220:223], v63 offset:256
    s_waitcnt lgkmcnt(5)
    v_mfma_f32_16x16x32_bf16 v[16:19], a[200:203], a[8:11], v[16:19]
    v_mfma_f32_16x16x32_bf16 v[20:23], a[200:203], a[40:43], v[20:23]
    v_mfma_f32_16x16x32_bf16 v[24:27], a[200:203], a[72:75], v[24:27]
    ds_read_b128 a[224:227], v60 offset:2048
    s_waitcnt lgkmcnt(5)
    v_mfma_f32_16x16x32_bf16 v[16:19], a[204:207], a[12:15], v[16:19]
    v_max3_f32 v52, v52, v28, v29
    v_mfma_f32_16x16x32_bf16 v[20:23], a[204:207], a[44:47], v[20:23]
    v_cvt_pk_bf16_f32 v102, v28, v29
    v_mfma_f32_16x16x32_bf16 v[24:27], a[204:207], a[76:79], v[24:27]
    v_max3_f32 v52, v52, v30, v31
    ds_read_b128 a[228:231], v61 offset:2048
    s_waitcnt lgkmcnt(5)
    v_mfma_f32_16x16x32_bf16 v[16:19], a[208:211], a[16:19], v[16:19]
    v_cvt_pk_bf16_f32 v103, v30, v31
    v_mfma_f32_16x16x32_bf16 v[20:23], a[208:211], a[48:51], v[20:23]
    v_max3_f32 v53, v53, v32, v33
    v_mfma_f32_16x16x32_bf16 v[24:27], a[208:211], a[80:83], v[24:27]
    v_cvt_pk_bf16_f32 v106, v32, v33
    ds_read_b128 a[232:235], v62 offset:2048
    s_waitcnt lgkmcnt(5)
    v_mfma_f32_16x16x32_bf16 v[16:19], a[212:215], a[20:23], v[16:19]
    v_max3_f32 v53, v53, v34, v35
    v_mfma_f32_16x16x32_bf16 v[20:23], a[212:215], a[52:55], v[20:23]
    v_cvt_pk_bf16_f32 v107, v34, v35
    v_mfma_f32_16x16x32_bf16 v[24:27], a[212:215], a[84:87], v[24:27]
    v_max3_f32 v54, v54, v36, v37
    ds_read_b128 a[236:239], v63 offset:2048
    s_waitcnt lgkmcnt(5)
    v_mfma_f32_16x16x32_bf16 v[16:19], a[216:219], a[24:27], v[16:19]
    v_cvt_pk_bf16_f32 v110, v36, v37
    v_mfma_f32_16x16x32_bf16 v[20:23], a[216:219], a[56:59], v[20:23]
    v_max3_f32 v54, v54, v38, v39
    v_mfma_f32_16x16x32_bf16 v[24:27], a[216:219], a[88:91], v[24:27]
    v_cvt_pk_bf16_f32 v111, v38, v39
    ds_read_b128 a[192:195], v60 offset:2304
    s_waitcnt lgkmcnt(5)
    v_mfma_f32_16x16x32_bf16 v[16:19], a[220:223], a[28:31], v[16:19]
    v_mfma_f32_16x16x32_bf16 v[20:23], a[220:223], a[60:63], v[20:23]
    v_mfma_f32_16x16x32_bf16 v[24:27], a[220:223], a[92:95], v[24:27]
    ds_read_b128 a[196:199], v61 offset:2304
    s_waitcnt lgkmcnt(5)
    v_mfma_f32_16x16x32_bf16 v[28:31], a[224:227], a[0:3], 0
    v_mfma_f32_16x16x32_bf16 v[32:35], a[224:227], a[32:35], 0
    v_mfma_f32_16x16x32_bf16 v[36:39], a[224:227], a[64:67], 0
    ds_read_b128 a[200:203], v62 offset:2304
    s_waitcnt lgkmcnt(5)
    v_mfma_f32_16x16x32_bf16 v[28:31], a[228:231], a[4:7], v[28:31]
    v_mfma_f32_16x16x32_bf16 v[32:35], a[228:231], a[36:39], v[32:35]
    v_mfma_f32_16x16x32_bf16 v[36:39], a[228:231], a[68:71], v[36:39]
    ds_read_b128 a[204:207], v63 offset:2304
    s_waitcnt lgkmcnt(5)
    v_mfma_f32_16x16x32_bf16 v[28:31], a[232:235], a[8:11], v[28:31]
    v_mfma_f32_16x16x32_bf16 v[32:35], a[232:235], a[40:43], v[32:35]
    v_mfma_f32_16x16x32_bf16 v[36:39], a[232:235], a[72:75], v[36:39]
    s_barrier
    v_add_u32 v60, 147456, v8
    v_add_u32 v61, 147456, v9
    v_add_u32 v62, 147456, v10
    v_add_u32 v63, 147456, v11
    ds_read_b128 a[208:211], v60 offset:0
    s_waitcnt lgkmcnt(5)
    v_mfma_f32_16x16x32_bf16 v[28:31], a[236:239], a[12:15], v[28:31]
    v_max3_f32 v52, v52, v16, v17
    v_mfma_f32_16x16x32_bf16 v[32:35], a[236:239], a[44:47], v[32:35]
    v_cvt_pk_bf16_f32 v112, v16, v17
    v_mfma_f32_16x16x32_bf16 v[36:39], a[236:239], a[76:79], v[36:39]
    v_max3_f32 v52, v52, v18, v19
    ds_read_b128 a[212:215], v61 offset:0
    s_waitcnt lgkmcnt(5)
    v_mfma_f32_16x16x32_bf16 v[28:31], a[192:195], a[16:19], v[28:31]
    v_cvt_pk_bf16_f32 v113, v18, v19
    v_mfma_f32_16x16x32_bf16 v[32:35], a[192:195], a[48:51], v[32:35]
    v_max3_f32 v53, v53, v20, v21
    v_mfma_f32_16x16x32_bf16 v[36:39], a[192:195], a[80:83], v[36:39]
    v_cvt_pk_bf16_f32 v116, v20, v21
    ds_read_b128 a[216:219], v62 offset:0
    s_waitcnt lgkmcnt(5)
    v_mfma_f32_16x16x32_bf16 v[28:31], a[196:199], a[20:23], v[28:31]
    v_max3_f32 v53, v53, v22, v23
    v_mfma_f32_16x16x32_bf16 v[32:35], a[196:199], a[52:55], v[32:35]
    v_cvt_pk_bf16_f32 v117, v22, v23
    v_mfma_f32_16x16x32_bf16 v[36:39], a[196:199], a[84:87], v[36:39]
    v_max3_f32 v54, v54, v24, v25
    ds_read_b128 a[220:223], v63 offset:0
    s_waitcnt lgkmcnt(5)
    v_mfma_f32_16x16x32_bf16 v[28:31], a[200:203], a[24:27], v[28:31]
    v_cvt_pk_bf16_f32 v120, v24, v25
    v_mfma_f32_16x16x32_bf16 v[32:35], a[200:203], a[56:59], v[32:35]
    v_max3_f32 v54, v54, v26, v27
    v_mfma_f32_16x16x32_bf16 v[36:39], a[200:203], a[88:91], v[36:39]
    v_cvt_pk_bf16_f32 v121, v26, v27
    ds_read_b128 a[224:227], v60 offset:256
    s_waitcnt lgkmcnt(5)
    v_mfma_f32_16x16x32_bf16 v[28:31], a[204:207], a[28:31], v[28:31]
    v_mfma_f32_16x16x32_bf16 v[32:35], a[204:207], a[60:63], v[32:35]
    v_mfma_f32_16x16x32_bf16 v[36:39], a[204:207], a[92:95], v[36:39]
    ds_read_b128 a[228:231], v61 offset:256
    s_waitcnt lgkmcnt(5)
    v_mfma_f32_16x16x32_bf16 v[16:19], a[208:211], a[0:3], 0
    v_mfma_f32_16x16x32_bf16 v[20:23], a[208:211], a[32:35], 0
    v_mfma_f32_16x16x32_bf16 v[24:27], a[208:211], a[64:67], 0
    ds_read_b128 a[232:235], v62 offset:256
    s_waitcnt lgkmcnt(5)
    v_mfma_f32_16x16x32_bf16 v[16:19], a[212:215], a[4:7], v[16:19]
    v_mfma_f32_16x16x32_bf16 v[20:23], a[212:215], a[36:39], v[20:23]
    v_mfma_f32_16x16x32_bf16 v[24:27], a[212:215], a[68:71], v[24:27]
    ds_read_b128 a[236:239], v63 offset:256
    s_waitcnt lgkmcnt(5)
    v_mfma_f32_16x16x32_bf16 v[16:19], a[216:219], a[8:11], v[16:19]
    v_mfma_f32_16x16x32_bf16 v[20:23], a[216:219], a[40:43], v[20:23]
    v_mfma_f32_16x16x32_bf16 v[24:27], a[216:219], a[72:75], v[24:27]
    ds_read_b128 a[192:195], v60 offset:2048
    s_waitcnt lgkmcnt(5)
    v_mfma_f32_16x16x32_bf16 v[16:19], a[220:223], a[12:15], v[16:19]
    v_max3_f32 v52, v52, v28, v29
    v_mfma_f32_16x16x32_bf16 v[20:23], a[220:223], a[44:47], v[20:23]
    v_cvt_pk_bf16_f32 v114, v28, v29
    v_mfma_f32_16x16x32_bf16 v[24:27], a[220:223], a[76:79], v[24:27]
    v_max3_f32 v52, v52, v30, v31
    ds_read_b128 a[196:199], v61 offset:2048
    s_waitcnt lgkmcnt(5)
    v_mfma_f32_16x16x32_bf16 v[16:19], a[224:227], a[16:19], v[16:19]
    v_cvt_pk_bf16_f32 v115, v30, v31
    v_mfma_f32_16x16x32_bf16 v[20:23], a[224:227], a[48:51], v[20:23]
    v_max3_f32 v53, v53, v32, v33
    v_mfma_f32_16x16x32_bf16 v[24:27], a[224:227], a[80:83], v[24:27]
    v_cvt_pk_bf16_f32 v118, v32, v33
    ds_read_b128 a[200:203], v62 offset:2048
    s_waitcnt lgkmcnt(5)
    v_mfma_f32_16x16x32_bf16 v[16:19], a[228:231], a[20:23], v[16:19]
    v_max3_f32 v53, v53, v34, v35
    v_mfma_f32_16x16x32_bf16 v[20:23], a[228:231], a[52:55], v[20:23]
    v_cvt_pk_bf16_f32 v119, v34, v35
    v_mfma_f32_16x16x32_bf16 v[24:27], a[228:231], a[84:87], v[24:27]
    v_max3_f32 v54, v54, v36, v37
    ds_read_b128 a[204:207], v63 offset:2048
    s_waitcnt lgkmcnt(5)
    v_mfma_f32_16x16x32_bf16 v[16:19], a[232:235], a[24:27], v[16:19]
    v_cvt_pk_bf16_f32 v122, v36, v37
    v_mfma_f32_16x16x32_bf16 v[20:23], a[232:235], a[56:59], v[20:23]
    v_max3_f32 v54, v54, v38, v39
    v_mfma_f32_16x16x32_bf16 v[24:27], a[232:235], a[88:91], v[24:27]
    v_cvt_pk_bf16_f32 v123, v38, v39
    ds_read_b128 a[208:211], v60 offset:2304
    s_waitcnt lgkmcnt(5)
    v_mfma_f32_16x16x32_bf16 v[16:19], a[236:239], a[28:31], v[16:19]
    v_mfma_f32_16x16x32_bf16 v[20:23], a[236:239], a[60:63], v[20:23]
    v_mfma_f32_16x16x32_bf16 v[24:27], a[236:239], a[92:95], v[24:27]
    ds_read_b128 a[212:215], v61 offset:2304
    s_waitcnt lgkmcnt(5)
    v_mfma_f32_16x16x32_bf16 v[28:31], a[192:195], a[0:3], 0
    v_mfma_f32_16x16x32_bf16 v[32:35], a[192:195], a[32:35], 0
    v_mfma_f32_16x16x32_bf16 v[36:39], a[192:195], a[64:67], 0
    ds_read_b128 a[216:219], v62 offset:2304
    s_waitcnt lgkmcnt(5)
    v_mfma_f32_16x16x32_bf16 v[28:31], a[196:199], a[4:7], v[28:31]
    v_mfma_f32_16x16x32_bf16 v[32:35], a[196:199], a[36:39], v[32:35]
    v_mfma_f32_16x16x32_bf16 v[36:39], a[196:199], a[68:71], v[36:39]
    ds_read_b128 a[220:223], v63 offset:2304
    s_waitcnt lgkmcnt(5)
    v_mfma_f32_16x16x32_bf16 v[28:31], a[200:203], a[8:11], v[28:31]
    v_mfma_f32_16x16x32_bf16 v[32:35], a[200:203], a[40:43], v[32:35]
    v_mfma_f32_16x16x32_bf16 v[36:39], a[200:203], a[72:75], v[36:39]
    s_barrier
    v_add_u32 v60, 32768, v8
    v_add_u32 v61, 32768, v9
    v_add_u32 v62, 32768, v10
    v_add_u32 v63, 32768, v11
    ds_read_b128 a[224:227], v60 offset:0
    s_waitcnt lgkmcnt(5)
    v_mfma_f32_16x16x32_bf16 v[28:31], a[204:207], a[12:15], v[28:31]
    v_max3_f32 v52, v52, v16, v17
    v_mfma_f32_16x16x32_bf16 v[32:35], a[204:207], a[44:47], v[32:35]
    v_cvt_pk_bf16_f32 v124, v16, v17
    v_mfma_f32_16x16x32_bf16 v[36:39], a[204:207], a[76:79], v[36:39]
    v_max3_f32 v52, v52, v18, v19
    ds_read_b128 a[228:231], v61 offset:0
    s_waitcnt lgkmcnt(5)
    v_mfma_f32_16x16x32_bf16 v[28:31], a[208:211], a[16:19], v[28:31]
    v_cvt_pk_bf16_f32 v125, v18, v19
    v_mfma_f32_16x16x32_bf16 v[32:35], a[208:211], a[48:51], v[32:35]
    v_max3_f32 v53, v53, v20, v21
    v_mfma_f32_16x16x32_bf16 v[36:39], a[208:211], a[80:83], v[36:39]
    v_cvt_pk_bf16_f32 v128, v20, v21
    ds_read_b128 a[232:235], v62 offset:0
    s_waitcnt lgkmcnt(5)
    v_mfma_f32_16x16x32_bf16 v[28:31], a[212:215], a[20:23], v[28:31]
    v_max3_f32 v53, v53, v22, v23
    v_mfma_f32_16x16x32_bf16 v[32:35], a[212:215], a[52:55], v[32:35]
    v_cvt_pk_bf16_f32 v129, v22, v23
    v_mfma_f32_16x16x32_bf16 v[36:39], a[212:215], a[84:87], v[36:39]
    v_max3_f32 v54, v54, v24, v25
    ds_read_b128 a[236:239], v63 offset:0
    s_waitcnt lgkmcnt(5)
    v_mfma_f32_16x16x32_bf16 v[28:31], a[216:219], a[24:27], v[28:31]
    v_cvt_pk_bf16_f32 v132, v24, v25
    v_mfma_f32_16x16x32_bf16 v[32:35], a[216:219], a[56:59], v[32:35]
    v_max3_f32 v54, v54, v26, v27
    v_mfma_f32_16x16x32_bf16 v[36:39], a[216:219], a[88:91], v[36:39]
    v_cvt_pk_bf16_f32 v133, v26, v27
    ds_read_b128 a[192:195], v60 offset:256
    s_waitcnt lgkmcnt(5)
    v_mfma_f32_16x16x32_bf16 v[28:31], a[220:223], a[28:31], v[28:31]
    v_mfma_f32_16x16x32_bf16 v[32:35], a[220:223], a[60:63], v[32:35]
    v_mfma_f32_16x16x32_bf16 v[36:39], a[220:223], a[92:95], v[36:39]
    ds_read_b128 a[196:199], v61 offset:256
    s_waitcnt lgkmcnt(5)
    v_mfma_f32_16x16x32_bf16 v[16:19], a[224:227], a[0:3], 0
    v_mfma_f32_16x16x32_bf16 v[20:23], a[224:227], a[32:35], 0
    v_mfma_f32_16x16x32_bf16 v[24:27], a[224:227], a[64:67], 0
    ds_read_b128 a[200:203], v62 offset:256
    s_waitcnt lgkmcnt(5)
    v_mfma_f32_16x16x32_bf16 v[16:19], a[228:231], a[4:7], v[16:19]
    v_mfma_f32_16x16x32_bf16 v[20:23], a[228:231], a[36:39], v[20:23]
    v_mfma_f32_16x16x32_bf16 v[24:27], a[228:231], a[68:71], v[24:27]
    ds_read_b128 a[204:207], v63 offset:256
    s_waitcnt lgkmcnt(5)
    v_mfma_f32_16x16x32_bf16 v[16:19], a[232:235], a[8:11], v[16:19]
    v_mfma_f32_16x16x32_bf16 v[20:23], a[232:235], a[40:43], v[20:23]
    v_mfma_f32_16x16x32_bf16 v[24:27], a[232:235], a[72:75], v[24:27]
    ds_read_b128 a[208:211], v60 offset:2048
    s_waitcnt lgkmcnt(5)
    v_mfma_f32_16x16x32_bf16 v[16:19], a[236:239], a[12:15], v[16:19]
    v_max3_f32 v52, v52, v28, v29
    v_mfma_f32_16x16x32_bf16 v[20:23], a[236:239], a[44:47], v[20:23]
    v_cvt_pk_bf16_f32 v126, v28, v29
    v_mfma_f32_16x16x32_bf16 v[24:27], a[236:239], a[76:79], v[24:27]
    v_max3_f32 v52, v52, v30, v31
    ds_read_b128 a[212:215], v61 offset:2048
    s_waitcnt lgkmcnt(5)
    v_mfma_f32_16x16x32_bf16 v[16:19], a[192:195], a[16:19], v[16:19]
    v_cvt_pk_bf16_f32 v127, v30, v31
    v_mfma_f32_16x16x32_bf16 v[20:23], a[192:195], a[48:51], v[20:23]
    v_max3_f32 v53, v53, v32, v33
    v_mfma_f32_16x16x32_bf16 v[24:27], a[192:195], a[80:83], v[24:27]
    v_cvt_pk_bf16_f32 v130, v32, v33
    ds_read_b128 a[216:219], v62 offset:2048
    s_waitcnt lgkmcnt(5)
    v_mfma_f32_16x16x32_bf16 v[16:19], a[196:199], a[20:23], v[16:19]
    v_max3_f32 v53, v53, v34, v35
    v_mfma_f32_16x16x32_bf16 v[20:23], a[196:199], a[52:55], v[20:23]
    v_cvt_pk_bf16_f32 v131, v34, v35
    v_mfma_f32_16x16x32_bf16 v[24:27], a[196:199], a[84:87], v[24:27]
    v_max3_f32 v54, v54, v36, v37
    ds_read_b128 a[220:223], v63 offset:2048
    s_waitcnt lgkmcnt(5)
    v_mfma_f32_16x16x32_bf16 v[16:19], a[200:203], a[24:27], v[16:19]
    v_cvt_pk_bf16_f32 v134, v36, v37
    v_mfma_f32_16x16x32_bf16 v[20:23], a[200:203], a[56:59], v[20:23]
    v_max3_f32 v54, v54, v38, v39
    v_mfma_f32_16x16x32_bf16 v[24:27], a[200:203], a[88:91], v[24:27]
    v_cvt_pk_bf16_f32 v135, v38, v39
    ds_read_b128 a[224:227], v60 offset:2304
    s_waitcnt lgkmcnt(5)
    v_mfma_f32_16x16x32_bf16 v[16:19], a[204:207], a[28:31], v[16:19]
    v_mfma_f32_16x16x32_bf16 v[20:23], a[204:207], a[60:63], v[20:23]
    v_mfma_f32_16x16x32_bf16 v[24:27], a[204:207], a[92:95], v[24:27]
    ds_read_b128 a[228:231], v61 offset:2304
    s_waitcnt lgkmcnt(5)
    v_mfma_f32_16x16x32_bf16 v[28:31], a[208:211], a[0:3], 0
    v_mfma_f32_16x16x32_bf16 v[32:35], a[208:211], a[32:35], 0
    v_mfma_f32_16x16x32_bf16 v[36:39], a[208:211], a[64:67], 0
    ds_read_b128 a[232:235], v62 offset:2304
    s_waitcnt lgkmcnt(5)
    v_mfma_f32_16x16x32_bf16 v[28:31], a[212:215], a[4:7], v[28:31]
    v_mfma_f32_16x16x32_bf16 v[32:35], a[212:215], a[36:39], v[32:35]
    v_mfma_f32_16x16x32_bf16 v[36:39], a[212:215], a[68:71], v[36:39]
    ds_read_b128 a[236:239], v63 offset:2304
    s_waitcnt lgkmcnt(5)
    v_mfma_f32_16x16x32_bf16 v[28:31], a[216:219], a[8:11], v[28:31]
    v_mfma_f32_16x16x32_bf16 v[32:35], a[216:219], a[40:43], v[32:35]
    v_mfma_f32_16x16x32_bf16 v[36:39], a[216:219], a[72:75], v[36:39]
    s_barrier
    v_add_u32 v60, 49152, v8
    v_add_u32 v61, 49152, v9
    v_add_u32 v62, 49152, v10
    v_add_u32 v63, 49152, v11
    ds_read_b128 a[192:195], v60 offset:0
    s_waitcnt lgkmcnt(5)
    v_mfma_f32_16x16x32_bf16 v[28:31], a[220:223], a[12:15], v[28:31]
    v_max3_f32 v52, v52, v16, v17
    v_mfma_f32_16x16x32_bf16 v[32:35], a[220:223], a[44:47], v[32:35]
    v_cvt_pk_bf16_f32 v136, v16, v17
    v_mfma_f32_16x16x32_bf16 v[36:39], a[220:223], a[76:79], v[36:39]
    v_max3_f32 v52, v52, v18, v19
    ds_read_b128 a[196:199], v61 offset:0
    s_waitcnt lgkmcnt(5)
    v_mfma_f32_16x16x32_bf16 v[28:31], a[224:227], a[16:19], v[28:31]
    v_cvt_pk_bf16_f32 v137, v18, v19
    v_mfma_f32_16x16x32_bf16 v[32:35], a[224:227], a[48:51], v[32:35]
    v_max3_f32 v53, v53, v20, v21
    v_mfma_f32_16x16x32_bf16 v[36:39], a[224:227], a[80:83], v[36:39]
    v_cvt_pk_bf16_f32 v140, v20, v21
    ds_read_b128 a[200:203], v62 offset:0
    s_waitcnt lgkmcnt(5)
    v_mfma_f32_16x16x32_bf16 v[28:31], a[228:231], a[20:23], v[28:31]
    v_max3_f32 v53, v53, v22, v23
    v_mfma_f32_16x16x32_bf16 v[32:35], a[228:231], a[52:55], v[32:35]
    v_cvt_pk_bf16_f32 v141, v22, v23
    v_mfma_f32_16x16x32_bf16 v[36:39], a[228:231], a[84:87], v[36:39]
    v_max3_f32 v54, v54, v24, v25
    ds_read_b128 a[204:207], v63 offset:0
    s_waitcnt lgkmcnt(5)
    v_mfma_f32_16x16x32_bf16 v[28:31], a[232:235], a[24:27], v[28:31]
    v_cvt_pk_bf16_f32 v144, v24, v25
    v_mfma_f32_16x16x32_bf16 v[32:35], a[232:235], a[56:59], v[32:35]
    v_max3_f32 v54, v54, v26, v27
    v_mfma_f32_16x16x32_bf16 v[36:39], a[232:235], a[88:91], v[36:39]
    v_cvt_pk_bf16_f32 v145, v26, v27
    ds_read_b128 a[208:211], v60 offset:256
    s_waitcnt lgkmcnt(5)
    v_mfma_f32_16x16x32_bf16 v[28:31], a[236:239], a[28:31], v[28:31]
    v_mfma_f32_16x16x32_bf16 v[32:35], a[236:239], a[60:63], v[32:35]
    v_mfma_f32_16x16x32_bf16 v[36:39], a[236:239], a[92:95], v[36:39]
    ds_read_b128 a[212:215], v61 offset:256
    s_waitcnt lgkmcnt(5)
    v_mfma_f32_16x16x32_bf16 v[16:19], a[192:195], a[0:3], 0
    v_mfma_f32_16x16x32_bf16 v[20:23], a[192:195], a[32:35], 0
    v_mfma_f32_16x16x32_bf16 v[24:27], a[192:195], a[64:67], 0
    ds_read_b128 a[216:219], v62 offset:256
    s_waitcnt lgkmcnt(5)
    v_mfma_f32_16x16x32_bf16 v[16:19], a[196:199], a[4:7], v[16:19]
    v_mfma_f32_16x16x32_bf16 v[20:23], a[196:199], a[36:39], v[20:23]
    v_mfma_f32_16x16x32_bf16 v[24:27], a[196:199], a[68:71], v[24:27]
    ds_read_b128 a[220:223], v63 offset:256
    s_waitcnt lgkmcnt(5)
    v_mfma_f32_16x16x32_bf16 v[16:19], a[200:203], a[8:11], v[16:19]
    v_mfma_f32_16x16x32_bf16 v[20:23], a[200:203], a[40:43], v[20:23]
    v_mfma_f32_16x16x32_bf16 v[24:27], a[200:203], a[72:75], v[24:27]
    ds_read_b128 a[224:227], v60 offset:2048
    s_waitcnt lgkmcnt(5)
    v_mfma_f32_16x16x32_bf16 v[16:19], a[204:207], a[12:15], v[16:19]
    v_max3_f32 v52, v52, v28, v29
    v_mfma_f32_16x16x32_bf16 v[20:23], a[204:207], a[44:47], v[20:23]
    v_cvt_pk_bf16_f32 v138, v28, v29
    v_mfma_f32_16x16x32_bf16 v[24:27], a[204:207], a[76:79], v[24:27]
    v_max3_f32 v52, v52, v30, v31
    ds_read_b128 a[228:231], v61 offset:2048
    s_waitcnt lgkmcnt(5)
    v_mfma_f32_16x16x32_bf16 v[16:19], a[208:211], a[16:19], v[16:19]
    v_cvt_pk_bf16_f32 v139, v30, v31
    v_mfma_f32_16x16x32_bf16 v[20:23], a[208:211], a[48:51], v[20:23]
    v_max3_f32 v53, v53, v32, v33
    v_mfma_f32_16x16x32_bf16 v[24:27], a[208:211], a[80:83], v[24:27]
    v_cvt_pk_bf16_f32 v142, v32, v33
    ds_read_b128 a[232:235], v62 offset:2048
    s_waitcnt lgkmcnt(5)
    v_mfma_f32_16x16x32_bf16 v[16:19], a[212:215], a[20:23], v[16:19]
    v_max3_f32 v53, v53, v34, v35
    v_mfma_f32_16x16x32_bf16 v[20:23], a[212:215], a[52:55], v[20:23]
    v_cvt_pk_bf16_f32 v143, v34, v35
    v_mfma_f32_16x16x32_bf16 v[24:27], a[212:215], a[84:87], v[24:27]
    v_max3_f32 v54, v54, v36, v37
    ds_read_b128 a[236:239], v63 offset:2048
    s_waitcnt lgkmcnt(5)
    v_mfma_f32_16x16x32_bf16 v[16:19], a[216:219], a[24:27], v[16:19]
    v_cvt_pk_bf16_f32 v146, v36, v37
    v_mfma_f32_16x16x32_bf16 v[20:23], a[216:219], a[56:59], v[20:23]
    v_max3_f32 v54, v54, v38, v39
    v_mfma_f32_16x16x32_bf16 v[24:27], a[216:219], a[88:91], v[24:27]
    v_cvt_pk_bf16_f32 v147, v38, v39
    ds_read_b128 a[192:195], v60 offset:2304
    s_waitcnt lgkmcnt(5)
    v_mfma_f32_16x16x32_bf16 v[16:19], a[220:223], a[28:31], v[16:19]
    v_mfma_f32_16x16x32_bf16 v[20:23], a[220:223], a[60:63], v[20:23]
    v_mfma_f32_16x16x32_bf16 v[24:27], a[220:223], a[92:95], v[24:27]
    ds_read_b128 a[196:199], v61 offset:2304
    s_waitcnt lgkmcnt(5)
    v_mfma_f32_16x16x32_bf16 v[28:31], a[224:227], a[0:3], 0
    v_mfma_f32_16x16x32_bf16 v[32:35], a[224:227], a[32:35], 0
    v_mfma_f32_16x16x32_bf16 v[36:39], a[224:227], a[64:67], 0
    ds_read_b128 a[200:203], v62 offset:2304
    s_waitcnt lgkmcnt(5)
    v_mfma_f32_16x16x32_bf16 v[28:31], a[228:231], a[4:7], v[28:31]
    v_mfma_f32_16x16x32_bf16 v[32:35], a[228:231], a[36:39], v[32:35]
    v_mfma_f32_16x16x32_bf16 v[36:39], a[228:231], a[68:71], v[36:39]
    ds_read_b128 a[204:207], v63 offset:2304
    s_waitcnt lgkmcnt(5)
    v_mfma_f32_16x16x32_bf16 v[28:31], a[232:235], a[8:11], v[28:31]
    v_mfma_f32_16x16x32_bf16 v[32:35], a[232:235], a[40:43], v[32:35]
    v_mfma_f32_16x16x32_bf16 v[36:39], a[232:235], a[72:75], v[36:39]
    s_barrier
    v_add_u32 v60, 0, v8
    v_add_u32 v61, 0, v9
    v_add_u32 v62, 0, v10
    v_add_u32 v63, 0, v11
    ds_read_b128 a[208:211], v60 offset:0
    s_waitcnt lgkmcnt(5)
    v_mfma_f32_16x16x32_bf16 v[28:31], a[236:239], a[12:15], v[28:31]
    v_max3_f32 v52, v52, v16, v17
    v_mfma_f32_16x16x32_bf16 v[32:35], a[236:239], a[44:47], v[32:35]
    v_cvt_pk_bf16_f32 v148, v16, v17
    v_mfma_f32_16x16x32_bf16 v[36:39], a[236:239], a[76:79], v[36:39]
    v_max3_f32 v52, v52, v18, v19
    ds_read_b128 a[212:215], v61 offset:0
    s_waitcnt lgkmcnt(5)
    v_mfma_f32_16x16x32_bf16 v[28:31], a[192:195], a[16:19], v[28:31]
    v_cvt_pk_bf16_f32 v149, v18, v19
    v_mfma_f32_16x16x32_bf16 v[32:35], a[192:195], a[48:51], v[32:35]
    v_max3_f32 v53, v53, v20, v21
    v_mfma_f32_16x16x32_bf16 v[36:39], a[192:195], a[80:83], v[36:39]
    v_cvt_pk_bf16_f32 v152, v20, v21
    ds_read_b128 a[216:219], v62 offset:0
    s_waitcnt lgkmcnt(5)
    v_mfma_f32_16x16x32_bf16 v[28:31], a[196:199], a[20:23], v[28:31]
    v_max3_f32 v53, v53, v22, v23
    v_mfma_f32_16x16x32_bf16 v[32:35], a[196:199], a[52:55], v[32:35]
    v_cvt_pk_bf16_f32 v153, v22, v23
    v_mfma_f32_16x16x32_bf16 v[36:39], a[196:199], a[84:87], v[36:39]
    v_max3_f32 v54, v54, v24, v25
    ds_read_b128 a[220:223], v63 offset:0
    s_waitcnt lgkmcnt(5)
    v_mfma_f32_16x16x32_bf16 v[28:31], a[200:203], a[24:27], v[28:31]
    v_cvt_pk_bf16_f32 v156, v24, v25
    v_mfma_f32_16x16x32_bf16 v[32:35], a[200:203], a[56:59], v[32:35]
    v_max3_f32 v54, v54, v26, v27
    v_mfma_f32_16x16x32_bf16 v[36:39], a[200:203], a[88:91], v[36:39]
    v_cvt_pk_bf16_f32 v157, v26, v27
    ds_read_b128 a[224:227], v60 offset:256
    s_waitcnt lgkmcnt(5)
    v_mfma_f32_16x16x32_bf16 v[28:31], a[204:207], a[28:31], v[28:31]
    v_mfma_f32_16x16x32_bf16 v[32:35], a[204:207], a[60:63], v[32:35]
    v_mfma_f32_16x16x32_bf16 v[36:39], a[204:207], a[92:95], v[36:39]
    ds_read_b128 a[228:231], v61 offset:256
    s_waitcnt lgkmcnt(5)
    v_mfma_f32_16x16x32_bf16 v[16:19], a[208:211], a[0:3], 0
    v_mfma_f32_16x16x32_bf16 v[20:23], a[208:211], a[32:35], 0
    v_mfma_f32_16x16x32_bf16 v[24:27], a[208:211], a[64:67], 0
    ds_read_b128 a[232:235], v62 offset:256
    s_waitcnt lgkmcnt(5)
    v_mfma_f32_16x16x32_bf16 v[16:19], a[212:215], a[4:7], v[16:19]
    v_mfma_f32_16x16x32_bf16 v[20:23], a[212:215], a[36:39], v[20:23]
    v_mfma_f32_16x16x32_bf16 v[24:27], a[212:215], a[68:71], v[24:27]
    ds_read_b128 a[236:239], v63 offset:256
    s_waitcnt lgkmcnt(5)
    v_mfma_f32_16x16x32_bf16 v[16:19], a[216:219], a[8:11], v[16:19]
    v_mfma_f32_16x16x32_bf16 v[20:23], a[216:219], a[40:43], v[20:23]
    v_mfma_f32_16x16x32_bf16 v[24:27], a[216:219], a[72:75], v[24:27]
    ds_read_b128 a[192:195], v60 offset:2048
    s_waitcnt lgkmcnt(5)
    v_mfma_f32_16x16x32_bf16 v[16:19], a[220:223], a[12:15], v[16:19]
    v_max3_f32 v52, v52, v28, v29
    v_mfma_f32_16x16x32_bf16 v[20:23], a[220:223], a[44:47], v[20:23]
    v_cvt_pk_bf16_f32 v150, v28, v29
    v_mfma_f32_16x16x32_bf16 v[24:27], a[220:223], a[76:79], v[24:27]
    v_max3_f32 v52, v52, v30, v31
    ds_read_b128 a[196:199], v61 offset:2048
    s_waitcnt lgkmcnt(5)
    v_mfma_f32_16x16x32_bf16 v[16:19], a[224:227], a[16:19], v[16:19]
    v_cvt_pk_bf16_f32 v151, v30, v31
    v_mfma_f32_16x16x32_bf16 v[20:23], a[224:227], a[48:51], v[20:23]
    v_max3_f32 v53, v53, v32, v33
    v_mfma_f32_16x16x32_bf16 v[24:27], a[224:227], a[80:83], v[24:27]
    v_cvt_pk_bf16_f32 v154, v32, v33
    ds_read_b128 a[200:203], v62 offset:2048
    s_waitcnt lgkmcnt(5)
    v_mfma_f32_16x16x32_bf16 v[16:19], a[228:231], a[20:23], v[16:19]
    v_max3_f32 v53, v53, v34, v35
    v_mfma_f32_16x16x32_bf16 v[20:23], a[228:231], a[52:55], v[20:23]
    v_cvt_pk_bf16_f32 v155, v34, v35
    v_mfma_f32_16x16x32_bf16 v[24:27], a[228:231], a[84:87], v[24:27]
    v_max3_f32 v54, v54, v36, v37
    ds_read_b128 a[204:207], v63 offset:2048
    s_waitcnt lgkmcnt(5)
    v_mfma_f32_16x16x32_bf16 v[16:19], a[232:235], a[24:27], v[16:19]
    v_cvt_pk_bf16_f32 v158, v36, v37
    v_mfma_f32_16x16x32_bf16 v[20:23], a[232:235], a[56:59], v[20:23]
    v_max3_f32 v54, v54, v38, v39
    v_mfma_f32_16x16x32_bf16 v[24:27], a[232:235], a[88:91], v[24:27]
    v_cvt_pk_bf16_f32 v159, v38, v39
    ds_read_b128 a[208:211], v60 offset:2304
    s_waitcnt lgkmcnt(5)
    v_mfma_f32_16x16x32_bf16 v[16:19], a[236:239], a[28:31], v[16:19]
    v_mfma_f32_16x16x32_bf16 v[20:23], a[236:239], a[60:63], v[20:23]
    v_mfma_f32_16x16x32_bf16 v[24:27], a[236:239], a[92:95], v[24:27]
    ds_read_b128 a[212:215], v61 offset:2304
    s_waitcnt lgkmcnt(5)
    v_mfma_f32_16x16x32_bf16 v[28:31], a[192:195], a[0:3], 0
    v_mfma_f32_16x16x32_bf16 v[32:35], a[192:195], a[32:35], 0
    v_mfma_f32_16x16x32_bf16 v[36:39], a[192:195], a[64:67], 0
    ds_read_b128 a[216:219], v62 offset:2304
    s_waitcnt lgkmcnt(5)
    v_mfma_f32_16x16x32_bf16 v[28:31], a[196:199], a[4:7], v[28:31]
    v_mfma_f32_16x16x32_bf16 v[32:35], a[196:199], a[36:39], v[32:35]
    v_mfma_f32_16x16x32_bf16 v[36:39], a[196:199], a[68:71], v[36:39]
    ds_read_b128 a[220:223], v63 offset:2304
    s_waitcnt lgkmcnt(5)
    v_mfma_f32_16x16x32_bf16 v[28:31], a[200:203], a[8:11], v[28:31]
    v_mfma_f32_16x16x32_bf16 v[32:35], a[200:203], a[40:43], v[32:35]
    v_mfma_f32_16x16x32_bf16 v[36:39], a[200:203], a[72:75], v[36:39]
    s_barrier
    v_add_u32 v60, 16384, v8
    v_add_u32 v61, 16384, v9
    v_add_u32 v62, 16384, v10
    v_add_u32 v63, 16384, v11
    ds_read_b128 a[224:227], v60 offset:0
    s_waitcnt lgkmcnt(5)
    v_mfma_f32_16x16x32_bf16 v[28:31], a[204:207], a[12:15], v[28:31]
    v_max3_f32 v52, v52, v16, v17
    v_mfma_f32_16x16x32_bf16 v[32:35], a[204:207], a[44:47], v[32:35]
    v_cvt_pk_bf16_f32 v160, v16, v17
    v_mfma_f32_16x16x32_bf16 v[36:39], a[204:207], a[76:79], v[36:39]
    v_max3_f32 v52, v52, v18, v19
    ds_read_b128 a[228:231], v61 offset:0
    s_waitcnt lgkmcnt(5)
    v_mfma_f32_16x16x32_bf16 v[28:31], a[208:211], a[16:19], v[28:31]
    v_cvt_pk_bf16_f32 v161, v18, v19
    v_mfma_f32_16x16x32_bf16 v[32:35], a[208:211], a[48:51], v[32:35]
    v_max3_f32 v53, v53, v20, v21
    v_mfma_f32_16x16x32_bf16 v[36:39], a[208:211], a[80:83], v[36:39]
    v_cvt_pk_bf16_f32 v164, v20, v21
    ds_read_b128 a[232:235], v62 offset:0
    s_waitcnt lgkmcnt(5)
    v_mfma_f32_16x16x32_bf16 v[28:31], a[212:215], a[20:23], v[28:31]
    v_max3_f32 v53, v53, v22, v23
    v_mfma_f32_16x16x32_bf16 v[32:35], a[212:215], a[52:55], v[32:35]
    v_cvt_pk_bf16_f32 v165, v22, v23
    v_mfma_f32_16x16x32_bf16 v[36:39], a[212:215], a[84:87], v[36:39]
    v_max3_f32 v54, v54, v24, v25
    ds_read_b128 a[236:239], v63 offset:0
    s_waitcnt lgkmcnt(5)
    v_mfma_f32_16x16x32_bf16 v[28:31], a[216:219], a[24:27], v[28:31]
    v_cvt_pk_bf16_f32 v168, v24, v25
    v_mfma_f32_16x16x32_bf16 v[32:35], a[216:219], a[56:59], v[32:35]
    v_max3_f32 v54, v54, v26, v27
    v_mfma_f32_16x16x32_bf16 v[36:39], a[216:219], a[88:91], v[36:39]
    v_cvt_pk_bf16_f32 v169, v26, v27
    ds_read_b128 a[192:195], v60 offset:256
    s_waitcnt lgkmcnt(5)
    v_mfma_f32_16x16x32_bf16 v[28:31], a[220:223], a[28:31], v[28:31]
    v_mfma_f32_16x16x32_bf16 v[32:35], a[220:223], a[60:63], v[32:35]
    v_mfma_f32_16x16x32_bf16 v[36:39], a[220:223], a[92:95], v[36:39]
    ds_read_b128 a[196:199], v61 offset:256
    s_waitcnt lgkmcnt(5)
    v_mfma_f32_16x16x32_bf16 v[16:19], a[224:227], a[0:3], 0
    v_mfma_f32_16x16x32_bf16 v[20:23], a[224:227], a[32:35], 0
    v_mfma_f32_16x16x32_bf16 v[24:27], a[224:227], a[64:67], 0
    ds_read_b128 a[200:203], v62 offset:256
    s_waitcnt lgkmcnt(5)
    v_mfma_f32_16x16x32_bf16 v[16:19], a[228:231], a[4:7], v[16:19]
    v_mfma_f32_16x16x32_bf16 v[20:23], a[228:231], a[36:39], v[20:23]
    v_mfma_f32_16x16x32_bf16 v[24:27], a[228:231], a[68:71], v[24:27]
    ds_read_b128 a[204:207], v63 offset:256
    s_waitcnt lgkmcnt(5)
    v_mfma_f32_16x16x32_bf16 v[16:19], a[232:235], a[8:11], v[16:19]
    v_mfma_f32_16x16x32_bf16 v[20:23], a[232:235], a[40:43], v[20:23]
    v_mfma_f32_16x16x32_bf16 v[24:27], a[232:235], a[72:75], v[24:27]
    ds_read_b128 a[208:211], v60 offset:2048
    s_waitcnt lgkmcnt(5)
    v_mfma_f32_16x16x32_bf16 v[16:19], a[236:239], a[12:15], v[16:19]
    v_max3_f32 v52, v52, v28, v29
    v_mfma_f32_16x16x32_bf16 v[20:23], a[236:239], a[44:47], v[20:23]
    v_cvt_pk_bf16_f32 v162, v28, v29
    v_mfma_f32_16x16x32_bf16 v[24:27], a[236:239], a[76:79], v[24:27]
    v_max3_f32 v52, v52, v30, v31
    ds_read_b128 a[212:215], v61 offset:2048
    s_waitcnt lgkmcnt(5)
    v_mfma_f32_16x16x32_bf16 v[16:19], a[192:195], a[16:19], v[16:19]
    v_cvt_pk_bf16_f32 v163, v30, v31
    v_mfma_f32_16x16x32_bf16 v[20:23], a[192:195], a[48:51], v[20:23]
    v_max3_f32 v53, v53, v32, v33
    v_mfma_f32_16x16x32_bf16 v[24:27], a[192:195], a[80:83], v[24:27]
    v_cvt_pk_bf16_f32 v166, v32, v33
    ds_read_b128 a[216:219], v62 offset:2048
    s_waitcnt lgkmcnt(5)
    v_mfma_f32_16x16x32_bf16 v[16:19], a[196:199], a[20:23], v[16:19]
    v_max3_f32 v53, v53, v34, v35
    v_mfma_f32_16x16x32_bf16 v[20:23], a[196:199], a[52:55], v[20:23]
    v_cvt_pk_bf16_f32 v167, v34, v35
    v_mfma_f32_16x16x32_bf16 v[24:27], a[196:199], a[84:87], v[24:27]
    v_max3_f32 v54, v54, v36, v37
    ds_read_b128 a[220:223], v63 offset:2048
    s_waitcnt lgkmcnt(5)
    v_mfma_f32_16x16x32_bf16 v[16:19], a[200:203], a[24:27], v[16:19]
    v_cvt_pk_bf16_f32 v170, v36, v37
    v_mfma_f32_16x16x32_bf16 v[20:23], a[200:203], a[56:59], v[20:23]
    v_max3_f32 v54, v54, v38, v39
    v_mfma_f32_16x16x32_bf16 v[24:27], a[200:203], a[88:91], v[24:27]
    v_cvt_pk_bf16_f32 v171, v38, v39
    ds_read_b128 a[224:227], v60 offset:2304
    s_waitcnt lgkmcnt(5)
    v_mfma_f32_16x16x32_bf16 v[16:19], a[204:207], a[28:31], v[16:19]
    v_mfma_f32_16x16x32_bf16 v[20:23], a[204:207], a[60:63], v[20:23]
    v_mfma_f32_16x16x32_bf16 v[24:27], a[204:207], a[92:95], v[24:27]
    ds_read_b128 a[228:231], v61 offset:2304
    s_waitcnt lgkmcnt(5)
    v_mfma_f32_16x16x32_bf16 v[28:31], a[208:211], a[0:3], 0
    v_mfma_f32_16x16x32_bf16 v[32:35], a[208:211], a[32:35], 0
    v_mfma_f32_16x16x32_bf16 v[36:39], a[208:211], a[64:67], 0
    ds_read_b128 a[232:235], v62 offset:2304
    s_waitcnt lgkmcnt(5)
    v_mfma_f32_16x16x32_bf16 v[28:31], a[212:215], a[4:7], v[28:31]
    v_mfma_f32_16x16x32_bf16 v[32:35], a[212:215], a[36:39], v[32:35]
    v_mfma_f32_16x16x32_bf16 v[36:39], a[212:215], a[68:71], v[36:39]
    ds_read_b128 a[236:239], v63 offset:2304
    s_waitcnt lgkmcnt(5)
    v_mfma_f32_16x16x32_bf16 v[28:31], a[216:219], a[8:11], v[28:31]
    v_mfma_f32_16x16x32_bf16 v[32:35], a[216:219], a[40:43], v[32:35]
    v_mfma_f32_16x16x32_bf16 v[36:39], a[216:219], a[72:75], v[36:39]
    s_barrier
    v_add_u32 v60, 65536, v8
    v_add_u32 v61, 65536, v9
    v_add_u32 v62, 65536, v10
    v_add_u32 v63, 65536, v11
    ds_read_b128 a[192:195], v60 offset:0
    s_waitcnt lgkmcnt(5)
    v_mfma_f32_16x16x32_bf16 v[28:31], a[220:223], a[12:15], v[28:31]
    v_max3_f32 v52, v52, v16, v17
    v_mfma_f32_16x16x32_bf16 v[32:35], a[220:223], a[44:47], v[32:35]
    v_cvt_pk_bf16_f32 v172, v16, v17
    v_mfma_f32_16x16x32_bf16 v[36:39], a[220:223], a[76:79], v[36:39]
    v_max3_f32 v52, v52, v18, v19
    ds_read_b128 a[196:199], v61 offset:0
    s_waitcnt lgkmcnt(5)
    v_mfma_f32_16x16x32_bf16 v[28:31], a[224:227], a[16:19], v[28:31]
    v_cvt_pk_bf16_f32 v173, v18, v19
    v_mfma_f32_16x16x32_bf16 v[32:35], a[224:227], a[48:51], v[32:35]
    v_max3_f32 v53, v53, v20, v21
    v_mfma_f32_16x16x32_bf16 v[36:39], a[224:227], a[80:83], v[36:39]
    v_cvt_pk_bf16_f32 v176, v20, v21
    ds_read_b128 a[200:203], v62 offset:0
    s_waitcnt lgkmcnt(5)
    v_mfma_f32_16x16x32_bf16 v[28:31], a[228:231], a[20:23], v[28:31]
    v_max3_f32 v53, v53, v22, v23
    v_mfma_f32_16x16x32_bf16 v[32:35], a[228:231], a[52:55], v[32:35]
    v_cvt_pk_bf16_f32 v177, v22, v23
    v_mfma_f32_16x16x32_bf16 v[36:39], a[228:231], a[84:87], v[36:39]
    v_max3_f32 v54, v54, v24, v25
    ds_read_b128 a[204:207], v63 offset:0
    s_waitcnt lgkmcnt(5)
    v_mfma_f32_16x16x32_bf16 v[28:31], a[232:235], a[24:27], v[28:31]
    v_cvt_pk_bf16_f32 v180, v24, v25
    v_mfma_f32_16x16x32_bf16 v[32:35], a[232:235], a[56:59], v[32:35]
    v_max3_f32 v54, v54, v26, v27
    v_mfma_f32_16x16x32_bf16 v[36:39], a[232:235], a[88:91], v[36:39]
    v_cvt_pk_bf16_f32 v181, v26, v27
    ds_read_b128 a[208:211], v60 offset:256
    s_waitcnt lgkmcnt(5)
    v_mfma_f32_16x16x32_bf16 v[28:31], a[236:239], a[28:31], v[28:31]
    v_mfma_f32_16x16x32_bf16 v[32:35], a[236:239], a[60:63], v[32:35]
    v_mfma_f32_16x16x32_bf16 v[36:39], a[236:239], a[92:95], v[36:39]
    ds_read_b128 a[212:215], v61 offset:256
    s_waitcnt lgkmcnt(5)
    v_mfma_f32_16x16x32_bf16 v[16:19], a[192:195], a[0:3], 0
    v_mfma_f32_16x16x32_bf16 v[20:23], a[192:195], a[32:35], 0
    v_mfma_f32_16x16x32_bf16 v[24:27], a[192:195], a[64:67], 0
    ds_read_b128 a[216:219], v62 offset:256
    s_waitcnt lgkmcnt(5)
    v_mfma_f32_16x16x32_bf16 v[16:19], a[196:199], a[4:7], v[16:19]
    v_mfma_f32_16x16x32_bf16 v[20:23], a[196:199], a[36:39], v[20:23]
    v_mfma_f32_16x16x32_bf16 v[24:27], a[196:199], a[68:71], v[24:27]
    ds_read_b128 a[220:223], v63 offset:256
    s_waitcnt lgkmcnt(5)
    v_mfma_f32_16x16x32_bf16 v[16:19], a[200:203], a[8:11], v[16:19]
    v_mfma_f32_16x16x32_bf16 v[20:23], a[200:203], a[40:43], v[20:23]
    v_mfma_f32_16x16x32_bf16 v[24:27], a[200:203], a[72:75], v[24:27]
    ds_read_b128 a[224:227], v60 offset:2048
    s_waitcnt lgkmcnt(5)
    v_mfma_f32_16x16x32_bf16 v[16:19], a[204:207], a[12:15], v[16:19]
    v_max3_f32 v52, v52, v28, v29
    v_mfma_f32_16x16x32_bf16 v[20:23], a[204:207], a[44:47], v[20:23]
    v_cvt_pk_bf16_f32 v174, v28, v29
    v_mfma_f32_16x16x32_bf16 v[24:27], a[204:207], a[76:79], v[24:27]
    v_max3_f32 v52, v52, v30, v31
    ds_read_b128 a[228:231], v61 offset:2048
    s_waitcnt lgkmcnt(5)
    v_mfma_f32_16x16x32_bf16 v[16:19], a[208:211], a[16:19], v[16:19]
    v_cvt_pk_bf16_f32 v175, v30, v31
    v_mfma_f32_16x16x32_bf16 v[20:23], a[208:211], a[48:51], v[20:23]
    v_max3_f32 v53, v53, v32, v33
    v_mfma_f32_16x16x32_bf16 v[24:27], a[208:211], a[80:83], v[24:27]
    v_cvt_pk_bf16_f32 v178, v32, v33
    ds_read_b128 a[232:235], v62 offset:2048
    s_waitcnt lgkmcnt(5)
    v_mfma_f32_16x16x32_bf16 v[16:19], a[212:215], a[20:23], v[16:19]
    v_max3_f32 v53, v53, v34, v35
    v_mfma_f32_16x16x32_bf16 v[20:23], a[212:215], a[52:55], v[20:23]
    v_cvt_pk_bf16_f32 v179, v34, v35
    v_mfma_f32_16x16x32_bf16 v[24:27], a[212:215], a[84:87], v[24:27]
    v_max3_f32 v54, v54, v36, v37
    ds_read_b128 a[236:239], v63 offset:2048
    s_waitcnt lgkmcnt(5)
    v_mfma_f32_16x16x32_bf16 v[16:19], a[216:219], a[24:27], v[16:19]
    v_cvt_pk_bf16_f32 v182, v36, v37
    v_mfma_f32_16x16x32_bf16 v[20:23], a[216:219], a[56:59], v[20:23]
    v_max3_f32 v54, v54, v38, v39
    v_mfma_f32_16x16x32_bf16 v[24:27], a[216:219], a[88:91], v[24:27]
    v_cvt_pk_bf16_f32 v183, v38, v39
    ds_read_b128 a[192:195], v60 offset:2304
    s_waitcnt lgkmcnt(5)
    v_mfma_f32_16x16x32_bf16 v[16:19], a[220:223], a[28:31], v[16:19]
    v_mfma_f32_16x16x32_bf16 v[20:23], a[220:223], a[60:63], v[20:23]
    v_mfma_f32_16x16x32_bf16 v[24:27], a[220:223], a[92:95], v[24:27]
    ds_read_b128 a[196:199], v61 offset:2304
    s_waitcnt lgkmcnt(5)
    v_mfma_f32_16x16x32_bf16 v[28:31], a[224:227], a[0:3], 0
    v_mfma_f32_16x16x32_bf16 v[32:35], a[224:227], a[32:35], 0
    v_mfma_f32_16x16x32_bf16 v[36:39], a[224:227], a[64:67], 0
    ds_read_b128 a[200:203], v62 offset:2304
    s_waitcnt lgkmcnt(5)
    v_mfma_f32_16x16x32_bf16 v[28:31], a[228:231], a[4:7], v[28:31]
    v_mfma_f32_16x16x32_bf16 v[32:35], a[228:231], a[36:39], v[32:35]
    v_mfma_f32_16x16x32_bf16 v[36:39], a[228:231], a[68:71], v[36:39]
    ds_read_b128 a[204:207], v63 offset:2304
    s_waitcnt lgkmcnt(5)
    v_mfma_f32_16x16x32_bf16 v[28:31], a[232:235], a[8:11], v[28:31]
    v_mfma_f32_16x16x32_bf16 v[32:35], a[232:235], a[40:43], v[32:35]
    v_mfma_f32_16x16x32_bf16 v[36:39], a[232:235], a[72:75], v[36:39]
    s_barrier
    v_add_u32 v60, 81920, v8
    v_add_u32 v61, 81920, v9
    v_add_u32 v62, 81920, v10
    v_add_u32 v63, 81920, v11
    ds_read_b128 a[208:211], v60 offset:0
    s_waitcnt lgkmcnt(5)
    v_mfma_f32_16x16x32_bf16 v[28:31], a[236:239], a[12:15], v[28:31]
    v_max3_f32 v52, v52, v16, v17
    v_mfma_f32_16x16x32_bf16 v[32:35], a[236:239], a[44:47], v[32:35]
    v_cvt_pk_bf16_f32 v184, v16, v17
    v_mfma_f32_16x16x32_bf16 v[36:39], a[236:239], a[76:79], v[36:39]
    v_max3_f32 v52, v52, v18, v19
    ds_read_b128 a[212:215], v61 offset:0
    s_waitcnt lgkmcnt(5)
    v_mfma_f32_16x16x32_bf16 v[28:31], a[192:195], a[16:19], v[28:31]
    v_cvt_pk_bf16_f32 v185, v18, v19
    v_mfma_f32_16x16x32_bf16 v[32:35], a[192:195], a[48:51], v[32:35]
    v_max3_f32 v53, v53, v20, v21
    v_mfma_f32_16x16x32_bf16 v[36:39], a[192:195], a[80:83], v[36:39]
    v_cvt_pk_bf16_f32 v188, v20, v21
    ds_read_b128 a[216:219], v62 offset:0
    s_waitcnt lgkmcnt(5)
    v_mfma_f32_16x16x32_bf16 v[28:31], a[196:199], a[20:23], v[28:31]
    v_max3_f32 v53, v53, v22, v23
    v_mfma_f32_16x16x32_bf16 v[32:35], a[196:199], a[52:55], v[32:35]
    v_cvt_pk_bf16_f32 v189, v22, v23
    v_mfma_f32_16x16x32_bf16 v[36:39], a[196:199], a[84:87], v[36:39]
    v_max3_f32 v54, v54, v24, v25
    ds_read_b128 a[220:223], v63 offset:0
    s_waitcnt lgkmcnt(5)
    v_mfma_f32_16x16x32_bf16 v[28:31], a[200:203], a[24:27], v[28:31]
    v_cvt_pk_bf16_f32 v192, v24, v25
    v_mfma_f32_16x16x32_bf16 v[32:35], a[200:203], a[56:59], v[32:35]
    v_max3_f32 v54, v54, v26, v27
    v_mfma_f32_16x16x32_bf16 v[36:39], a[200:203], a[88:91], v[36:39]
    v_cvt_pk_bf16_f32 v193, v26, v27
    ds_read_b128 a[224:227], v60 offset:256
    s_waitcnt lgkmcnt(5)
    v_mfma_f32_16x16x32_bf16 v[28:31], a[204:207], a[28:31], v[28:31]
    v_mfma_f32_16x16x32_bf16 v[32:35], a[204:207], a[60:63], v[32:35]
    v_mfma_f32_16x16x32_bf16 v[36:39], a[204:207], a[92:95], v[36:39]
    ds_read_b128 a[228:231], v61 offset:256
    s_waitcnt lgkmcnt(5)
    v_mfma_f32_16x16x32_bf16 v[16:19], a[208:211], a[0:3], 0
    v_mfma_f32_16x16x32_bf16 v[20:23], a[208:211], a[32:35], 0
    v_mfma_f32_16x16x32_bf16 v[24:27], a[208:211], a[64:67], 0
    ds_read_b128 a[232:235], v62 offset:256
    s_waitcnt lgkmcnt(5)
    v_mfma_f32_16x16x32_bf16 v[16:19], a[212:215], a[4:7], v[16:19]
    v_mfma_f32_16x16x32_bf16 v[20:23], a[212:215], a[36:39], v[20:23]
    v_mfma_f32_16x16x32_bf16 v[24:27], a[212:215], a[68:71], v[24:27]
    ds_read_b128 a[236:239], v63 offset:256
    s_waitcnt lgkmcnt(5)
    v_mfma_f32_16x16x32_bf16 v[16:19], a[216:219], a[8:11], v[16:19]
    v_mfma_f32_16x16x32_bf16 v[20:23], a[216:219], a[40:43], v[20:23]
    v_mfma_f32_16x16x32_bf16 v[24:27], a[216:219], a[72:75], v[24:27]
    ds_read_b128 a[192:195], v60 offset:2048
    s_waitcnt lgkmcnt(5)
    v_mfma_f32_16x16x32_bf16 v[16:19], a[220:223], a[12:15], v[16:19]
    v_max3_f32 v52, v52, v28, v29
    v_mfma_f32_16x16x32_bf16 v[20:23], a[220:223], a[44:47], v[20:23]
    v_cvt_pk_bf16_f32 v186, v28, v29
    v_mfma_f32_16x16x32_bf16 v[24:27], a[220:223], a[76:79], v[24:27]
    v_max3_f32 v52, v52, v30, v31
    ds_read_b128 a[196:199], v61 offset:2048
    s_waitcnt lgkmcnt(5)
    v_mfma_f32_16x16x32_bf16 v[16:19], a[224:227], a[16:19], v[16:19]
    v_cvt_pk_bf16_f32 v187, v30, v31
    v_mfma_f32_16x16x32_bf16 v[20:23], a[224:227], a[48:51], v[20:23]
    v_max3_f32 v53, v53, v32, v33
    v_mfma_f32_16x16x32_bf16 v[24:27], a[224:227], a[80:83], v[24:27]
    v_cvt_pk_bf16_f32 v190, v32, v33
    ds_read_b128 a[200:203], v62 offset:2048
    s_waitcnt lgkmcnt(5)
    v_mfma_f32_16x16x32_bf16 v[16:19], a[228:231], a[20:23], v[16:19]
    v_max3_f32 v53, v53, v34, v35
    v_mfma_f32_16x16x32_bf16 v[20:23], a[228:231], a[52:55], v[20:23]
    v_cvt_pk_bf16_f32 v191, v34, v35
    v_mfma_f32_16x16x32_bf16 v[24:27], a[228:231], a[84:87], v[24:27]
    v_max3_f32 v54, v54, v36, v37
    ds_read_b128 a[204:207], v63 offset:2048
    s_waitcnt lgkmcnt(5)
    v_mfma_f32_16x16x32_bf16 v[16:19], a[232:235], a[24:27], v[16:19]
    v_cvt_pk_bf16_f32 v194, v36, v37
    v_mfma_f32_16x16x32_bf16 v[20:23], a[232:235], a[56:59], v[20:23]
    v_max3_f32 v54, v54, v38, v39
    v_mfma_f32_16x16x32_bf16 v[24:27], a[232:235], a[88:91], v[24:27]
    v_cvt_pk_bf16_f32 v195, v38, v39
    ds_read_b128 a[208:211], v60 offset:2304
    s_waitcnt lgkmcnt(5)
    v_mfma_f32_16x16x32_bf16 v[16:19], a[236:239], a[28:31], v[16:19]
    v_mfma_f32_16x16x32_bf16 v[20:23], a[236:239], a[60:63], v[20:23]
    v_mfma_f32_16x16x32_bf16 v[24:27], a[236:239], a[92:95], v[24:27]
    ds_read_b128 a[212:215], v61 offset:2304
    s_waitcnt lgkmcnt(5)
    v_mfma_f32_16x16x32_bf16 v[28:31], a[192:195], a[0:3], 0
    v_mfma_f32_16x16x32_bf16 v[32:35], a[192:195], a[32:35], 0
    v_mfma_f32_16x16x32_bf16 v[36:39], a[192:195], a[64:67], 0
    ds_read_b128 a[216:219], v62 offset:2304
    s_waitcnt lgkmcnt(5)
    v_mfma_f32_16x16x32_bf16 v[28:31], a[196:199], a[4:7], v[28:31]
    v_mfma_f32_16x16x32_bf16 v[32:35], a[196:199], a[36:39], v[32:35]
    v_mfma_f32_16x16x32_bf16 v[36:39], a[196:199], a[68:71], v[36:39]
    ds_read_b128 a[220:223], v63 offset:2304
    s_waitcnt lgkmcnt(5)
    v_mfma_f32_16x16x32_bf16 v[28:31], a[200:203], a[8:11], v[28:31]
    v_mfma_f32_16x16x32_bf16 v[32:35], a[200:203], a[40:43], v[32:35]
    v_mfma_f32_16x16x32_bf16 v[36:39], a[200:203], a[72:75], v[36:39]
    s_barrier
    v_add_u32 v60, 98304, v8
    v_add_u32 v61, 98304, v9
    v_add_u32 v62, 98304, v10
    v_add_u32 v63, 98304, v11
    ds_read_b128 a[224:227], v60 offset:0
    s_waitcnt lgkmcnt(5)
    v_mfma_f32_16x16x32_bf16 v[28:31], a[204:207], a[12:15], v[28:31]
    v_max3_f32 v52, v52, v16, v17
    v_mfma_f32_16x16x32_bf16 v[32:35], a[204:207], a[44:47], v[32:35]
    v_cvt_pk_bf16_f32 v196, v16, v17
    v_mfma_f32_16x16x32_bf16 v[36:39], a[204:207], a[76:79], v[36:39]
    v_max3_f32 v52, v52, v18, v19
    ds_read_b128 a[228:231], v61 offset:0
    s_waitcnt lgkmcnt(5)
    v_mfma_f32_16x16x32_bf16 v[28:31], a[208:211], a[16:19], v[28:31]
    v_cvt_pk_bf16_f32 v197, v18, v19
    v_mfma_f32_16x16x32_bf16 v[32:35], a[208:211], a[48:51], v[32:35]
    v_max3_f32 v53, v53, v20, v21
    v_mfma_f32_16x16x32_bf16 v[36:39], a[208:211], a[80:83], v[36:39]
    v_cvt_pk_bf16_f32 v200, v20, v21
    ds_read_b128 a[232:235], v62 offset:0
    s_waitcnt lgkmcnt(5)
    v_mfma_f32_16x16x32_bf16 v[28:31], a[212:215], a[20:23], v[28:31]
    v_max3_f32 v53, v53, v22, v23
    v_mfma_f32_16x16x32_bf16 v[32:35], a[212:215], a[52:55], v[32:35]
    v_cvt_pk_bf16_f32 v201, v22, v23
    v_mfma_f32_16x16x32_bf16 v[36:39], a[212:215], a[84:87], v[36:39]
    v_max3_f32 v54, v54, v24, v25
    ds_read_b128 a[236:239], v63 offset:0
    s_waitcnt lgkmcnt(5)
    v_mfma_f32_16x16x32_bf16 v[28:31], a[216:219], a[24:27], v[28:31]
    v_cvt_pk_bf16_f32 v204, v24, v25
    v_mfma_f32_16x16x32_bf16 v[32:35], a[216:219], a[56:59], v[32:35]
    v_max3_f32 v54, v54, v26, v27
    v_mfma_f32_16x16x32_bf16 v[36:39], a[216:219], a[88:91], v[36:39]
    v_cvt_pk_bf16_f32 v205, v26, v27
    ds_read_b128 a[192:195], v60 offset:256
    s_waitcnt lgkmcnt(5)
    v_mfma_f32_16x16x32_bf16 v[28:31], a[220:223], a[28:31], v[28:31]
    v_mfma_f32_16x16x32_bf16 v[32:35], a[220:223], a[60:63], v[32:35]
    v_mfma_f32_16x16x32_bf16 v[36:39], a[220:223], a[92:95], v[36:39]
    ds_read_b128 a[196:199], v61 offset:256
    s_waitcnt lgkmcnt(5)
    v_mfma_f32_16x16x32_bf16 v[16:19], a[224:227], a[0:3], 0
    v_mfma_f32_16x16x32_bf16 v[20:23], a[224:227], a[32:35], 0
    v_mfma_f32_16x16x32_bf16 v[24:27], a[224:227], a[64:67], 0
    ds_read_b128 a[200:203], v62 offset:256
    s_waitcnt lgkmcnt(5)
    v_mfma_f32_16x16x32_bf16 v[16:19], a[228:231], a[4:7], v[16:19]
    v_mfma_f32_16x16x32_bf16 v[20:23], a[228:231], a[36:39], v[20:23]
    v_mfma_f32_16x16x32_bf16 v[24:27], a[228:231], a[68:71], v[24:27]
    ds_read_b128 a[204:207], v63 offset:256
    s_waitcnt lgkmcnt(5)
    v_mfma_f32_16x16x32_bf16 v[16:19], a[232:235], a[8:11], v[16:19]
    v_mfma_f32_16x16x32_bf16 v[20:23], a[232:235], a[40:43], v[20:23]
    v_mfma_f32_16x16x32_bf16 v[24:27], a[232:235], a[72:75], v[24:27]
    ds_read_b128 a[208:211], v60 offset:2048
    s_waitcnt lgkmcnt(5)
    v_mfma_f32_16x16x32_bf16 v[16:19], a[236:239], a[12:15], v[16:19]
    v_max3_f32 v52, v52, v28, v29
    v_mfma_f32_16x16x32_bf16 v[20:23], a[236:239], a[44:47], v[20:23]
    v_cvt_pk_bf16_f32 v198, v28, v29
    v_mfma_f32_16x16x32_bf16 v[24:27], a[236:239], a[76:79], v[24:27]
    v_max3_f32 v52, v52, v30, v31
    ds_read_b128 a[212:215], v61 offset:2048
    s_waitcnt lgkmcnt(5)
    v_mfma_f32_16x16x32_bf16 v[16:19], a[192:195], a[16:19], v[16:19]
    v_cvt_pk_bf16_f32 v199, v30, v31
    v_mfma_f32_16x16x32_bf16 v[20:23], a[192:195], a[48:51], v[20:23]
    v_max3_f32 v53, v53, v32, v33
    v_mfma_f32_16x16x32_bf16 v[24:27], a[192:195], a[80:83], v[24:27]
    v_cvt_pk_bf16_f32 v202, v32, v33
    ds_read_b128 a[216:219], v62 offset:2048
    s_waitcnt lgkmcnt(5)
    v_mfma_f32_16x16x32_bf16 v[16:19], a[196:199], a[20:23], v[16:19]
    v_max3_f32 v53, v53, v34, v35
    v_mfma_f32_16x16x32_bf16 v[20:23], a[196:199], a[52:55], v[20:23]
    v_cvt_pk_bf16_f32 v203, v34, v35
    v_mfma_f32_16x16x32_bf16 v[24:27], a[196:199], a[84:87], v[24:27]
    v_max3_f32 v54, v54, v36, v37
    ds_read_b128 a[220:223], v63 offset:2048
    s_waitcnt lgkmcnt(5)
    v_mfma_f32_16x16x32_bf16 v[16:19], a[200:203], a[24:27], v[16:19]
    v_cvt_pk_bf16_f32 v206, v36, v37
    v_mfma_f32_16x16x32_bf16 v[20:23], a[200:203], a[56:59], v[20:23]
    v_max3_f32 v54, v54, v38, v39
    v_mfma_f32_16x16x32_bf16 v[24:27], a[200:203], a[88:91], v[24:27]
    v_cvt_pk_bf16_f32 v207, v38, v39
    ds_read_b128 a[224:227], v60 offset:2304
    s_waitcnt lgkmcnt(5)
    v_mfma_f32_16x16x32_bf16 v[16:19], a[204:207], a[28:31], v[16:19]
    v_mfma_f32_16x16x32_bf16 v[20:23], a[204:207], a[60:63], v[20:23]
    v_mfma_f32_16x16x32_bf16 v[24:27], a[204:207], a[92:95], v[24:27]
    ds_read_b128 a[228:231], v61 offset:2304
    s_waitcnt lgkmcnt(5)
    v_mfma_f32_16x16x32_bf16 v[28:31], a[208:211], a[0:3], 0
    v_mfma_f32_16x16x32_bf16 v[32:35], a[208:211], a[32:35], 0
    v_mfma_f32_16x16x32_bf16 v[36:39], a[208:211], a[64:67], 0
    ds_read_b128 a[232:235], v62 offset:2304
    s_waitcnt lgkmcnt(5)
    v_mfma_f32_16x16x32_bf16 v[28:31], a[212:215], a[4:7], v[28:31]
    v_mfma_f32_16x16x32_bf16 v[32:35], a[212:215], a[36:39], v[32:35]
    v_mfma_f32_16x16x32_bf16 v[36:39], a[212:215], a[68:71], v[36:39]
    ds_read_b128 a[236:239], v63 offset:2304
    s_waitcnt lgkmcnt(5)
    v_mfma_f32_16x16x32_bf16 v[28:31], a[216:219], a[8:11], v[28:31]
    v_mfma_f32_16x16x32_bf16 v[32:35], a[216:219], a[40:43], v[32:35]
    v_mfma_f32_16x16x32_bf16 v[36:39], a[216:219], a[72:75], v[36:39]
    s_barrier
    v_add_u32 v60, 114688, v8
    v_add_u32 v61, 114688, v9
    v_add_u32 v62, 114688, v10
    v_add_u32 v63, 114688, v11
    ds_read_b128 a[192:195], v60 offset:0
    s_waitcnt lgkmcnt(5)
    v_mfma_f32_16x16x32_bf16 v[28:31], a[220:223], a[12:15], v[28:31]
    v_max3_f32 v52, v52, v16, v17
    v_mfma_f32_16x16x32_bf16 v[32:35], a[220:223], a[44:47], v[32:35]
    v_cvt_pk_bf16_f32 v208, v16, v17
    v_mfma_f32_16x16x32_bf16 v[36:39], a[220:223], a[76:79], v[36:39]
    v_max3_f32 v52, v52, v18, v19
    ds_read_b128 a[196:199], v61 offset:0
    s_waitcnt lgkmcnt(5)
    v_mfma_f32_16x16x32_bf16 v[28:31], a[224:227], a[16:19], v[28:31]
    v_cvt_pk_bf16_f32 v209, v18, v19
    v_mfma_f32_16x16x32_bf16 v[32:35], a[224:227], a[48:51], v[32:35]
    v_max3_f32 v53, v53, v20, v21
    v_mfma_f32_16x16x32_bf16 v[36:39], a[224:227], a[80:83], v[36:39]
    v_cvt_pk_bf16_f32 v212, v20, v21
    ds_read_b128 a[200:203], v62 offset:0
    s_waitcnt lgkmcnt(5)
    v_mfma_f32_16x16x32_bf16 v[28:31], a[228:231], a[20:23], v[28:31]
    v_max3_f32 v53, v53, v22, v23
    v_mfma_f32_16x16x32_bf16 v[32:35], a[228:231], a[52:55], v[32:35]
    v_cvt_pk_bf16_f32 v213, v22, v23
    v_mfma_f32_16x16x32_bf16 v[36:39], a[228:231], a[84:87], v[36:39]
    v_max3_f32 v54, v54, v24, v25
    ds_read_b128 a[204:207], v63 offset:0
    s_waitcnt lgkmcnt(5)
    v_mfma_f32_16x16x32_bf16 v[28:31], a[232:235], a[24:27], v[28:31]
    v_cvt_pk_bf16_f32 v216, v24, v25
    v_mfma_f32_16x16x32_bf16 v[32:35], a[232:235], a[56:59], v[32:35]
    v_max3_f32 v54, v54, v26, v27
    v_mfma_f32_16x16x32_bf16 v[36:39], a[232:235], a[88:91], v[36:39]
    v_cvt_pk_bf16_f32 v217, v26, v27
    ds_read_b128 a[208:211], v60 offset:256
    s_waitcnt lgkmcnt(5)
    v_mfma_f32_16x16x32_bf16 v[28:31], a[236:239], a[28:31], v[28:31]
    v_mfma_f32_16x16x32_bf16 v[32:35], a[236:239], a[60:63], v[32:35]
    v_mfma_f32_16x16x32_bf16 v[36:39], a[236:239], a[92:95], v[36:39]
    ds_read_b128 a[212:215], v61 offset:256
    s_waitcnt lgkmcnt(5)
    v_mfma_f32_16x16x32_bf16 v[16:19], a[192:195], a[0:3], 0
    v_mfma_f32_16x16x32_bf16 v[20:23], a[192:195], a[32:35], 0
    v_mfma_f32_16x16x32_bf16 v[24:27], a[192:195], a[64:67], 0
    ds_read_b128 a[216:219], v62 offset:256
    s_waitcnt lgkmcnt(5)
    v_mfma_f32_16x16x32_bf16 v[16:19], a[196:199], a[4:7], v[16:19]
    v_mfma_f32_16x16x32_bf16 v[20:23], a[196:199], a[36:39], v[20:23]
    v_mfma_f32_16x16x32_bf16 v[24:27], a[196:199], a[68:71], v[24:27]
    ds_read_b128 a[220:223], v63 offset:256
    s_waitcnt lgkmcnt(5)
    v_mfma_f32_16x16x32_bf16 v[16:19], a[200:203], a[8:11], v[16:19]
    v_mfma_f32_16x16x32_bf16 v[20:23], a[200:203], a[40:43], v[20:23]
    v_mfma_f32_16x16x32_bf16 v[24:27], a[200:203], a[72:75], v[24:27]
    ds_read_b128 a[224:227], v60 offset:2048
    s_waitcnt lgkmcnt(5)
    v_mfma_f32_16x16x32_bf16 v[16:19], a[204:207], a[12:15], v[16:19]
    v_max3_f32 v52, v52, v28, v29
    v_mfma_f32_16x16x32_bf16 v[20:23], a[204:207], a[44:47], v[20:23]
    v_cvt_pk_bf16_f32 v210, v28, v29
    v_mfma_f32_16x16x32_bf16 v[24:27], a[204:207], a[76:79], v[24:27]
    v_max3_f32 v52, v52, v30, v31
    ds_read_b128 a[228:231], v61 offset:2048
    s_waitcnt lgkmcnt(5)
    v_mfma_f32_16x16x32_bf16 v[16:19], a[208:211], a[16:19], v[16:19]
    v_cvt_pk_bf16_f32 v211, v30, v31
    v_mfma_f32_16x16x32_bf16 v[20:23], a[208:211], a[48:51], v[20:23]
    v_max3_f32 v53, v53, v32, v33
    v_mfma_f32_16x16x32_bf16 v[24:27], a[208:211], a[80:83], v[24:27]
    v_cvt_pk_bf16_f32 v214, v32, v33
    ds_read_b128 a[232:235], v62 offset:2048
    s_waitcnt lgkmcnt(5)
    v_mfma_f32_16x16x32_bf16 v[16:19], a[212:215], a[20:23], v[16:19]
    v_max3_f32 v53, v53, v34, v35
    v_mfma_f32_16x16x32_bf16 v[20:23], a[212:215], a[52:55], v[20:23]
    v_cvt_pk_bf16_f32 v215, v34, v35
    v_mfma_f32_16x16x32_bf16 v[24:27], a[212:215], a[84:87], v[24:27]
    v_max3_f32 v54, v54, v36, v37
    ds_read_b128 a[236:239], v63 offset:2048
    s_waitcnt lgkmcnt(5)
    v_mfma_f32_16x16x32_bf16 v[16:19], a[216:219], a[24:27], v[16:19]
    v_cvt_pk_bf16_f32 v218, v36, v37
    v_mfma_f32_16x16x32_bf16 v[20:23], a[216:219], a[56:59], v[20:23]
    v_max3_f32 v54, v54, v38, v39
    v_mfma_f32_16x16x32_bf16 v[24:27], a[216:219], a[88:91], v[24:27]
    v_cvt_pk_bf16_f32 v219, v38, v39
    ds_read_b128 a[192:195], v60 offset:2304
    s_waitcnt lgkmcnt(5)
    v_mfma_f32_16x16x32_bf16 v[16:19], a[220:223], a[28:31], v[16:19]
    v_mfma_f32_16x16x32_bf16 v[20:23], a[220:223], a[60:63], v[20:23]
    v_mfma_f32_16x16x32_bf16 v[24:27], a[220:223], a[92:95], v[24:27]
    ds_read_b128 a[196:199], v61 offset:2304
    s_waitcnt lgkmcnt(5)
    v_mfma_f32_16x16x32_bf16 v[28:31], a[224:227], a[0:3], 0
    v_mfma_f32_16x16x32_bf16 v[32:35], a[224:227], a[32:35], 0
    v_mfma_f32_16x16x32_bf16 v[36:39], a[224:227], a[64:67], 0
    ds_read_b128 a[200:203], v62 offset:2304
    s_waitcnt lgkmcnt(5)
    v_mfma_f32_16x16x32_bf16 v[28:31], a[228:231], a[4:7], v[28:31]
    v_mfma_f32_16x16x32_bf16 v[32:35], a[228:231], a[36:39], v[32:35]
    v_mfma_f32_16x16x32_bf16 v[36:39], a[228:231], a[68:71], v[36:39]
    ds_read_b128 a[204:207], v63 offset:2304
    s_waitcnt lgkmcnt(5)
    v_mfma_f32_16x16x32_bf16 v[28:31], a[232:235], a[8:11], v[28:31]
    v_mfma_f32_16x16x32_bf16 v[32:35], a[232:235], a[40:43], v[32:35]
    v_mfma_f32_16x16x32_bf16 v[36:39], a[232:235], a[72:75], v[36:39]
    s_barrier
    v_add_u32 v60, 131072, v8
    v_add_u32 v61, 131072, v9
    v_add_u32 v62, 131072, v10
    v_add_u32 v63, 131072, v11
    ds_read_b128 a[208:211], v60 offset:0
    s_waitcnt lgkmcnt(5)
    v_mfma_f32_16x16x32_bf16 v[28:31], a[236:239], a[12:15], v[28:31]
    v_max3_f32 v52, v52, v16, v17
    v_mfma_f32_16x16x32_bf16 v[32:35], a[236:239], a[44:47], v[32:35]
    v_cvt_pk_bf16_f32 v220, v16, v17
    v_mfma_f32_16x16x32_bf16 v[36:39], a[236:239], a[76:79], v[36:39]
    v_max3_f32 v52, v52, v18, v19
    ds_read_b128 a[212:215], v61 offset:0
    s_waitcnt lgkmcnt(5)
    v_mfma_f32_16x16x32_bf16 v[28:31], a[192:195], a[16:19], v[28:31]
    v_cvt_pk_bf16_f32 v221, v18, v19
    v_mfma_f32_16x16x32_bf16 v[32:35], a[192:195], a[48:51], v[32:35]
    v_max3_f32 v53, v53, v20, v21
    v_mfma_f32_16x16x32_bf16 v[36:39], a[192:195], a[80:83], v[36:39]
    v_cvt_pk_bf16_f32 v224, v20, v21
    ds_read_b128 a[216:219], v62 offset:0
    s_waitcnt lgkmcnt(5)
    v_mfma_f32_16x16x32_bf16 v[28:31], a[196:199], a[20:23], v[28:31]
    v_max3_f32 v53, v53, v22, v23
    v_mfma_f32_16x16x32_bf16 v[32:35], a[196:199], a[52:55], v[32:35]
    v_cvt_pk_bf16_f32 v225, v22, v23
    v_mfma_f32_16x16x32_bf16 v[36:39], a[196:199], a[84:87], v[36:39]
    v_max3_f32 v54, v54, v24, v25
    ds_read_b128 a[220:223], v63 offset:0
    s_waitcnt lgkmcnt(5)
    v_mfma_f32_16x16x32_bf16 v[28:31], a[200:203], a[24:27], v[28:31]
    v_cvt_pk_bf16_f32 v228, v24, v25
    v_mfma_f32_16x16x32_bf16 v[32:35], a[200:203], a[56:59], v[32:35]
    v_max3_f32 v54, v54, v26, v27
    v_mfma_f32_16x16x32_bf16 v[36:39], a[200:203], a[88:91], v[36:39]
    v_cvt_pk_bf16_f32 v229, v26, v27
    ds_read_b128 a[224:227], v60 offset:256
    s_waitcnt lgkmcnt(5)
    v_mfma_f32_16x16x32_bf16 v[28:31], a[204:207], a[28:31], v[28:31]
    v_mfma_f32_16x16x32_bf16 v[32:35], a[204:207], a[60:63], v[32:35]
    v_mfma_f32_16x16x32_bf16 v[36:39], a[204:207], a[92:95], v[36:39]
    ds_read_b128 a[228:231], v61 offset:256
    s_waitcnt lgkmcnt(5)
    v_mfma_f32_16x16x32_bf16 v[16:19], a[208:211], a[0:3], 0
    v_mfma_f32_16x16x32_bf16 v[20:23], a[208:211], a[32:35], 0
    v_mfma_f32_16x16x32_bf16 v[24:27], a[208:211], a[64:67], 0
    ds_read_b128 a[232:235], v62 offset:256
    s_waitcnt lgkmcnt(5)
    v_mfma_f32_16x16x32_bf16 v[16:19], a[212:215], a[4:7], v[16:19]
    v_mfma_f32_16x16x32_bf16 v[20:23], a[212:215], a[36:39], v[20:23]
    v_mfma_f32_16x16x32_bf16 v[24:27], a[212:215], a[68:71], v[24:27]
    ds_read_b128 a[236:239], v63 offset:256
    s_waitcnt lgkmcnt(5)
    v_mfma_f32_16x16x32_bf16 v[16:19], a[216:219], a[8:11], v[16:19]
    v_mfma_f32_16x16x32_bf16 v[20:23], a[216:219], a[40:43], v[20:23]
    v_mfma_f32_16x16x32_bf16 v[24:27], a[216:219], a[72:75], v[24:27]
    ds_read_b128 a[192:195], v60 offset:2048
    s_waitcnt lgkmcnt(5)
    v_mfma_f32_16x16x32_bf16 v[16:19], a[220:223], a[12:15], v[16:19]
    v_max3_f32 v52, v52, v28, v29
    v_mfma_f32_16x16x32_bf16 v[20:23], a[220:223], a[44:47], v[20:23]
    v_cvt_pk_bf16_f32 v222, v28, v29
    v_mfma_f32_16x16x32_bf16 v[24:27], a[220:223], a[76:79], v[24:27]
    v_max3_f32 v52, v52, v30, v31
    ds_read_b128 a[196:199], v61 offset:2048
    s_waitcnt lgkmcnt(5)
    v_mfma_f32_16x16x32_bf16 v[16:19], a[224:227], a[16:19], v[16:19]
    v_cvt_pk_bf16_f32 v223, v30, v31
    v_mfma_f32_16x16x32_bf16 v[20:23], a[224:227], a[48:51], v[20:23]
    v_max3_f32 v53, v53, v32, v33
    v_mfma_f32_16x16x32_bf16 v[24:27], a[224:227], a[80:83], v[24:27]
    v_cvt_pk_bf16_f32 v226, v32, v33
    ds_read_b128 a[200:203], v62 offset:2048
    s_waitcnt lgkmcnt(5)
    v_mfma_f32_16x16x32_bf16 v[16:19], a[228:231], a[20:23], v[16:19]
    v_max3_f32 v53, v53, v34, v35
    v_mfma_f32_16x16x32_bf16 v[20:23], a[228:231], a[52:55], v[20:23]
    v_cvt_pk_bf16_f32 v227, v34, v35
    v_mfma_f32_16x16x32_bf16 v[24:27], a[228:231], a[84:87], v[24:27]
    v_max3_f32 v54, v54, v36, v37
    ds_read_b128 a[204:207], v63 offset:2048
    s_waitcnt lgkmcnt(5)
    v_mfma_f32_16x16x32_bf16 v[16:19], a[232:235], a[24:27], v[16:19]
    v_cvt_pk_bf16_f32 v230, v36, v37
    v_mfma_f32_16x16x32_bf16 v[20:23], a[232:235], a[56:59], v[20:23]
    v_max3_f32 v54, v54, v38, v39
    v_mfma_f32_16x16x32_bf16 v[24:27], a[232:235], a[88:91], v[24:27]
    v_cvt_pk_bf16_f32 v231, v38, v39
    ds_read_b128 a[208:211], v60 offset:2304
    s_waitcnt lgkmcnt(5)
    v_mfma_f32_16x16x32_bf16 v[16:19], a[236:239], a[28:31], v[16:19]
    v_mfma_f32_16x16x32_bf16 v[20:23], a[236:239], a[60:63], v[20:23]
    v_mfma_f32_16x16x32_bf16 v[24:27], a[236:239], a[92:95], v[24:27]
    ds_read_b128 a[212:215], v61 offset:2304
    s_waitcnt lgkmcnt(5)
    v_mfma_f32_16x16x32_bf16 v[28:31], a[192:195], a[0:3], 0
    v_mfma_f32_16x16x32_bf16 v[32:35], a[192:195], a[32:35], 0
    v_mfma_f32_16x16x32_bf16 v[36:39], a[192:195], a[64:67], 0
    ds_read_b128 a[216:219], v62 offset:2304
    s_waitcnt lgkmcnt(5)
    v_mfma_f32_16x16x32_bf16 v[28:31], a[196:199], a[4:7], v[28:31]
    v_mfma_f32_16x16x32_bf16 v[32:35], a[196:199], a[36:39], v[32:35]
    v_mfma_f32_16x16x32_bf16 v[36:39], a[196:199], a[68:71], v[36:39]
    ds_read_b128 a[220:223], v63 offset:2304
    s_waitcnt lgkmcnt(5)
    v_mfma_f32_16x16x32_bf16 v[28:31], a[200:203], a[8:11], v[28:31]
    v_mfma_f32_16x16x32_bf16 v[32:35], a[200:203], a[40:43], v[32:35]
    v_mfma_f32_16x16x32_bf16 v[36:39], a[200:203], a[72:75], v[36:39]
    s_barrier
    v_add_u32 v60, 147456, v8
    v_add_u32 v61, 147456, v9
    v_add_u32 v62, 147456, v10
    v_add_u32 v63, 147456, v11
    ds_read_b128 a[224:227], v60 offset:0
    s_waitcnt lgkmcnt(5)
    v_mfma_f32_16x16x32_bf16 v[28:31], a[204:207], a[12:15], v[28:31]
    v_max3_f32 v52, v52, v16, v17
    v_mfma_f32_16x16x32_bf16 v[32:35], a[204:207], a[44:47], v[32:35]
    v_cvt_pk_bf16_f32 v232, v16, v17
    v_mfma_f32_16x16x32_bf16 v[36:39], a[204:207], a[76:79], v[36:39]
    v_max3_f32 v52, v52, v18, v19
    ds_read_b128 a[228:231], v61 offset:0
    s_waitcnt lgkmcnt(5)
    v_mfma_f32_16x16x32_bf16 v[28:31], a[208:211], a[16:19], v[28:31]
    v_cvt_pk_bf16_f32 v233, v18, v19
    v_mfma_f32_16x16x32_bf16 v[32:35], a[208:211], a[48:51], v[32:35]
    v_max3_f32 v53, v53, v20, v21
    v_mfma_f32_16x16x32_bf16 v[36:39], a[208:211], a[80:83], v[36:39]
    v_cvt_pk_bf16_f32 v236, v20, v21
    ds_read_b128 a[232:235], v62 offset:0
    s_waitcnt lgkmcnt(5)
    v_mfma_f32_16x16x32_bf16 v[28:31], a[212:215], a[20:23], v[28:31]
    v_max3_f32 v53, v53, v22, v23
    v_mfma_f32_16x16x32_bf16 v[32:35], a[212:215], a[52:55], v[32:35]
    v_cvt_pk_bf16_f32 v237, v22, v23
    v_mfma_f32_16x16x32_bf16 v[36:39], a[212:215], a[84:87], v[36:39]
    v_max3_f32 v54, v54, v24, v25
    ds_read_b128 a[236:239], v63 offset:0
    s_waitcnt lgkmcnt(5)
    v_mfma_f32_16x16x32_bf16 v[28:31], a[216:219], a[24:27], v[28:31]
    v_cvt_pk_bf16_f32 v240, v24, v25
    v_mfma_f32_16x16x32_bf16 v[32:35], a[216:219], a[56:59], v[32:35]
    v_max3_f32 v54, v54, v26, v27
    v_mfma_f32_16x16x32_bf16 v[36:39], a[216:219], a[88:91], v[36:39]
    v_cvt_pk_bf16_f32 v241, v26, v27
    ds_read_b128 a[192:195], v60 offset:256
    s_waitcnt lgkmcnt(5)
    v_mfma_f32_16x16x32_bf16 v[28:31], a[220:223], a[28:31], v[28:31]
    v_mfma_f32_16x16x32_bf16 v[32:35], a[220:223], a[60:63], v[32:35]
    v_mfma_f32_16x16x32_bf16 v[36:39], a[220:223], a[92:95], v[36:39]
    ds_read_b128 a[196:199], v61 offset:256
    s_waitcnt lgkmcnt(5)
    v_mfma_f32_16x16x32_bf16 v[16:19], a[224:227], a[0:3], 0
    v_mfma_f32_16x16x32_bf16 v[20:23], a[224:227], a[32:35], 0
    v_mfma_f32_16x16x32_bf16 v[24:27], a[224:227], a[64:67], 0
    ds_read_b128 a[200:203], v62 offset:256
    s_waitcnt lgkmcnt(5)
    v_mfma_f32_16x16x32_bf16 v[16:19], a[228:231], a[4:7], v[16:19]
    v_mfma_f32_16x16x32_bf16 v[20:23], a[228:231], a[36:39], v[20:23]
    v_mfma_f32_16x16x32_bf16 v[24:27], a[228:231], a[68:71], v[24:27]
    ds_read_b128 a[204:207], v63 offset:256
    s_waitcnt lgkmcnt(5)
    v_mfma_f32_16x16x32_bf16 v[16:19], a[232:235], a[8:11], v[16:19]
    v_mfma_f32_16x16x32_bf16 v[20:23], a[232:235], a[40:43], v[20:23]
    v_mfma_f32_16x16x32_bf16 v[24:27], a[232:235], a[72:75], v[24:27]
    ds_read_b128 a[208:211], v60 offset:2048
    s_waitcnt lgkmcnt(5)
    v_mfma_f32_16x16x32_bf16 v[16:19], a[236:239], a[12:15], v[16:19]
    v_max3_f32 v52, v52, v28, v29
    v_mfma_f32_16x16x32_bf16 v[20:23], a[236:239], a[44:47], v[20:23]
    v_cvt_pk_bf16_f32 v234, v28, v29
    v_mfma_f32_16x16x32_bf16 v[24:27], a[236:239], a[76:79], v[24:27]
    v_max3_f32 v52, v52, v30, v31
    ds_read_b128 a[212:215], v61 offset:2048
    s_waitcnt lgkmcnt(5)
    v_mfma_f32_16x16x32_bf16 v[16:19], a[192:195], a[16:19], v[16:19]
    v_cvt_pk_bf16_f32 v235, v30, v31
    v_mfma_f32_16x16x32_bf16 v[20:23], a[192:195], a[48:51], v[20:23]
    v_max3_f32 v53, v53, v32, v33
    v_mfma_f32_16x16x32_bf16 v[24:27], a[192:195], a[80:83], v[24:27]
    v_cvt_pk_bf16_f32 v238, v32, v33
    ds_read_b128 a[216:219], v62 offset:2048
    s_waitcnt lgkmcnt(5)
    v_mfma_f32_16x16x32_bf16 v[16:19], a[196:199], a[20:23], v[16:19]
    v_max3_f32 v53, v53, v34, v35
    v_mfma_f32_16x16x32_bf16 v[20:23], a[196:199], a[52:55], v[20:23]
    v_cvt_pk_bf16_f32 v239, v34, v35
    v_mfma_f32_16x16x32_bf16 v[24:27], a[196:199], a[84:87], v[24:27]
    v_max3_f32 v54, v54, v36, v37
    ds_read_b128 a[220:223], v63 offset:2048
    s_waitcnt lgkmcnt(5)
    v_mfma_f32_16x16x32_bf16 v[16:19], a[200:203], a[24:27], v[16:19]
    v_cvt_pk_bf16_f32 v242, v36, v37
    v_mfma_f32_16x16x32_bf16 v[20:23], a[200:203], a[56:59], v[20:23]
    v_max3_f32 v54, v54, v38, v39
    v_mfma_f32_16x16x32_bf16 v[24:27], a[200:203], a[88:91], v[24:27]
    v_cvt_pk_bf16_f32 v243, v38, v39
    ds_read_b128 a[224:227], v60 offset:2304
    s_waitcnt lgkmcnt(5)
    v_mfma_f32_16x16x32_bf16 v[16:19], a[204:207], a[28:31], v[16:19]
    v_mfma_f32_16x16x32_bf16 v[20:23], a[204:207], a[60:63], v[20:23]
    v_mfma_f32_16x16x32_bf16 v[24:27], a[204:207], a[92:95], v[24:27]
    ds_read_b128 a[228:231], v61 offset:2304
    s_waitcnt lgkmcnt(5)
    v_mfma_f32_16x16x32_bf16 v[28:31], a[208:211], a[0:3], 0
    v_mfma_f32_16x16x32_bf16 v[32:35], a[208:211], a[32:35], 0
    v_mfma_f32_16x16x32_bf16 v[36:39], a[208:211], a[64:67], 0
    ds_read_b128 a[232:235], v62 offset:2304
    s_waitcnt lgkmcnt(5)
    v_mfma_f32_16x16x32_bf16 v[28:31], a[212:215], a[4:7], v[28:31]
    v_mfma_f32_16x16x32_bf16 v[32:35], a[212:215], a[36:39], v[32:35]
    v_mfma_f32_16x16x32_bf16 v[36:39], a[212:215], a[68:71], v[36:39]
    ds_read_b128 a[236:239], v63 offset:2304
    s_waitcnt lgkmcnt(5)
    v_mfma_f32_16x16x32_bf16 v[28:31], a[216:219], a[8:11], v[28:31]
    v_mfma_f32_16x16x32_bf16 v[32:35], a[216:219], a[40:43], v[32:35]
    v_mfma_f32_16x16x32_bf16 v[36:39], a[216:219], a[72:75], v[36:39]
    s_barrier
    v_add_u32 v60, 32768, v4
    v_add_u32 v61, 32768, v5
    v_add_u32 v62, 32768, v6
    v_add_u32 v63, 32768, v7
    ds_read_b64_tr_b16 a[192:193], v60 offset:0
    ds_read_b64_tr_b16 a[194:195], v60 offset:2048
    s_waitcnt lgkmcnt(6)
    v_mfma_f32_16x16x32_bf16 v[28:31], a[220:223], a[12:15], v[28:31]
    v_max3_f32 v52, v52, v16, v17
    v_mfma_f32_16x16x32_bf16 v[32:35], a[220:223], a[44:47], v[32:35]
    v_cvt_pk_bf16_f32 v244, v16, v17
    v_mfma_f32_16x16x32_bf16 v[36:39], a[220:223], a[76:79], v[36:39]
    v_max3_f32 v52, v52, v18, v19
    ds_read_b64_tr_b16 a[196:197], v60 offset:8
    ds_read_b64_tr_b16 a[198:199], v60 offset:2056
    s_waitcnt lgkmcnt(7)
    v_mfma_f32_16x16x32_bf16 v[28:31], a[224:227], a[16:19], v[28:31]
    v_cvt_pk_bf16_f32 v245, v18, v19
    v_mfma_f32_16x16x32_bf16 v[32:35], a[224:227], a[48:51], v[32:35]
    v_max3_f32 v53, v53, v20, v21
    v_mfma_f32_16x16x32_bf16 v[36:39], a[224:227], a[80:83], v[36:39]
    v_cvt_pk_bf16_f32 v248, v20, v21
    ds_read_b64_tr_b16 a[200:201], v61 offset:0
    ds_read_b64_tr_b16 a[202:203], v61 offset:2048
    s_waitcnt lgkmcnt(8)
    v_mfma_f32_16x16x32_bf16 v[28:31], a[228:231], a[20:23], v[28:31]
    v_max3_f32 v53, v53, v22, v23
    v_mfma_f32_16x16x32_bf16 v[32:35], a[228:231], a[52:55], v[32:35]
    v_cvt_pk_bf16_f32 v249, v22, v23
    v_mfma_f32_16x16x32_bf16 v[36:39], a[228:231], a[84:87], v[36:39]
    v_max3_f32 v54, v54, v24, v25
    ds_read_b64_tr_b16 a[204:205], v61 offset:8
    ds_read_b64_tr_b16 a[206:207], v61 offset:2056
    s_waitcnt lgkmcnt(9)
    v_mfma_f32_16x16x32_bf16 v[28:31], a[232:235], a[24:27], v[28:31]
    v_cvt_pk_bf16_f32 v252, v24, v25
    v_mfma_f32_16x16x32_bf16 v[32:35], a[232:235], a[56:59], v[32:35]
    v_max3_f32 v54, v54, v26, v27
    v_mfma_f32_16x16x32_bf16 v[36:39], a[232:235], a[88:91], v[36:39]
    v_cvt_pk_bf16_f32 v253, v26, v27
    ds_read_b64_tr_b16 a[208:209], v62 offset:0
    ds_read_b64_tr_b16 a[210:211], v62 offset:2048
    s_waitcnt lgkmcnt(10)
    v_mfma_f32_16x16x32_bf16 v[28:31], a[236:239], a[28:31], v[28:31]
    v_mfma_f32_16x16x32_bf16 v[32:35], a[236:239], a[60:63], v[32:35]
    v_mfma_f32_16x16x32_bf16 v[36:39], a[236:239], a[92:95], v[36:39]
    s_nop 7
    s_nop 1
    v_max3_f32 v52, v52, v28, v29
    v_cvt_pk_bf16_f32 v246, v28, v29
    v_max3_f32 v52, v52, v30, v31
    v_cvt_pk_bf16_f32 v247, v30, v31
    v_max3_f32 v53, v53, v32, v33
    v_cvt_pk_bf16_f32 v250, v32, v33
    v_max3_f32 v53, v53, v34, v35
    v_cvt_pk_bf16_f32 v251, v34, v35
    v_max3_f32 v54, v54, v36, v37
    v_cvt_pk_bf16_f32 v254, v36, v37
    v_max3_f32 v54, v54, v38, v39
    v_cvt_pk_bf16_f32 v255, v38, v39
    ds_bpermute_b32 v20, v58, v52
    ds_bpermute_b32 v21, v58, v53
    ds_bpermute_b32 v22, v58, v54
    s_waitcnt lgkmcnt(0)
    v_max_f32 v52, v52, v20
    v_max_f32 v53, v53, v21
    v_max_f32 v54, v54, v22
    ds_bpermute_b32 v20, v59, v52
    ds_bpermute_b32 v21, v59, v53
    ds_bpermute_b32 v22, v59, v54
    s_waitcnt lgkmcnt(0)
    v_max_f32 v52, v52, v20
    v_max_f32 v53, v53, v21
    v_max_f32 v54, v54, v22
    s_mov_b32 s46, 0x3db8aa3b
    v_mul_f32 v52, s46, v52
    v_mul_f32 v53, s46, v53
    v_mul_f32 v54, s46, v54
    v_mov_b32 v55, 0
    v_mov_b32 v56, 0
    v_mov_b32 v57, 0
    v_lshlrev_b32 v16, 16, v64
    v_and_b32 v17, 0xffff0000, v64
    v_lshlrev_b32 v18, 16, v65
    v_and_b32 v19, 0xffff0000, v65
    v_fma_f32 v16, v16, s46, -v52
    v_fma_f32 v17, v17, s46, -v52
    v_fma_f32 v18, v18, s46, -v52
    v_fma_f32 v19, v19, s46, -v52
    v_exp_f32 v16, v16
    v_exp_f32 v17, v17
    v_exp_f32 v18, v18
    v_exp_f32 v19, v19
    s_nop 0
    v_cvt_pk_bf16_f32 v64, v16, v17
    v_cvt_pk_bf16_f32 v65, v18, v19
    v_lshlrev_b32 v16, 16, v66
    v_and_b32 v17, 0xffff0000, v66
    v_lshlrev_b32 v18, 16, v67
    v_and_b32 v19, 0xffff0000, v67
    v_fma_f32 v16, v16, s46, -v52
    v_fma_f32 v17, v17, s46, -v52
    v_fma_f32 v18, v18, s46, -v52
    v_fma_f32 v19, v19, s46, -v52
    v_exp_f32 v16, v16
    v_exp_f32 v17, v17
    v_exp_f32 v18, v18
    v_exp_f32 v19, v19
    s_nop 0
    v_cvt_pk_bf16_f32 v66, v16, v17
    v_cvt_pk_bf16_f32 v67, v18, v19
    v_lshlrev_b32 v16, 16, v68
    v_and_b32 v17, 0xffff0000, v68
    v_lshlrev_b32 v18, 16, v69
    v_and_b32 v19, 0xffff0000, v69
    v_fma_f32 v16, v16, s46, -v53
    v_fma_f32 v17, v17, s46, -v53
    v_fma_f32 v18, v18, s46, -v53
    v_fma_f32 v19, v19, s46, -v53
    v_exp_f32 v16, v16
    v_exp_f32 v17, v17
    v_exp_f32 v18, v18
    v_exp_f32 v19, v19
    s_nop 0
    v_cvt_pk_bf16_f32 v68, v16, v17
    v_cvt_pk_bf16_f32 v69, v18, v19
    v_lshlrev_b32 v16, 16, v70
    v_and_b32 v17, 0xffff0000, v70
    v_lshlrev_b32 v18, 16, v71
    v_and_b32 v19, 0xffff0000, v71
    v_fma_f32 v16, v16, s46, -v53
    v_fma_f32 v17, v17, s46, -v53
    v_fma_f32 v18, v18, s46, -v53
    v_fma_f32 v19, v19, s46, -v53
    v_exp_f32 v16, v16
    v_exp_f32 v17, v17
    v_exp_f32 v18, v18
    v_exp_f32 v19, v19
    s_nop 0
    v_cvt_pk_bf16_f32 v70, v16, v17
    v_cvt_pk_bf16_f32 v71, v18, v19
    v_lshlrev_b32 v16, 16, v72
    v_and_b32 v17, 0xffff0000, v72
    v_lshlrev_b32 v18, 16, v73
    v_and_b32 v19, 0xffff0000, v73
    v_fma_f32 v16, v16, s46, -v54
    v_fma_f32 v17, v17, s46, -v54
    v_fma_f32 v18, v18, s46, -v54
    v_fma_f32 v19, v19, s46, -v54
    v_exp_f32 v16, v16
    v_exp_f32 v17, v17
    v_exp_f32 v18, v18
    v_exp_f32 v19, v19
    s_nop 0
    v_cvt_pk_bf16_f32 v72, v16, v17
    v_cvt_pk_bf16_f32 v73, v18, v19
    v_lshlrev_b32 v16, 16, v74
    v_and_b32 v17, 0xffff0000, v74
    v_lshlrev_b32 v18, 16, v75
    v_and_b32 v19, 0xffff0000, v75
    v_fma_f32 v16, v16, s46, -v54
    v_fma_f32 v17, v17, s46, -v54
    v_fma_f32 v18, v18, s46, -v54
    v_fma_f32 v19, v19, s46, -v54
    v_exp_f32 v16, v16
    v_exp_f32 v17, v17
    v_exp_f32 v18, v18
    v_exp_f32 v19, v19
    s_nop 0
    v_cvt_pk_bf16_f32 v74, v16, v17
    v_cvt_pk_bf16_f32 v75, v18, v19
    s_nop 1
    ds_read_b64_tr_b16 a[212:213], v62 offset:8
    ds_read_b64_tr_b16 a[214:215], v62 offset:2056
    s_waitcnt lgkmcnt(2)
    v_mfma_f32_16x16x32_bf16 a[0:3], a[192:195], v[64:67], 0
    v_lshlrev_b32 v16, 16, v76
    v_and_b32 v17, 0xffff0000, v76
    v_mfma_f32_16x16x32_bf16 a[4:7], a[192:195], v[68:71], 0
    v_lshlrev_b32 v18, 16, v77
    v_and_b32 v19, 0xffff0000, v77
    v_mfma_f32_16x16x32_bf16 a[8:11], a[192:195], v[72:75], 0
    v_fma_f32 v16, v16, s46, -v52
    v_fma_f32 v17, v17, s46, -v52
    ds_read_b64_tr_b16 a[216:217], v63 offset:0
    ds_read_b64_tr_b16 a[218:219], v63 offset:2048
    s_waitcnt lgkmcnt(4)
    v_mfma_f32_16x16x32_bf16 a[12:15], a[196:199], v[64:67], 0
    v_fma_f32 v18, v18, s46, -v52
    v_fma_f32 v19, v19, s46, -v52
    v_mfma_f32_16x16x32_bf16 a[16:19], a[196:199], v[68:71], 0
    v_exp_f32 v16, v16
    v_exp_f32 v17, v17
    v_mfma_f32_16x16x32_bf16 a[20:23], a[196:199], v[72:75], 0
    v_exp_f32 v18, v18
    v_exp_f32 v19, v19
    ds_read_b64_tr_b16 a[220:221], v63 offset:8
    ds_read_b64_tr_b16 a[222:223], v63 offset:2056
    s_waitcnt lgkmcnt(6)
    v_mfma_f32_16x16x32_bf16 a[24:27], a[200:203], v[64:67], 0
    s_nop 0
    v_cvt_pk_bf16_f32 v76, v16, v17
    v_mfma_f32_16x16x32_bf16 a[28:31], a[200:203], v[68:71], 0
    v_cvt_pk_bf16_f32 v77, v18, v19
    v_lshlrev_b32 v16, 16, v78
    v_mfma_f32_16x16x32_bf16 a[32:35], a[200:203], v[72:75], 0
    v_and_b32 v17, 0xffff0000, v78
    v_lshlrev_b32 v18, 16, v79
    ds_read_b64_tr_b16 a[224:225], v60 offset:256
    ds_read_b64_tr_b16 a[226:227], v60 offset:2304
    s_waitcnt lgkmcnt(8)
    v_mfma_f32_16x16x32_bf16 a[36:39], a[204:207], v[64:67], 0
    v_and_b32 v19, 0xffff0000, v79
    v_fma_f32 v16, v16, s46, -v52
    v_mfma_f32_16x16x32_bf16 a[40:43], a[204:207], v[68:71], 0
    v_fma_f32 v17, v17, s46, -v52
    v_fma_f32 v18, v18, s46, -v52
    v_mfma_f32_16x16x32_bf16 a[44:47], a[204:207], v[72:75], 0
    v_fma_f32 v19, v19, s46, -v52
    v_exp_f32 v16, v16
    ds_read_b64_tr_b16 a[228:229], v60 offset:264
    ds_read_b64_tr_b16 a[230:231], v60 offset:2312
    s_waitcnt lgkmcnt(10)
    v_mfma_f32_16x16x32_bf16 a[48:51], a[208:211], v[64:67], 0
    v_exp_f32 v17, v17
    v_exp_f32 v18, v18
    v_mfma_f32_16x16x32_bf16 a[52:55], a[208:211], v[68:71], 0
    v_exp_f32 v19, v19
    s_nop 0
    v_mfma_f32_16x16x32_bf16 a[56:59], a[208:211], v[72:75], 0
    v_cvt_pk_bf16_f32 v78, v16, v17
    v_cvt_pk_bf16_f32 v79, v18, v19
    ds_read_b64_tr_b16 a[232:233], v61 offset:256
    ds_read_b64_tr_b16 a[234:235], v61 offset:2304
    s_waitcnt lgkmcnt(10)
    v_mfma_f32_16x16x32_bf16 a[60:63], a[212:215], v[64:67], 0
    v_lshlrev_b32 v16, 16, v80
    v_and_b32 v17, 0xffff0000, v80
    v_mfma_f32_16x16x32_bf16 a[64:67], a[212:215], v[68:71], 0
    v_lshlrev_b32 v18, 16, v81
    v_and_b32 v19, 0xffff0000, v81
    v_mfma_f32_16x16x32_bf16 a[68:71], a[212:215], v[72:75], 0
    v_fma_f32 v16, v16, s46, -v53
    v_fma_f32 v17, v17, s46, -v53
    ds_read_b64_tr_b16 a[236:237], v61 offset:264
    ds_read_b64_tr_b16 a[238:239], v61 offset:2312
    s_waitcnt lgkmcnt(10)
    v_mfma_f32_16x16x32_bf16 a[72:75], a[216:219], v[64:67], 0
    v_fma_f32 v18, v18, s46, -v53
    v_fma_f32 v19, v19, s46, -v53
    v_mfma_f32_16x16x32_bf16 a[76:79], a[216:219], v[68:71], 0
    v_exp_f32 v16, v16
    v_exp_f32 v17, v17
    v_mfma_f32_16x16x32_bf16 a[80:83], a[216:219], v[72:75], 0
    v_exp_f32 v18, v18
    v_exp_f32 v19, v19
    ds_read_b64_tr_b16 a[192:193], v62 offset:256
    ds_read_b64_tr_b16 a[194:195], v62 offset:2304
    s_waitcnt lgkmcnt(10)
    v_mfma_f32_16x16x32_bf16 a[84:87], a[220:223], v[64:67], 0
    s_nop 0
    v_cvt_pk_bf16_f32 v80, v16, v17
    v_mfma_f32_16x16x32_bf16 a[88:91], a[220:223], v[68:71], 0
    v_cvt_pk_bf16_f32 v81, v18, v19
    v_lshlrev_b32 v16, 16, v82
    v_mfma_f32_16x16x32_bf16 a[92:95], a[220:223], v[72:75], 0
    v_and_b32 v17, 0xffff0000, v82
    v_lshlrev_b32 v18, 16, v83
    ds_read_b64_tr_b16 a[196:197], v62 offset:264
    ds_read_b64_tr_b16 a[198:199], v62 offset:2312
    s_waitcnt lgkmcnt(10)
    v_mfma_f32_16x16x32_bf16 a[96:99], a[224:227], v[64:67], 0
    v_and_b32 v19, 0xffff0000, v83
    v_fma_f32 v16, v16, s46, -v53
    v_mfma_f32_16x16x32_bf16 a[100:103], a[224:227], v[68:71], 0
    v_fma_f32 v17, v17, s46, -v53
    v_fma_f32 v18, v18, s46, -v53
    v_mfma_f32_16x16x32_bf16 a[104:107], a[224:227], v[72:75], 0
    v_fma_f32 v19, v19, s46, -v53
    v_exp_f32 v16, v16
    v_mfma_f32_16x16x32_bf16 a[244:247], a[240:243], v[64:67], 0
    v_exp_f32 v17, v17
    v_exp_f32 v18, v18
    v_mfma_f32_16x16x32_bf16 a[248:251], a[240:243], v[68:71], 0
    v_exp_f32 v19, v19
    s_nop 0
    v_mfma_f32_16x16x32_bf16 a[252:255], a[240:243], v[72:75], 0
    v_cvt_pk_bf16_f32 v82, v16, v17
    v_cvt_pk_bf16_f32 v83, v18, v19
    ds_read_b64_tr_b16 a[200:201], v63 offset:256
    ds_read_b64_tr_b16 a[202:203], v63 offset:2304
    s_waitcnt lgkmcnt(10)
    v_mfma_f32_16x16x32_bf16 a[108:111], a[228:231], v[64:67], 0
    v_lshlrev_b32 v16, 16, v84
    v_and_b32 v17, 0xffff0000, v84
    v_mfma_f32_16x16x32_bf16 a[112:115], a[228:231], v[68:71], 0
    v_lshlrev_b32 v18, 16, v85
    v_and_b32 v19, 0xffff0000, v85
    v_mfma_f32_16x16x32_bf16 a[116:119], a[228:231], v[72:75], 0
    v_fma_f32 v16, v16, s46, -v54
    v_fma_f32 v17, v17, s46, -v54
    ds_read_b64_tr_b16 a[204:205], v63 offset:264
    ds_read_b64_tr_b16 a[206:207], v63 offset:2312
    s_waitcnt lgkmcnt(10)
    v_mfma_f32_16x16x32_bf16 a[120:123], a[232:235], v[64:67], 0
    v_fma_f32 v18, v18, s46, -v54
    v_fma_f32 v19, v19, s46, -v54
    v_mfma_f32_16x16x32_bf16 a[124:127], a[232:235], v[68:71], 0
    v_exp_f32 v16, v16
    v_exp_f32 v17, v17
    v_mfma_f32_16x16x32_bf16 a[128:131], a[232:235], v[72:75], 0
    v_exp_f32 v18, v18
    v_exp_f32 v19, v19
    s_barrier
    v_add_u32 v60, 49152, v4
    v_add_u32 v61, 49152, v5
    v_add_u32 v62, 49152, v6
    v_add_u32 v63, 49152, v7
    ds_read_b64_tr_b16 a[208:209], v60 offset:0
    ds_read_b64_tr_b16 a[210:211], v60 offset:2048
    s_waitcnt lgkmcnt(10)
    v_mfma_f32_16x16x32_bf16 a[132:135], a[236:239], v[64:67], 0
    s_nop 0
    v_cvt_pk_bf16_f32 v84, v16, v17
    v_mfma_f32_16x16x32_bf16 a[136:139], a[236:239], v[68:71], 0
    v_cvt_pk_bf16_f32 v85, v18, v19
    v_lshlrev_b32 v16, 16, v86
    v_mfma_f32_16x16x32_bf16 a[140:143], a[236:239], v[72:75], 0
    v_and_b32 v17, 0xffff0000, v86
    v_lshlrev_b32 v18, 16, v87
    ds_read_b64_tr_b16 a[212:213], v60 offset:8
    ds_read_b64_tr_b16 a[214:215], v60 offset:2056
    s_waitcnt lgkmcnt(10)
    v_mfma_f32_16x16x32_bf16 a[144:147], a[192:195], v[64:67], 0
    v_and_b32 v19, 0xffff0000, v87
    v_fma_f32 v16, v16, s46, -v54
    v_mfma_f32_16x16x32_bf16 a[148:151], a[192:195], v[68:71], 0
    v_fma_f32 v17, v17, s46, -v54
    v_fma_f32 v18, v18, s46, -v54
    v_mfma_f32_16x16x32_bf16 a[152:155], a[192:195], v[72:75], 0
    v_fma_f32 v19, v19, s46, -v54
    v_exp_f32 v16, v16
    ds_read_b64_tr_b16 a[216:217], v61 offset:0
    ds_read_b64_tr_b16 a[218:219], v61 offset:2048
    s_waitcnt lgkmcnt(10)
    v_mfma_f32_16x16x32_bf16 a[156:159], a[196:199], v[64:67], 0
    v_exp_f32 v17, v17
    v_exp_f32 v18, v18
    v_mfma_f32_16x16x32_bf16 a[160:163], a[196:199], v[68:71], 0
    v_exp_f32 v19, v19
    s_nop 0
    v_mfma_f32_16x16x32_bf16 a[164:167], a[196:199], v[72:75], 0
    v_cvt_pk_bf16_f32 v86, v16, v17
    v_cvt_pk_bf16_f32 v87, v18, v19
    ds_read_b64_tr_b16 a[220:221], v61 offset:8
    ds_read_b64_tr_b16 a[222:223], v61 offset:2056
    s_waitcnt lgkmcnt(10)
    v_mfma_f32_16x16x32_bf16 a[168:171], a[200:203], v[64:67], 0
    v_mfma_f32_16x16x32_bf16 a[172:175], a[200:203], v[68:71], 0
    v_mfma_f32_16x16x32_bf16 a[176:179], a[200:203], v[72:75], 0
    ds_read_b64_tr_b16 a[224:225], v62 offset:0
    ds_read_b64_tr_b16 a[226:227], v62 offset:2048
    s_waitcnt lgkmcnt(10)
    v_mfma_f32_16x16x32_bf16 a[180:183], a[204:207], v[64:67], 0
    v_mfma_f32_16x16x32_bf16 a[184:187], a[204:207], v[68:71], 0
    v_mfma_f32_16x16x32_bf16 a[188:191], a[204:207], v[72:75], 0
    ds_read_b64_tr_b16 a[228:229], v62 offset:8
    ds_read_b64_tr_b16 a[230:231], v62 offset:2056
    s_waitcnt lgkmcnt(10)
    v_mfma_f32_16x16x32_bf16 a[0:3], a[208:211], v[76:79], a[0:3]
    v_lshlrev_b32 v16, 16, v88
    v_and_b32 v17, 0xffff0000, v88
    v_mfma_f32_16x16x32_bf16 a[4:7], a[208:211], v[80:83], a[4:7]
    v_lshlrev_b32 v18, 16, v89
    v_and_b32 v19, 0xffff0000, v89
    v_mfma_f32_16x16x32_bf16 a[8:11], a[208:211], v[84:87], a[8:11]
    v_fma_f32 v16, v16, s46, -v52
    v_fma_f32 v17, v17, s46, -v52
    ds_read_b64_tr_b16 a[232:233], v63 offset:0
    ds_read_b64_tr_b16 a[234:235], v63 offset:2048
    s_waitcnt lgkmcnt(10)
    v_mfma_f32_16x16x32_bf16 a[12:15], a[212:215], v[76:79], a[12:15]
    v_fma_f32 v18, v18, s46, -v52
    v_fma_f32 v19, v19, s46, -v52
    v_mfma_f32_16x16x32_bf16 a[16:19], a[212:215], v[80:83], a[16:19]
    v_exp_f32 v16, v16
    v_exp_f32 v17, v17
    v_mfma_f32_16x16x32_bf16 a[20:23], a[212:215], v[84:87], a[20:23]
    v_exp_f32 v18, v18
    v_exp_f32 v19, v19
    ds_read_b64_tr_b16 a[236:237], v63 offset:8
    ds_read_b64_tr_b16 a[238:239], v63 offset:2056
    s_waitcnt lgkmcnt(10)
    v_mfma_f32_16x16x32_bf16 a[24:27], a[216:219], v[76:79], a[24:27]
    s_nop 0
    v_cvt_pk_bf16_f32 v88, v16, v17
    v_mfma_f32_16x16x32_bf16 a[28:31], a[216:219], v[80:83], a[28:31]
    v_cvt_pk_bf16_f32 v89, v18, v19
    v_lshlrev_b32 v16, 16, v90
    v_mfma_f32_16x16x32_bf16 a[32:35], a[216:219], v[84:87], a[32:35]
    v_and_b32 v17, 0xffff0000, v90
    v_lshlrev_b32 v18, 16, v91
    ds_read_b64_tr_b16 a[192:193], v60 offset:256
    ds_read_b64_tr_b16 a[194:195], v60 offset:2304
    s_waitcnt lgkmcnt(10)
    v_mfma_f32_16x16x32_bf16 a[36:39], a[220:223], v[76:79], a[36:39]
    v_and_b32 v19, 0xffff0000, v91
    v_fma_f32 v16, v16, s46, -v52
    v_mfma_f32_16x16x32_bf16 a[40:43], a[220:223], v[80:83], a[40:43]
    v_fma_f32 v17, v17, s46, -v52
    v_fma_f32 v18, v18, s46, -v52
    v_mfma_f32_16x16x32_bf16 a[44:47], a[220:223], v[84:87], a[44:47]
    v_fma_f32 v19, v19, s46, -v52
    v_exp_f32 v16, v16
    ds_read_b64_tr_b16 a[196:197], v60 offset:264
    ds_read_b64_tr_b16 a[198:199], v60 offset:2312
    s_waitcnt lgkmcnt(10)
    v_mfma_f32_16x16x32_bf16 a[48:51], a[224:227], v[76:79], a[48:51]
    v_exp_f32 v17, v17
    v_exp_f32 v18, v18
    v_mfma_f32_16x16x32_bf16 a[52:55], a[224:227], v[80:83], a[52:55]
    v_exp_f32 v19, v19
    s_nop 0
    v_mfma_f32_16x16x32_bf16 a[56:59], a[224:227], v[84:87], a[56:59]
    v_cvt_pk_bf16_f32 v90, v16, v17
    v_cvt_pk_bf16_f32 v91, v18, v19
    ds_read_b64_tr_b16 a[200:201], v61 offset:256
    ds_read_b64_tr_b16 a[202:203], v61 offset:2304
    s_waitcnt lgkmcnt(10)
    v_mfma_f32_16x16x32_bf16 a[60:63], a[228:231], v[76:79], a[60:63]
    v_lshlrev_b32 v16, 16, v92
    v_and_b32 v17, 0xffff0000, v92
    v_mfma_f32_16x16x32_bf16 a[64:67], a[228:231], v[80:83], a[64:67]
    v_lshlrev_b32 v18, 16, v93
    v_and_b32 v19, 0xffff0000, v93
    v_mfma_f32_16x16x32_bf16 a[68:71], a[228:231], v[84:87], a[68:71]
    v_fma_f32 v16, v16, s46, -v53
    v_fma_f32 v17, v17, s46, -v53
    ds_read_b64_tr_b16 a[204:205], v61 offset:264
    ds_read_b64_tr_b16 a[206:207], v61 offset:2312
    s_waitcnt lgkmcnt(10)
    v_mfma_f32_16x16x32_bf16 a[72:75], a[232:235], v[76:79], a[72:75]
    v_fma_f32 v18, v18, s46, -v53
    v_fma_f32 v19, v19, s46, -v53
    v_mfma_f32_16x16x32_bf16 a[76:79], a[232:235], v[80:83], a[76:79]
    v_exp_f32 v16, v16
    v_exp_f32 v17, v17
    v_mfma_f32_16x16x32_bf16 a[80:83], a[232:235], v[84:87], a[80:83]
    v_exp_f32 v18, v18
    v_exp_f32 v19, v19
    ds_read_b64_tr_b16 a[208:209], v62 offset:256
    ds_read_b64_tr_b16 a[210:211], v62 offset:2304
    s_waitcnt lgkmcnt(10)
    v_mfma_f32_16x16x32_bf16 a[84:87], a[236:239], v[76:79], a[84:87]
    s_nop 0
    v_cvt_pk_bf16_f32 v92, v16, v17
    v_mfma_f32_16x16x32_bf16 a[88:91], a[236:239], v[80:83], a[88:91]
    v_cvt_pk_bf16_f32 v93, v18, v19
    v_lshlrev_b32 v16, 16, v94
    v_mfma_f32_16x16x32_bf16 a[92:95], a[236:239], v[84:87], a[92:95]
    v_and_b32 v17, 0xffff0000, v94
    v_lshlrev_b32 v18, 16, v95
    ds_read_b64_tr_b16 a[212:213], v62 offset:264
    ds_read_b64_tr_b16 a[214:215], v62 offset:2312
    s_waitcnt lgkmcnt(10)
    v_mfma_f32_16x16x32_bf16 a[96:99], a[192:195], v[76:79], a[96:99]
    v_and_b32 v19, 0xffff0000, v95
    v_fma_f32 v16, v16, s46, -v53
    v_mfma_f32_16x16x32_bf16 a[100:103], a[192:195], v[80:83], a[100:103]
    v_fma_f32 v17, v17, s46, -v53
    v_fma_f32 v18, v18, s46, -v53
    v_mfma_f32_16x16x32_bf16 a[104:107], a[192:195], v[84:87], a[104:107]
    v_fma_f32 v19, v19, s46, -v53
    v_exp_f32 v16, v16
    v_mfma_f32_16x16x32_bf16 a[244:247], a[240:243], v[76:79], a[244:247]
    v_exp_f32 v17, v17
    v_exp_f32 v18, v18
    v_mfma_f32_16x16x32_bf16 a[248:251], a[240:243], v[80:83], a[248:251]
    v_exp_f32 v19, v19
    s_nop 0
    v_mfma_f32_16x16x32_bf16 a[252:255], a[240:243], v[84:87], a[252:255]
    v_cvt_pk_bf16_f32 v94, v16, v17
    v_cvt_pk_bf16_f32 v95, v18, v19
    ds_read_b64_tr_b16 a[216:217], v63 offset:256
    ds_read_b64_tr_b16 a[218:219], v63 offset:2304
    s_waitcnt lgkmcnt(10)
    v_mfma_f32_16x16x32_bf16 a[108:111], a[196:199], v[76:79], a[108:111]
    v_lshlrev_b32 v16, 16, v96
    v_and_b32 v17, 0xffff0000, v96
    v_mfma_f32_16x16x32_bf16 a[112:115], a[196:199], v[80:83], a[112:115]
    v_lshlrev_b32 v18, 16, v97
    v_and_b32 v19, 0xffff0000, v97
    v_mfma_f32_16x16x32_bf16 a[116:119], a[196:199], v[84:87], a[116:119]
    v_fma_f32 v16, v16, s46, -v54
    v_fma_f32 v17, v17, s46, -v54
    ds_read_b64_tr_b16 a[220:221], v63 offset:264
    ds_read_b64_tr_b16 a[222:223], v63 offset:2312
    s_waitcnt lgkmcnt(10)
    v_mfma_f32_16x16x32_bf16 a[120:123], a[200:203], v[76:79], a[120:123]
    v_fma_f32 v18, v18, s46, -v54
    v_fma_f32 v19, v19, s46, -v54
    v_mfma_f32_16x16x32_bf16 a[124:127], a[200:203], v[80:83], a[124:127]
    v_exp_f32 v16, v16
    v_exp_f32 v17, v17
    v_mfma_f32_16x16x32_bf16 a[128:131], a[200:203], v[84:87], a[128:131]
    v_exp_f32 v18, v18
    v_exp_f32 v19, v19
    s_barrier
    v_add_u32 v60, 0, v4
    v_add_u32 v61, 0, v5
    v_add_u32 v62, 0, v6
    v_add_u32 v63, 0, v7
    ds_read_b64_tr_b16 a[224:225], v60 offset:0
    ds_read_b64_tr_b16 a[226:227], v60 offset:2048
    s_waitcnt lgkmcnt(10)
    v_mfma_f32_16x16x32_bf16 a[132:135], a[204:207], v[76:79], a[132:135]
    s_nop 0
    v_cvt_pk_bf16_f32 v96, v16, v17
    v_mfma_f32_16x16x32_bf16 a[136:139], a[204:207], v[80:83], a[136:139]
    v_cvt_pk_bf16_f32 v97, v18, v19
    v_lshlrev_b32 v16, 16, v98
    v_mfma_f32_16x16x32_bf16 a[140:143], a[204:207], v[84:87], a[140:143]
    v_and_b32 v17, 0xffff0000, v98
    v_lshlrev_b32 v18, 16, v99
    ds_read_b64_tr_b16 a[228:229], v60 offset:8
    ds_read_b64_tr_b16 a[230:231], v60 offset:2056
    s_waitcnt lgkmcnt(10)
    v_mfma_f32_16x16x32_bf16 a[144:147], a[208:211], v[76:79], a[144:147]
    v_and_b32 v19, 0xffff0000, v99
    v_fma_f32 v16, v16, s46, -v54
    v_mfma_f32_16x16x32_bf16 a[148:151], a[208:211], v[80:83], a[148:151]
    v_fma_f32 v17, v17, s46, -v54
    v_fma_f32 v18, v18, s46, -v54
    v_mfma_f32_16x16x32_bf16 a[152:155], a[208:211], v[84:87], a[152:155]
    v_fma_f32 v19, v19, s46, -v54
    v_exp_f32 v16, v16
    ds_read_b64_tr_b16 a[232:233], v61 offset:0
    ds_read_b64_tr_b16 a[234:235], v61 offset:2048
    s_waitcnt lgkmcnt(10)
    v_mfma_f32_16x16x32_bf16 a[156:159], a[212:215], v[76:79], a[156:159]
    v_exp_f32 v17, v17
    v_exp_f32 v18, v18
    v_mfma_f32_16x16x32_bf16 a[160:163], a[212:215], v[80:83], a[160:163]
    v_exp_f32 v19, v19
    s_nop 0
    v_mfma_f32_16x16x32_bf16 a[164:167], a[212:215], v[84:87], a[164:167]
    v_cvt_pk_bf16_f32 v98, v16, v17
    v_cvt_pk_bf16_f32 v99, v18, v19
    ds_read_b64_tr_b16 a[236:237], v61 offset:8
    ds_read_b64_tr_b16 a[238:239], v61 offset:2056
    s_waitcnt lgkmcnt(10)
    v_mfma_f32_16x16x32_bf16 a[168:171], a[216:219], v[76:79], a[168:171]
    v_mfma_f32_16x16x32_bf16 a[172:175], a[216:219], v[80:83], a[172:175]
    v_mfma_f32_16x16x32_bf16 a[176:179], a[216:219], v[84:87], a[176:179]
    ds_read_b64_tr_b16 a[192:193], v62 offset:0
    ds_read_b64_tr_b16 a[194:195], v62 offset:2048
    s_waitcnt lgkmcnt(10)
    v_mfma_f32_16x16x32_bf16 a[180:183], a[220:223], v[76:79], a[180:183]
    v_mfma_f32_16x16x32_bf16 a[184:187], a[220:223], v[80:83], a[184:187]
    v_mfma_f32_16x16x32_bf16 a[188:191], a[220:223], v[84:87], a[188:191]
    ds_read_b64_tr_b16 a[196:197], v62 offset:8
    ds_read_b64_tr_b16 a[198:199], v62 offset:2056
    s_waitcnt lgkmcnt(10)
    v_mfma_f32_16x16x32_bf16 a[0:3], a[224:227], v[88:91], a[0:3]
    v_lshlrev_b32 v16, 16, v100
    v_and_b32 v17, 0xffff0000, v100
    v_mfma_f32_16x16x32_bf16 a[4:7], a[224:227], v[92:95], a[4:7]
    v_lshlrev_b32 v18, 16, v101
    v_and_b32 v19, 0xffff0000, v101
    v_mfma_f32_16x16x32_bf16 a[8:11], a[224:227], v[96:99], a[8:11]
    v_fma_f32 v16, v16, s46, -v52
    v_fma_f32 v17, v17, s46, -v52
    ds_read_b64_tr_b16 a[200:201], v63 offset:0
    ds_read_b64_tr_b16 a[202:203], v63 offset:2048
    s_waitcnt lgkmcnt(10)
    v_mfma_f32_16x16x32_bf16 a[12:15], a[228:231], v[88:91], a[12:15]
    v_fma_f32 v18, v18, s46, -v52
    v_fma_f32 v19, v19, s46, -v52
    v_mfma_f32_16x16x32_bf16 a[16:19], a[228:231], v[92:95], a[16:19]
    v_exp_f32 v16, v16
    v_exp_f32 v17, v17
    v_mfma_f32_16x16x32_bf16 a[20:23], a[228:231], v[96:99], a[20:23]
    v_exp_f32 v18, v18
    v_exp_f32 v19, v19
    ds_read_b64_tr_b16 a[204:205], v63 offset:8
    ds_read_b64_tr_b16 a[206:207], v63 offset:2056
    s_waitcnt lgkmcnt(10)
    v_mfma_f32_16x16x32_bf16 a[24:27], a[232:235], v[88:91], a[24:27]
    s_nop 0
    v_cvt_pk_bf16_f32 v100, v16, v17
    v_mfma_f32_16x16x32_bf16 a[28:31], a[232:235], v[92:95], a[28:31]
    v_cvt_pk_bf16_f32 v101, v18, v19
    v_lshlrev_b32 v16, 16, v102
    v_mfma_f32_16x16x32_bf16 a[32:35], a[232:235], v[96:99], a[32:35]
    v_and_b32 v17, 0xffff0000, v102
    v_lshlrev_b32 v18, 16, v103
    ds_read_b64_tr_b16 a[208:209], v60 offset:256
    ds_read_b64_tr_b16 a[210:211], v60 offset:2304
    s_waitcnt lgkmcnt(10)
    v_mfma_f32_16x16x32_bf16 a[36:39], a[236:239], v[88:91], a[36:39]
    v_and_b32 v19, 0xffff0000, v103
    v_fma_f32 v16, v16, s46, -v52
    v_mfma_f32_16x16x32_bf16 a[40:43], a[236:239], v[92:95], a[40:43]
    v_fma_f32 v17, v17, s46, -v52
    v_fma_f32 v18, v18, s46, -v52
    v_mfma_f32_16x16x32_bf16 a[44:47], a[236:239], v[96:99], a[44:47]
    v_fma_f32 v19, v19, s46, -v52
    v_exp_f32 v16, v16
    ds_read_b64_tr_b16 a[212:213], v60 offset:264
    ds_read_b64_tr_b16 a[214:215], v60 offset:2312
    s_waitcnt lgkmcnt(10)
    v_mfma_f32_16x16x32_bf16 a[48:51], a[192:195], v[88:91], a[48:51]
    v_exp_f32 v17, v17
    v_exp_f32 v18, v18
    v_mfma_f32_16x16x32_bf16 a[52:55], a[192:195], v[92:95], a[52:55]
    v_exp_f32 v19, v19
    s_nop 0
    v_mfma_f32_16x16x32_bf16 a[56:59], a[192:195], v[96:99], a[56:59]
    v_cvt_pk_bf16_f32 v102, v16, v17
    v_cvt_pk_bf16_f32 v103, v18, v19
    ds_read_b64_tr_b16 a[216:217], v61 offset:256
    ds_read_b64_tr_b16 a[218:219], v61 offset:2304
    s_waitcnt lgkmcnt(10)
    v_mfma_f32_16x16x32_bf16 a[60:63], a[196:199], v[88:91], a[60:63]
    v_lshlrev_b32 v16, 16, v104
    v_and_b32 v17, 0xffff0000, v104
    v_mfma_f32_16x16x32_bf16 a[64:67], a[196:199], v[92:95], a[64:67]
    v_lshlrev_b32 v18, 16, v105
    v_and_b32 v19, 0xffff0000, v105
    v_mfma_f32_16x16x32_bf16 a[68:71], a[196:199], v[96:99], a[68:71]
    v_fma_f32 v16, v16, s46, -v53
    v_fma_f32 v17, v17, s46, -v53
    ds_read_b64_tr_b16 a[220:221], v61 offset:264
    ds_read_b64_tr_b16 a[222:223], v61 offset:2312
    s_waitcnt lgkmcnt(10)
    v_mfma_f32_16x16x32_bf16 a[72:75], a[200:203], v[88:91], a[72:75]
    v_fma_f32 v18, v18, s46, -v53
    v_fma_f32 v19, v19, s46, -v53
    v_mfma_f32_16x16x32_bf16 a[76:79], a[200:203], v[92:95], a[76:79]
    v_exp_f32 v16, v16
    v_exp_f32 v17, v17
    v_mfma_f32_16x16x32_bf16 a[80:83], a[200:203], v[96:99], a[80:83]
    v_exp_f32 v18, v18
    v_exp_f32 v19, v19
    ds_read_b64_tr_b16 a[224:225], v62 offset:256
    ds_read_b64_tr_b16 a[226:227], v62 offset:2304
    s_waitcnt lgkmcnt(10)
    v_mfma_f32_16x16x32_bf16 a[84:87], a[204:207], v[88:91], a[84:87]
    s_nop 0
    v_cvt_pk_bf16_f32 v104, v16, v17
    v_mfma_f32_16x16x32_bf16 a[88:91], a[204:207], v[92:95], a[88:91]
    v_cvt_pk_bf16_f32 v105, v18, v19
    v_lshlrev_b32 v16, 16, v106
    v_mfma_f32_16x16x32_bf16 a[92:95], a[204:207], v[96:99], a[92:95]
    v_and_b32 v17, 0xffff0000, v106
    v_lshlrev_b32 v18, 16, v107
    ds_read_b64_tr_b16 a[228:229], v62 offset:264
    ds_read_b64_tr_b16 a[230:231], v62 offset:2312
    s_waitcnt lgkmcnt(10)
    v_mfma_f32_16x16x32_bf16 a[96:99], a[208:211], v[88:91], a[96:99]
    v_and_b32 v19, 0xffff0000, v107
    v_fma_f32 v16, v16, s46, -v53
    v_mfma_f32_16x16x32_bf16 a[100:103], a[208:211], v[92:95], a[100:103]
    v_fma_f32 v17, v17, s46, -v53
    v_fma_f32 v18, v18, s46, -v53
    v_mfma_f32_16x16x32_bf16 a[104:107], a[208:211], v[96:99], a[104:107]
    v_fma_f32 v19, v19, s46, -v53
    v_exp_f32 v16, v16
    v_mfma_f32_16x16x32_bf16 a[244:247], a[240:243], v[88:91], a[244:247]
    v_exp_f32 v17, v17
    v_exp_f32 v18, v18
    v_mfma_f32_16x16x32_bf16 a[248:251], a[240:243], v[92:95], a[248:251]
    v_exp_f32 v19, v19
    s_nop 0
    v_mfma_f32_16x16x32_bf16 a[252:255], a[240:243], v[96:99], a[252:255]
    v_cvt_pk_bf16_f32 v106, v16, v17
    v_cvt_pk_bf16_f32 v107, v18, v19
    ds_read_b64_tr_b16 a[232:233], v63 offset:256
    ds_read_b64_tr_b16 a[234:235], v63 offset:2304
    s_waitcnt lgkmcnt(10)
    v_mfma_f32_16x16x32_bf16 a[108:111], a[212:215], v[88:91], a[108:111]
    v_lshlrev_b32 v16, 16, v108
    v_and_b32 v17, 0xffff0000, v108
    v_mfma_f32_16x16x32_bf16 a[112:115], a[212:215], v[92:95], a[112:115]
    v_lshlrev_b32 v18, 16, v109
    v_and_b32 v19, 0xffff0000, v109
    v_mfma_f32_16x16x32_bf16 a[116:119], a[212:215], v[96:99], a[116:119]
    v_fma_f32 v16, v16, s46, -v54
    v_fma_f32 v17, v17, s46, -v54
    ds_read_b64_tr_b16 a[236:237], v63 offset:264
    ds_read_b64_tr_b16 a[238:239], v63 offset:2312
    s_waitcnt lgkmcnt(10)
    v_mfma_f32_16x16x32_bf16 a[120:123], a[216:219], v[88:91], a[120:123]
    v_fma_f32 v18, v18, s46, -v54
    v_fma_f32 v19, v19, s46, -v54
    v_mfma_f32_16x16x32_bf16 a[124:127], a[216:219], v[92:95], a[124:127]
    v_exp_f32 v16, v16
    v_exp_f32 v17, v17
    v_mfma_f32_16x16x32_bf16 a[128:131], a[216:219], v[96:99], a[128:131]
    v_exp_f32 v18, v18
    v_exp_f32 v19, v19
    s_barrier
    v_add_u32 v60, 16384, v4
    v_add_u32 v61, 16384, v5
    v_add_u32 v62, 16384, v6
    v_add_u32 v63, 16384, v7
    ds_read_b64_tr_b16 a[192:193], v60 offset:0
    ds_read_b64_tr_b16 a[194:195], v60 offset:2048
    s_waitcnt lgkmcnt(10)
    v_mfma_f32_16x16x32_bf16 a[132:135], a[220:223], v[88:91], a[132:135]
    s_nop 0
    v_cvt_pk_bf16_f32 v108, v16, v17
    v_mfma_f32_16x16x32_bf16 a[136:139], a[220:223], v[92:95], a[136:139]
    v_cvt_pk_bf16_f32 v109, v18, v19
    v_lshlrev_b32 v16, 16, v110
    v_mfma_f32_16x16x32_bf16 a[140:143], a[220:223], v[96:99], a[140:143]
    v_and_b32 v17, 0xffff0000, v110
    v_lshlrev_b32 v18, 16, v111
    ds_read_b64_tr_b16 a[196:197], v60 offset:8
    ds_read_b64_tr_b16 a[198:199], v60 offset:2056
    s_waitcnt lgkmcnt(10)
    v_mfma_f32_16x16x32_bf16 a[144:147], a[224:227], v[88:91], a[144:147]
    v_and_b32 v19, 0xffff0000, v111
    v_fma_f32 v16, v16, s46, -v54
    v_mfma_f32_16x16x32_bf16 a[148:151], a[224:227], v[92:95], a[148:151]
    v_fma_f32 v17, v17, s46, -v54
    v_fma_f32 v18, v18, s46, -v54
    v_mfma_f32_16x16x32_bf16 a[152:155], a[224:227], v[96:99], a[152:155]
    v_fma_f32 v19, v19, s46, -v54
    v_exp_f32 v16, v16
    ds_read_b64_tr_b16 a[200:201], v61 offset:0
    ds_read_b64_tr_b16 a[202:203], v61 offset:2048
    s_waitcnt lgkmcnt(10)
    v_mfma_f32_16x16x32_bf16 a[156:159], a[228:231], v[88:91], a[156:159]
    v_exp_f32 v17, v17
    v_exp_f32 v18, v18
    v_mfma_f32_16x16x32_bf16 a[160:163], a[228:231], v[92:95], a[160:163]
    v_exp_f32 v19, v19
    s_nop 0
    v_mfma_f32_16x16x32_bf16 a[164:167], a[228:231], v[96:99], a[164:167]
    v_cvt_pk_bf16_f32 v110, v16, v17
    v_cvt_pk_bf16_f32 v111, v18, v19
    ds_read_b64_tr_b16 a[204:205], v61 offset:8
    ds_read_b64_tr_b16 a[206:207], v61 offset:2056
    s_waitcnt lgkmcnt(10)
    v_mfma_f32_16x16x32_bf16 a[168:171], a[232:235], v[88:91], a[168:171]
    v_mfma_f32_16x16x32_bf16 a[172:175], a[232:235], v[92:95], a[172:175]
    v_mfma_f32_16x16x32_bf16 a[176:179], a[232:235], v[96:99], a[176:179]
    ds_read_b64_tr_b16 a[208:209], v62 offset:0
    ds_read_b64_tr_b16 a[210:211], v62 offset:2048
    s_waitcnt lgkmcnt(10)
    v_mfma_f32_16x16x32_bf16 a[180:183], a[236:239], v[88:91], a[180:183]
    v_mfma_f32_16x16x32_bf16 a[184:187], a[236:239], v[92:95], a[184:187]
    v_mfma_f32_16x16x32_bf16 a[188:191], a[236:239], v[96:99], a[188:191]
    ds_read_b64_tr_b16 a[212:213], v62 offset:8
    ds_read_b64_tr_b16 a[214:215], v62 offset:2056
    s_waitcnt lgkmcnt(10)
    v_mfma_f32_16x16x32_bf16 a[0:3], a[192:195], v[100:103], a[0:3]
    v_lshlrev_b32 v16, 16, v112
    v_and_b32 v17, 0xffff0000, v112
    v_mfma_f32_16x16x32_bf16 a[4:7], a[192:195], v[104:107], a[4:7]
    v_lshlrev_b32 v18, 16, v113
    v_and_b32 v19, 0xffff0000, v113
    v_mfma_f32_16x16x32_bf16 a[8:11], a[192:195], v[108:111], a[8:11]
    v_fma_f32 v16, v16, s46, -v52
    v_fma_f32 v17, v17, s46, -v52
    ds_read_b64_tr_b16 a[216:217], v63 offset:0
    ds_read_b64_tr_b16 a[218:219], v63 offset:2048
    s_waitcnt lgkmcnt(10)
    v_mfma_f32_16x16x32_bf16 a[12:15], a[196:199], v[100:103], a[12:15]
    v_fma_f32 v18, v18, s46, -v52
    v_fma_f32 v19, v19, s46, -v52
    v_mfma_f32_16x16x32_bf16 a[16:19], a[196:199], v[104:107], a[16:19]
    v_exp_f32 v16, v16
    v_exp_f32 v17, v17
    v_mfma_f32_16x16x32_bf16 a[20:23], a[196:199], v[108:111], a[20:23]
    v_exp_f32 v18, v18
    v_exp_f32 v19, v19
    ds_read_b64_tr_b16 a[220:221], v63 offset:8
    ds_read_b64_tr_b16 a[222:223], v63 offset:2056
    s_waitcnt lgkmcnt(10)
    v_mfma_f32_16x16x32_bf16 a[24:27], a[200:203], v[100:103], a[24:27]
    s_nop 0
    v_cvt_pk_bf16_f32 v112, v16, v17
    v_mfma_f32_16x16x32_bf16 a[28:31], a[200:203], v[104:107], a[28:31]
    v_cvt_pk_bf16_f32 v113, v18, v19
    v_lshlrev_b32 v16, 16, v114
    v_mfma_f32_16x16x32_bf16 a[32:35], a[200:203], v[108:111], a[32:35]
    v_and_b32 v17, 0xffff0000, v114
    v_lshlrev_b32 v18, 16, v115
    ds_read_b64_tr_b16 a[224:225], v60 offset:256
    ds_read_b64_tr_b16 a[226:227], v60 offset:2304
    s_waitcnt lgkmcnt(10)
    v_mfma_f32_16x16x32_bf16 a[36:39], a[204:207], v[100:103], a[36:39]
    v_and_b32 v19, 0xffff0000, v115
    v_fma_f32 v16, v16, s46, -v52
    v_mfma_f32_16x16x32_bf16 a[40:43], a[204:207], v[104:107], a[40:43]
    v_fma_f32 v17, v17, s46, -v52
    v_fma_f32 v18, v18, s46, -v52
    v_mfma_f32_16x16x32_bf16 a[44:47], a[204:207], v[108:111], a[44:47]
    v_fma_f32 v19, v19, s46, -v52
    v_exp_f32 v16, v16
    ds_read_b64_tr_b16 a[228:229], v60 offset:264
    ds_read_b64_tr_b16 a[230:231], v60 offset:2312
    s_waitcnt lgkmcnt(10)
    v_mfma_f32_16x16x32_bf16 a[48:51], a[208:211], v[100:103], a[48:51]
    v_exp_f32 v17, v17
    v_exp_f32 v18, v18
    v_mfma_f32_16x16x32_bf16 a[52:55], a[208:211], v[104:107], a[52:55]
    v_exp_f32 v19, v19
    s_nop 0
    v_mfma_f32_16x16x32_bf16 a[56:59], a[208:211], v[108:111], a[56:59]
    v_cvt_pk_bf16_f32 v114, v16, v17
    v_cvt_pk_bf16_f32 v115, v18, v19
    ds_read_b64_tr_b16 a[232:233], v61 offset:256
    ds_read_b64_tr_b16 a[234:235], v61 offset:2304
    s_waitcnt lgkmcnt(10)
    v_mfma_f32_16x16x32_bf16 a[60:63], a[212:215], v[100:103], a[60:63]
    v_lshlrev_b32 v16, 16, v116
    v_and_b32 v17, 0xffff0000, v116
    v_mfma_f32_16x16x32_bf16 a[64:67], a[212:215], v[104:107], a[64:67]
    v_lshlrev_b32 v18, 16, v117
    v_and_b32 v19, 0xffff0000, v117
    v_mfma_f32_16x16x32_bf16 a[68:71], a[212:215], v[108:111], a[68:71]
    v_fma_f32 v16, v16, s46, -v53
    v_fma_f32 v17, v17, s46, -v53
    ds_read_b64_tr_b16 a[236:237], v61 offset:264
    ds_read_b64_tr_b16 a[238:239], v61 offset:2312
    s_waitcnt lgkmcnt(10)
    v_mfma_f32_16x16x32_bf16 a[72:75], a[216:219], v[100:103], a[72:75]
    v_fma_f32 v18, v18, s46, -v53
    v_fma_f32 v19, v19, s46, -v53
    v_mfma_f32_16x16x32_bf16 a[76:79], a[216:219], v[104:107], a[76:79]
    v_exp_f32 v16, v16
    v_exp_f32 v17, v17
    v_mfma_f32_16x16x32_bf16 a[80:83], a[216:219], v[108:111], a[80:83]
    v_exp_f32 v18, v18
    v_exp_f32 v19, v19
    ds_read_b64_tr_b16 a[192:193], v62 offset:256
    ds_read_b64_tr_b16 a[194:195], v62 offset:2304
    s_waitcnt lgkmcnt(10)
    v_mfma_f32_16x16x32_bf16 a[84:87], a[220:223], v[100:103], a[84:87]
    s_nop 0
    v_cvt_pk_bf16_f32 v116, v16, v17
    v_mfma_f32_16x16x32_bf16 a[88:91], a[220:223], v[104:107], a[88:91]
    v_cvt_pk_bf16_f32 v117, v18, v19
    v_lshlrev_b32 v16, 16, v118
    v_mfma_f32_16x16x32_bf16 a[92:95], a[220:223], v[108:111], a[92:95]
    v_and_b32 v17, 0xffff0000, v118
    v_lshlrev_b32 v18, 16, v119
    ds_read_b64_tr_b16 a[196:197], v62 offset:264
    ds_read_b64_tr_b16 a[198:199], v62 offset:2312
    s_waitcnt lgkmcnt(10)
    v_mfma_f32_16x16x32_bf16 a[96:99], a[224:227], v[100:103], a[96:99]
    v_and_b32 v19, 0xffff0000, v119
    v_fma_f32 v16, v16, s46, -v53
    v_mfma_f32_16x16x32_bf16 a[100:103], a[224:227], v[104:107], a[100:103]
    v_fma_f32 v17, v17, s46, -v53
    v_fma_f32 v18, v18, s46, -v53
    v_mfma_f32_16x16x32_bf16 a[104:107], a[224:227], v[108:111], a[104:107]
    v_fma_f32 v19, v19, s46, -v53
    v_exp_f32 v16, v16
    v_mfma_f32_16x16x32_bf16 a[244:247], a[240:243], v[100:103], a[244:247]
    v_exp_f32 v17, v17
    v_exp_f32 v18, v18
    v_mfma_f32_16x16x32_bf16 a[248:251], a[240:243], v[104:107], a[248:251]
    v_exp_f32 v19, v19
    s_nop 0
    v_mfma_f32_16x16x32_bf16 a[252:255], a[240:243], v[108:111], a[252:255]
    v_cvt_pk_bf16_f32 v118, v16, v17
    v_cvt_pk_bf16_f32 v119, v18, v19
    ds_read_b64_tr_b16 a[200:201], v63 offset:256
    ds_read_b64_tr_b16 a[202:203], v63 offset:2304
    s_waitcnt lgkmcnt(10)
    v_mfma_f32_16x16x32_bf16 a[108:111], a[228:231], v[100:103], a[108:111]
    v_lshlrev_b32 v16, 16, v120
    v_and_b32 v17, 0xffff0000, v120
    v_mfma_f32_16x16x32_bf16 a[112:115], a[228:231], v[104:107], a[112:115]
    v_lshlrev_b32 v18, 16, v121
    v_and_b32 v19, 0xffff0000, v121
    v_mfma_f32_16x16x32_bf16 a[116:119], a[228:231], v[108:111], a[116:119]
    v_fma_f32 v16, v16, s46, -v54
    v_fma_f32 v17, v17, s46, -v54
    ds_read_b64_tr_b16 a[204:205], v63 offset:264
    ds_read_b64_tr_b16 a[206:207], v63 offset:2312
    s_waitcnt lgkmcnt(10)
    v_mfma_f32_16x16x32_bf16 a[120:123], a[232:235], v[100:103], a[120:123]
    v_fma_f32 v18, v18, s46, -v54
    v_fma_f32 v19, v19, s46, -v54
    v_mfma_f32_16x16x32_bf16 a[124:127], a[232:235], v[104:107], a[124:127]
    v_exp_f32 v16, v16
    v_exp_f32 v17, v17
    v_mfma_f32_16x16x32_bf16 a[128:131], a[232:235], v[108:111], a[128:131]
    v_exp_f32 v18, v18
    v_exp_f32 v19, v19
    s_barrier
    v_add_u32 v60, 65536, v4
    v_add_u32 v61, 65536, v5
    v_add_u32 v62, 65536, v6
    v_add_u32 v63, 65536, v7
    ds_read_b64_tr_b16 a[208:209], v60 offset:0
    ds_read_b64_tr_b16 a[210:211], v60 offset:2048
    s_waitcnt lgkmcnt(10)
    v_mfma_f32_16x16x32_bf16 a[132:135], a[236:239], v[100:103], a[132:135]
    s_nop 0
    v_cvt_pk_bf16_f32 v120, v16, v17
    v_mfma_f32_16x16x32_bf16 a[136:139], a[236:239], v[104:107], a[136:139]
    v_cvt_pk_bf16_f32 v121, v18, v19
    v_lshlrev_b32 v16, 16, v122
    v_mfma_f32_16x16x32_bf16 a[140:143], a[236:239], v[108:111], a[140:143]
    v_and_b32 v17, 0xffff0000, v122
    v_lshlrev_b32 v18, 16, v123
    ds_read_b64_tr_b16 a[212:213], v60 offset:8
    ds_read_b64_tr_b16 a[214:215], v60 offset:2056
    s_waitcnt lgkmcnt(10)
    v_mfma_f32_16x16x32_bf16 a[144:147], a[192:195], v[100:103], a[144:147]
    v_and_b32 v19, 0xffff0000, v123
    v_fma_f32 v16, v16, s46, -v54
    v_mfma_f32_16x16x32_bf16 a[148:151], a[192:195], v[104:107], a[148:151]
    v_fma_f32 v17, v17, s46, -v54
    v_fma_f32 v18, v18, s46, -v54
    v_mfma_f32_16x16x32_bf16 a[152:155], a[192:195], v[108:111], a[152:155]
    v_fma_f32 v19, v19, s46, -v54
    v_exp_f32 v16, v16
    ds_read_b64_tr_b16 a[216:217], v61 offset:0
    ds_read_b64_tr_b16 a[218:219], v61 offset:2048
    s_waitcnt lgkmcnt(10)
    v_mfma_f32_16x16x32_bf16 a[156:159], a[196:199], v[100:103], a[156:159]
    v_exp_f32 v17, v17
    v_exp_f32 v18, v18
    v_mfma_f32_16x16x32_bf16 a[160:163], a[196:199], v[104:107], a[160:163]
    v_exp_f32 v19, v19
    s_nop 0
    v_mfma_f32_16x16x32_bf16 a[164:167], a[196:199], v[108:111], a[164:167]
    v_cvt_pk_bf16_f32 v122, v16, v17
    v_cvt_pk_bf16_f32 v123, v18, v19
    ds_read_b64_tr_b16 a[220:221], v61 offset:8
    ds_read_b64_tr_b16 a[222:223], v61 offset:2056
    s_waitcnt lgkmcnt(10)
    v_mfma_f32_16x16x32_bf16 a[168:171], a[200:203], v[100:103], a[168:171]
    v_mfma_f32_16x16x32_bf16 a[172:175], a[200:203], v[104:107], a[172:175]
    v_mfma_f32_16x16x32_bf16 a[176:179], a[200:203], v[108:111], a[176:179]
    ds_read_b64_tr_b16 a[224:225], v62 offset:0
    ds_read_b64_tr_b16 a[226:227], v62 offset:2048
    s_waitcnt lgkmcnt(10)
    v_mfma_f32_16x16x32_bf16 a[180:183], a[204:207], v[100:103], a[180:183]
    v_mfma_f32_16x16x32_bf16 a[184:187], a[204:207], v[104:107], a[184:187]
    v_mfma_f32_16x16x32_bf16 a[188:191], a[204:207], v[108:111], a[188:191]
    ds_read_b64_tr_b16 a[228:229], v62 offset:8
    ds_read_b64_tr_b16 a[230:231], v62 offset:2056
    s_waitcnt lgkmcnt(10)
    v_mfma_f32_16x16x32_bf16 a[0:3], a[208:211], v[112:115], a[0:3]
    v_lshlrev_b32 v16, 16, v124
    v_and_b32 v17, 0xffff0000, v124
    v_mfma_f32_16x16x32_bf16 a[4:7], a[208:211], v[116:119], a[4:7]
    v_lshlrev_b32 v18, 16, v125
    v_and_b32 v19, 0xffff0000, v125
    v_mfma_f32_16x16x32_bf16 a[8:11], a[208:211], v[120:123], a[8:11]
    v_fma_f32 v16, v16, s46, -v52
    v_fma_f32 v17, v17, s46, -v52
    ds_read_b64_tr_b16 a[232:233], v63 offset:0
    ds_read_b64_tr_b16 a[234:235], v63 offset:2048
    s_waitcnt lgkmcnt(10)
    v_mfma_f32_16x16x32_bf16 a[12:15], a[212:215], v[112:115], a[12:15]
    v_fma_f32 v18, v18, s46, -v52
    v_fma_f32 v19, v19, s46, -v52
    v_mfma_f32_16x16x32_bf16 a[16:19], a[212:215], v[116:119], a[16:19]
    v_exp_f32 v16, v16
    v_exp_f32 v17, v17
    v_mfma_f32_16x16x32_bf16 a[20:23], a[212:215], v[120:123], a[20:23]
    v_exp_f32 v18, v18
    v_exp_f32 v19, v19
    ds_read_b64_tr_b16 a[236:237], v63 offset:8
    ds_read_b64_tr_b16 a[238:239], v63 offset:2056
    s_waitcnt lgkmcnt(10)
    v_mfma_f32_16x16x32_bf16 a[24:27], a[216:219], v[112:115], a[24:27]
    s_nop 0
    v_cvt_pk_bf16_f32 v124, v16, v17
    v_mfma_f32_16x16x32_bf16 a[28:31], a[216:219], v[116:119], a[28:31]
    v_cvt_pk_bf16_f32 v125, v18, v19
    v_lshlrev_b32 v16, 16, v126
    v_mfma_f32_16x16x32_bf16 a[32:35], a[216:219], v[120:123], a[32:35]
    v_and_b32 v17, 0xffff0000, v126
    v_lshlrev_b32 v18, 16, v127
    ds_read_b64_tr_b16 a[192:193], v60 offset:256
    ds_read_b64_tr_b16 a[194:195], v60 offset:2304
    s_waitcnt lgkmcnt(10)
    v_mfma_f32_16x16x32_bf16 a[36:39], a[220:223], v[112:115], a[36:39]
    v_and_b32 v19, 0xffff0000, v127
    v_fma_f32 v16, v16, s46, -v52
    v_mfma_f32_16x16x32_bf16 a[40:43], a[220:223], v[116:119], a[40:43]
    v_fma_f32 v17, v17, s46, -v52
    v_fma_f32 v18, v18, s46, -v52
    v_mfma_f32_16x16x32_bf16 a[44:47], a[220:223], v[120:123], a[44:47]
    v_fma_f32 v19, v19, s46, -v52
    v_exp_f32 v16, v16
    ds_read_b64_tr_b16 a[196:197], v60 offset:264
    ds_read_b64_tr_b16 a[198:199], v60 offset:2312
    s_waitcnt lgkmcnt(10)
    v_mfma_f32_16x16x32_bf16 a[48:51], a[224:227], v[112:115], a[48:51]
    v_exp_f32 v17, v17
    v_exp_f32 v18, v18
    v_mfma_f32_16x16x32_bf16 a[52:55], a[224:227], v[116:119], a[52:55]
    v_exp_f32 v19, v19
    s_nop 0
    v_mfma_f32_16x16x32_bf16 a[56:59], a[224:227], v[120:123], a[56:59]
    v_cvt_pk_bf16_f32 v126, v16, v17
    v_cvt_pk_bf16_f32 v127, v18, v19
    ds_read_b64_tr_b16 a[200:201], v61 offset:256
    ds_read_b64_tr_b16 a[202:203], v61 offset:2304
    s_waitcnt lgkmcnt(10)
    v_mfma_f32_16x16x32_bf16 a[60:63], a[228:231], v[112:115], a[60:63]
    v_lshlrev_b32 v16, 16, v128
    v_and_b32 v17, 0xffff0000, v128
    v_mfma_f32_16x16x32_bf16 a[64:67], a[228:231], v[116:119], a[64:67]
    v_lshlrev_b32 v18, 16, v129
    v_and_b32 v19, 0xffff0000, v129
    v_mfma_f32_16x16x32_bf16 a[68:71], a[228:231], v[120:123], a[68:71]
    v_fma_f32 v16, v16, s46, -v53
    v_fma_f32 v17, v17, s46, -v53
    ds_read_b64_tr_b16 a[204:205], v61 offset:264
    ds_read_b64_tr_b16 a[206:207], v61 offset:2312
    s_waitcnt lgkmcnt(10)
    v_mfma_f32_16x16x32_bf16 a[72:75], a[232:235], v[112:115], a[72:75]
    v_fma_f32 v18, v18, s46, -v53
    v_fma_f32 v19, v19, s46, -v53
    v_mfma_f32_16x16x32_bf16 a[76:79], a[232:235], v[116:119], a[76:79]
    v_exp_f32 v16, v16
    v_exp_f32 v17, v17
    v_mfma_f32_16x16x32_bf16 a[80:83], a[232:235], v[120:123], a[80:83]
    v_exp_f32 v18, v18
    v_exp_f32 v19, v19
    ds_read_b64_tr_b16 a[208:209], v62 offset:256
    ds_read_b64_tr_b16 a[210:211], v62 offset:2304
    s_waitcnt lgkmcnt(10)
    v_mfma_f32_16x16x32_bf16 a[84:87], a[236:239], v[112:115], a[84:87]
    s_nop 0
    v_cvt_pk_bf16_f32 v128, v16, v17
    v_mfma_f32_16x16x32_bf16 a[88:91], a[236:239], v[116:119], a[88:91]
    v_cvt_pk_bf16_f32 v129, v18, v19
    v_lshlrev_b32 v16, 16, v130
    v_mfma_f32_16x16x32_bf16 a[92:95], a[236:239], v[120:123], a[92:95]
    v_and_b32 v17, 0xffff0000, v130
    v_lshlrev_b32 v18, 16, v131
    ds_read_b64_tr_b16 a[212:213], v62 offset:264
    ds_read_b64_tr_b16 a[214:215], v62 offset:2312
    s_waitcnt lgkmcnt(10)
    v_mfma_f32_16x16x32_bf16 a[96:99], a[192:195], v[112:115], a[96:99]
    v_and_b32 v19, 0xffff0000, v131
    v_fma_f32 v16, v16, s46, -v53
    v_mfma_f32_16x16x32_bf16 a[100:103], a[192:195], v[116:119], a[100:103]
    v_fma_f32 v17, v17, s46, -v53
    v_fma_f32 v18, v18, s46, -v53
    v_mfma_f32_16x16x32_bf16 a[104:107], a[192:195], v[120:123], a[104:107]
    v_fma_f32 v19, v19, s46, -v53
    v_exp_f32 v16, v16
    v_mfma_f32_16x16x32_bf16 a[244:247], a[240:243], v[112:115], a[244:247]
    v_exp_f32 v17, v17
    v_exp_f32 v18, v18
    v_mfma_f32_16x16x32_bf16 a[248:251], a[240:243], v[116:119], a[248:251]
    v_exp_f32 v19, v19
    s_nop 0
    v_mfma_f32_16x16x32_bf16 a[252:255], a[240:243], v[120:123], a[252:255]
    v_cvt_pk_bf16_f32 v130, v16, v17
    v_cvt_pk_bf16_f32 v131, v18, v19
    ds_read_b64_tr_b16 a[216:217], v63 offset:256
    ds_read_b64_tr_b16 a[218:219], v63 offset:2304
    s_waitcnt lgkmcnt(10)
    v_mfma_f32_16x16x32_bf16 a[108:111], a[196:199], v[112:115], a[108:111]
    v_lshlrev_b32 v16, 16, v132
    v_and_b32 v17, 0xffff0000, v132
    v_mfma_f32_16x16x32_bf16 a[112:115], a[196:199], v[116:119], a[112:115]
    v_lshlrev_b32 v18, 16, v133
    v_and_b32 v19, 0xffff0000, v133
    v_mfma_f32_16x16x32_bf16 a[116:119], a[196:199], v[120:123], a[116:119]
    v_fma_f32 v16, v16, s46, -v54
    v_fma_f32 v17, v17, s46, -v54
    ds_read_b64_tr_b16 a[220:221], v63 offset:264
    ds_read_b64_tr_b16 a[222:223], v63 offset:2312
    s_waitcnt lgkmcnt(10)
    v_mfma_f32_16x16x32_bf16 a[120:123], a[200:203], v[112:115], a[120:123]
    v_fma_f32 v18, v18, s46, -v54
    v_fma_f32 v19, v19, s46, -v54
    v_mfma_f32_16x16x32_bf16 a[124:127], a[200:203], v[116:119], a[124:127]
    v_exp_f32 v16, v16
    v_exp_f32 v17, v17
    v_mfma_f32_16x16x32_bf16 a[128:131], a[200:203], v[120:123], a[128:131]
    v_exp_f32 v18, v18
    v_exp_f32 v19, v19
    s_barrier
    v_add_u32 v60, 81920, v4
    v_add_u32 v61, 81920, v5
    v_add_u32 v62, 81920, v6
    v_add_u32 v63, 81920, v7
    ds_read_b64_tr_b16 a[224:225], v60 offset:0
    ds_read_b64_tr_b16 a[226:227], v60 offset:2048
    s_waitcnt lgkmcnt(10)
    v_mfma_f32_16x16x32_bf16 a[132:135], a[204:207], v[112:115], a[132:135]
    s_nop 0
    v_cvt_pk_bf16_f32 v132, v16, v17
    v_mfma_f32_16x16x32_bf16 a[136:139], a[204:207], v[116:119], a[136:139]
    v_cvt_pk_bf16_f32 v133, v18, v19
    v_lshlrev_b32 v16, 16, v134
    v_mfma_f32_16x16x32_bf16 a[140:143], a[204:207], v[120:123], a[140:143]
    v_and_b32 v17, 0xffff0000, v134
    v_lshlrev_b32 v18, 16, v135
    ds_read_b64_tr_b16 a[228:229], v60 offset:8
    ds_read_b64_tr_b16 a[230:231], v60 offset:2056
    s_waitcnt lgkmcnt(10)
    v_mfma_f32_16x16x32_bf16 a[144:147], a[208:211], v[112:115], a[144:147]
    v_and_b32 v19, 0xffff0000, v135
    v_fma_f32 v16, v16, s46, -v54
    v_mfma_f32_16x16x32_bf16 a[148:151], a[208:211], v[116:119], a[148:151]
    v_fma_f32 v17, v17, s46, -v54
    v_fma_f32 v18, v18, s46, -v54
    v_mfma_f32_16x16x32_bf16 a[152:155], a[208:211], v[120:123], a[152:155]
    v_fma_f32 v19, v19, s46, -v54
    v_exp_f32 v16, v16
    ds_read_b64_tr_b16 a[232:233], v61 offset:0
    ds_read_b64_tr_b16 a[234:235], v61 offset:2048
    s_waitcnt lgkmcnt(10)
    v_mfma_f32_16x16x32_bf16 a[156:159], a[212:215], v[112:115], a[156:159]
    v_exp_f32 v17, v17
    v_exp_f32 v18, v18
    v_mfma_f32_16x16x32_bf16 a[160:163], a[212:215], v[116:119], a[160:163]
    v_exp_f32 v19, v19
    s_nop 0
    v_mfma_f32_16x16x32_bf16 a[164:167], a[212:215], v[120:123], a[164:167]
    v_cvt_pk_bf16_f32 v134, v16, v17
    v_cvt_pk_bf16_f32 v135, v18, v19
    ds_read_b64_tr_b16 a[236:237], v61 offset:8
    ds_read_b64_tr_b16 a[238:239], v61 offset:2056
    s_waitcnt lgkmcnt(10)
    v_mfma_f32_16x16x32_bf16 a[168:171], a[216:219], v[112:115], a[168:171]
    v_mfma_f32_16x16x32_bf16 a[172:175], a[216:219], v[116:119], a[172:175]
    v_mfma_f32_16x16x32_bf16 a[176:179], a[216:219], v[120:123], a[176:179]
    ds_read_b64_tr_b16 a[192:193], v62 offset:0
    ds_read_b64_tr_b16 a[194:195], v62 offset:2048
    s_waitcnt lgkmcnt(10)
    v_mfma_f32_16x16x32_bf16 a[180:183], a[220:223], v[112:115], a[180:183]
    v_mfma_f32_16x16x32_bf16 a[184:187], a[220:223], v[116:119], a[184:187]
    v_mfma_f32_16x16x32_bf16 a[188:191], a[220:223], v[120:123], a[188:191]
    ds_read_b64_tr_b16 a[196:197], v62 offset:8
    ds_read_b64_tr_b16 a[198:199], v62 offset:2056
    s_waitcnt lgkmcnt(10)
    v_mfma_f32_16x16x32_bf16 a[0:3], a[224:227], v[124:127], a[0:3]
    v_lshlrev_b32 v16, 16, v136
    v_and_b32 v17, 0xffff0000, v136
    v_mfma_f32_16x16x32_bf16 a[4:7], a[224:227], v[128:131], a[4:7]
    v_lshlrev_b32 v18, 16, v137
    v_and_b32 v19, 0xffff0000, v137
    v_mfma_f32_16x16x32_bf16 a[8:11], a[224:227], v[132:135], a[8:11]
    v_fma_f32 v16, v16, s46, -v52
    v_fma_f32 v17, v17, s46, -v52
    ds_read_b64_tr_b16 a[200:201], v63 offset:0
    ds_read_b64_tr_b16 a[202:203], v63 offset:2048
    s_waitcnt lgkmcnt(10)
    v_mfma_f32_16x16x32_bf16 a[12:15], a[228:231], v[124:127], a[12:15]
    v_fma_f32 v18, v18, s46, -v52
    v_fma_f32 v19, v19, s46, -v52
    v_mfma_f32_16x16x32_bf16 a[16:19], a[228:231], v[128:131], a[16:19]
    v_exp_f32 v16, v16
    v_exp_f32 v17, v17
    v_mfma_f32_16x16x32_bf16 a[20:23], a[228:231], v[132:135], a[20:23]
    v_exp_f32 v18, v18
    v_exp_f32 v19, v19
    ds_read_b64_tr_b16 a[204:205], v63 offset:8
    ds_read_b64_tr_b16 a[206:207], v63 offset:2056
    s_waitcnt lgkmcnt(10)
    v_mfma_f32_16x16x32_bf16 a[24:27], a[232:235], v[124:127], a[24:27]
    s_nop 0
    v_cvt_pk_bf16_f32 v136, v16, v17
    v_mfma_f32_16x16x32_bf16 a[28:31], a[232:235], v[128:131], a[28:31]
    v_cvt_pk_bf16_f32 v137, v18, v19
    v_lshlrev_b32 v16, 16, v138
    v_mfma_f32_16x16x32_bf16 a[32:35], a[232:235], v[132:135], a[32:35]
    v_and_b32 v17, 0xffff0000, v138
    v_lshlrev_b32 v18, 16, v139
    ds_read_b64_tr_b16 a[208:209], v60 offset:256
    ds_read_b64_tr_b16 a[210:211], v60 offset:2304
    s_waitcnt lgkmcnt(10)
    v_mfma_f32_16x16x32_bf16 a[36:39], a[236:239], v[124:127], a[36:39]
    v_and_b32 v19, 0xffff0000, v139
    v_fma_f32 v16, v16, s46, -v52
    v_mfma_f32_16x16x32_bf16 a[40:43], a[236:239], v[128:131], a[40:43]
    v_fma_f32 v17, v17, s46, -v52
    v_fma_f32 v18, v18, s46, -v52
    v_mfma_f32_16x16x32_bf16 a[44:47], a[236:239], v[132:135], a[44:47]
    v_fma_f32 v19, v19, s46, -v52
    v_exp_f32 v16, v16
    ds_read_b64_tr_b16 a[212:213], v60 offset:264
    ds_read_b64_tr_b16 a[214:215], v60 offset:2312
    s_waitcnt lgkmcnt(10)
    v_mfma_f32_16x16x32_bf16 a[48:51], a[192:195], v[124:127], a[48:51]
    v_exp_f32 v17, v17
    v_exp_f32 v18, v18
    v_mfma_f32_16x16x32_bf16 a[52:55], a[192:195], v[128:131], a[52:55]
    v_exp_f32 v19, v19
    s_nop 0
    v_mfma_f32_16x16x32_bf16 a[56:59], a[192:195], v[132:135], a[56:59]
    v_cvt_pk_bf16_f32 v138, v16, v17
    v_cvt_pk_bf16_f32 v139, v18, v19
    ds_read_b64_tr_b16 a[216:217], v61 offset:256
    ds_read_b64_tr_b16 a[218:219], v61 offset:2304
    s_waitcnt lgkmcnt(10)
    v_mfma_f32_16x16x32_bf16 a[60:63], a[196:199], v[124:127], a[60:63]
    v_lshlrev_b32 v16, 16, v140
    v_and_b32 v17, 0xffff0000, v140
    v_mfma_f32_16x16x32_bf16 a[64:67], a[196:199], v[128:131], a[64:67]
    v_lshlrev_b32 v18, 16, v141
    v_and_b32 v19, 0xffff0000, v141
    v_mfma_f32_16x16x32_bf16 a[68:71], a[196:199], v[132:135], a[68:71]
    v_fma_f32 v16, v16, s46, -v53
    v_fma_f32 v17, v17, s46, -v53
    ds_read_b64_tr_b16 a[220:221], v61 offset:264
    ds_read_b64_tr_b16 a[222:223], v61 offset:2312
    s_waitcnt lgkmcnt(10)
    v_mfma_f32_16x16x32_bf16 a[72:75], a[200:203], v[124:127], a[72:75]
    v_fma_f32 v18, v18, s46, -v53
    v_fma_f32 v19, v19, s46, -v53
    v_mfma_f32_16x16x32_bf16 a[76:79], a[200:203], v[128:131], a[76:79]
    v_exp_f32 v16, v16
    v_exp_f32 v17, v17
    v_mfma_f32_16x16x32_bf16 a[80:83], a[200:203], v[132:135], a[80:83]
    v_exp_f32 v18, v18
    v_exp_f32 v19, v19
    ds_read_b64_tr_b16 a[224:225], v62 offset:256
    ds_read_b64_tr_b16 a[226:227], v62 offset:2304
    s_waitcnt lgkmcnt(10)
    v_mfma_f32_16x16x32_bf16 a[84:87], a[204:207], v[124:127], a[84:87]
    s_nop 0
    v_cvt_pk_bf16_f32 v140, v16, v17
    v_mfma_f32_16x16x32_bf16 a[88:91], a[204:207], v[128:131], a[88:91]
    v_cvt_pk_bf16_f32 v141, v18, v19
    v_lshlrev_b32 v16, 16, v142
    v_mfma_f32_16x16x32_bf16 a[92:95], a[204:207], v[132:135], a[92:95]
    v_and_b32 v17, 0xffff0000, v142
    v_lshlrev_b32 v18, 16, v143
    ds_read_b64_tr_b16 a[228:229], v62 offset:264
    ds_read_b64_tr_b16 a[230:231], v62 offset:2312
    s_waitcnt lgkmcnt(10)
    v_mfma_f32_16x16x32_bf16 a[96:99], a[208:211], v[124:127], a[96:99]
    v_and_b32 v19, 0xffff0000, v143
    v_fma_f32 v16, v16, s46, -v53
    v_mfma_f32_16x16x32_bf16 a[100:103], a[208:211], v[128:131], a[100:103]
    v_fma_f32 v17, v17, s46, -v53
    v_fma_f32 v18, v18, s46, -v53
    v_mfma_f32_16x16x32_bf16 a[104:107], a[208:211], v[132:135], a[104:107]
    v_fma_f32 v19, v19, s46, -v53
    v_exp_f32 v16, v16
    v_mfma_f32_16x16x32_bf16 a[244:247], a[240:243], v[124:127], a[244:247]
    v_exp_f32 v17, v17
    v_exp_f32 v18, v18
    v_mfma_f32_16x16x32_bf16 a[248:251], a[240:243], v[128:131], a[248:251]
    v_exp_f32 v19, v19
    s_nop 0
    v_mfma_f32_16x16x32_bf16 a[252:255], a[240:243], v[132:135], a[252:255]
    v_cvt_pk_bf16_f32 v142, v16, v17
    v_cvt_pk_bf16_f32 v143, v18, v19
    ds_read_b64_tr_b16 a[232:233], v63 offset:256
    ds_read_b64_tr_b16 a[234:235], v63 offset:2304
    s_waitcnt lgkmcnt(10)
    v_mfma_f32_16x16x32_bf16 a[108:111], a[212:215], v[124:127], a[108:111]
    v_lshlrev_b32 v16, 16, v144
    v_and_b32 v17, 0xffff0000, v144
    v_mfma_f32_16x16x32_bf16 a[112:115], a[212:215], v[128:131], a[112:115]
    v_lshlrev_b32 v18, 16, v145
    v_and_b32 v19, 0xffff0000, v145
    v_mfma_f32_16x16x32_bf16 a[116:119], a[212:215], v[132:135], a[116:119]
    v_fma_f32 v16, v16, s46, -v54
    v_fma_f32 v17, v17, s46, -v54
    ds_read_b64_tr_b16 a[236:237], v63 offset:264
    ds_read_b64_tr_b16 a[238:239], v63 offset:2312
    s_waitcnt lgkmcnt(10)
    v_mfma_f32_16x16x32_bf16 a[120:123], a[216:219], v[124:127], a[120:123]
    v_fma_f32 v18, v18, s46, -v54
    v_fma_f32 v19, v19, s46, -v54
    v_mfma_f32_16x16x32_bf16 a[124:127], a[216:219], v[128:131], a[124:127]
    v_exp_f32 v16, v16
    v_exp_f32 v17, v17
    v_mfma_f32_16x16x32_bf16 a[128:131], a[216:219], v[132:135], a[128:131]
    v_exp_f32 v18, v18
    v_exp_f32 v19, v19
    s_barrier
    v_add_u32 v60, 98304, v4
    v_add_u32 v61, 98304, v5
    v_add_u32 v62, 98304, v6
    v_add_u32 v63, 98304, v7
    ds_read_b64_tr_b16 a[192:193], v60 offset:0
    ds_read_b64_tr_b16 a[194:195], v60 offset:2048
    s_waitcnt lgkmcnt(10)
    v_mfma_f32_16x16x32_bf16 a[132:135], a[220:223], v[124:127], a[132:135]
    s_nop 0
    v_cvt_pk_bf16_f32 v144, v16, v17
    v_mfma_f32_16x16x32_bf16 a[136:139], a[220:223], v[128:131], a[136:139]
    v_cvt_pk_bf16_f32 v145, v18, v19
    v_lshlrev_b32 v16, 16, v146
    v_mfma_f32_16x16x32_bf16 a[140:143], a[220:223], v[132:135], a[140:143]
    v_and_b32 v17, 0xffff0000, v146
    v_lshlrev_b32 v18, 16, v147
    ds_read_b64_tr_b16 a[196:197], v60 offset:8
    ds_read_b64_tr_b16 a[198:199], v60 offset:2056
    s_waitcnt lgkmcnt(10)
    v_mfma_f32_16x16x32_bf16 a[144:147], a[224:227], v[124:127], a[144:147]
    v_and_b32 v19, 0xffff0000, v147
    v_fma_f32 v16, v16, s46, -v54
    v_mfma_f32_16x16x32_bf16 a[148:151], a[224:227], v[128:131], a[148:151]
    v_fma_f32 v17, v17, s46, -v54
    v_fma_f32 v18, v18, s46, -v54
    v_mfma_f32_16x16x32_bf16 a[152:155], a[224:227], v[132:135], a[152:155]
    v_fma_f32 v19, v19, s46, -v54
    v_exp_f32 v16, v16
    ds_read_b64_tr_b16 a[200:201], v61 offset:0
    ds_read_b64_tr_b16 a[202:203], v61 offset:2048
    s_waitcnt lgkmcnt(10)
    v_mfma_f32_16x16x32_bf16 a[156:159], a[228:231], v[124:127], a[156:159]
    v_exp_f32 v17, v17
    v_exp_f32 v18, v18
    v_mfma_f32_16x16x32_bf16 a[160:163], a[228:231], v[128:131], a[160:163]
    v_exp_f32 v19, v19
    s_nop 0
    v_mfma_f32_16x16x32_bf16 a[164:167], a[228:231], v[132:135], a[164:167]
    v_cvt_pk_bf16_f32 v146, v16, v17
    v_cvt_pk_bf16_f32 v147, v18, v19
    ds_read_b64_tr_b16 a[204:205], v61 offset:8
    ds_read_b64_tr_b16 a[206:207], v61 offset:2056
    s_waitcnt lgkmcnt(10)
    v_mfma_f32_16x16x32_bf16 a[168:171], a[232:235], v[124:127], a[168:171]
    v_mfma_f32_16x16x32_bf16 a[172:175], a[232:235], v[128:131], a[172:175]
    v_mfma_f32_16x16x32_bf16 a[176:179], a[232:235], v[132:135], a[176:179]
    ds_read_b64_tr_b16 a[208:209], v62 offset:0
    ds_read_b64_tr_b16 a[210:211], v62 offset:2048
    s_waitcnt lgkmcnt(10)
    v_mfma_f32_16x16x32_bf16 a[180:183], a[236:239], v[124:127], a[180:183]
    v_mfma_f32_16x16x32_bf16 a[184:187], a[236:239], v[128:131], a[184:187]
    v_mfma_f32_16x16x32_bf16 a[188:191], a[236:239], v[132:135], a[188:191]
    ds_read_b64_tr_b16 a[212:213], v62 offset:8
    ds_read_b64_tr_b16 a[214:215], v62 offset:2056
    s_waitcnt lgkmcnt(10)
    v_mfma_f32_16x16x32_bf16 a[0:3], a[192:195], v[136:139], a[0:3]
    v_lshlrev_b32 v16, 16, v148
    v_and_b32 v17, 0xffff0000, v148
    v_mfma_f32_16x16x32_bf16 a[4:7], a[192:195], v[140:143], a[4:7]
    v_lshlrev_b32 v18, 16, v149
    v_and_b32 v19, 0xffff0000, v149
    v_mfma_f32_16x16x32_bf16 a[8:11], a[192:195], v[144:147], a[8:11]
    v_fma_f32 v16, v16, s46, -v52
    v_fma_f32 v17, v17, s46, -v52
    ds_read_b64_tr_b16 a[216:217], v63 offset:0
    ds_read_b64_tr_b16 a[218:219], v63 offset:2048
    s_waitcnt lgkmcnt(10)
    v_mfma_f32_16x16x32_bf16 a[12:15], a[196:199], v[136:139], a[12:15]
    v_fma_f32 v18, v18, s46, -v52
    v_fma_f32 v19, v19, s46, -v52
    v_mfma_f32_16x16x32_bf16 a[16:19], a[196:199], v[140:143], a[16:19]
    v_exp_f32 v16, v16
    v_exp_f32 v17, v17
    v_mfma_f32_16x16x32_bf16 a[20:23], a[196:199], v[144:147], a[20:23]
    v_exp_f32 v18, v18
    v_exp_f32 v19, v19
    ds_read_b64_tr_b16 a[220:221], v63 offset:8
    ds_read_b64_tr_b16 a[222:223], v63 offset:2056
    s_waitcnt lgkmcnt(10)
    v_mfma_f32_16x16x32_bf16 a[24:27], a[200:203], v[136:139], a[24:27]
    s_nop 0
    v_cvt_pk_bf16_f32 v148, v16, v17
    v_mfma_f32_16x16x32_bf16 a[28:31], a[200:203], v[140:143], a[28:31]
    v_cvt_pk_bf16_f32 v149, v18, v19
    v_lshlrev_b32 v16, 16, v150
    v_mfma_f32_16x16x32_bf16 a[32:35], a[200:203], v[144:147], a[32:35]
    v_and_b32 v17, 0xffff0000, v150
    v_lshlrev_b32 v18, 16, v151
    ds_read_b64_tr_b16 a[224:225], v60 offset:256
    ds_read_b64_tr_b16 a[226:227], v60 offset:2304
    s_waitcnt lgkmcnt(10)
    v_mfma_f32_16x16x32_bf16 a[36:39], a[204:207], v[136:139], a[36:39]
    v_and_b32 v19, 0xffff0000, v151
    v_fma_f32 v16, v16, s46, -v52
    v_mfma_f32_16x16x32_bf16 a[40:43], a[204:207], v[140:143], a[40:43]
    v_fma_f32 v17, v17, s46, -v52
    v_fma_f32 v18, v18, s46, -v52
    v_mfma_f32_16x16x32_bf16 a[44:47], a[204:207], v[144:147], a[44:47]
    v_fma_f32 v19, v19, s46, -v52
    v_exp_f32 v16, v16
    ds_read_b64_tr_b16 a[228:229], v60 offset:264
    ds_read_b64_tr_b16 a[230:231], v60 offset:2312
    s_waitcnt lgkmcnt(10)
    v_mfma_f32_16x16x32_bf16 a[48:51], a[208:211], v[136:139], a[48:51]
    v_exp_f32 v17, v17
    v_exp_f32 v18, v18
    v_mfma_f32_16x16x32_bf16 a[52:55], a[208:211], v[140:143], a[52:55]
    v_exp_f32 v19, v19
    s_nop 0
    v_mfma_f32_16x16x32_bf16 a[56:59], a[208:211], v[144:147], a[56:59]
    v_cvt_pk_bf16_f32 v150, v16, v17
    v_cvt_pk_bf16_f32 v151, v18, v19
    ds_read_b64_tr_b16 a[232:233], v61 offset:256
    ds_read_b64_tr_b16 a[234:235], v61 offset:2304
    s_waitcnt lgkmcnt(10)
    v_mfma_f32_16x16x32_bf16 a[60:63], a[212:215], v[136:139], a[60:63]
    v_lshlrev_b32 v16, 16, v152
    v_and_b32 v17, 0xffff0000, v152
    v_mfma_f32_16x16x32_bf16 a[64:67], a[212:215], v[140:143], a[64:67]
    v_lshlrev_b32 v18, 16, v153
    v_and_b32 v19, 0xffff0000, v153
    v_mfma_f32_16x16x32_bf16 a[68:71], a[212:215], v[144:147], a[68:71]
    v_fma_f32 v16, v16, s46, -v53
    v_fma_f32 v17, v17, s46, -v53
    ds_read_b64_tr_b16 a[236:237], v61 offset:264
    ds_read_b64_tr_b16 a[238:239], v61 offset:2312
    s_waitcnt lgkmcnt(10)
    v_mfma_f32_16x16x32_bf16 a[72:75], a[216:219], v[136:139], a[72:75]
    v_fma_f32 v18, v18, s46, -v53
    v_fma_f32 v19, v19, s46, -v53
    v_mfma_f32_16x16x32_bf16 a[76:79], a[216:219], v[140:143], a[76:79]
    v_exp_f32 v16, v16
    v_exp_f32 v17, v17
    v_mfma_f32_16x16x32_bf16 a[80:83], a[216:219], v[144:147], a[80:83]
    v_exp_f32 v18, v18
    v_exp_f32 v19, v19
    ds_read_b64_tr_b16 a[192:193], v62 offset:256
    ds_read_b64_tr_b16 a[194:195], v62 offset:2304
    s_waitcnt lgkmcnt(10)
    v_mfma_f32_16x16x32_bf16 a[84:87], a[220:223], v[136:139], a[84:87]
    s_nop 0
    v_cvt_pk_bf16_f32 v152, v16, v17
    v_mfma_f32_16x16x32_bf16 a[88:91], a[220:223], v[140:143], a[88:91]
    v_cvt_pk_bf16_f32 v153, v18, v19
    v_lshlrev_b32 v16, 16, v154
    v_mfma_f32_16x16x32_bf16 a[92:95], a[220:223], v[144:147], a[92:95]
    v_and_b32 v17, 0xffff0000, v154
    v_lshlrev_b32 v18, 16, v155
    ds_read_b64_tr_b16 a[196:197], v62 offset:264
    ds_read_b64_tr_b16 a[198:199], v62 offset:2312
    s_waitcnt lgkmcnt(10)
    v_mfma_f32_16x16x32_bf16 a[96:99], a[224:227], v[136:139], a[96:99]
    v_and_b32 v19, 0xffff0000, v155
    v_fma_f32 v16, v16, s46, -v53
    v_mfma_f32_16x16x32_bf16 a[100:103], a[224:227], v[140:143], a[100:103]
    v_fma_f32 v17, v17, s46, -v53
    v_fma_f32 v18, v18, s46, -v53
    v_mfma_f32_16x16x32_bf16 a[104:107], a[224:227], v[144:147], a[104:107]
    v_fma_f32 v19, v19, s46, -v53
    v_exp_f32 v16, v16
    v_mfma_f32_16x16x32_bf16 a[244:247], a[240:243], v[136:139], a[244:247]
    v_exp_f32 v17, v17
    v_exp_f32 v18, v18
    v_mfma_f32_16x16x32_bf16 a[248:251], a[240:243], v[140:143], a[248:251]
    v_exp_f32 v19, v19
    s_nop 0
    v_mfma_f32_16x16x32_bf16 a[252:255], a[240:243], v[144:147], a[252:255]
    v_cvt_pk_bf16_f32 v154, v16, v17
    v_cvt_pk_bf16_f32 v155, v18, v19
    ds_read_b64_tr_b16 a[200:201], v63 offset:256
    ds_read_b64_tr_b16 a[202:203], v63 offset:2304
    s_waitcnt lgkmcnt(10)
    v_mfma_f32_16x16x32_bf16 a[108:111], a[228:231], v[136:139], a[108:111]
    v_lshlrev_b32 v16, 16, v156
    v_and_b32 v17, 0xffff0000, v156
    v_mfma_f32_16x16x32_bf16 a[112:115], a[228:231], v[140:143], a[112:115]
    v_lshlrev_b32 v18, 16, v157
    v_and_b32 v19, 0xffff0000, v157
    v_mfma_f32_16x16x32_bf16 a[116:119], a[228:231], v[144:147], a[116:119]
    v_fma_f32 v16, v16, s46, -v54
    v_fma_f32 v17, v17, s46, -v54
    ds_read_b64_tr_b16 a[204:205], v63 offset:264
    ds_read_b64_tr_b16 a[206:207], v63 offset:2312
    s_waitcnt lgkmcnt(10)
    v_mfma_f32_16x16x32_bf16 a[120:123], a[232:235], v[136:139], a[120:123]
    v_fma_f32 v18, v18, s46, -v54
    v_fma_f32 v19, v19, s46, -v54
    v_mfma_f32_16x16x32_bf16 a[124:127], a[232:235], v[140:143], a[124:127]
    v_exp_f32 v16, v16
    v_exp_f32 v17, v17
    v_mfma_f32_16x16x32_bf16 a[128:131], a[232:235], v[144:147], a[128:131]
    v_exp_f32 v18, v18
    v_exp_f32 v19, v19
    s_barrier
    v_add_u32 v60, 114688, v4
    v_add_u32 v61, 114688, v5
    v_add_u32 v62, 114688, v6
    v_add_u32 v63, 114688, v7
    ds_read_b64_tr_b16 a[208:209], v60 offset:0
    ds_read_b64_tr_b16 a[210:211], v60 offset:2048
    s_waitcnt lgkmcnt(10)
    v_mfma_f32_16x16x32_bf16 a[132:135], a[236:239], v[136:139], a[132:135]
    s_nop 0
    v_cvt_pk_bf16_f32 v156, v16, v17
    v_mfma_f32_16x16x32_bf16 a[136:139], a[236:239], v[140:143], a[136:139]
    v_cvt_pk_bf16_f32 v157, v18, v19
    v_lshlrev_b32 v16, 16, v158
    v_mfma_f32_16x16x32_bf16 a[140:143], a[236:239], v[144:147], a[140:143]
    v_and_b32 v17, 0xffff0000, v158
    v_lshlrev_b32 v18, 16, v159
    ds_read_b64_tr_b16 a[212:213], v60 offset:8
    ds_read_b64_tr_b16 a[214:215], v60 offset:2056
    s_waitcnt lgkmcnt(10)
    v_mfma_f32_16x16x32_bf16 a[144:147], a[192:195], v[136:139], a[144:147]
    v_and_b32 v19, 0xffff0000, v159
    v_fma_f32 v16, v16, s46, -v54
    v_mfma_f32_16x16x32_bf16 a[148:151], a[192:195], v[140:143], a[148:151]
    v_fma_f32 v17, v17, s46, -v54
    v_fma_f32 v18, v18, s46, -v54
    v_mfma_f32_16x16x32_bf16 a[152:155], a[192:195], v[144:147], a[152:155]
    v_fma_f32 v19, v19, s46, -v54
    v_exp_f32 v16, v16
    ds_read_b64_tr_b16 a[216:217], v61 offset:0
    ds_read_b64_tr_b16 a[218:219], v61 offset:2048
    s_waitcnt lgkmcnt(10)
    v_mfma_f32_16x16x32_bf16 a[156:159], a[196:199], v[136:139], a[156:159]
    v_exp_f32 v17, v17
    v_exp_f32 v18, v18
    v_mfma_f32_16x16x32_bf16 a[160:163], a[196:199], v[140:143], a[160:163]
    v_exp_f32 v19, v19
    s_nop 0
    v_mfma_f32_16x16x32_bf16 a[164:167], a[196:199], v[144:147], a[164:167]
    v_cvt_pk_bf16_f32 v158, v16, v17
    v_cvt_pk_bf16_f32 v159, v18, v19
    ds_read_b64_tr_b16 a[220:221], v61 offset:8
    ds_read_b64_tr_b16 a[222:223], v61 offset:2056
    s_waitcnt lgkmcnt(10)
    v_mfma_f32_16x16x32_bf16 a[168:171], a[200:203], v[136:139], a[168:171]
    v_mfma_f32_16x16x32_bf16 a[172:175], a[200:203], v[140:143], a[172:175]
    v_mfma_f32_16x16x32_bf16 a[176:179], a[200:203], v[144:147], a[176:179]
    ds_read_b64_tr_b16 a[224:225], v62 offset:0
    ds_read_b64_tr_b16 a[226:227], v62 offset:2048
    s_waitcnt lgkmcnt(10)
    v_mfma_f32_16x16x32_bf16 a[180:183], a[204:207], v[136:139], a[180:183]
    v_mfma_f32_16x16x32_bf16 a[184:187], a[204:207], v[140:143], a[184:187]
    v_mfma_f32_16x16x32_bf16 a[188:191], a[204:207], v[144:147], a[188:191]
    ds_read_b64_tr_b16 a[228:229], v62 offset:8
    ds_read_b64_tr_b16 a[230:231], v62 offset:2056
    s_waitcnt lgkmcnt(10)
    v_mfma_f32_16x16x32_bf16 a[0:3], a[208:211], v[148:151], a[0:3]
    v_lshlrev_b32 v16, 16, v160
    v_and_b32 v17, 0xffff0000, v160
    v_mfma_f32_16x16x32_bf16 a[4:7], a[208:211], v[152:155], a[4:7]
    v_lshlrev_b32 v18, 16, v161
    v_and_b32 v19, 0xffff0000, v161
    v_mfma_f32_16x16x32_bf16 a[8:11], a[208:211], v[156:159], a[8:11]
    v_fma_f32 v16, v16, s46, -v52
    v_fma_f32 v17, v17, s46, -v52
    ds_read_b64_tr_b16 a[232:233], v63 offset:0
    ds_read_b64_tr_b16 a[234:235], v63 offset:2048
    s_waitcnt lgkmcnt(10)
    v_mfma_f32_16x16x32_bf16 a[12:15], a[212:215], v[148:151], a[12:15]
    v_fma_f32 v18, v18, s46, -v52
    v_fma_f32 v19, v19, s46, -v52
    v_mfma_f32_16x16x32_bf16 a[16:19], a[212:215], v[152:155], a[16:19]
    v_exp_f32 v16, v16
    v_exp_f32 v17, v17
    v_mfma_f32_16x16x32_bf16 a[20:23], a[212:215], v[156:159], a[20:23]
    v_exp_f32 v18, v18
    v_exp_f32 v19, v19
    ds_read_b64_tr_b16 a[236:237], v63 offset:8
    ds_read_b64_tr_b16 a[238:239], v63 offset:2056
    s_waitcnt lgkmcnt(10)
    v_mfma_f32_16x16x32_bf16 a[24:27], a[216:219], v[148:151], a[24:27]
    s_nop 0
    v_cvt_pk_bf16_f32 v160, v16, v17
    v_mfma_f32_16x16x32_bf16 a[28:31], a[216:219], v[152:155], a[28:31]
    v_cvt_pk_bf16_f32 v161, v18, v19
    v_lshlrev_b32 v16, 16, v162
    v_mfma_f32_16x16x32_bf16 a[32:35], a[216:219], v[156:159], a[32:35]
    v_and_b32 v17, 0xffff0000, v162
    v_lshlrev_b32 v18, 16, v163
    ds_read_b64_tr_b16 a[192:193], v60 offset:256
    ds_read_b64_tr_b16 a[194:195], v60 offset:2304
    s_waitcnt lgkmcnt(10)
    v_mfma_f32_16x16x32_bf16 a[36:39], a[220:223], v[148:151], a[36:39]
    v_and_b32 v19, 0xffff0000, v163
    v_fma_f32 v16, v16, s46, -v52
    v_mfma_f32_16x16x32_bf16 a[40:43], a[220:223], v[152:155], a[40:43]
    v_fma_f32 v17, v17, s46, -v52
    v_fma_f32 v18, v18, s46, -v52
    v_mfma_f32_16x16x32_bf16 a[44:47], a[220:223], v[156:159], a[44:47]
    v_fma_f32 v19, v19, s46, -v52
    v_exp_f32 v16, v16
    ds_read_b64_tr_b16 a[196:197], v60 offset:264
    ds_read_b64_tr_b16 a[198:199], v60 offset:2312
    s_waitcnt lgkmcnt(10)
    v_mfma_f32_16x16x32_bf16 a[48:51], a[224:227], v[148:151], a[48:51]
    v_exp_f32 v17, v17
    v_exp_f32 v18, v18
    v_mfma_f32_16x16x32_bf16 a[52:55], a[224:227], v[152:155], a[52:55]
    v_exp_f32 v19, v19
    s_nop 0
    v_mfma_f32_16x16x32_bf16 a[56:59], a[224:227], v[156:159], a[56:59]
    v_cvt_pk_bf16_f32 v162, v16, v17
    v_cvt_pk_bf16_f32 v163, v18, v19
    ds_read_b64_tr_b16 a[200:201], v61 offset:256
    ds_read_b64_tr_b16 a[202:203], v61 offset:2304
    s_waitcnt lgkmcnt(10)
    v_mfma_f32_16x16x32_bf16 a[60:63], a[228:231], v[148:151], a[60:63]
    v_lshlrev_b32 v16, 16, v164
    v_and_b32 v17, 0xffff0000, v164
    v_mfma_f32_16x16x32_bf16 a[64:67], a[228:231], v[152:155], a[64:67]
    v_lshlrev_b32 v18, 16, v165
    v_and_b32 v19, 0xffff0000, v165
    v_mfma_f32_16x16x32_bf16 a[68:71], a[228:231], v[156:159], a[68:71]
    v_fma_f32 v16, v16, s46, -v53
    v_fma_f32 v17, v17, s46, -v53
    ds_read_b64_tr_b16 a[204:205], v61 offset:264
    ds_read_b64_tr_b16 a[206:207], v61 offset:2312
    s_waitcnt lgkmcnt(10)
    v_mfma_f32_16x16x32_bf16 a[72:75], a[232:235], v[148:151], a[72:75]
    v_fma_f32 v18, v18, s46, -v53
    v_fma_f32 v19, v19, s46, -v53
    v_mfma_f32_16x16x32_bf16 a[76:79], a[232:235], v[152:155], a[76:79]
    v_exp_f32 v16, v16
    v_exp_f32 v17, v17
    v_mfma_f32_16x16x32_bf16 a[80:83], a[232:235], v[156:159], a[80:83]
    v_exp_f32 v18, v18
    v_exp_f32 v19, v19
    ds_read_b64_tr_b16 a[208:209], v62 offset:256
    ds_read_b64_tr_b16 a[210:211], v62 offset:2304
    s_waitcnt lgkmcnt(10)
    v_mfma_f32_16x16x32_bf16 a[84:87], a[236:239], v[148:151], a[84:87]
    s_nop 0
    v_cvt_pk_bf16_f32 v164, v16, v17
    v_mfma_f32_16x16x32_bf16 a[88:91], a[236:239], v[152:155], a[88:91]
    v_cvt_pk_bf16_f32 v165, v18, v19
    v_lshlrev_b32 v16, 16, v166
    v_mfma_f32_16x16x32_bf16 a[92:95], a[236:239], v[156:159], a[92:95]
    v_and_b32 v17, 0xffff0000, v166
    v_lshlrev_b32 v18, 16, v167
    ds_read_b64_tr_b16 a[212:213], v62 offset:264
    ds_read_b64_tr_b16 a[214:215], v62 offset:2312
    s_waitcnt lgkmcnt(10)
    v_mfma_f32_16x16x32_bf16 a[96:99], a[192:195], v[148:151], a[96:99]
    v_and_b32 v19, 0xffff0000, v167
    v_fma_f32 v16, v16, s46, -v53
    v_mfma_f32_16x16x32_bf16 a[100:103], a[192:195], v[152:155], a[100:103]
    v_fma_f32 v17, v17, s46, -v53
    v_fma_f32 v18, v18, s46, -v53
    v_mfma_f32_16x16x32_bf16 a[104:107], a[192:195], v[156:159], a[104:107]
    v_fma_f32 v19, v19, s46, -v53
    v_exp_f32 v16, v16
    v_mfma_f32_16x16x32_bf16 a[244:247], a[240:243], v[148:151], a[244:247]
    v_exp_f32 v17, v17
    v_exp_f32 v18, v18
    v_mfma_f32_16x16x32_bf16 a[248:251], a[240:243], v[152:155], a[248:251]
    v_exp_f32 v19, v19
    s_nop 0
    v_mfma_f32_16x16x32_bf16 a[252:255], a[240:243], v[156:159], a[252:255]
    v_cvt_pk_bf16_f32 v166, v16, v17
    v_cvt_pk_bf16_f32 v167, v18, v19
    ds_read_b64_tr_b16 a[216:217], v63 offset:256
    ds_read_b64_tr_b16 a[218:219], v63 offset:2304
    s_waitcnt lgkmcnt(10)
    v_mfma_f32_16x16x32_bf16 a[108:111], a[196:199], v[148:151], a[108:111]
    v_lshlrev_b32 v16, 16, v168
    v_and_b32 v17, 0xffff0000, v168
    v_mfma_f32_16x16x32_bf16 a[112:115], a[196:199], v[152:155], a[112:115]
    v_lshlrev_b32 v18, 16, v169
    v_and_b32 v19, 0xffff0000, v169
    v_mfma_f32_16x16x32_bf16 a[116:119], a[196:199], v[156:159], a[116:119]
    v_fma_f32 v16, v16, s46, -v54
    v_fma_f32 v17, v17, s46, -v54
    ds_read_b64_tr_b16 a[220:221], v63 offset:264
    ds_read_b64_tr_b16 a[222:223], v63 offset:2312
    s_waitcnt lgkmcnt(10)
    v_mfma_f32_16x16x32_bf16 a[120:123], a[200:203], v[148:151], a[120:123]
    v_fma_f32 v18, v18, s46, -v54
    v_fma_f32 v19, v19, s46, -v54
    v_mfma_f32_16x16x32_bf16 a[124:127], a[200:203], v[152:155], a[124:127]
    v_exp_f32 v16, v16
    v_exp_f32 v17, v17
    v_mfma_f32_16x16x32_bf16 a[128:131], a[200:203], v[156:159], a[128:131]
    v_exp_f32 v18, v18
    v_exp_f32 v19, v19
    s_barrier
    v_add_u32 v60, 131072, v4
    v_add_u32 v61, 131072, v5
    v_add_u32 v62, 131072, v6
    v_add_u32 v63, 131072, v7
    ds_read_b64_tr_b16 a[224:225], v60 offset:0
    ds_read_b64_tr_b16 a[226:227], v60 offset:2048
    s_waitcnt lgkmcnt(10)
    v_mfma_f32_16x16x32_bf16 a[132:135], a[204:207], v[148:151], a[132:135]
    s_nop 0
    v_cvt_pk_bf16_f32 v168, v16, v17
    v_mfma_f32_16x16x32_bf16 a[136:139], a[204:207], v[152:155], a[136:139]
    v_cvt_pk_bf16_f32 v169, v18, v19
    v_lshlrev_b32 v16, 16, v170
    v_mfma_f32_16x16x32_bf16 a[140:143], a[204:207], v[156:159], a[140:143]
    v_and_b32 v17, 0xffff0000, v170
    v_lshlrev_b32 v18, 16, v171
    ds_read_b64_tr_b16 a[228:229], v60 offset:8
    ds_read_b64_tr_b16 a[230:231], v60 offset:2056
    s_waitcnt lgkmcnt(10)
    v_mfma_f32_16x16x32_bf16 a[144:147], a[208:211], v[148:151], a[144:147]
    v_and_b32 v19, 0xffff0000, v171
    v_fma_f32 v16, v16, s46, -v54
    v_mfma_f32_16x16x32_bf16 a[148:151], a[208:211], v[152:155], a[148:151]
    v_fma_f32 v17, v17, s46, -v54
    v_fma_f32 v18, v18, s46, -v54
    v_mfma_f32_16x16x32_bf16 a[152:155], a[208:211], v[156:159], a[152:155]
    v_fma_f32 v19, v19, s46, -v54
    v_exp_f32 v16, v16
    ds_read_b64_tr_b16 a[232:233], v61 offset:0
    ds_read_b64_tr_b16 a[234:235], v61 offset:2048
    s_waitcnt lgkmcnt(10)
    v_mfma_f32_16x16x32_bf16 a[156:159], a[212:215], v[148:151], a[156:159]
    v_exp_f32 v17, v17
    v_exp_f32 v18, v18
    v_mfma_f32_16x16x32_bf16 a[160:163], a[212:215], v[152:155], a[160:163]
    v_exp_f32 v19, v19
    s_nop 0
    v_mfma_f32_16x16x32_bf16 a[164:167], a[212:215], v[156:159], a[164:167]
    v_cvt_pk_bf16_f32 v170, v16, v17
    v_cvt_pk_bf16_f32 v171, v18, v19
    ds_read_b64_tr_b16 a[236:237], v61 offset:8
    ds_read_b64_tr_b16 a[238:239], v61 offset:2056
    s_waitcnt lgkmcnt(10)
    v_mfma_f32_16x16x32_bf16 a[168:171], a[216:219], v[148:151], a[168:171]
    v_mfma_f32_16x16x32_bf16 a[172:175], a[216:219], v[152:155], a[172:175]
    v_mfma_f32_16x16x32_bf16 a[176:179], a[216:219], v[156:159], a[176:179]
    ds_read_b64_tr_b16 a[192:193], v62 offset:0
    ds_read_b64_tr_b16 a[194:195], v62 offset:2048
    s_waitcnt lgkmcnt(10)
    v_mfma_f32_16x16x32_bf16 a[180:183], a[220:223], v[148:151], a[180:183]
    v_mfma_f32_16x16x32_bf16 a[184:187], a[220:223], v[152:155], a[184:187]
    v_mfma_f32_16x16x32_bf16 a[188:191], a[220:223], v[156:159], a[188:191]
    ds_read_b64_tr_b16 a[196:197], v62 offset:8
    ds_read_b64_tr_b16 a[198:199], v62 offset:2056
    s_waitcnt lgkmcnt(10)
    v_mfma_f32_16x16x32_bf16 a[0:3], a[224:227], v[160:163], a[0:3]
    v_lshlrev_b32 v16, 16, v172
    v_and_b32 v17, 0xffff0000, v172
    v_mfma_f32_16x16x32_bf16 a[4:7], a[224:227], v[164:167], a[4:7]
    v_lshlrev_b32 v18, 16, v173
    v_and_b32 v19, 0xffff0000, v173
    v_mfma_f32_16x16x32_bf16 a[8:11], a[224:227], v[168:171], a[8:11]
    v_fma_f32 v16, v16, s46, -v52
    v_fma_f32 v17, v17, s46, -v52
    ds_read_b64_tr_b16 a[200:201], v63 offset:0
    ds_read_b64_tr_b16 a[202:203], v63 offset:2048
    s_waitcnt lgkmcnt(10)
    v_mfma_f32_16x16x32_bf16 a[12:15], a[228:231], v[160:163], a[12:15]
    v_fma_f32 v18, v18, s46, -v52
    v_fma_f32 v19, v19, s46, -v52
    v_mfma_f32_16x16x32_bf16 a[16:19], a[228:231], v[164:167], a[16:19]
    v_exp_f32 v16, v16
    v_exp_f32 v17, v17
    v_mfma_f32_16x16x32_bf16 a[20:23], a[228:231], v[168:171], a[20:23]
    v_exp_f32 v18, v18
    v_exp_f32 v19, v19
    ds_read_b64_tr_b16 a[204:205], v63 offset:8
    ds_read_b64_tr_b16 a[206:207], v63 offset:2056
    s_waitcnt lgkmcnt(10)
    v_mfma_f32_16x16x32_bf16 a[24:27], a[232:235], v[160:163], a[24:27]
    s_nop 0
    v_cvt_pk_bf16_f32 v172, v16, v17
    v_mfma_f32_16x16x32_bf16 a[28:31], a[232:235], v[164:167], a[28:31]
    v_cvt_pk_bf16_f32 v173, v18, v19
    v_lshlrev_b32 v16, 16, v174
    v_mfma_f32_16x16x32_bf16 a[32:35], a[232:235], v[168:171], a[32:35]
    v_and_b32 v17, 0xffff0000, v174
    v_lshlrev_b32 v18, 16, v175
    ds_read_b64_tr_b16 a[208:209], v60 offset:256
    ds_read_b64_tr_b16 a[210:211], v60 offset:2304
    s_waitcnt lgkmcnt(10)
    v_mfma_f32_16x16x32_bf16 a[36:39], a[236:239], v[160:163], a[36:39]
    v_and_b32 v19, 0xffff0000, v175
    v_fma_f32 v16, v16, s46, -v52
    v_mfma_f32_16x16x32_bf16 a[40:43], a[236:239], v[164:167], a[40:43]
    v_fma_f32 v17, v17, s46, -v52
    v_fma_f32 v18, v18, s46, -v52
    v_mfma_f32_16x16x32_bf16 a[44:47], a[236:239], v[168:171], a[44:47]
    v_fma_f32 v19, v19, s46, -v52
    v_exp_f32 v16, v16
    ds_read_b64_tr_b16 a[212:213], v60 offset:264
    ds_read_b64_tr_b16 a[214:215], v60 offset:2312
    s_waitcnt lgkmcnt(10)
    v_mfma_f32_16x16x32_bf16 a[48:51], a[192:195], v[160:163], a[48:51]
    v_exp_f32 v17, v17
    v_exp_f32 v18, v18
    v_mfma_f32_16x16x32_bf16 a[52:55], a[192:195], v[164:167], a[52:55]
    v_exp_f32 v19, v19
    s_nop 0
    v_mfma_f32_16x16x32_bf16 a[56:59], a[192:195], v[168:171], a[56:59]
    v_cvt_pk_bf16_f32 v174, v16, v17
    v_cvt_pk_bf16_f32 v175, v18, v19
    ds_read_b64_tr_b16 a[216:217], v61 offset:256
    ds_read_b64_tr_b16 a[218:219], v61 offset:2304
    s_waitcnt lgkmcnt(10)
    v_mfma_f32_16x16x32_bf16 a[60:63], a[196:199], v[160:163], a[60:63]
    v_lshlrev_b32 v16, 16, v176
    v_and_b32 v17, 0xffff0000, v176
    v_mfma_f32_16x16x32_bf16 a[64:67], a[196:199], v[164:167], a[64:67]
    v_lshlrev_b32 v18, 16, v177
    v_and_b32 v19, 0xffff0000, v177
    v_mfma_f32_16x16x32_bf16 a[68:71], a[196:199], v[168:171], a[68:71]
    v_fma_f32 v16, v16, s46, -v53
    v_fma_f32 v17, v17, s46, -v53
    ds_read_b64_tr_b16 a[220:221], v61 offset:264
    ds_read_b64_tr_b16 a[222:223], v61 offset:2312
    s_waitcnt lgkmcnt(10)
    v_mfma_f32_16x16x32_bf16 a[72:75], a[200:203], v[160:163], a[72:75]
    v_fma_f32 v18, v18, s46, -v53
    v_fma_f32 v19, v19, s46, -v53
    v_mfma_f32_16x16x32_bf16 a[76:79], a[200:203], v[164:167], a[76:79]
    v_exp_f32 v16, v16
    v_exp_f32 v17, v17
    v_mfma_f32_16x16x32_bf16 a[80:83], a[200:203], v[168:171], a[80:83]
    v_exp_f32 v18, v18
    v_exp_f32 v19, v19
    ds_read_b64_tr_b16 a[224:225], v62 offset:256
    ds_read_b64_tr_b16 a[226:227], v62 offset:2304
    s_waitcnt lgkmcnt(10)
    v_mfma_f32_16x16x32_bf16 a[84:87], a[204:207], v[160:163], a[84:87]
    s_nop 0
    v_cvt_pk_bf16_f32 v176, v16, v17
    v_mfma_f32_16x16x32_bf16 a[88:91], a[204:207], v[164:167], a[88:91]
    v_cvt_pk_bf16_f32 v177, v18, v19
    v_lshlrev_b32 v16, 16, v178
    v_mfma_f32_16x16x32_bf16 a[92:95], a[204:207], v[168:171], a[92:95]
    v_and_b32 v17, 0xffff0000, v178
    v_lshlrev_b32 v18, 16, v179
    ds_read_b64_tr_b16 a[228:229], v62 offset:264
    ds_read_b64_tr_b16 a[230:231], v62 offset:2312
    s_waitcnt lgkmcnt(10)
    v_mfma_f32_16x16x32_bf16 a[96:99], a[208:211], v[160:163], a[96:99]
    v_and_b32 v19, 0xffff0000, v179
    v_fma_f32 v16, v16, s46, -v53
    v_mfma_f32_16x16x32_bf16 a[100:103], a[208:211], v[164:167], a[100:103]
    v_fma_f32 v17, v17, s46, -v53
    v_fma_f32 v18, v18, s46, -v53
    v_mfma_f32_16x16x32_bf16 a[104:107], a[208:211], v[168:171], a[104:107]
    v_fma_f32 v19, v19, s46, -v53
    v_exp_f32 v16, v16
    v_mfma_f32_16x16x32_bf16 a[244:247], a[240:243], v[160:163], a[244:247]
    v_exp_f32 v17, v17
    v_exp_f32 v18, v18
    v_mfma_f32_16x16x32_bf16 a[248:251], a[240:243], v[164:167], a[248:251]
    v_exp_f32 v19, v19
    s_nop 0
    v_mfma_f32_16x16x32_bf16 a[252:255], a[240:243], v[168:171], a[252:255]
    v_cvt_pk_bf16_f32 v178, v16, v17
    v_cvt_pk_bf16_f32 v179, v18, v19
    ds_read_b64_tr_b16 a[232:233], v63 offset:256
    ds_read_b64_tr_b16 a[234:235], v63 offset:2304
    s_waitcnt lgkmcnt(10)
    v_mfma_f32_16x16x32_bf16 a[108:111], a[212:215], v[160:163], a[108:111]
    v_lshlrev_b32 v16, 16, v180
    v_and_b32 v17, 0xffff0000, v180
    v_mfma_f32_16x16x32_bf16 a[112:115], a[212:215], v[164:167], a[112:115]
    v_lshlrev_b32 v18, 16, v181
    v_and_b32 v19, 0xffff0000, v181
    v_mfma_f32_16x16x32_bf16 a[116:119], a[212:215], v[168:171], a[116:119]
    v_fma_f32 v16, v16, s46, -v54
    v_fma_f32 v17, v17, s46, -v54
    ds_read_b64_tr_b16 a[236:237], v63 offset:264
    ds_read_b64_tr_b16 a[238:239], v63 offset:2312
    s_waitcnt lgkmcnt(10)
    v_mfma_f32_16x16x32_bf16 a[120:123], a[216:219], v[160:163], a[120:123]
    v_fma_f32 v18, v18, s46, -v54
    v_fma_f32 v19, v19, s46, -v54
    v_mfma_f32_16x16x32_bf16 a[124:127], a[216:219], v[164:167], a[124:127]
    v_exp_f32 v16, v16
    v_exp_f32 v17, v17
    v_mfma_f32_16x16x32_bf16 a[128:131], a[216:219], v[168:171], a[128:131]
    v_exp_f32 v18, v18
    v_exp_f32 v19, v19
    s_barrier
    v_add_u32 v60, 147456, v4
    v_add_u32 v61, 147456, v5
    v_add_u32 v62, 147456, v6
    v_add_u32 v63, 147456, v7
    ds_read_b64_tr_b16 a[192:193], v60 offset:0
    ds_read_b64_tr_b16 a[194:195], v60 offset:2048
    s_waitcnt lgkmcnt(10)
    v_mfma_f32_16x16x32_bf16 a[132:135], a[220:223], v[160:163], a[132:135]
    s_nop 0
    v_cvt_pk_bf16_f32 v180, v16, v17
    v_mfma_f32_16x16x32_bf16 a[136:139], a[220:223], v[164:167], a[136:139]
    v_cvt_pk_bf16_f32 v181, v18, v19
    v_lshlrev_b32 v16, 16, v182
    v_mfma_f32_16x16x32_bf16 a[140:143], a[220:223], v[168:171], a[140:143]
    v_and_b32 v17, 0xffff0000, v182
    v_lshlrev_b32 v18, 16, v183
    ds_read_b64_tr_b16 a[196:197], v60 offset:8
    ds_read_b64_tr_b16 a[198:199], v60 offset:2056
    s_waitcnt lgkmcnt(10)
    v_mfma_f32_16x16x32_bf16 a[144:147], a[224:227], v[160:163], a[144:147]
    v_and_b32 v19, 0xffff0000, v183
    v_fma_f32 v16, v16, s46, -v54
    v_mfma_f32_16x16x32_bf16 a[148:151], a[224:227], v[164:167], a[148:151]
    v_fma_f32 v17, v17, s46, -v54
    v_fma_f32 v18, v18, s46, -v54
    v_mfma_f32_16x16x32_bf16 a[152:155], a[224:227], v[168:171], a[152:155]
    v_fma_f32 v19, v19, s46, -v54
    v_exp_f32 v16, v16
    ds_read_b64_tr_b16 a[200:201], v61 offset:0
    ds_read_b64_tr_b16 a[202:203], v61 offset:2048
    s_waitcnt lgkmcnt(10)
    v_mfma_f32_16x16x32_bf16 a[156:159], a[228:231], v[160:163], a[156:159]
    v_exp_f32 v17, v17
    v_exp_f32 v18, v18
    v_mfma_f32_16x16x32_bf16 a[160:163], a[228:231], v[164:167], a[160:163]
    v_exp_f32 v19, v19
    s_nop 0
    v_mfma_f32_16x16x32_bf16 a[164:167], a[228:231], v[168:171], a[164:167]
    v_cvt_pk_bf16_f32 v182, v16, v17
    v_cvt_pk_bf16_f32 v183, v18, v19
    ds_read_b64_tr_b16 a[204:205], v61 offset:8
    ds_read_b64_tr_b16 a[206:207], v61 offset:2056
    s_waitcnt lgkmcnt(10)
    v_mfma_f32_16x16x32_bf16 a[168:171], a[232:235], v[160:163], a[168:171]
    v_mfma_f32_16x16x32_bf16 a[172:175], a[232:235], v[164:167], a[172:175]
    v_mfma_f32_16x16x32_bf16 a[176:179], a[232:235], v[168:171], a[176:179]
    ds_read_b64_tr_b16 a[208:209], v62 offset:0
    ds_read_b64_tr_b16 a[210:211], v62 offset:2048
    s_waitcnt lgkmcnt(10)
    v_mfma_f32_16x16x32_bf16 a[180:183], a[236:239], v[160:163], a[180:183]
    v_mfma_f32_16x16x32_bf16 a[184:187], a[236:239], v[164:167], a[184:187]
    v_mfma_f32_16x16x32_bf16 a[188:191], a[236:239], v[168:171], a[188:191]
    ds_read_b64_tr_b16 a[212:213], v62 offset:8
    ds_read_b64_tr_b16 a[214:215], v62 offset:2056
    s_waitcnt lgkmcnt(10)
    v_mfma_f32_16x16x32_bf16 a[0:3], a[192:195], v[172:175], a[0:3]
    v_lshlrev_b32 v16, 16, v184
    v_and_b32 v17, 0xffff0000, v184
    v_mfma_f32_16x16x32_bf16 a[4:7], a[192:195], v[176:179], a[4:7]
    v_lshlrev_b32 v18, 16, v185
    v_and_b32 v19, 0xffff0000, v185
    v_mfma_f32_16x16x32_bf16 a[8:11], a[192:195], v[180:183], a[8:11]
    v_fma_f32 v16, v16, s46, -v52
    v_fma_f32 v17, v17, s46, -v52
    ds_read_b64_tr_b16 a[216:217], v63 offset:0
    ds_read_b64_tr_b16 a[218:219], v63 offset:2048
    s_waitcnt lgkmcnt(10)
    v_mfma_f32_16x16x32_bf16 a[12:15], a[196:199], v[172:175], a[12:15]
    v_fma_f32 v18, v18, s46, -v52
    v_fma_f32 v19, v19, s46, -v52
    v_mfma_f32_16x16x32_bf16 a[16:19], a[196:199], v[176:179], a[16:19]
    v_exp_f32 v16, v16
    v_exp_f32 v17, v17
    v_mfma_f32_16x16x32_bf16 a[20:23], a[196:199], v[180:183], a[20:23]
    v_exp_f32 v18, v18
    v_exp_f32 v19, v19
    ds_read_b64_tr_b16 a[220:221], v63 offset:8
    ds_read_b64_tr_b16 a[222:223], v63 offset:2056
    s_waitcnt lgkmcnt(10)
    v_mfma_f32_16x16x32_bf16 a[24:27], a[200:203], v[172:175], a[24:27]
    s_nop 0
    v_cvt_pk_bf16_f32 v184, v16, v17
    v_mfma_f32_16x16x32_bf16 a[28:31], a[200:203], v[176:179], a[28:31]
    v_cvt_pk_bf16_f32 v185, v18, v19
    v_lshlrev_b32 v16, 16, v186
    v_mfma_f32_16x16x32_bf16 a[32:35], a[200:203], v[180:183], a[32:35]
    v_and_b32 v17, 0xffff0000, v186
    v_lshlrev_b32 v18, 16, v187
    ds_read_b64_tr_b16 a[224:225], v60 offset:256
    ds_read_b64_tr_b16 a[226:227], v60 offset:2304
    s_waitcnt lgkmcnt(10)
    v_mfma_f32_16x16x32_bf16 a[36:39], a[204:207], v[172:175], a[36:39]
    v_and_b32 v19, 0xffff0000, v187
    v_fma_f32 v16, v16, s46, -v52
    v_mfma_f32_16x16x32_bf16 a[40:43], a[204:207], v[176:179], a[40:43]
    v_fma_f32 v17, v17, s46, -v52
    v_fma_f32 v18, v18, s46, -v52
    v_mfma_f32_16x16x32_bf16 a[44:47], a[204:207], v[180:183], a[44:47]
    v_fma_f32 v19, v19, s46, -v52
    v_exp_f32 v16, v16
    ds_read_b64_tr_b16 a[228:229], v60 offset:264
    ds_read_b64_tr_b16 a[230:231], v60 offset:2312
    s_waitcnt lgkmcnt(10)
    v_mfma_f32_16x16x32_bf16 a[48:51], a[208:211], v[172:175], a[48:51]
    v_exp_f32 v17, v17
    v_exp_f32 v18, v18
    v_mfma_f32_16x16x32_bf16 a[52:55], a[208:211], v[176:179], a[52:55]
    v_exp_f32 v19, v19
    s_nop 0
    v_mfma_f32_16x16x32_bf16 a[56:59], a[208:211], v[180:183], a[56:59]
    v_cvt_pk_bf16_f32 v186, v16, v17
    v_cvt_pk_bf16_f32 v187, v18, v19
    ds_read_b64_tr_b16 a[232:233], v61 offset:256
    ds_read_b64_tr_b16 a[234:235], v61 offset:2304
    s_waitcnt lgkmcnt(10)
    v_mfma_f32_16x16x32_bf16 a[60:63], a[212:215], v[172:175], a[60:63]
    v_lshlrev_b32 v16, 16, v188
    v_and_b32 v17, 0xffff0000, v188
    v_mfma_f32_16x16x32_bf16 a[64:67], a[212:215], v[176:179], a[64:67]
    v_lshlrev_b32 v18, 16, v189
    v_and_b32 v19, 0xffff0000, v189
    v_mfma_f32_16x16x32_bf16 a[68:71], a[212:215], v[180:183], a[68:71]
    v_fma_f32 v16, v16, s46, -v53
    v_fma_f32 v17, v17, s46, -v53
    ds_read_b64_tr_b16 a[236:237], v61 offset:264
    ds_read_b64_tr_b16 a[238:239], v61 offset:2312
    s_waitcnt lgkmcnt(10)
    v_mfma_f32_16x16x32_bf16 a[72:75], a[216:219], v[172:175], a[72:75]
    v_fma_f32 v18, v18, s46, -v53
    v_fma_f32 v19, v19, s46, -v53
    v_mfma_f32_16x16x32_bf16 a[76:79], a[216:219], v[176:179], a[76:79]
    v_exp_f32 v16, v16
    v_exp_f32 v17, v17
    v_mfma_f32_16x16x32_bf16 a[80:83], a[216:219], v[180:183], a[80:83]
    v_exp_f32 v18, v18
    v_exp_f32 v19, v19
    ds_read_b64_tr_b16 a[192:193], v62 offset:256
    ds_read_b64_tr_b16 a[194:195], v62 offset:2304
    s_waitcnt lgkmcnt(10)
    v_mfma_f32_16x16x32_bf16 a[84:87], a[220:223], v[172:175], a[84:87]
    s_nop 0
    v_cvt_pk_bf16_f32 v188, v16, v17
    v_mfma_f32_16x16x32_bf16 a[88:91], a[220:223], v[176:179], a[88:91]
    v_cvt_pk_bf16_f32 v189, v18, v19
    v_lshlrev_b32 v16, 16, v190
    v_mfma_f32_16x16x32_bf16 a[92:95], a[220:223], v[180:183], a[92:95]
    v_and_b32 v17, 0xffff0000, v190
    v_lshlrev_b32 v18, 16, v191
    ds_read_b64_tr_b16 a[196:197], v62 offset:264
    ds_read_b64_tr_b16 a[198:199], v62 offset:2312
    s_waitcnt lgkmcnt(10)
    v_mfma_f32_16x16x32_bf16 a[96:99], a[224:227], v[172:175], a[96:99]
    v_and_b32 v19, 0xffff0000, v191
    v_fma_f32 v16, v16, s46, -v53
    v_mfma_f32_16x16x32_bf16 a[100:103], a[224:227], v[176:179], a[100:103]
    v_fma_f32 v17, v17, s46, -v53
    v_fma_f32 v18, v18, s46, -v53
    v_mfma_f32_16x16x32_bf16 a[104:107], a[224:227], v[180:183], a[104:107]
    v_fma_f32 v19, v19, s46, -v53
    v_exp_f32 v16, v16
    v_mfma_f32_16x16x32_bf16 a[244:247], a[240:243], v[172:175], a[244:247]
    v_exp_f32 v17, v17
    v_exp_f32 v18, v18
    v_mfma_f32_16x16x32_bf16 a[248:251], a[240:243], v[176:179], a[248:251]
    v_exp_f32 v19, v19
    s_nop 0
    v_mfma_f32_16x16x32_bf16 a[252:255], a[240:243], v[180:183], a[252:255]
    v_cvt_pk_bf16_f32 v190, v16, v17
    v_cvt_pk_bf16_f32 v191, v18, v19
    ds_read_b64_tr_b16 a[200:201], v63 offset:256
    ds_read_b64_tr_b16 a[202:203], v63 offset:2304
    s_waitcnt lgkmcnt(10)
    v_mfma_f32_16x16x32_bf16 a[108:111], a[228:231], v[172:175], a[108:111]
    v_lshlrev_b32 v16, 16, v192
    v_and_b32 v17, 0xffff0000, v192
    v_mfma_f32_16x16x32_bf16 a[112:115], a[228:231], v[176:179], a[112:115]
    v_lshlrev_b32 v18, 16, v193
    v_and_b32 v19, 0xffff0000, v193
    v_mfma_f32_16x16x32_bf16 a[116:119], a[228:231], v[180:183], a[116:119]
    v_fma_f32 v16, v16, s46, -v54
    v_fma_f32 v17, v17, s46, -v54
    ds_read_b64_tr_b16 a[204:205], v63 offset:264
    ds_read_b64_tr_b16 a[206:207], v63 offset:2312
    s_waitcnt lgkmcnt(10)
    v_mfma_f32_16x16x32_bf16 a[120:123], a[232:235], v[172:175], a[120:123]
    v_fma_f32 v18, v18, s46, -v54
    v_fma_f32 v19, v19, s46, -v54
    v_mfma_f32_16x16x32_bf16 a[124:127], a[232:235], v[176:179], a[124:127]
    v_exp_f32 v16, v16
    v_exp_f32 v17, v17
    v_mfma_f32_16x16x32_bf16 a[128:131], a[232:235], v[180:183], a[128:131]
    v_exp_f32 v18, v18
    v_exp_f32 v19, v19
    s_barrier
    v_add_u32 v60, 32768, v4
    v_add_u32 v61, 32768, v5
    v_add_u32 v62, 32768, v6
    v_add_u32 v63, 32768, v7
    ds_read_b64_tr_b16 a[208:209], v60 offset:0
    ds_read_b64_tr_b16 a[210:211], v60 offset:2048
    s_waitcnt lgkmcnt(10)
    v_mfma_f32_16x16x32_bf16 a[132:135], a[236:239], v[172:175], a[132:135]
    s_nop 0
    v_cvt_pk_bf16_f32 v192, v16, v17
    v_mfma_f32_16x16x32_bf16 a[136:139], a[236:239], v[176:179], a[136:139]
    v_cvt_pk_bf16_f32 v193, v18, v19
    v_lshlrev_b32 v16, 16, v194
    v_mfma_f32_16x16x32_bf16 a[140:143], a[236:239], v[180:183], a[140:143]
    v_and_b32 v17, 0xffff0000, v194
    v_lshlrev_b32 v18, 16, v195
    ds_read_b64_tr_b16 a[212:213], v60 offset:8
    ds_read_b64_tr_b16 a[214:215], v60 offset:2056
    s_waitcnt lgkmcnt(10)
    v_mfma_f32_16x16x32_bf16 a[144:147], a[192:195], v[172:175], a[144:147]
    v_and_b32 v19, 0xffff0000, v195
    v_fma_f32 v16, v16, s46, -v54
    v_mfma_f32_16x16x32_bf16 a[148:151], a[192:195], v[176:179], a[148:151]
    v_fma_f32 v17, v17, s46, -v54
    v_fma_f32 v18, v18, s46, -v54
    v_mfma_f32_16x16x32_bf16 a[152:155], a[192:195], v[180:183], a[152:155]
    v_fma_f32 v19, v19, s46, -v54
    v_exp_f32 v16, v16
    ds_read_b64_tr_b16 a[216:217], v61 offset:0
    ds_read_b64_tr_b16 a[218:219], v61 offset:2048
    s_waitcnt lgkmcnt(10)
    v_mfma_f32_16x16x32_bf16 a[156:159], a[196:199], v[172:175], a[156:159]
    v_exp_f32 v17, v17
    v_exp_f32 v18, v18
    v_mfma_f32_16x16x32_bf16 a[160:163], a[196:199], v[176:179], a[160:163]
    v_exp_f32 v19, v19
    s_nop 0
    v_mfma_f32_16x16x32_bf16 a[164:167], a[196:199], v[180:183], a[164:167]
    v_cvt_pk_bf16_f32 v194, v16, v17
    v_cvt_pk_bf16_f32 v195, v18, v19
    ds_read_b64_tr_b16 a[220:221], v61 offset:8
    ds_read_b64_tr_b16 a[222:223], v61 offset:2056
    s_waitcnt lgkmcnt(10)
    v_mfma_f32_16x16x32_bf16 a[168:171], a[200:203], v[172:175], a[168:171]
    v_mfma_f32_16x16x32_bf16 a[172:175], a[200:203], v[176:179], a[172:175]
    v_mfma_f32_16x16x32_bf16 a[176:179], a[200:203], v[180:183], a[176:179]
    ds_read_b64_tr_b16 a[224:225], v62 offset:0
    ds_read_b64_tr_b16 a[226:227], v62 offset:2048
    s_waitcnt lgkmcnt(10)
    v_mfma_f32_16x16x32_bf16 a[180:183], a[204:207], v[172:175], a[180:183]
    v_mfma_f32_16x16x32_bf16 a[184:187], a[204:207], v[176:179], a[184:187]
    v_mfma_f32_16x16x32_bf16 a[188:191], a[204:207], v[180:183], a[188:191]
    ds_read_b64_tr_b16 a[228:229], v62 offset:8
    ds_read_b64_tr_b16 a[230:231], v62 offset:2056
    s_waitcnt lgkmcnt(10)
    v_mfma_f32_16x16x32_bf16 a[0:3], a[208:211], v[184:187], a[0:3]
    v_lshlrev_b32 v16, 16, v196
    v_and_b32 v17, 0xffff0000, v196
    v_mfma_f32_16x16x32_bf16 a[4:7], a[208:211], v[188:191], a[4:7]
    v_lshlrev_b32 v18, 16, v197
    v_and_b32 v19, 0xffff0000, v197
    v_mfma_f32_16x16x32_bf16 a[8:11], a[208:211], v[192:195], a[8:11]
    v_fma_f32 v16, v16, s46, -v52
    v_fma_f32 v17, v17, s46, -v52
    ds_read_b64_tr_b16 a[232:233], v63 offset:0
    ds_read_b64_tr_b16 a[234:235], v63 offset:2048
    s_waitcnt lgkmcnt(10)
    v_mfma_f32_16x16x32_bf16 a[12:15], a[212:215], v[184:187], a[12:15]
    v_fma_f32 v18, v18, s46, -v52
    v_fma_f32 v19, v19, s46, -v52
    v_mfma_f32_16x16x32_bf16 a[16:19], a[212:215], v[188:191], a[16:19]
    v_exp_f32 v16, v16
    v_exp_f32 v17, v17
    v_mfma_f32_16x16x32_bf16 a[20:23], a[212:215], v[192:195], a[20:23]
    v_exp_f32 v18, v18
    v_exp_f32 v19, v19
    ds_read_b64_tr_b16 a[236:237], v63 offset:8
    ds_read_b64_tr_b16 a[238:239], v63 offset:2056
    s_waitcnt lgkmcnt(10)
    v_mfma_f32_16x16x32_bf16 a[24:27], a[216:219], v[184:187], a[24:27]
    s_nop 0
    v_cvt_pk_bf16_f32 v196, v16, v17
    v_mfma_f32_16x16x32_bf16 a[28:31], a[216:219], v[188:191], a[28:31]
    v_cvt_pk_bf16_f32 v197, v18, v19
    v_lshlrev_b32 v16, 16, v198
    v_mfma_f32_16x16x32_bf16 a[32:35], a[216:219], v[192:195], a[32:35]
    v_and_b32 v17, 0xffff0000, v198
    v_lshlrev_b32 v18, 16, v199
    ds_read_b64_tr_b16 a[192:193], v60 offset:256
    ds_read_b64_tr_b16 a[194:195], v60 offset:2304
    s_waitcnt lgkmcnt(10)
    v_mfma_f32_16x16x32_bf16 a[36:39], a[220:223], v[184:187], a[36:39]
    v_and_b32 v19, 0xffff0000, v199
    v_fma_f32 v16, v16, s46, -v52
    v_mfma_f32_16x16x32_bf16 a[40:43], a[220:223], v[188:191], a[40:43]
    v_fma_f32 v17, v17, s46, -v52
    v_fma_f32 v18, v18, s46, -v52
    v_mfma_f32_16x16x32_bf16 a[44:47], a[220:223], v[192:195], a[44:47]
    v_fma_f32 v19, v19, s46, -v52
    v_exp_f32 v16, v16
    ds_read_b64_tr_b16 a[196:197], v60 offset:264
    ds_read_b64_tr_b16 a[198:199], v60 offset:2312
    s_waitcnt lgkmcnt(10)
    v_mfma_f32_16x16x32_bf16 a[48:51], a[224:227], v[184:187], a[48:51]
    v_exp_f32 v17, v17
    v_exp_f32 v18, v18
    v_mfma_f32_16x16x32_bf16 a[52:55], a[224:227], v[188:191], a[52:55]
    v_exp_f32 v19, v19
    s_nop 0
    v_mfma_f32_16x16x32_bf16 a[56:59], a[224:227], v[192:195], a[56:59]
    v_cvt_pk_bf16_f32 v198, v16, v17
    v_cvt_pk_bf16_f32 v199, v18, v19
    ds_read_b64_tr_b16 a[200:201], v61 offset:256
    ds_read_b64_tr_b16 a[202:203], v61 offset:2304
    s_waitcnt lgkmcnt(10)
    v_mfma_f32_16x16x32_bf16 a[60:63], a[228:231], v[184:187], a[60:63]
    v_lshlrev_b32 v16, 16, v200
    v_and_b32 v17, 0xffff0000, v200
    v_mfma_f32_16x16x32_bf16 a[64:67], a[228:231], v[188:191], a[64:67]
    v_lshlrev_b32 v18, 16, v201
    v_and_b32 v19, 0xffff0000, v201
    v_mfma_f32_16x16x32_bf16 a[68:71], a[228:231], v[192:195], a[68:71]
    v_fma_f32 v16, v16, s46, -v53
    v_fma_f32 v17, v17, s46, -v53
    ds_read_b64_tr_b16 a[204:205], v61 offset:264
    ds_read_b64_tr_b16 a[206:207], v61 offset:2312
    s_waitcnt lgkmcnt(10)
    v_mfma_f32_16x16x32_bf16 a[72:75], a[232:235], v[184:187], a[72:75]
    v_fma_f32 v18, v18, s46, -v53
    v_fma_f32 v19, v19, s46, -v53
    v_mfma_f32_16x16x32_bf16 a[76:79], a[232:235], v[188:191], a[76:79]
    v_exp_f32 v16, v16
    v_exp_f32 v17, v17
    v_mfma_f32_16x16x32_bf16 a[80:83], a[232:235], v[192:195], a[80:83]
    v_exp_f32 v18, v18
    v_exp_f32 v19, v19
    ds_read_b64_tr_b16 a[208:209], v62 offset:256
    ds_read_b64_tr_b16 a[210:211], v62 offset:2304
    s_waitcnt lgkmcnt(10)
    v_mfma_f32_16x16x32_bf16 a[84:87], a[236:239], v[184:187], a[84:87]
    s_nop 0
    v_cvt_pk_bf16_f32 v200, v16, v17
    v_mfma_f32_16x16x32_bf16 a[88:91], a[236:239], v[188:191], a[88:91]
    v_cvt_pk_bf16_f32 v201, v18, v19
    v_lshlrev_b32 v16, 16, v202
    v_mfma_f32_16x16x32_bf16 a[92:95], a[236:239], v[192:195], a[92:95]
    v_and_b32 v17, 0xffff0000, v202
    v_lshlrev_b32 v18, 16, v203
    ds_read_b64_tr_b16 a[212:213], v62 offset:264
    ds_read_b64_tr_b16 a[214:215], v62 offset:2312
    s_waitcnt lgkmcnt(10)
    v_mfma_f32_16x16x32_bf16 a[96:99], a[192:195], v[184:187], a[96:99]
    v_and_b32 v19, 0xffff0000, v203
    v_fma_f32 v16, v16, s46, -v53
    v_mfma_f32_16x16x32_bf16 a[100:103], a[192:195], v[188:191], a[100:103]
    v_fma_f32 v17, v17, s46, -v53
    v_fma_f32 v18, v18, s46, -v53
    v_mfma_f32_16x16x32_bf16 a[104:107], a[192:195], v[192:195], a[104:107]
    v_fma_f32 v19, v19, s46, -v53
    v_exp_f32 v16, v16
    v_mfma_f32_16x16x32_bf16 a[244:247], a[240:243], v[184:187], a[244:247]
    v_exp_f32 v17, v17
    v_exp_f32 v18, v18
    v_mfma_f32_16x16x32_bf16 a[248:251], a[240:243], v[188:191], a[248:251]
    v_exp_f32 v19, v19
    s_nop 0
    v_mfma_f32_16x16x32_bf16 a[252:255], a[240:243], v[192:195], a[252:255]
    v_cvt_pk_bf16_f32 v202, v16, v17
    v_cvt_pk_bf16_f32 v203, v18, v19
    ds_read_b64_tr_b16 a[216:217], v63 offset:256
    ds_read_b64_tr_b16 a[218:219], v63 offset:2304
    s_waitcnt lgkmcnt(10)
    v_mfma_f32_16x16x32_bf16 a[108:111], a[196:199], v[184:187], a[108:111]
    v_lshlrev_b32 v16, 16, v204
    v_and_b32 v17, 0xffff0000, v204
    v_mfma_f32_16x16x32_bf16 a[112:115], a[196:199], v[188:191], a[112:115]
    v_lshlrev_b32 v18, 16, v205
    v_and_b32 v19, 0xffff0000, v205
    v_mfma_f32_16x16x32_bf16 a[116:119], a[196:199], v[192:195], a[116:119]
    v_fma_f32 v16, v16, s46, -v54
    v_fma_f32 v17, v17, s46, -v54
    ds_read_b64_tr_b16 a[220:221], v63 offset:264
    ds_read_b64_tr_b16 a[222:223], v63 offset:2312
    s_waitcnt lgkmcnt(10)
    v_mfma_f32_16x16x32_bf16 a[120:123], a[200:203], v[184:187], a[120:123]
    v_fma_f32 v18, v18, s46, -v54
    v_fma_f32 v19, v19, s46, -v54
    v_mfma_f32_16x16x32_bf16 a[124:127], a[200:203], v[188:191], a[124:127]
    v_exp_f32 v16, v16
    v_exp_f32 v17, v17
    v_mfma_f32_16x16x32_bf16 a[128:131], a[200:203], v[192:195], a[128:131]
    v_exp_f32 v18, v18
    v_exp_f32 v19, v19
    s_barrier
    v_add_u32 v60, 49152, v4
    v_add_u32 v61, 49152, v5
    v_add_u32 v62, 49152, v6
    v_add_u32 v63, 49152, v7
    ds_read_b64_tr_b16 a[224:225], v60 offset:0
    ds_read_b64_tr_b16 a[226:227], v60 offset:2048
    s_waitcnt lgkmcnt(10)
    v_mfma_f32_16x16x32_bf16 a[132:135], a[204:207], v[184:187], a[132:135]
    s_nop 0
    v_cvt_pk_bf16_f32 v204, v16, v17
    v_mfma_f32_16x16x32_bf16 a[136:139], a[204:207], v[188:191], a[136:139]
    v_cvt_pk_bf16_f32 v205, v18, v19
    v_lshlrev_b32 v16, 16, v206
    v_mfma_f32_16x16x32_bf16 a[140:143], a[204:207], v[192:195], a[140:143]
    v_and_b32 v17, 0xffff0000, v206
    v_lshlrev_b32 v18, 16, v207
    ds_read_b64_tr_b16 a[228:229], v60 offset:8
    ds_read_b64_tr_b16 a[230:231], v60 offset:2056
    s_waitcnt lgkmcnt(10)
    v_mfma_f32_16x16x32_bf16 a[144:147], a[208:211], v[184:187], a[144:147]
    v_and_b32 v19, 0xffff0000, v207
    v_fma_f32 v16, v16, s46, -v54
    v_mfma_f32_16x16x32_bf16 a[148:151], a[208:211], v[188:191], a[148:151]
    v_fma_f32 v17, v17, s46, -v54
    v_fma_f32 v18, v18, s46, -v54
    v_mfma_f32_16x16x32_bf16 a[152:155], a[208:211], v[192:195], a[152:155]
    v_fma_f32 v19, v19, s46, -v54
    v_exp_f32 v16, v16
    ds_read_b64_tr_b16 a[232:233], v61 offset:0
    ds_read_b64_tr_b16 a[234:235], v61 offset:2048
    s_waitcnt lgkmcnt(10)
    v_mfma_f32_16x16x32_bf16 a[156:159], a[212:215], v[184:187], a[156:159]
    v_exp_f32 v17, v17
    v_exp_f32 v18, v18
    v_mfma_f32_16x16x32_bf16 a[160:163], a[212:215], v[188:191], a[160:163]
    v_exp_f32 v19, v19
    s_nop 0
    v_mfma_f32_16x16x32_bf16 a[164:167], a[212:215], v[192:195], a[164:167]
    v_cvt_pk_bf16_f32 v206, v16, v17
    v_cvt_pk_bf16_f32 v207, v18, v19
    ds_read_b64_tr_b16 a[236:237], v61 offset:8
    ds_read_b64_tr_b16 a[238:239], v61 offset:2056
    s_waitcnt lgkmcnt(10)
    v_mfma_f32_16x16x32_bf16 a[168:171], a[216:219], v[184:187], a[168:171]
    v_mfma_f32_16x16x32_bf16 a[172:175], a[216:219], v[188:191], a[172:175]
    v_mfma_f32_16x16x32_bf16 a[176:179], a[216:219], v[192:195], a[176:179]
    ds_read_b64_tr_b16 a[192:193], v62 offset:0
    ds_read_b64_tr_b16 a[194:195], v62 offset:2048
    s_waitcnt lgkmcnt(10)
    v_mfma_f32_16x16x32_bf16 a[180:183], a[220:223], v[184:187], a[180:183]
    v_mfma_f32_16x16x32_bf16 a[184:187], a[220:223], v[188:191], a[184:187]
    v_mfma_f32_16x16x32_bf16 a[188:191], a[220:223], v[192:195], a[188:191]
    ds_read_b64_tr_b16 a[196:197], v62 offset:8
    ds_read_b64_tr_b16 a[198:199], v62 offset:2056
    s_waitcnt lgkmcnt(10)
    v_mfma_f32_16x16x32_bf16 a[0:3], a[224:227], v[196:199], a[0:3]
    v_lshlrev_b32 v16, 16, v208
    v_and_b32 v17, 0xffff0000, v208
    v_mfma_f32_16x16x32_bf16 a[4:7], a[224:227], v[200:203], a[4:7]
    v_lshlrev_b32 v18, 16, v209
    v_and_b32 v19, 0xffff0000, v209
    v_mfma_f32_16x16x32_bf16 a[8:11], a[224:227], v[204:207], a[8:11]
    v_fma_f32 v16, v16, s46, -v52
    v_fma_f32 v17, v17, s46, -v52
    ds_read_b64_tr_b16 a[200:201], v63 offset:0
    ds_read_b64_tr_b16 a[202:203], v63 offset:2048
    s_waitcnt lgkmcnt(10)
    v_mfma_f32_16x16x32_bf16 a[12:15], a[228:231], v[196:199], a[12:15]
    v_fma_f32 v18, v18, s46, -v52
    v_fma_f32 v19, v19, s46, -v52
    v_mfma_f32_16x16x32_bf16 a[16:19], a[228:231], v[200:203], a[16:19]
    v_exp_f32 v16, v16
    v_exp_f32 v17, v17
    v_mfma_f32_16x16x32_bf16 a[20:23], a[228:231], v[204:207], a[20:23]
    v_exp_f32 v18, v18
    v_exp_f32 v19, v19
    ds_read_b64_tr_b16 a[204:205], v63 offset:8
    ds_read_b64_tr_b16 a[206:207], v63 offset:2056
    s_waitcnt lgkmcnt(10)
    v_mfma_f32_16x16x32_bf16 a[24:27], a[232:235], v[196:199], a[24:27]
    s_nop 0
    v_cvt_pk_bf16_f32 v208, v16, v17
    v_mfma_f32_16x16x32_bf16 a[28:31], a[232:235], v[200:203], a[28:31]
    v_cvt_pk_bf16_f32 v209, v18, v19
    v_lshlrev_b32 v16, 16, v210
    v_mfma_f32_16x16x32_bf16 a[32:35], a[232:235], v[204:207], a[32:35]
    v_and_b32 v17, 0xffff0000, v210
    v_lshlrev_b32 v18, 16, v211
    ds_read_b64_tr_b16 a[208:209], v60 offset:256
    ds_read_b64_tr_b16 a[210:211], v60 offset:2304
    s_waitcnt lgkmcnt(10)
    v_mfma_f32_16x16x32_bf16 a[36:39], a[236:239], v[196:199], a[36:39]
    v_and_b32 v19, 0xffff0000, v211
    v_fma_f32 v16, v16, s46, -v52
    v_mfma_f32_16x16x32_bf16 a[40:43], a[236:239], v[200:203], a[40:43]
    v_fma_f32 v17, v17, s46, -v52
    v_fma_f32 v18, v18, s46, -v52
    v_mfma_f32_16x16x32_bf16 a[44:47], a[236:239], v[204:207], a[44:47]
    v_fma_f32 v19, v19, s46, -v52
    v_exp_f32 v16, v16
    ds_read_b64_tr_b16 a[212:213], v60 offset:264
    ds_read_b64_tr_b16 a[214:215], v60 offset:2312
    s_waitcnt lgkmcnt(10)
    v_mfma_f32_16x16x32_bf16 a[48:51], a[192:195], v[196:199], a[48:51]
    v_exp_f32 v17, v17
    v_exp_f32 v18, v18
    v_mfma_f32_16x16x32_bf16 a[52:55], a[192:195], v[200:203], a[52:55]
    v_exp_f32 v19, v19
    s_nop 0
    v_mfma_f32_16x16x32_bf16 a[56:59], a[192:195], v[204:207], a[56:59]
    v_cvt_pk_bf16_f32 v210, v16, v17
    v_cvt_pk_bf16_f32 v211, v18, v19
    ds_read_b64_tr_b16 a[216:217], v61 offset:256
    ds_read_b64_tr_b16 a[218:219], v61 offset:2304
    s_waitcnt lgkmcnt(10)
    v_mfma_f32_16x16x32_bf16 a[60:63], a[196:199], v[196:199], a[60:63]
    v_lshlrev_b32 v16, 16, v212
    v_and_b32 v17, 0xffff0000, v212
    v_mfma_f32_16x16x32_bf16 a[64:67], a[196:199], v[200:203], a[64:67]
    v_lshlrev_b32 v18, 16, v213
    v_and_b32 v19, 0xffff0000, v213
    v_mfma_f32_16x16x32_bf16 a[68:71], a[196:199], v[204:207], a[68:71]
    v_fma_f32 v16, v16, s46, -v53
    v_fma_f32 v17, v17, s46, -v53
    ds_read_b64_tr_b16 a[220:221], v61 offset:264
    ds_read_b64_tr_b16 a[222:223], v61 offset:2312
    s_waitcnt lgkmcnt(10)
    v_mfma_f32_16x16x32_bf16 a[72:75], a[200:203], v[196:199], a[72:75]
    v_fma_f32 v18, v18, s46, -v53
    v_fma_f32 v19, v19, s46, -v53
    v_mfma_f32_16x16x32_bf16 a[76:79], a[200:203], v[200:203], a[76:79]
    v_exp_f32 v16, v16
    v_exp_f32 v17, v17
    v_mfma_f32_16x16x32_bf16 a[80:83], a[200:203], v[204:207], a[80:83]
    v_exp_f32 v18, v18
    v_exp_f32 v19, v19
    ds_read_b64_tr_b16 a[224:225], v62 offset:256
    ds_read_b64_tr_b16 a[226:227], v62 offset:2304
    s_waitcnt lgkmcnt(10)
    v_mfma_f32_16x16x32_bf16 a[84:87], a[204:207], v[196:199], a[84:87]
    s_nop 0
    v_cvt_pk_bf16_f32 v212, v16, v17
    v_mfma_f32_16x16x32_bf16 a[88:91], a[204:207], v[200:203], a[88:91]
    v_cvt_pk_bf16_f32 v213, v18, v19
    v_lshlrev_b32 v16, 16, v214
    v_mfma_f32_16x16x32_bf16 a[92:95], a[204:207], v[204:207], a[92:95]
    v_and_b32 v17, 0xffff0000, v214
    v_lshlrev_b32 v18, 16, v215
    ds_read_b64_tr_b16 a[228:229], v62 offset:264
    ds_read_b64_tr_b16 a[230:231], v62 offset:2312
    s_waitcnt lgkmcnt(10)
    v_mfma_f32_16x16x32_bf16 a[96:99], a[208:211], v[196:199], a[96:99]
    v_and_b32 v19, 0xffff0000, v215
    v_fma_f32 v16, v16, s46, -v53
    v_mfma_f32_16x16x32_bf16 a[100:103], a[208:211], v[200:203], a[100:103]
    v_fma_f32 v17, v17, s46, -v53
    v_fma_f32 v18, v18, s46, -v53
    v_mfma_f32_16x16x32_bf16 a[104:107], a[208:211], v[204:207], a[104:107]
    v_fma_f32 v19, v19, s46, -v53
    v_exp_f32 v16, v16
    v_mfma_f32_16x16x32_bf16 a[244:247], a[240:243], v[196:199], a[244:247]
    v_exp_f32 v17, v17
    v_exp_f32 v18, v18
    v_mfma_f32_16x16x32_bf16 a[248:251], a[240:243], v[200:203], a[248:251]
    v_exp_f32 v19, v19
    s_nop 0
    v_mfma_f32_16x16x32_bf16 a[252:255], a[240:243], v[204:207], a[252:255]
    v_cvt_pk_bf16_f32 v214, v16, v17
    v_cvt_pk_bf16_f32 v215, v18, v19
    ds_read_b64_tr_b16 a[232:233], v63 offset:256
    ds_read_b64_tr_b16 a[234:235], v63 offset:2304
    s_waitcnt lgkmcnt(10)
    v_mfma_f32_16x16x32_bf16 a[108:111], a[212:215], v[196:199], a[108:111]
    v_lshlrev_b32 v16, 16, v216
    v_and_b32 v17, 0xffff0000, v216
    v_mfma_f32_16x16x32_bf16 a[112:115], a[212:215], v[200:203], a[112:115]
    v_lshlrev_b32 v18, 16, v217
    v_and_b32 v19, 0xffff0000, v217
    v_mfma_f32_16x16x32_bf16 a[116:119], a[212:215], v[204:207], a[116:119]
    v_fma_f32 v16, v16, s46, -v54
    v_fma_f32 v17, v17, s46, -v54
    ds_read_b64_tr_b16 a[236:237], v63 offset:264
    ds_read_b64_tr_b16 a[238:239], v63 offset:2312
    s_waitcnt lgkmcnt(10)
    v_mfma_f32_16x16x32_bf16 a[120:123], a[216:219], v[196:199], a[120:123]
    v_fma_f32 v18, v18, s46, -v54
    v_fma_f32 v19, v19, s46, -v54
    v_mfma_f32_16x16x32_bf16 a[124:127], a[216:219], v[200:203], a[124:127]
    v_exp_f32 v16, v16
    v_exp_f32 v17, v17
    v_mfma_f32_16x16x32_bf16 a[128:131], a[216:219], v[204:207], a[128:131]
    v_exp_f32 v18, v18
    v_exp_f32 v19, v19
    s_barrier
    v_add_u32 v60, 0, v4
    v_add_u32 v61, 0, v5
    v_add_u32 v62, 0, v6
    v_add_u32 v63, 0, v7
    ds_read_b64_tr_b16 a[192:193], v60 offset:0
    ds_read_b64_tr_b16 a[194:195], v60 offset:2048
    s_waitcnt lgkmcnt(10)
    v_mfma_f32_16x16x32_bf16 a[132:135], a[220:223], v[196:199], a[132:135]
    s_nop 0
    v_cvt_pk_bf16_f32 v216, v16, v17
    v_mfma_f32_16x16x32_bf16 a[136:139], a[220:223], v[200:203], a[136:139]
    v_cvt_pk_bf16_f32 v217, v18, v19
    v_lshlrev_b32 v16, 16, v218
    v_mfma_f32_16x16x32_bf16 a[140:143], a[220:223], v[204:207], a[140:143]
    v_and_b32 v17, 0xffff0000, v218
    v_lshlrev_b32 v18, 16, v219
    ds_read_b64_tr_b16 a[196:197], v60 offset:8
    ds_read_b64_tr_b16 a[198:199], v60 offset:2056
    s_waitcnt lgkmcnt(10)
    v_mfma_f32_16x16x32_bf16 a[144:147], a[224:227], v[196:199], a[144:147]
    v_and_b32 v19, 0xffff0000, v219
    v_fma_f32 v16, v16, s46, -v54
    v_mfma_f32_16x16x32_bf16 a[148:151], a[224:227], v[200:203], a[148:151]
    v_fma_f32 v17, v17, s46, -v54
    v_fma_f32 v18, v18, s46, -v54
    v_mfma_f32_16x16x32_bf16 a[152:155], a[224:227], v[204:207], a[152:155]
    v_fma_f32 v19, v19, s46, -v54
    v_exp_f32 v16, v16
    ds_read_b64_tr_b16 a[200:201], v61 offset:0
    ds_read_b64_tr_b16 a[202:203], v61 offset:2048
    s_waitcnt lgkmcnt(10)
    v_mfma_f32_16x16x32_bf16 a[156:159], a[228:231], v[196:199], a[156:159]
    v_exp_f32 v17, v17
    v_exp_f32 v18, v18
    v_mfma_f32_16x16x32_bf16 a[160:163], a[228:231], v[200:203], a[160:163]
    v_exp_f32 v19, v19
    s_nop 0
    v_mfma_f32_16x16x32_bf16 a[164:167], a[228:231], v[204:207], a[164:167]
    v_cvt_pk_bf16_f32 v218, v16, v17
    v_cvt_pk_bf16_f32 v219, v18, v19
    ds_read_b64_tr_b16 a[204:205], v61 offset:8
    ds_read_b64_tr_b16 a[206:207], v61 offset:2056
    s_waitcnt lgkmcnt(10)
    v_mfma_f32_16x16x32_bf16 a[168:171], a[232:235], v[196:199], a[168:171]
    v_mfma_f32_16x16x32_bf16 a[172:175], a[232:235], v[200:203], a[172:175]
    v_mfma_f32_16x16x32_bf16 a[176:179], a[232:235], v[204:207], a[176:179]
    ds_read_b64_tr_b16 a[208:209], v62 offset:0
    ds_read_b64_tr_b16 a[210:211], v62 offset:2048
    s_waitcnt lgkmcnt(10)
    v_mfma_f32_16x16x32_bf16 a[180:183], a[236:239], v[196:199], a[180:183]
    v_mfma_f32_16x16x32_bf16 a[184:187], a[236:239], v[200:203], a[184:187]
    v_mfma_f32_16x16x32_bf16 a[188:191], a[236:239], v[204:207], a[188:191]
    ds_read_b64_tr_b16 a[212:213], v62 offset:8
    ds_read_b64_tr_b16 a[214:215], v62 offset:2056
    s_waitcnt lgkmcnt(10)
    v_mfma_f32_16x16x32_bf16 a[0:3], a[192:195], v[208:211], a[0:3]
    v_lshlrev_b32 v16, 16, v220
    v_and_b32 v17, 0xffff0000, v220
    v_mfma_f32_16x16x32_bf16 a[4:7], a[192:195], v[212:215], a[4:7]
    v_lshlrev_b32 v18, 16, v221
    v_and_b32 v19, 0xffff0000, v221
    v_mfma_f32_16x16x32_bf16 a[8:11], a[192:195], v[216:219], a[8:11]
    v_fma_f32 v16, v16, s46, -v52
    v_fma_f32 v17, v17, s46, -v52
    ds_read_b64_tr_b16 a[216:217], v63 offset:0
    ds_read_b64_tr_b16 a[218:219], v63 offset:2048
    s_waitcnt lgkmcnt(10)
    v_mfma_f32_16x16x32_bf16 a[12:15], a[196:199], v[208:211], a[12:15]
    v_fma_f32 v18, v18, s46, -v52
    v_fma_f32 v19, v19, s46, -v52
    v_mfma_f32_16x16x32_bf16 a[16:19], a[196:199], v[212:215], a[16:19]
    v_exp_f32 v16, v16
    v_exp_f32 v17, v17
    v_mfma_f32_16x16x32_bf16 a[20:23], a[196:199], v[216:219], a[20:23]
    v_exp_f32 v18, v18
    v_exp_f32 v19, v19
    ds_read_b64_tr_b16 a[220:221], v63 offset:8
    ds_read_b64_tr_b16 a[222:223], v63 offset:2056
    s_waitcnt lgkmcnt(10)
    v_mfma_f32_16x16x32_bf16 a[24:27], a[200:203], v[208:211], a[24:27]
    s_nop 0
    v_cvt_pk_bf16_f32 v220, v16, v17
    v_mfma_f32_16x16x32_bf16 a[28:31], a[200:203], v[212:215], a[28:31]
    v_cvt_pk_bf16_f32 v221, v18, v19
    v_lshlrev_b32 v16, 16, v222
    v_mfma_f32_16x16x32_bf16 a[32:35], a[200:203], v[216:219], a[32:35]
    v_and_b32 v17, 0xffff0000, v222
    v_lshlrev_b32 v18, 16, v223
    ds_read_b64_tr_b16 a[224:225], v60 offset:256
    ds_read_b64_tr_b16 a[226:227], v60 offset:2304
    s_waitcnt lgkmcnt(10)
    v_mfma_f32_16x16x32_bf16 a[36:39], a[204:207], v[208:211], a[36:39]
    v_and_b32 v19, 0xffff0000, v223
    v_fma_f32 v16, v16, s46, -v52
    v_mfma_f32_16x16x32_bf16 a[40:43], a[204:207], v[212:215], a[40:43]
    v_fma_f32 v17, v17, s46, -v52
    v_fma_f32 v18, v18, s46, -v52
    v_mfma_f32_16x16x32_bf16 a[44:47], a[204:207], v[216:219], a[44:47]
    v_fma_f32 v19, v19, s46, -v52
    v_exp_f32 v16, v16
    ds_read_b64_tr_b16 a[228:229], v60 offset:264
    ds_read_b64_tr_b16 a[230:231], v60 offset:2312
    s_waitcnt lgkmcnt(10)
    v_mfma_f32_16x16x32_bf16 a[48:51], a[208:211], v[208:211], a[48:51]
    v_exp_f32 v17, v17
    v_exp_f32 v18, v18
    v_mfma_f32_16x16x32_bf16 a[52:55], a[208:211], v[212:215], a[52:55]
    v_exp_f32 v19, v19
    s_nop 0
    v_mfma_f32_16x16x32_bf16 a[56:59], a[208:211], v[216:219], a[56:59]
    v_cvt_pk_bf16_f32 v222, v16, v17
    v_cvt_pk_bf16_f32 v223, v18, v19
    ds_read_b64_tr_b16 a[232:233], v61 offset:256
    ds_read_b64_tr_b16 a[234:235], v61 offset:2304
    s_waitcnt lgkmcnt(10)
    v_mfma_f32_16x16x32_bf16 a[60:63], a[212:215], v[208:211], a[60:63]
    v_lshlrev_b32 v16, 16, v224
    v_and_b32 v17, 0xffff0000, v224
    v_mfma_f32_16x16x32_bf16 a[64:67], a[212:215], v[212:215], a[64:67]
    v_lshlrev_b32 v18, 16, v225
    v_and_b32 v19, 0xffff0000, v225
    v_mfma_f32_16x16x32_bf16 a[68:71], a[212:215], v[216:219], a[68:71]
    v_fma_f32 v16, v16, s46, -v53
    v_fma_f32 v17, v17, s46, -v53
    ds_read_b64_tr_b16 a[236:237], v61 offset:264
    ds_read_b64_tr_b16 a[238:239], v61 offset:2312
    s_waitcnt lgkmcnt(10)
    v_mfma_f32_16x16x32_bf16 a[72:75], a[216:219], v[208:211], a[72:75]
    v_fma_f32 v18, v18, s46, -v53
    v_fma_f32 v19, v19, s46, -v53
    v_mfma_f32_16x16x32_bf16 a[76:79], a[216:219], v[212:215], a[76:79]
    v_exp_f32 v16, v16
    v_exp_f32 v17, v17
    v_mfma_f32_16x16x32_bf16 a[80:83], a[216:219], v[216:219], a[80:83]
    v_exp_f32 v18, v18
    v_exp_f32 v19, v19
    ds_read_b64_tr_b16 a[192:193], v62 offset:256
    ds_read_b64_tr_b16 a[194:195], v62 offset:2304
    s_waitcnt lgkmcnt(10)
    v_mfma_f32_16x16x32_bf16 a[84:87], a[220:223], v[208:211], a[84:87]
    s_nop 0
    v_cvt_pk_bf16_f32 v224, v16, v17
    v_mfma_f32_16x16x32_bf16 a[88:91], a[220:223], v[212:215], a[88:91]
    v_cvt_pk_bf16_f32 v225, v18, v19
    v_lshlrev_b32 v16, 16, v226
    v_mfma_f32_16x16x32_bf16 a[92:95], a[220:223], v[216:219], a[92:95]
    v_and_b32 v17, 0xffff0000, v226
    v_lshlrev_b32 v18, 16, v227
    ds_read_b64_tr_b16 a[196:197], v62 offset:264
    ds_read_b64_tr_b16 a[198:199], v62 offset:2312
    s_waitcnt lgkmcnt(10)
    v_mfma_f32_16x16x32_bf16 a[96:99], a[224:227], v[208:211], a[96:99]
    v_and_b32 v19, 0xffff0000, v227
    v_fma_f32 v16, v16, s46, -v53
    v_mfma_f32_16x16x32_bf16 a[100:103], a[224:227], v[212:215], a[100:103]
    v_fma_f32 v17, v17, s46, -v53
    v_fma_f32 v18, v18, s46, -v53
    v_mfma_f32_16x16x32_bf16 a[104:107], a[224:227], v[216:219], a[104:107]
    v_fma_f32 v19, v19, s46, -v53
    v_exp_f32 v16, v16
    v_mfma_f32_16x16x32_bf16 a[244:247], a[240:243], v[208:211], a[244:247]
    v_exp_f32 v17, v17
    v_exp_f32 v18, v18
    v_mfma_f32_16x16x32_bf16 a[248:251], a[240:243], v[212:215], a[248:251]
    v_exp_f32 v19, v19
    s_nop 0
    v_mfma_f32_16x16x32_bf16 a[252:255], a[240:243], v[216:219], a[252:255]
    v_cvt_pk_bf16_f32 v226, v16, v17
    v_cvt_pk_bf16_f32 v227, v18, v19
    ds_read_b64_tr_b16 a[200:201], v63 offset:256
    ds_read_b64_tr_b16 a[202:203], v63 offset:2304
    s_waitcnt lgkmcnt(10)
    v_mfma_f32_16x16x32_bf16 a[108:111], a[228:231], v[208:211], a[108:111]
    v_lshlrev_b32 v16, 16, v228
    v_and_b32 v17, 0xffff0000, v228
    v_mfma_f32_16x16x32_bf16 a[112:115], a[228:231], v[212:215], a[112:115]
    v_lshlrev_b32 v18, 16, v229
    v_and_b32 v19, 0xffff0000, v229
    v_mfma_f32_16x16x32_bf16 a[116:119], a[228:231], v[216:219], a[116:119]
    v_fma_f32 v16, v16, s46, -v54
    v_fma_f32 v17, v17, s46, -v54
    ds_read_b64_tr_b16 a[204:205], v63 offset:264
    ds_read_b64_tr_b16 a[206:207], v63 offset:2312
    s_waitcnt lgkmcnt(10)
    v_mfma_f32_16x16x32_bf16 a[120:123], a[232:235], v[208:211], a[120:123]
    v_fma_f32 v18, v18, s46, -v54
    v_fma_f32 v19, v19, s46, -v54
    v_mfma_f32_16x16x32_bf16 a[124:127], a[232:235], v[212:215], a[124:127]
    v_exp_f32 v16, v16
    v_exp_f32 v17, v17
    v_mfma_f32_16x16x32_bf16 a[128:131], a[232:235], v[216:219], a[128:131]
    v_exp_f32 v18, v18
    v_exp_f32 v19, v19
    s_barrier
    v_add_u32 v60, 16384, v4
    v_add_u32 v61, 16384, v5
    v_add_u32 v62, 16384, v6
    v_add_u32 v63, 16384, v7
    ds_read_b64_tr_b16 a[208:209], v60 offset:0
    ds_read_b64_tr_b16 a[210:211], v60 offset:2048
    s_waitcnt lgkmcnt(10)
    v_mfma_f32_16x16x32_bf16 a[132:135], a[236:239], v[208:211], a[132:135]
    s_nop 0
    v_cvt_pk_bf16_f32 v228, v16, v17
    v_mfma_f32_16x16x32_bf16 a[136:139], a[236:239], v[212:215], a[136:139]
    v_cvt_pk_bf16_f32 v229, v18, v19
    v_lshlrev_b32 v16, 16, v230
    v_mfma_f32_16x16x32_bf16 a[140:143], a[236:239], v[216:219], a[140:143]
    v_and_b32 v17, 0xffff0000, v230
    v_lshlrev_b32 v18, 16, v231
    ds_read_b64_tr_b16 a[212:213], v60 offset:8
    ds_read_b64_tr_b16 a[214:215], v60 offset:2056
    s_waitcnt lgkmcnt(10)
    v_mfma_f32_16x16x32_bf16 a[144:147], a[192:195], v[208:211], a[144:147]
    v_and_b32 v19, 0xffff0000, v231
    v_fma_f32 v16, v16, s46, -v54
    v_mfma_f32_16x16x32_bf16 a[148:151], a[192:195], v[212:215], a[148:151]
    v_fma_f32 v17, v17, s46, -v54
    v_fma_f32 v18, v18, s46, -v54
    v_mfma_f32_16x16x32_bf16 a[152:155], a[192:195], v[216:219], a[152:155]
    v_fma_f32 v19, v19, s46, -v54
    v_exp_f32 v16, v16
    ds_read_b64_tr_b16 a[216:217], v61 offset:0
    ds_read_b64_tr_b16 a[218:219], v61 offset:2048
    s_waitcnt lgkmcnt(10)
    v_mfma_f32_16x16x32_bf16 a[156:159], a[196:199], v[208:211], a[156:159]
    v_exp_f32 v17, v17
    v_exp_f32 v18, v18
    v_mfma_f32_16x16x32_bf16 a[160:163], a[196:199], v[212:215], a[160:163]
    v_exp_f32 v19, v19
    s_nop 0
    v_mfma_f32_16x16x32_bf16 a[164:167], a[196:199], v[216:219], a[164:167]
    v_cvt_pk_bf16_f32 v230, v16, v17
    v_cvt_pk_bf16_f32 v231, v18, v19
    ds_read_b64_tr_b16 a[220:221], v61 offset:8
    ds_read_b64_tr_b16 a[222:223], v61 offset:2056
    s_waitcnt lgkmcnt(10)
    v_mfma_f32_16x16x32_bf16 a[168:171], a[200:203], v[208:211], a[168:171]
    v_mfma_f32_16x16x32_bf16 a[172:175], a[200:203], v[212:215], a[172:175]
    v_mfma_f32_16x16x32_bf16 a[176:179], a[200:203], v[216:219], a[176:179]
    ds_read_b64_tr_b16 a[224:225], v62 offset:0
    ds_read_b64_tr_b16 a[226:227], v62 offset:2048
    s_waitcnt lgkmcnt(10)
    v_mfma_f32_16x16x32_bf16 a[180:183], a[204:207], v[208:211], a[180:183]
    v_mfma_f32_16x16x32_bf16 a[184:187], a[204:207], v[212:215], a[184:187]
    v_mfma_f32_16x16x32_bf16 a[188:191], a[204:207], v[216:219], a[188:191]
    ds_read_b64_tr_b16 a[228:229], v62 offset:8
    ds_read_b64_tr_b16 a[230:231], v62 offset:2056
    s_waitcnt lgkmcnt(10)
    v_mfma_f32_16x16x32_bf16 a[0:3], a[208:211], v[220:223], a[0:3]
    v_lshlrev_b32 v16, 16, v232
    v_and_b32 v17, 0xffff0000, v232
    v_mfma_f32_16x16x32_bf16 a[4:7], a[208:211], v[224:227], a[4:7]
    v_lshlrev_b32 v18, 16, v233
    v_and_b32 v19, 0xffff0000, v233
    v_mfma_f32_16x16x32_bf16 a[8:11], a[208:211], v[228:231], a[8:11]
    v_fma_f32 v16, v16, s46, -v52
    v_fma_f32 v17, v17, s46, -v52
    ds_read_b64_tr_b16 a[232:233], v63 offset:0
    ds_read_b64_tr_b16 a[234:235], v63 offset:2048
    s_waitcnt lgkmcnt(10)
    v_mfma_f32_16x16x32_bf16 a[12:15], a[212:215], v[220:223], a[12:15]
    v_fma_f32 v18, v18, s46, -v52
    v_fma_f32 v19, v19, s46, -v52
    v_mfma_f32_16x16x32_bf16 a[16:19], a[212:215], v[224:227], a[16:19]
    v_exp_f32 v16, v16
    v_exp_f32 v17, v17
    v_mfma_f32_16x16x32_bf16 a[20:23], a[212:215], v[228:231], a[20:23]
    v_exp_f32 v18, v18
    v_exp_f32 v19, v19
    ds_read_b64_tr_b16 a[236:237], v63 offset:8
    ds_read_b64_tr_b16 a[238:239], v63 offset:2056
    s_waitcnt lgkmcnt(10)
    v_mfma_f32_16x16x32_bf16 a[24:27], a[216:219], v[220:223], a[24:27]
    s_nop 0
    v_cvt_pk_bf16_f32 v232, v16, v17
    v_mfma_f32_16x16x32_bf16 a[28:31], a[216:219], v[224:227], a[28:31]
    v_cvt_pk_bf16_f32 v233, v18, v19
    v_lshlrev_b32 v16, 16, v234
    v_mfma_f32_16x16x32_bf16 a[32:35], a[216:219], v[228:231], a[32:35]
    v_and_b32 v17, 0xffff0000, v234
    v_lshlrev_b32 v18, 16, v235
    ds_read_b64_tr_b16 a[192:193], v60 offset:256
    ds_read_b64_tr_b16 a[194:195], v60 offset:2304
    s_waitcnt lgkmcnt(10)
    v_mfma_f32_16x16x32_bf16 a[36:39], a[220:223], v[220:223], a[36:39]
    v_and_b32 v19, 0xffff0000, v235
    v_fma_f32 v16, v16, s46, -v52
    v_mfma_f32_16x16x32_bf16 a[40:43], a[220:223], v[224:227], a[40:43]
    v_fma_f32 v17, v17, s46, -v52
    v_fma_f32 v18, v18, s46, -v52
    v_mfma_f32_16x16x32_bf16 a[44:47], a[220:223], v[228:231], a[44:47]
    v_fma_f32 v19, v19, s46, -v52
    v_exp_f32 v16, v16
    ds_read_b64_tr_b16 a[196:197], v60 offset:264
    ds_read_b64_tr_b16 a[198:199], v60 offset:2312
    s_waitcnt lgkmcnt(10)
    v_mfma_f32_16x16x32_bf16 a[48:51], a[224:227], v[220:223], a[48:51]
    v_exp_f32 v17, v17
    v_exp_f32 v18, v18
    v_mfma_f32_16x16x32_bf16 a[52:55], a[224:227], v[224:227], a[52:55]
    v_exp_f32 v19, v19
    s_nop 0
    v_mfma_f32_16x16x32_bf16 a[56:59], a[224:227], v[228:231], a[56:59]
    v_cvt_pk_bf16_f32 v234, v16, v17
    v_cvt_pk_bf16_f32 v235, v18, v19
    ds_read_b64_tr_b16 a[200:201], v61 offset:256
    ds_read_b64_tr_b16 a[202:203], v61 offset:2304
    s_waitcnt lgkmcnt(10)
    v_mfma_f32_16x16x32_bf16 a[60:63], a[228:231], v[220:223], a[60:63]
    v_lshlrev_b32 v16, 16, v236
    v_and_b32 v17, 0xffff0000, v236
    v_mfma_f32_16x16x32_bf16 a[64:67], a[228:231], v[224:227], a[64:67]
    v_lshlrev_b32 v18, 16, v237
    v_and_b32 v19, 0xffff0000, v237
    v_mfma_f32_16x16x32_bf16 a[68:71], a[228:231], v[228:231], a[68:71]
    v_fma_f32 v16, v16, s46, -v53
    v_fma_f32 v17, v17, s46, -v53
    ds_read_b64_tr_b16 a[204:205], v61 offset:264
    ds_read_b64_tr_b16 a[206:207], v61 offset:2312
    s_waitcnt lgkmcnt(10)
    v_mfma_f32_16x16x32_bf16 a[72:75], a[232:235], v[220:223], a[72:75]
    v_fma_f32 v18, v18, s46, -v53
    v_fma_f32 v19, v19, s46, -v53
    v_mfma_f32_16x16x32_bf16 a[76:79], a[232:235], v[224:227], a[76:79]
    v_exp_f32 v16, v16
    v_exp_f32 v17, v17
    v_mfma_f32_16x16x32_bf16 a[80:83], a[232:235], v[228:231], a[80:83]
    v_exp_f32 v18, v18
    v_exp_f32 v19, v19
    ds_read_b64_tr_b16 a[208:209], v62 offset:256
    ds_read_b64_tr_b16 a[210:211], v62 offset:2304
    s_waitcnt lgkmcnt(10)
    v_mfma_f32_16x16x32_bf16 a[84:87], a[236:239], v[220:223], a[84:87]
    s_nop 0
    v_cvt_pk_bf16_f32 v236, v16, v17
    v_mfma_f32_16x16x32_bf16 a[88:91], a[236:239], v[224:227], a[88:91]
    v_cvt_pk_bf16_f32 v237, v18, v19
    v_lshlrev_b32 v16, 16, v238
    v_mfma_f32_16x16x32_bf16 a[92:95], a[236:239], v[228:231], a[92:95]
    v_and_b32 v17, 0xffff0000, v238
    v_lshlrev_b32 v18, 16, v239
    ds_read_b64_tr_b16 a[212:213], v62 offset:264
    ds_read_b64_tr_b16 a[214:215], v62 offset:2312
    s_waitcnt lgkmcnt(10)
    v_mfma_f32_16x16x32_bf16 a[96:99], a[192:195], v[220:223], a[96:99]
    v_and_b32 v19, 0xffff0000, v239
    v_fma_f32 v16, v16, s46, -v53
    v_mfma_f32_16x16x32_bf16 a[100:103], a[192:195], v[224:227], a[100:103]
    v_fma_f32 v17, v17, s46, -v53
    v_fma_f32 v18, v18, s46, -v53
    v_mfma_f32_16x16x32_bf16 a[104:107], a[192:195], v[228:231], a[104:107]
    v_fma_f32 v19, v19, s46, -v53
    v_exp_f32 v16, v16
    v_mfma_f32_16x16x32_bf16 a[244:247], a[240:243], v[220:223], a[244:247]
    v_exp_f32 v17, v17
    v_exp_f32 v18, v18
    v_mfma_f32_16x16x32_bf16 a[248:251], a[240:243], v[224:227], a[248:251]
    v_exp_f32 v19, v19
    s_nop 0
    v_mfma_f32_16x16x32_bf16 a[252:255], a[240:243], v[228:231], a[252:255]
    v_cvt_pk_bf16_f32 v238, v16, v17
    v_cvt_pk_bf16_f32 v239, v18, v19
    ds_read_b64_tr_b16 a[216:217], v63 offset:256
    ds_read_b64_tr_b16 a[218:219], v63 offset:2304
    s_waitcnt lgkmcnt(10)
    v_mfma_f32_16x16x32_bf16 a[108:111], a[196:199], v[220:223], a[108:111]
    v_lshlrev_b32 v16, 16, v240
    v_and_b32 v17, 0xffff0000, v240
    v_mfma_f32_16x16x32_bf16 a[112:115], a[196:199], v[224:227], a[112:115]
    v_lshlrev_b32 v18, 16, v241
    v_and_b32 v19, 0xffff0000, v241
    v_mfma_f32_16x16x32_bf16 a[116:119], a[196:199], v[228:231], a[116:119]
    v_fma_f32 v16, v16, s46, -v54
    v_fma_f32 v17, v17, s46, -v54
    ds_read_b64_tr_b16 a[220:221], v63 offset:264
    ds_read_b64_tr_b16 a[222:223], v63 offset:2312
    s_waitcnt lgkmcnt(10)
    v_mfma_f32_16x16x32_bf16 a[120:123], a[200:203], v[220:223], a[120:123]
    v_fma_f32 v18, v18, s46, -v54
    v_fma_f32 v19, v19, s46, -v54
    v_mfma_f32_16x16x32_bf16 a[124:127], a[200:203], v[224:227], a[124:127]
    v_exp_f32 v16, v16
    v_exp_f32 v17, v17
    v_mfma_f32_16x16x32_bf16 a[128:131], a[200:203], v[228:231], a[128:131]
    v_exp_f32 v18, v18
    v_exp_f32 v19, v19
    s_barrier
    v_add_u32 v60, 65536, v4
    v_add_u32 v61, 65536, v5
    v_add_u32 v62, 65536, v6
    v_add_u32 v63, 65536, v7
    ds_read_b64_tr_b16 a[224:225], v60 offset:0
    ds_read_b64_tr_b16 a[226:227], v60 offset:2048
    s_waitcnt lgkmcnt(10)
    v_mfma_f32_16x16x32_bf16 a[132:135], a[204:207], v[220:223], a[132:135]
    s_nop 0
    v_cvt_pk_bf16_f32 v240, v16, v17
    v_mfma_f32_16x16x32_bf16 a[136:139], a[204:207], v[224:227], a[136:139]
    v_cvt_pk_bf16_f32 v241, v18, v19
    v_lshlrev_b32 v16, 16, v242
    v_mfma_f32_16x16x32_bf16 a[140:143], a[204:207], v[228:231], a[140:143]
    v_and_b32 v17, 0xffff0000, v242
    v_lshlrev_b32 v18, 16, v243
    ds_read_b64_tr_b16 a[228:229], v60 offset:8
    ds_read_b64_tr_b16 a[230:231], v60 offset:2056
    s_waitcnt lgkmcnt(10)
    v_mfma_f32_16x16x32_bf16 a[144:147], a[208:211], v[220:223], a[144:147]
    v_and_b32 v19, 0xffff0000, v243
    v_fma_f32 v16, v16, s46, -v54
    v_mfma_f32_16x16x32_bf16 a[148:151], a[208:211], v[224:227], a[148:151]
    v_fma_f32 v17, v17, s46, -v54
    v_fma_f32 v18, v18, s46, -v54
    v_mfma_f32_16x16x32_bf16 a[152:155], a[208:211], v[228:231], a[152:155]
    v_fma_f32 v19, v19, s46, -v54
    v_exp_f32 v16, v16
    ds_read_b64_tr_b16 a[232:233], v61 offset:0
    ds_read_b64_tr_b16 a[234:235], v61 offset:2048
    s_waitcnt lgkmcnt(10)
    v_mfma_f32_16x16x32_bf16 a[156:159], a[212:215], v[220:223], a[156:159]
    v_exp_f32 v17, v17
    v_exp_f32 v18, v18
    v_mfma_f32_16x16x32_bf16 a[160:163], a[212:215], v[224:227], a[160:163]
    v_exp_f32 v19, v19
    s_nop 0
    v_mfma_f32_16x16x32_bf16 a[164:167], a[212:215], v[228:231], a[164:167]
    v_cvt_pk_bf16_f32 v242, v16, v17
    v_cvt_pk_bf16_f32 v243, v18, v19
    ds_read_b64_tr_b16 a[236:237], v61 offset:8
    ds_read_b64_tr_b16 a[238:239], v61 offset:2056
    s_waitcnt lgkmcnt(10)
    v_mfma_f32_16x16x32_bf16 a[168:171], a[216:219], v[220:223], a[168:171]
    v_mfma_f32_16x16x32_bf16 a[172:175], a[216:219], v[224:227], a[172:175]
    v_mfma_f32_16x16x32_bf16 a[176:179], a[216:219], v[228:231], a[176:179]
    ds_read_b64_tr_b16 a[192:193], v62 offset:0
    ds_read_b64_tr_b16 a[194:195], v62 offset:2048
    s_waitcnt lgkmcnt(10)
    v_mfma_f32_16x16x32_bf16 a[180:183], a[220:223], v[220:223], a[180:183]
    v_mfma_f32_16x16x32_bf16 a[184:187], a[220:223], v[224:227], a[184:187]
    v_mfma_f32_16x16x32_bf16 a[188:191], a[220:223], v[228:231], a[188:191]
    ds_read_b64_tr_b16 a[196:197], v62 offset:8
    ds_read_b64_tr_b16 a[198:199], v62 offset:2056
    s_waitcnt lgkmcnt(10)
    v_mfma_f32_16x16x32_bf16 a[0:3], a[224:227], v[232:235], a[0:3]
    v_lshlrev_b32 v16, 16, v244
    v_and_b32 v17, 0xffff0000, v244
    v_mfma_f32_16x16x32_bf16 a[4:7], a[224:227], v[236:239], a[4:7]
    v_lshlrev_b32 v18, 16, v245
    v_and_b32 v19, 0xffff0000, v245
    v_mfma_f32_16x16x32_bf16 a[8:11], a[224:227], v[240:243], a[8:11]
    v_fma_f32 v16, v16, s46, -v52
    v_fma_f32 v17, v17, s46, -v52
    ds_read_b64_tr_b16 a[200:201], v63 offset:0
    ds_read_b64_tr_b16 a[202:203], v63 offset:2048
    s_waitcnt lgkmcnt(10)
    v_mfma_f32_16x16x32_bf16 a[12:15], a[228:231], v[232:235], a[12:15]
    v_fma_f32 v18, v18, s46, -v52
    v_fma_f32 v19, v19, s46, -v52
    v_mfma_f32_16x16x32_bf16 a[16:19], a[228:231], v[236:239], a[16:19]
    v_exp_f32 v16, v16
    v_exp_f32 v17, v17
    v_mfma_f32_16x16x32_bf16 a[20:23], a[228:231], v[240:243], a[20:23]
    v_exp_f32 v18, v18
    v_exp_f32 v19, v19
    ds_read_b64_tr_b16 a[204:205], v63 offset:8
    ds_read_b64_tr_b16 a[206:207], v63 offset:2056
    s_waitcnt lgkmcnt(10)
    v_mfma_f32_16x16x32_bf16 a[24:27], a[232:235], v[232:235], a[24:27]
    s_nop 0
    v_cvt_pk_bf16_f32 v244, v16, v17
    v_mfma_f32_16x16x32_bf16 a[28:31], a[232:235], v[236:239], a[28:31]
    v_cvt_pk_bf16_f32 v245, v18, v19
    v_lshlrev_b32 v16, 16, v246
    v_mfma_f32_16x16x32_bf16 a[32:35], a[232:235], v[240:243], a[32:35]
    v_and_b32 v17, 0xffff0000, v246
    v_lshlrev_b32 v18, 16, v247
    ds_read_b64_tr_b16 a[208:209], v60 offset:256
    ds_read_b64_tr_b16 a[210:211], v60 offset:2304
    s_waitcnt lgkmcnt(10)
    v_mfma_f32_16x16x32_bf16 a[36:39], a[236:239], v[232:235], a[36:39]
    v_and_b32 v19, 0xffff0000, v247
    v_fma_f32 v16, v16, s46, -v52
    v_mfma_f32_16x16x32_bf16 a[40:43], a[236:239], v[236:239], a[40:43]
    v_fma_f32 v17, v17, s46, -v52
    v_fma_f32 v18, v18, s46, -v52
    v_mfma_f32_16x16x32_bf16 a[44:47], a[236:239], v[240:243], a[44:47]
    v_fma_f32 v19, v19, s46, -v52
    v_exp_f32 v16, v16
    ds_read_b64_tr_b16 a[212:213], v60 offset:264
    ds_read_b64_tr_b16 a[214:215], v60 offset:2312
    s_waitcnt lgkmcnt(10)
    v_mfma_f32_16x16x32_bf16 a[48:51], a[192:195], v[232:235], a[48:51]
    v_exp_f32 v17, v17
    v_exp_f32 v18, v18
    v_mfma_f32_16x16x32_bf16 a[52:55], a[192:195], v[236:239], a[52:55]
    v_exp_f32 v19, v19
    s_nop 0
    v_mfma_f32_16x16x32_bf16 a[56:59], a[192:195], v[240:243], a[56:59]
    v_cvt_pk_bf16_f32 v246, v16, v17
    v_cvt_pk_bf16_f32 v247, v18, v19
    ds_read_b64_tr_b16 a[216:217], v61 offset:256
    ds_read_b64_tr_b16 a[218:219], v61 offset:2304
    s_waitcnt lgkmcnt(10)
    v_mfma_f32_16x16x32_bf16 a[60:63], a[196:199], v[232:235], a[60:63]
    v_lshlrev_b32 v16, 16, v248
    v_and_b32 v17, 0xffff0000, v248
    v_mfma_f32_16x16x32_bf16 a[64:67], a[196:199], v[236:239], a[64:67]
    v_lshlrev_b32 v18, 16, v249
    v_and_b32 v19, 0xffff0000, v249
    v_mfma_f32_16x16x32_bf16 a[68:71], a[196:199], v[240:243], a[68:71]
    v_fma_f32 v16, v16, s46, -v53
    v_fma_f32 v17, v17, s46, -v53
    ds_read_b64_tr_b16 a[220:221], v61 offset:264
    ds_read_b64_tr_b16 a[222:223], v61 offset:2312
    s_waitcnt lgkmcnt(10)
    v_mfma_f32_16x16x32_bf16 a[72:75], a[200:203], v[232:235], a[72:75]
    v_fma_f32 v18, v18, s46, -v53
    v_fma_f32 v19, v19, s46, -v53
    v_mfma_f32_16x16x32_bf16 a[76:79], a[200:203], v[236:239], a[76:79]
    v_exp_f32 v16, v16
    v_exp_f32 v17, v17
    v_mfma_f32_16x16x32_bf16 a[80:83], a[200:203], v[240:243], a[80:83]
    v_exp_f32 v18, v18
    v_exp_f32 v19, v19
    ds_read_b64_tr_b16 a[224:225], v62 offset:256
    ds_read_b64_tr_b16 a[226:227], v62 offset:2304
    s_waitcnt lgkmcnt(10)
    v_mfma_f32_16x16x32_bf16 a[84:87], a[204:207], v[232:235], a[84:87]
    s_nop 0
    v_cvt_pk_bf16_f32 v248, v16, v17
    v_mfma_f32_16x16x32_bf16 a[88:91], a[204:207], v[236:239], a[88:91]
    v_cvt_pk_bf16_f32 v249, v18, v19
    v_lshlrev_b32 v16, 16, v250
    v_mfma_f32_16x16x32_bf16 a[92:95], a[204:207], v[240:243], a[92:95]
    v_and_b32 v17, 0xffff0000, v250
    v_lshlrev_b32 v18, 16, v251
    ds_read_b64_tr_b16 a[228:229], v62 offset:264
    ds_read_b64_tr_b16 a[230:231], v62 offset:2312
    s_waitcnt lgkmcnt(10)
    v_mfma_f32_16x16x32_bf16 a[96:99], a[208:211], v[232:235], a[96:99]
    v_and_b32 v19, 0xffff0000, v251
    v_fma_f32 v16, v16, s46, -v53
    v_mfma_f32_16x16x32_bf16 a[100:103], a[208:211], v[236:239], a[100:103]
    v_fma_f32 v17, v17, s46, -v53
    v_fma_f32 v18, v18, s46, -v53
    v_mfma_f32_16x16x32_bf16 a[104:107], a[208:211], v[240:243], a[104:107]
    v_fma_f32 v19, v19, s46, -v53
    v_exp_f32 v16, v16
    v_mfma_f32_16x16x32_bf16 a[244:247], a[240:243], v[232:235], a[244:247]
    v_exp_f32 v17, v17
    v_exp_f32 v18, v18
    v_mfma_f32_16x16x32_bf16 a[248:251], a[240:243], v[236:239], a[248:251]
    v_exp_f32 v19, v19
    s_nop 0
    v_mfma_f32_16x16x32_bf16 a[252:255], a[240:243], v[240:243], a[252:255]
    v_cvt_pk_bf16_f32 v250, v16, v17
    v_cvt_pk_bf16_f32 v251, v18, v19
    ds_read_b64_tr_b16 a[232:233], v63 offset:256
    ds_read_b64_tr_b16 a[234:235], v63 offset:2304
    s_waitcnt lgkmcnt(10)
    v_mfma_f32_16x16x32_bf16 a[108:111], a[212:215], v[232:235], a[108:111]
    v_lshlrev_b32 v16, 16, v252
    v_and_b32 v17, 0xffff0000, v252
    v_mfma_f32_16x16x32_bf16 a[112:115], a[212:215], v[236:239], a[112:115]
    v_lshlrev_b32 v18, 16, v253
    v_and_b32 v19, 0xffff0000, v253
    v_mfma_f32_16x16x32_bf16 a[116:119], a[212:215], v[240:243], a[116:119]
    v_fma_f32 v16, v16, s46, -v54
    v_fma_f32 v17, v17, s46, -v54
    ds_read_b64_tr_b16 a[236:237], v63 offset:264
    ds_read_b64_tr_b16 a[238:239], v63 offset:2312
    s_waitcnt lgkmcnt(10)
    v_mfma_f32_16x16x32_bf16 a[120:123], a[216:219], v[232:235], a[120:123]
    v_fma_f32 v18, v18, s46, -v54
    v_fma_f32 v19, v19, s46, -v54
    v_mfma_f32_16x16x32_bf16 a[124:127], a[216:219], v[236:239], a[124:127]
    v_exp_f32 v16, v16
    v_exp_f32 v17, v17
    v_mfma_f32_16x16x32_bf16 a[128:131], a[216:219], v[240:243], a[128:131]
    v_exp_f32 v18, v18
    v_exp_f32 v19, v19
    s_barrier
    v_add_u32 v60, 81920, v4
    v_add_u32 v61, 81920, v5
    v_add_u32 v62, 81920, v6
    v_add_u32 v63, 81920, v7
    ds_read_b64_tr_b16 a[192:193], v60 offset:0
    ds_read_b64_tr_b16 a[194:195], v60 offset:2048
    s_waitcnt lgkmcnt(10)
    v_mfma_f32_16x16x32_bf16 a[132:135], a[220:223], v[232:235], a[132:135]
    s_nop 0
    v_cvt_pk_bf16_f32 v252, v16, v17
    v_mfma_f32_16x16x32_bf16 a[136:139], a[220:223], v[236:239], a[136:139]
    v_cvt_pk_bf16_f32 v253, v18, v19
    v_lshlrev_b32 v16, 16, v254
    v_mfma_f32_16x16x32_bf16 a[140:143], a[220:223], v[240:243], a[140:143]
    v_and_b32 v17, 0xffff0000, v254
    v_lshlrev_b32 v18, 16, v255
    ds_read_b64_tr_b16 a[196:197], v60 offset:8
    ds_read_b64_tr_b16 a[198:199], v60 offset:2056
    s_waitcnt lgkmcnt(10)
    v_mfma_f32_16x16x32_bf16 a[144:147], a[224:227], v[232:235], a[144:147]
    v_and_b32 v19, 0xffff0000, v255
    v_fma_f32 v16, v16, s46, -v54
    v_mfma_f32_16x16x32_bf16 a[148:151], a[224:227], v[236:239], a[148:151]
    v_fma_f32 v17, v17, s46, -v54
    v_fma_f32 v18, v18, s46, -v54
    v_mfma_f32_16x16x32_bf16 a[152:155], a[224:227], v[240:243], a[152:155]
    v_fma_f32 v19, v19, s46, -v54
    v_exp_f32 v16, v16
    ds_read_b64_tr_b16 a[200:201], v61 offset:0
    ds_read_b64_tr_b16 a[202:203], v61 offset:2048
    s_waitcnt lgkmcnt(10)
    v_mfma_f32_16x16x32_bf16 a[156:159], a[228:231], v[232:235], a[156:159]
    v_exp_f32 v17, v17
    v_exp_f32 v18, v18
    v_mfma_f32_16x16x32_bf16 a[160:163], a[228:231], v[236:239], a[160:163]
    v_exp_f32 v19, v19
    s_nop 0
    v_mfma_f32_16x16x32_bf16 a[164:167], a[228:231], v[240:243], a[164:167]
    v_cvt_pk_bf16_f32 v254, v16, v17
    v_cvt_pk_bf16_f32 v255, v18, v19
    ds_read_b64_tr_b16 a[204:205], v61 offset:8
    ds_read_b64_tr_b16 a[206:207], v61 offset:2056
    s_waitcnt lgkmcnt(10)
    v_mfma_f32_16x16x32_bf16 a[168:171], a[232:235], v[232:235], a[168:171]
    v_mfma_f32_16x16x32_bf16 a[172:175], a[232:235], v[236:239], a[172:175]
    v_mfma_f32_16x16x32_bf16 a[176:179], a[232:235], v[240:243], a[176:179]
    ds_read_b64_tr_b16 a[208:209], v62 offset:0
    ds_read_b64_tr_b16 a[210:211], v62 offset:2048
    s_waitcnt lgkmcnt(10)
    v_mfma_f32_16x16x32_bf16 a[180:183], a[236:239], v[232:235], a[180:183]
    v_mfma_f32_16x16x32_bf16 a[184:187], a[236:239], v[236:239], a[184:187]
    v_mfma_f32_16x16x32_bf16 a[188:191], a[236:239], v[240:243], a[188:191]
    ds_read_b64_tr_b16 a[212:213], v62 offset:8
    ds_read_b64_tr_b16 a[214:215], v62 offset:2056
    s_waitcnt lgkmcnt(10)
    v_mfma_f32_16x16x32_bf16 a[0:3], a[192:195], v[244:247], a[0:3]
    v_mfma_f32_16x16x32_bf16 a[4:7], a[192:195], v[248:251], a[4:7]
    v_mfma_f32_16x16x32_bf16 a[8:11], a[192:195], v[252:255], a[8:11]
    ds_read_b64_tr_b16 a[216:217], v63 offset:0
    ds_read_b64_tr_b16 a[218:219], v63 offset:2048
    s_waitcnt lgkmcnt(10)
    v_mfma_f32_16x16x32_bf16 a[12:15], a[196:199], v[244:247], a[12:15]
    v_mfma_f32_16x16x32_bf16 a[16:19], a[196:199], v[248:251], a[16:19]
    v_mfma_f32_16x16x32_bf16 a[20:23], a[196:199], v[252:255], a[20:23]
    ds_read_b64_tr_b16 a[220:221], v63 offset:8
    ds_read_b64_tr_b16 a[222:223], v63 offset:2056
    s_waitcnt lgkmcnt(10)
    v_mfma_f32_16x16x32_bf16 a[24:27], a[200:203], v[244:247], a[24:27]
    v_mfma_f32_16x16x32_bf16 a[28:31], a[200:203], v[248:251], a[28:31]
    v_mfma_f32_16x16x32_bf16 a[32:35], a[200:203], v[252:255], a[32:35]
    ds_read_b64_tr_b16 a[224:225], v60 offset:256
    ds_read_b64_tr_b16 a[226:227], v60 offset:2304
    s_waitcnt lgkmcnt(10)
    v_mfma_f32_16x16x32_bf16 a[36:39], a[204:207], v[244:247], a[36:39]
    v_mfma_f32_16x16x32_bf16 a[40:43], a[204:207], v[248:251], a[40:43]
    v_mfma_f32_16x16x32_bf16 a[44:47], a[204:207], v[252:255], a[44:47]
    ds_read_b64_tr_b16 a[228:229], v60 offset:264
    ds_read_b64_tr_b16 a[230:231], v60 offset:2312
    s_waitcnt lgkmcnt(10)
    v_mfma_f32_16x16x32_bf16 a[48:51], a[208:211], v[244:247], a[48:51]
    v_mfma_f32_16x16x32_bf16 a[52:55], a[208:211], v[248:251], a[52:55]
    v_mfma_f32_16x16x32_bf16 a[56:59], a[208:211], v[252:255], a[56:59]
    ds_read_b64_tr_b16 a[232:233], v61 offset:256
    ds_read_b64_tr_b16 a[234:235], v61 offset:2304
    s_waitcnt lgkmcnt(10)
    v_mfma_f32_16x16x32_bf16 a[60:63], a[212:215], v[244:247], a[60:63]
    v_mfma_f32_16x16x32_bf16 a[64:67], a[212:215], v[248:251], a[64:67]
    v_mfma_f32_16x16x32_bf16 a[68:71], a[212:215], v[252:255], a[68:71]
    ds_read_b64_tr_b16 a[236:237], v61 offset:264
    ds_read_b64_tr_b16 a[238:239], v61 offset:2312
    s_waitcnt lgkmcnt(10)
    v_mfma_f32_16x16x32_bf16 a[72:75], a[216:219], v[244:247], a[72:75]
    v_mfma_f32_16x16x32_bf16 a[76:79], a[216:219], v[248:251], a[76:79]
    v_mfma_f32_16x16x32_bf16 a[80:83], a[216:219], v[252:255], a[80:83]
    ds_read_b64_tr_b16 a[192:193], v62 offset:256
    ds_read_b64_tr_b16 a[194:195], v62 offset:2304
    s_waitcnt lgkmcnt(10)
    v_mfma_f32_16x16x32_bf16 a[84:87], a[220:223], v[244:247], a[84:87]
    v_mfma_f32_16x16x32_bf16 a[88:91], a[220:223], v[248:251], a[88:91]
    v_mfma_f32_16x16x32_bf16 a[92:95], a[220:223], v[252:255], a[92:95]
    ds_read_b64_tr_b16 a[196:197], v62 offset:264
    ds_read_b64_tr_b16 a[198:199], v62 offset:2312
    s_waitcnt lgkmcnt(10)
    v_mfma_f32_16x16x32_bf16 a[96:99], a[224:227], v[244:247], a[96:99]
    v_mfma_f32_16x16x32_bf16 a[100:103], a[224:227], v[248:251], a[100:103]
    v_mfma_f32_16x16x32_bf16 a[104:107], a[224:227], v[252:255], a[104:107]
    v_mfma_f32_16x16x32_bf16 a[244:247], a[240:243], v[244:247], a[244:247]
    v_mfma_f32_16x16x32_bf16 a[248:251], a[240:243], v[248:251], a[248:251]
    v_mfma_f32_16x16x32_bf16 a[252:255], a[240:243], v[252:255], a[252:255]
    ds_read_b64_tr_b16 a[200:201], v63 offset:256
    ds_read_b64_tr_b16 a[202:203], v63 offset:2304
    s_waitcnt lgkmcnt(10)
    v_mfma_f32_16x16x32_bf16 a[108:111], a[228:231], v[244:247], a[108:111]
    v_mfma_f32_16x16x32_bf16 a[112:115], a[228:231], v[248:251], a[112:115]
    v_mfma_f32_16x16x32_bf16 a[116:119], a[228:231], v[252:255], a[116:119]
    ds_read_b64_tr_b16 a[204:205], v63 offset:264
    ds_read_b64_tr_b16 a[206:207], v63 offset:2312
    s_waitcnt lgkmcnt(10)
    v_mfma_f32_16x16x32_bf16 a[120:123], a[232:235], v[244:247], a[120:123]
    v_mfma_f32_16x16x32_bf16 a[124:127], a[232:235], v[248:251], a[124:127]
    v_mfma_f32_16x16x32_bf16 a[128:131], a[232:235], v[252:255], a[128:131]
    s_barrier
    v_add_u32 v8, 98304, v12
    ds_read_b64_tr_b16 a[208:209], v8 offset:0
    ds_read_b64_tr_b16 a[210:211], v8 offset:256
    s_waitcnt lgkmcnt(10)
    v_mfma_f32_16x16x32_bf16 a[132:135], a[236:239], v[244:247], a[132:135]
    v_mfma_f32_16x16x32_bf16 a[136:139], a[236:239], v[248:251], a[136:139]
    v_mfma_f32_16x16x32_bf16 a[140:143], a[236:239], v[252:255], a[140:143]
    ds_read_b64_tr_b16 a[212:213], v8 offset:8
    ds_read_b64_tr_b16 a[214:215], v8 offset:264
    s_waitcnt lgkmcnt(10)
    v_mfma_f32_16x16x32_bf16 a[144:147], a[192:195], v[244:247], a[144:147]
    v_mfma_f32_16x16x32_bf16 a[148:151], a[192:195], v[248:251], a[148:151]
    v_mfma_f32_16x16x32_bf16 a[152:155], a[192:195], v[252:255], a[152:155]
    ds_read_b64_tr_b16 a[216:217], v8 offset:2048
    ds_read_b64_tr_b16 a[218:219], v8 offset:2304
    s_waitcnt lgkmcnt(10)
    v_mfma_f32_16x16x32_bf16 a[156:159], a[196:199], v[244:247], a[156:159]
    v_mfma_f32_16x16x32_bf16 a[160:163], a[196:199], v[248:251], a[160:163]
    v_mfma_f32_16x16x32_bf16 a[164:167], a[196:199], v[252:255], a[164:167]
    ds_read_b64_tr_b16 a[220:221], v8 offset:2056
    ds_read_b64_tr_b16 a[222:223], v8 offset:2312
    s_waitcnt lgkmcnt(10)
    v_mfma_f32_16x16x32_bf16 a[168:171], a[200:203], v[244:247], a[168:171]
    v_mfma_f32_16x16x32_bf16 a[172:175], a[200:203], v[248:251], a[172:175]
    v_mfma_f32_16x16x32_bf16 a[176:179], a[200:203], v[252:255], a[176:179]
    ds_read_b64_tr_b16 a[224:225], v8 offset:4096
    ds_read_b64_tr_b16 a[226:227], v8 offset:4352
    s_waitcnt lgkmcnt(10)
    v_mfma_f32_16x16x32_bf16 a[180:183], a[204:207], v[244:247], a[180:183]
    v_mfma_f32_16x16x32_bf16 a[184:187], a[204:207], v[248:251], a[184:187]
    v_mfma_f32_16x16x32_bf16 a[188:191], a[204:207], v[252:255], a[188:191]
    s_nop 7
    s_nop 1
    v_accvgpr_read_b32 v120, a244
    v_accvgpr_read_b32 v121, a248
    v_accvgpr_read_b32 v122, a252
    v_rcp_f32 v120, v120
    v_rcp_f32 v121, v121
    v_rcp_f32 v122, v122
    v_accvgpr_read_b32 v112, a0
    v_accvgpr_read_b32 v113, a1
    v_accvgpr_read_b32 v114, a2
    v_accvgpr_read_b32 v115, a3
    v_accvgpr_read_b32 v116, a12
    v_accvgpr_read_b32 v117, a13
    v_accvgpr_read_b32 v118, a14
    v_accvgpr_read_b32 v119, a15
    v_cvt_pk_bf16_f32 v16, v112, v113
    v_cvt_pk_bf16_f32 v17, v114, v115
    v_cvt_pk_bf16_f32 v18, v116, v117
    v_cvt_pk_bf16_f32 v19, v118, v119
    v_accvgpr_read_b32 v112, a4
    v_accvgpr_read_b32 v113, a5
    v_accvgpr_read_b32 v114, a6
    v_accvgpr_read_b32 v115, a7
    v_accvgpr_read_b32 v116, a16
    v_accvgpr_read_b32 v117, a17
    v_accvgpr_read_b32 v118, a18
    v_accvgpr_read_b32 v119, a19
    v_cvt_pk_bf16_f32 v48, v112, v113
    v_cvt_pk_bf16_f32 v49, v114, v115
    v_cvt_pk_bf16_f32 v50, v116, v117
    v_cvt_pk_bf16_f32 v51, v118, v119
    v_accvgpr_read_b32 v112, a8
    v_accvgpr_read_b32 v113, a9
    v_accvgpr_read_b32 v114, a10
    v_accvgpr_read_b32 v115, a11
    v_accvgpr_read_b32 v116, a20
    v_accvgpr_read_b32 v117, a21
    v_accvgpr_read_b32 v118, a22
    v_accvgpr_read_b32 v119, a23
    v_cvt_pk_bf16_f32 v80, v112, v113
    v_cvt_pk_bf16_f32 v81, v114, v115
    v_cvt_pk_bf16_f32 v82, v116, v117
    v_cvt_pk_bf16_f32 v83, v118, v119
    v_accvgpr_read_b32 v112, a24
    v_accvgpr_read_b32 v113, a25
    v_accvgpr_read_b32 v114, a26
    v_accvgpr_read_b32 v115, a27
    v_accvgpr_read_b32 v116, a36
    v_accvgpr_read_b32 v117, a37
    v_accvgpr_read_b32 v118, a38
    v_accvgpr_read_b32 v119, a39
    v_cvt_pk_bf16_f32 v20, v112, v113
    v_cvt_pk_bf16_f32 v21, v114, v115
    v_cvt_pk_bf16_f32 v22, v116, v117
    v_cvt_pk_bf16_f32 v23, v118, v119
    v_accvgpr_read_b32 v112, a28
    v_accvgpr_read_b32 v113, a29
    v_accvgpr_read_b32 v114, a30
    v_accvgpr_read_b32 v115, a31
    v_accvgpr_read_b32 v116, a40
    v_accvgpr_read_b32 v117, a41
    v_accvgpr_read_b32 v118, a42
    v_accvgpr_read_b32 v119, a43
    v_cvt_pk_bf16_f32 v52, v112, v113
    v_cvt_pk_bf16_f32 v53, v114, v115
    v_cvt_pk_bf16_f32 v54, v116, v117
    v_cvt_pk_bf16_f32 v55, v118, v119
    v_accvgpr_read_b32 v112, a32
    v_accvgpr_read_b32 v113, a33
    v_accvgpr_read_b32 v114, a34
    v_accvgpr_read_b32 v115, a35
    v_accvgpr_read_b32 v116, a44
    v_accvgpr_read_b32 v117, a45
    v_accvgpr_read_b32 v118, a46
    v_accvgpr_read_b32 v119, a47
    v_cvt_pk_bf16_f32 v84, v112, v113
    v_cvt_pk_bf16_f32 v85, v114, v115
    v_cvt_pk_bf16_f32 v86, v116, v117
    v_cvt_pk_bf16_f32 v87, v118, v119
    v_accvgpr_read_b32 v112, a48
    v_accvgpr_read_b32 v113, a49
    v_accvgpr_read_b32 v114, a50
    v_accvgpr_read_b32 v115, a51
    v_accvgpr_read_b32 v116, a60
    v_accvgpr_read_b32 v117, a61
    v_accvgpr_read_b32 v118, a62
    v_accvgpr_read_b32 v119, a63
    v_cvt_pk_bf16_f32 v24, v112, v113
    v_cvt_pk_bf16_f32 v25, v114, v115
    v_cvt_pk_bf16_f32 v26, v116, v117
    v_cvt_pk_bf16_f32 v27, v118, v119
    v_accvgpr_read_b32 v112, a52
    v_accvgpr_read_b32 v113, a53
    v_accvgpr_read_b32 v114, a54
    v_accvgpr_read_b32 v115, a55
    v_accvgpr_read_b32 v116, a64
    v_accvgpr_read_b32 v117, a65
    v_accvgpr_read_b32 v118, a66
    v_accvgpr_read_b32 v119, a67
    v_cvt_pk_bf16_f32 v56, v112, v113
    v_cvt_pk_bf16_f32 v57, v114, v115
    v_cvt_pk_bf16_f32 v58, v116, v117
    v_cvt_pk_bf16_f32 v59, v118, v119
    v_accvgpr_read_b32 v112, a56
    v_accvgpr_read_b32 v113, a57
    v_accvgpr_read_b32 v114, a58
    v_accvgpr_read_b32 v115, a59
    v_accvgpr_read_b32 v116, a68
    v_accvgpr_read_b32 v117, a69
    v_accvgpr_read_b32 v118, a70
    v_accvgpr_read_b32 v119, a71
    v_cvt_pk_bf16_f32 v88, v112, v113
    v_cvt_pk_bf16_f32 v89, v114, v115
    v_cvt_pk_bf16_f32 v90, v116, v117
    v_cvt_pk_bf16_f32 v91, v118, v119
    v_accvgpr_read_b32 v112, a72
    v_accvgpr_read_b32 v113, a73
    v_accvgpr_read_b32 v114, a74
    v_accvgpr_read_b32 v115, a75
    v_accvgpr_read_b32 v116, a84
    v_accvgpr_read_b32 v117, a85
    v_accvgpr_read_b32 v118, a86
    v_accvgpr_read_b32 v119, a87
    v_cvt_pk_bf16_f32 v28, v112, v113
    v_cvt_pk_bf16_f32 v29, v114, v115
    v_cvt_pk_bf16_f32 v30, v116, v117
    v_cvt_pk_bf16_f32 v31, v118, v119
    v_accvgpr_read_b32 v112, a76
    v_accvgpr_read_b32 v113, a77
    v_accvgpr_read_b32 v114, a78
    v_accvgpr_read_b32 v115, a79
    v_accvgpr_read_b32 v116, a88
    v_accvgpr_read_b32 v117, a89
    v_accvgpr_read_b32 v118, a90
    v_accvgpr_read_b32 v119, a91
    v_cvt_pk_bf16_f32 v60, v112, v113
    v_cvt_pk_bf16_f32 v61, v114, v115
    v_cvt_pk_bf16_f32 v62, v116, v117
    v_cvt_pk_bf16_f32 v63, v118, v119
    v_accvgpr_read_b32 v112, a80
    v_accvgpr_read_b32 v113, a81
    v_accvgpr_read_b32 v114, a82
    v_accvgpr_read_b32 v115, a83
    v_accvgpr_read_b32 v116, a92
    v_accvgpr_read_b32 v117, a93
    v_accvgpr_read_b32 v118, a94
    v_accvgpr_read_b32 v119, a95
    v_cvt_pk_bf16_f32 v92, v112, v113
    v_cvt_pk_bf16_f32 v93, v114, v115
    v_cvt_pk_bf16_f32 v94, v116, v117
    v_cvt_pk_bf16_f32 v95, v118, v119
    v_accvgpr_read_b32 v112, a96
    v_accvgpr_read_b32 v113, a97
    v_accvgpr_read_b32 v114, a98
    v_accvgpr_read_b32 v115, a99
    v_accvgpr_read_b32 v116, a108
    v_accvgpr_read_b32 v117, a109
    v_accvgpr_read_b32 v118, a110
    v_accvgpr_read_b32 v119, a111
    v_cvt_pk_bf16_f32 v32, v112, v113
    v_cvt_pk_bf16_f32 v33, v114, v115
    v_cvt_pk_bf16_f32 v34, v116, v117
    v_cvt_pk_bf16_f32 v35, v118, v119
    v_accvgpr_read_b32 v112, a100
    v_accvgpr_read_b32 v113, a101
    v_accvgpr_read_b32 v114, a102
    v_accvgpr_read_b32 v115, a103
    v_accvgpr_read_b32 v116, a112
    v_accvgpr_read_b32 v117, a113
    v_accvgpr_read_b32 v118, a114
    v_accvgpr_read_b32 v119, a115
    v_cvt_pk_bf16_f32 v64, v112, v113
    v_cvt_pk_bf16_f32 v65, v114, v115
    v_cvt_pk_bf16_f32 v66, v116, v117
    v_cvt_pk_bf16_f32 v67, v118, v119
    v_accvgpr_read_b32 v112, a104
    v_accvgpr_read_b32 v113, a105
    v_accvgpr_read_b32 v114, a106
    v_accvgpr_read_b32 v115, a107
    v_accvgpr_read_b32 v116, a116
    v_accvgpr_read_b32 v117, a117
    v_accvgpr_read_b32 v118, a118
    v_accvgpr_read_b32 v119, a119
    v_cvt_pk_bf16_f32 v96, v112, v113
    v_cvt_pk_bf16_f32 v97, v114, v115
    v_cvt_pk_bf16_f32 v98, v116, v117
    v_cvt_pk_bf16_f32 v99, v118, v119
    v_accvgpr_read_b32 v112, a120
    v_accvgpr_read_b32 v113, a121
    v_accvgpr_read_b32 v114, a122
    v_accvgpr_read_b32 v115, a123
    v_accvgpr_read_b32 v116, a132
    v_accvgpr_read_b32 v117, a133
    v_accvgpr_read_b32 v118, a134
    v_accvgpr_read_b32 v119, a135
    v_cvt_pk_bf16_f32 v36, v112, v113
    v_cvt_pk_bf16_f32 v37, v114, v115
    v_cvt_pk_bf16_f32 v38, v116, v117
    v_cvt_pk_bf16_f32 v39, v118, v119
    v_accvgpr_read_b32 v112, a124
    v_accvgpr_read_b32 v113, a125
    v_accvgpr_read_b32 v114, a126
    v_accvgpr_read_b32 v115, a127
    v_accvgpr_read_b32 v116, a136
    v_accvgpr_read_b32 v117, a137
    v_accvgpr_read_b32 v118, a138
    v_accvgpr_read_b32 v119, a139
    v_cvt_pk_bf16_f32 v68, v112, v113
    v_cvt_pk_bf16_f32 v69, v114, v115
    v_cvt_pk_bf16_f32 v70, v116, v117
    v_cvt_pk_bf16_f32 v71, v118, v119
    v_accvgpr_read_b32 v112, a128
    v_accvgpr_read_b32 v113, a129
    v_accvgpr_read_b32 v114, a130
    v_accvgpr_read_b32 v115, a131
    v_accvgpr_read_b32 v116, a140
    v_accvgpr_read_b32 v117, a141
    v_accvgpr_read_b32 v118, a142
    v_accvgpr_read_b32 v119, a143
    v_cvt_pk_bf16_f32 v100, v112, v113
    v_cvt_pk_bf16_f32 v101, v114, v115
    v_cvt_pk_bf16_f32 v102, v116, v117
    v_cvt_pk_bf16_f32 v103, v118, v119
    v_accvgpr_read_b32 v112, a144
    v_accvgpr_read_b32 v113, a145
    v_accvgpr_read_b32 v114, a146
    v_accvgpr_read_b32 v115, a147
    v_accvgpr_read_b32 v116, a156
    v_accvgpr_read_b32 v117, a157
    v_accvgpr_read_b32 v118, a158
    v_accvgpr_read_b32 v119, a159
    v_cvt_pk_bf16_f32 v40, v112, v113
    v_cvt_pk_bf16_f32 v41, v114, v115
    v_cvt_pk_bf16_f32 v42, v116, v117
    v_cvt_pk_bf16_f32 v43, v118, v119
    v_accvgpr_read_b32 v112, a148
    v_accvgpr_read_b32 v113, a149
    v_accvgpr_read_b32 v114, a150
    v_accvgpr_read_b32 v115, a151
    v_accvgpr_read_b32 v116, a160
    v_accvgpr_read_b32 v117, a161
    v_accvgpr_read_b32 v118, a162
    v_accvgpr_read_b32 v119, a163
    v_cvt_pk_bf16_f32 v72, v112, v113
    v_cvt_pk_bf16_f32 v73, v114, v115
    v_cvt_pk_bf16_f32 v74, v116, v117
    v_cvt_pk_bf16_f32 v75, v118, v119
    v_accvgpr_read_b32 v112, a152
    v_accvgpr_read_b32 v113, a153
    v_accvgpr_read_b32 v114, a154
    v_accvgpr_read_b32 v115, a155
    v_accvgpr_read_b32 v116, a164
    v_accvgpr_read_b32 v117, a165
    v_accvgpr_read_b32 v118, a166
    v_accvgpr_read_b32 v119, a167
    v_cvt_pk_bf16_f32 v104, v112, v113
    v_cvt_pk_bf16_f32 v105, v114, v115
    v_cvt_pk_bf16_f32 v106, v116, v117
    v_cvt_pk_bf16_f32 v107, v118, v119
    v_accvgpr_read_b32 v112, a168
    v_accvgpr_read_b32 v113, a169
    v_accvgpr_read_b32 v114, a170
    v_accvgpr_read_b32 v115, a171
    v_accvgpr_read_b32 v116, a180
    v_accvgpr_read_b32 v117, a181
    v_accvgpr_read_b32 v118, a182
    v_accvgpr_read_b32 v119, a183
    v_cvt_pk_bf16_f32 v44, v112, v113
    v_cvt_pk_bf16_f32 v45, v114, v115
    v_cvt_pk_bf16_f32 v46, v116, v117
    v_cvt_pk_bf16_f32 v47, v118, v119
    v_accvgpr_read_b32 v112, a172
    v_accvgpr_read_b32 v113, a173
    v_accvgpr_read_b32 v114, a174
    v_accvgpr_read_b32 v115, a175
    v_accvgpr_read_b32 v116, a184
    v_accvgpr_read_b32 v117, a185
    v_accvgpr_read_b32 v118, a186
    v_accvgpr_read_b32 v119, a187
    v_cvt_pk_bf16_f32 v76, v112, v113
    v_cvt_pk_bf16_f32 v77, v114, v115
    v_cvt_pk_bf16_f32 v78, v116, v117
    v_cvt_pk_bf16_f32 v79, v118, v119
    v_accvgpr_read_b32 v112, a176
    v_accvgpr_read_b32 v113, a177
    v_accvgpr_read_b32 v114, a178
    v_accvgpr_read_b32 v115, a179
    v_accvgpr_read_b32 v116, a188
    v_accvgpr_read_b32 v117, a189
    v_accvgpr_read_b32 v118, a190
    v_accvgpr_read_b32 v119, a191
    v_cvt_pk_bf16_f32 v108, v112, v113
    v_cvt_pk_bf16_f32 v109, v114, v115
    v_cvt_pk_bf16_f32 v110, v116, v117
    v_cvt_pk_bf16_f32 v111, v118, v119
    v_add_u32 v4, s44, v1
    v_mul_u32_u24 v4, 896, v4
    v_lshl_add_u32 v4, v2, 4, v4
    v_add_u32 v5, 14336, v4
    v_add_u32 v6, 14336, v5
    ds_read_b64_tr_b16 a[228:229], v8 offset:4104
    ds_read_b64_tr_b16 a[230:231], v8 offset:4360
    s_waitcnt lgkmcnt(10)
    v_mfma_f32_16x16x32_bf16 v[128:131], a[208:211], v[16:19], 0
    v_mfma_f32_16x16x32_bf16 v[132:135], a[208:211], v[48:51], 0
    v_mfma_f32_16x16x32_bf16 v[136:139], a[208:211], v[80:83], 0
    ds_read_b64_tr_b16 a[232:233], v8 offset:6144
    ds_read_b64_tr_b16 a[234:235], v8 offset:6400
    s_waitcnt lgkmcnt(10)
    v_mfma_f32_16x16x32_bf16 v[140:143], a[212:215], v[16:19], 0
    v_mfma_f32_16x16x32_bf16 v[144:147], a[212:215], v[48:51], 0
    v_mfma_f32_16x16x32_bf16 v[148:151], a[212:215], v[80:83], 0
    ds_read_b64_tr_b16 a[236:237], v8 offset:6152
    ds_read_b64_tr_b16 a[238:239], v8 offset:6408
    s_waitcnt lgkmcnt(10)
    v_mfma_f32_16x16x32_bf16 v[128:131], a[216:219], v[20:23], v[128:131]
    v_mfma_f32_16x16x32_bf16 v[132:135], a[216:219], v[52:55], v[132:135]
    v_mfma_f32_16x16x32_bf16 v[136:139], a[216:219], v[84:87], v[136:139]
    ds_read_b64_tr_b16 a[192:193], v8 offset:8192
    ds_read_b64_tr_b16 a[194:195], v8 offset:8448
    s_waitcnt lgkmcnt(10)
    v_mfma_f32_16x16x32_bf16 v[140:143], a[220:223], v[20:23], v[140:143]
    v_mfma_f32_16x16x32_bf16 v[144:147], a[220:223], v[52:55], v[144:147]
    v_mfma_f32_16x16x32_bf16 v[148:151], a[220:223], v[84:87], v[148:151]
    ds_read_b64_tr_b16 a[196:197], v8 offset:8200
    ds_read_b64_tr_b16 a[198:199], v8 offset:8456
    s_waitcnt lgkmcnt(10)
    v_mfma_f32_16x16x32_bf16 v[128:131], a[224:227], v[24:27], v[128:131]
    v_mfma_f32_16x16x32_bf16 v[132:135], a[224:227], v[56:59], v[132:135]
    v_mfma_f32_16x16x32_bf16 v[136:139], a[224:227], v[88:91], v[136:139]
    ds_read_b64_tr_b16 a[200:201], v8 offset:10240
    ds_read_b64_tr_b16 a[202:203], v8 offset:10496
    s_waitcnt lgkmcnt(10)
    v_mfma_f32_16x16x32_bf16 v[140:143], a[228:231], v[24:27], v[140:143]
    v_mfma_f32_16x16x32_bf16 v[144:147], a[228:231], v[56:59], v[144:147]
    v_mfma_f32_16x16x32_bf16 v[148:151], a[228:231], v[88:91], v[148:151]
    ds_read_b64_tr_b16 a[204:205], v8 offset:10248
    ds_read_b64_tr_b16 a[206:207], v8 offset:10504
    s_waitcnt lgkmcnt(10)
    v_mfma_f32_16x16x32_bf16 v[128:131], a[232:235], v[28:31], v[128:131]
    v_mfma_f32_16x16x32_bf16 v[132:135], a[232:235], v[60:63], v[132:135]
    v_mfma_f32_16x16x32_bf16 v[136:139], a[232:235], v[92:95], v[136:139]
    ds_read_b64_tr_b16 a[208:209], v8 offset:12288
    ds_read_b64_tr_b16 a[210:211], v8 offset:12544
    s_waitcnt lgkmcnt(10)
    v_mfma_f32_16x16x32_bf16 v[140:143], a[236:239], v[28:31], v[140:143]
    v_mfma_f32_16x16x32_bf16 v[144:147], a[236:239], v[60:63], v[144:147]
    v_mfma_f32_16x16x32_bf16 v[148:151], a[236:239], v[92:95], v[148:151]
    ds_read_b64_tr_b16 a[212:213], v8 offset:12296
    ds_read_b64_tr_b16 a[214:215], v8 offset:12552
    s_waitcnt lgkmcnt(10)
    v_mfma_f32_16x16x32_bf16 v[128:131], a[192:195], v[32:35], v[128:131]
    v_mfma_f32_16x16x32_bf16 v[132:135], a[192:195], v[64:67], v[132:135]
    v_mfma_f32_16x16x32_bf16 v[136:139], a[192:195], v[96:99], v[136:139]
    ds_read_b64_tr_b16 a[216:217], v8 offset:14336
    ds_read_b64_tr_b16 a[218:219], v8 offset:14592
    s_waitcnt lgkmcnt(10)
    v_mfma_f32_16x16x32_bf16 v[140:143], a[196:199], v[32:35], v[140:143]
    v_mfma_f32_16x16x32_bf16 v[144:147], a[196:199], v[64:67], v[144:147]
    v_mfma_f32_16x16x32_bf16 v[148:151], a[196:199], v[96:99], v[148:151]
    ds_read_b64_tr_b16 a[220:221], v8 offset:14344
    ds_read_b64_tr_b16 a[222:223], v8 offset:14600
    s_waitcnt lgkmcnt(10)
    v_mfma_f32_16x16x32_bf16 v[128:131], a[200:203], v[36:39], v[128:131]
    v_mfma_f32_16x16x32_bf16 v[132:135], a[200:203], v[68:71], v[132:135]
    v_mfma_f32_16x16x32_bf16 v[136:139], a[200:203], v[100:103], v[136:139]
    s_barrier
    v_add_u32 v8, 114688, v12
    ds_read_b64_tr_b16 a[224:225], v8 offset:0
    ds_read_b64_tr_b16 a[226:227], v8 offset:256
    s_waitcnt lgkmcnt(10)
    v_mfma_f32_16x16x32_bf16 v[140:143], a[204:207], v[36:39], v[140:143]
    v_mfma_f32_16x16x32_bf16 v[144:147], a[204:207], v[68:71], v[144:147]
    v_mfma_f32_16x16x32_bf16 v[148:151], a[204:207], v[100:103], v[148:151]
    ds_read_b64_tr_b16 a[228:229], v8 offset:8
    ds_read_b64_tr_b16 a[230:231], v8 offset:264
    s_waitcnt lgkmcnt(10)
    v_mfma_f32_16x16x32_bf16 v[128:131], a[208:211], v[40:43], v[128:131]
    v_mfma_f32_16x16x32_bf16 v[132:135], a[208:211], v[72:75], v[132:135]
    v_mfma_f32_16x16x32_bf16 v[136:139], a[208:211], v[104:107], v[136:139]
    ds_read_b64_tr_b16 a[232:233], v8 offset:2048
    ds_read_b64_tr_b16 a[234:235], v8 offset:2304
    s_waitcnt lgkmcnt(10)
    v_mfma_f32_16x16x32_bf16 v[140:143], a[212:215], v[40:43], v[140:143]
    v_mfma_f32_16x16x32_bf16 v[144:147], a[212:215], v[72:75], v[144:147]
    v_mfma_f32_16x16x32_bf16 v[148:151], a[212:215], v[104:107], v[148:151]
    ds_read_b64_tr_b16 a[236:237], v8 offset:2056
    ds_read_b64_tr_b16 a[238:239], v8 offset:2312
    s_waitcnt lgkmcnt(10)
    v_mfma_f32_16x16x32_bf16 v[128:131], a[216:219], v[44:47], v[128:131]
    v_mfma_f32_16x16x32_bf16 v[132:135], a[216:219], v[76:79], v[132:135]
    v_mfma_f32_16x16x32_bf16 v[136:139], a[216:219], v[108:111], v[136:139]
    ds_read_b64_tr_b16 a[192:193], v8 offset:4096
    ds_read_b64_tr_b16 a[194:195], v8 offset:4352
    s_waitcnt lgkmcnt(10)
    v_mfma_f32_16x16x32_bf16 v[140:143], a[220:223], v[44:47], v[140:143]
    v_mfma_f32_16x16x32_bf16 v[144:147], a[220:223], v[76:79], v[144:147]
    v_mfma_f32_16x16x32_bf16 v[148:151], a[220:223], v[108:111], v[148:151]
    ds_read_b64_tr_b16 a[196:197], v8 offset:4104
    ds_read_b64_tr_b16 a[198:199], v8 offset:4360
    s_waitcnt lgkmcnt(10)
    v_mfma_f32_16x16x32_bf16 v[152:155], a[224:227], v[16:19], 0
    v_mfma_f32_16x16x32_bf16 v[156:159], a[224:227], v[48:51], 0
    v_mfma_f32_16x16x32_bf16 v[160:163], a[224:227], v[80:83], 0
    ds_read_b64_tr_b16 a[200:201], v8 offset:6144
    ds_read_b64_tr_b16 a[202:203], v8 offset:6400
    s_waitcnt lgkmcnt(10)
    v_mfma_f32_16x16x32_bf16 v[164:167], a[228:231], v[16:19], 0
    v_mfma_f32_16x16x32_bf16 v[168:171], a[228:231], v[48:51], 0
    v_mfma_f32_16x16x32_bf16 v[172:175], a[228:231], v[80:83], 0
    ds_read_b64_tr_b16 a[204:205], v8 offset:6152
    ds_read_b64_tr_b16 a[206:207], v8 offset:6408
    s_waitcnt lgkmcnt(10)
    v_mfma_f32_16x16x32_bf16 v[152:155], a[232:235], v[20:23], v[152:155]
    v_mfma_f32_16x16x32_bf16 v[156:159], a[232:235], v[52:55], v[156:159]
    v_mfma_f32_16x16x32_bf16 v[160:163], a[232:235], v[84:87], v[160:163]
    ds_read_b64_tr_b16 a[208:209], v8 offset:8192
    ds_read_b64_tr_b16 a[210:211], v8 offset:8448
    s_waitcnt lgkmcnt(10)
    v_mfma_f32_16x16x32_bf16 v[164:167], a[236:239], v[20:23], v[164:167]
    v_mul_f32 v128, v128, v120
    v_mfma_f32_16x16x32_bf16 v[168:171], a[236:239], v[52:55], v[168:171]
    v_mul_f32 v129, v129, v120
    v_mfma_f32_16x16x32_bf16 v[172:175], a[236:239], v[84:87], v[172:175]
    v_mul_f32 v130, v130, v120
    ds_read_b64_tr_b16 a[212:213], v8 offset:8200
    ds_read_b64_tr_b16 a[214:215], v8 offset:8456
    s_waitcnt lgkmcnt(10)
    v_mfma_f32_16x16x32_bf16 v[152:155], a[192:195], v[24:27], v[152:155]
    v_mul_f32 v131, v131, v120
    v_mfma_f32_16x16x32_bf16 v[156:159], a[192:195], v[56:59], v[156:159]
    v_mul_f32 v140, v140, v120
    v_mfma_f32_16x16x32_bf16 v[160:163], a[192:195], v[88:91], v[160:163]
    v_mul_f32 v141, v141, v120
    ds_read_b64_tr_b16 a[216:217], v8 offset:10240
    ds_read_b64_tr_b16 a[218:219], v8 offset:10496
    s_waitcnt lgkmcnt(10)
    v_mfma_f32_16x16x32_bf16 v[164:167], a[196:199], v[24:27], v[164:167]
    v_mul_f32 v142, v142, v120
    v_mfma_f32_16x16x32_bf16 v[168:171], a[196:199], v[56:59], v[168:171]
    v_mul_f32 v143, v143, v120
    v_mfma_f32_16x16x32_bf16 v[172:175], a[196:199], v[88:91], v[172:175]
    v_cvt_pk_bf16_f32 v112, v128, v129
    ds_read_b64_tr_b16 a[220:221], v8 offset:10248
    ds_read_b64_tr_b16 a[222:223], v8 offset:10504
    s_waitcnt lgkmcnt(10)
    v_mfma_f32_16x16x32_bf16 v[152:155], a[200:203], v[28:31], v[152:155]
    v_cvt_pk_bf16_f32 v113, v130, v131
    v_mfma_f32_16x16x32_bf16 v[156:159], a[200:203], v[60:63], v[156:159]
    v_cvt_pk_bf16_f32 v114, v140, v141
    v_mfma_f32_16x16x32_bf16 v[160:163], a[200:203], v[92:95], v[160:163]
    v_cvt_pk_bf16_f32 v115, v142, v143
    ds_read_b64_tr_b16 a[224:225], v8 offset:12288
    ds_read_b64_tr_b16 a[226:227], v8 offset:12544
    s_waitcnt lgkmcnt(10)
    v_mfma_f32_16x16x32_bf16 v[164:167], a[204:207], v[28:31], v[164:167]
    buffer_store_dwordx4 v[112:115], v4, s[40:43], 0 offen offset:0
    v_mfma_f32_16x16x32_bf16 v[168:171], a[204:207], v[60:63], v[168:171]
    v_mul_f32 v132, v132, v121
    v_mfma_f32_16x16x32_bf16 v[172:175], a[204:207], v[92:95], v[172:175]
    v_mul_f32 v133, v133, v121
    ds_read_b64_tr_b16 a[228:229], v8 offset:12296
    ds_read_b64_tr_b16 a[230:231], v8 offset:12552
    s_waitcnt lgkmcnt(10)
    v_mfma_f32_16x16x32_bf16 v[152:155], a[208:211], v[32:35], v[152:155]
    v_mul_f32 v134, v134, v121
    v_mfma_f32_16x16x32_bf16 v[156:159], a[208:211], v[64:67], v[156:159]
    v_mul_f32 v135, v135, v121
    v_mfma_f32_16x16x32_bf16 v[160:163], a[208:211], v[96:99], v[160:163]
    v_mul_f32 v144, v144, v121
    ds_read_b64_tr_b16 a[232:233], v8 offset:14336
    ds_read_b64_tr_b16 a[234:235], v8 offset:14592
    s_waitcnt lgkmcnt(10)
    v_mfma_f32_16x16x32_bf16 v[164:167], a[212:215], v[32:35], v[164:167]
    v_mul_f32 v145, v145, v121
    v_mfma_f32_16x16x32_bf16 v[168:171], a[212:215], v[64:67], v[168:171]
    v_mul_f32 v146, v146, v121
    v_mfma_f32_16x16x32_bf16 v[172:175], a[212:215], v[96:99], v[172:175]
    v_mul_f32 v147, v147, v121
    ds_read_b64_tr_b16 a[236:237], v8 offset:14344
    ds_read_b64_tr_b16 a[238:239], v8 offset:14600
    s_waitcnt lgkmcnt(10)
    v_mfma_f32_16x16x32_bf16 v[152:155], a[216:219], v[36:39], v[152:155]
    v_cvt_pk_bf16_f32 v116, v132, v133
    v_mfma_f32_16x16x32_bf16 v[156:159], a[216:219], v[68:71], v[156:159]
    v_cvt_pk_bf16_f32 v117, v134, v135
    v_mfma_f32_16x16x32_bf16 v[160:163], a[216:219], v[100:103], v[160:163]
    v_cvt_pk_bf16_f32 v118, v144, v145
    s_barrier
    v_add_u32 v8, 131072, v12
    ds_read_b64_tr_b16 a[192:193], v8 offset:0
    ds_read_b64_tr_b16 a[194:195], v8 offset:256
    s_waitcnt lgkmcnt(10)
    v_mfma_f32_16x16x32_bf16 v[164:167], a[220:223], v[36:39], v[164:167]
    v_cvt_pk_bf16_f32 v119, v146, v147
    v_mfma_f32_16x16x32_bf16 v[168:171], a[220:223], v[68:71], v[168:171]
    buffer_store_dwordx4 v[116:119], v5, s[40:43], 0 offen offset:0
    v_mfma_f32_16x16x32_bf16 v[172:175], a[220:223], v[100:103], v[172:175]
    v_mul_f32 v136, v136, v122
    ds_read_b64_tr_b16 a[196:197], v8 offset:8
    ds_read_b64_tr_b16 a[198:199], v8 offset:264
    s_waitcnt lgkmcnt(10)
    v_mfma_f32_16x16x32_bf16 v[152:155], a[224:227], v[40:43], v[152:155]
    v_mul_f32 v137, v137, v122
    v_mfma_f32_16x16x32_bf16 v[156:159], a[224:227], v[72:75], v[156:159]
    v_mul_f32 v138, v138, v122
    v_mfma_f32_16x16x32_bf16 v[160:163], a[224:227], v[104:107], v[160:163]
    v_mul_f32 v139, v139, v122
    ds_read_b64_tr_b16 a[200:201], v8 offset:2048
    ds_read_b64_tr_b16 a[202:203], v8 offset:2304
    s_waitcnt lgkmcnt(10)
    v_mfma_f32_16x16x32_bf16 v[164:167], a[228:231], v[40:43], v[164:167]
    v_mul_f32 v148, v148, v122
    v_mfma_f32_16x16x32_bf16 v[168:171], a[228:231], v[72:75], v[168:171]
    v_mul_f32 v149, v149, v122
    v_mfma_f32_16x16x32_bf16 v[172:175], a[228:231], v[104:107], v[172:175]
    v_mul_f32 v150, v150, v122
    ds_read_b64_tr_b16 a[204:205], v8 offset:2056
    ds_read_b64_tr_b16 a[206:207], v8 offset:2312
    s_waitcnt lgkmcnt(10)
    v_mfma_f32_16x16x32_bf16 v[152:155], a[232:235], v[44:47], v[152:155]
    v_mul_f32 v151, v151, v122
    v_mfma_f32_16x16x32_bf16 v[156:159], a[232:235], v[76:79], v[156:159]
    v_cvt_pk_bf16_f32 v112, v136, v137
    v_mfma_f32_16x16x32_bf16 v[160:163], a[232:235], v[108:111], v[160:163]
    v_cvt_pk_bf16_f32 v113, v138, v139
    ds_read_b64_tr_b16 a[208:209], v8 offset:4096
    ds_read_b64_tr_b16 a[210:211], v8 offset:4352
    s_waitcnt lgkmcnt(10)
    v_mfma_f32_16x16x32_bf16 v[164:167], a[236:239], v[44:47], v[164:167]
    v_cvt_pk_bf16_f32 v114, v148, v149
    v_mfma_f32_16x16x32_bf16 v[168:171], a[236:239], v[76:79], v[168:171]
    v_cvt_pk_bf16_f32 v115, v150, v151
    v_mfma_f32_16x16x32_bf16 v[172:175], a[236:239], v[108:111], v[172:175]
    buffer_store_dwordx4 v[112:115], v6, s[40:43], 0 offen offset:0
    ds_read_b64_tr_b16 a[212:213], v8 offset:4104
    ds_read_b64_tr_b16 a[214:215], v8 offset:4360
    s_waitcnt lgkmcnt(10)
    v_mfma_f32_16x16x32_bf16 v[128:131], a[192:195], v[16:19], 0
    v_mfma_f32_16x16x32_bf16 v[132:135], a[192:195], v[48:51], 0
    v_mfma_f32_16x16x32_bf16 v[136:139], a[192:195], v[80:83], 0
    ds_read_b64_tr_b16 a[216:217], v8 offset:6144
    ds_read_b64_tr_b16 a[218:219], v8 offset:6400
    s_waitcnt lgkmcnt(10)
    v_mfma_f32_16x16x32_bf16 v[140:143], a[196:199], v[16:19], 0
    v_mfma_f32_16x16x32_bf16 v[144:147], a[196:199], v[48:51], 0
    v_mfma_f32_16x16x32_bf16 v[148:151], a[196:199], v[80:83], 0
    ds_read_b64_tr_b16 a[220:221], v8 offset:6152
    ds_read_b64_tr_b16 a[222:223], v8 offset:6408
    s_waitcnt lgkmcnt(10)
    v_mfma_f32_16x16x32_bf16 v[128:131], a[200:203], v[20:23], v[128:131]
    v_mfma_f32_16x16x32_bf16 v[132:135], a[200:203], v[52:55], v[132:135]
    v_mfma_f32_16x16x32_bf16 v[136:139], a[200:203], v[84:87], v[136:139]
    ds_read_b64_tr_b16 a[224:225], v8 offset:8192
    ds_read_b64_tr_b16 a[226:227], v8 offset:8448
    s_waitcnt lgkmcnt(10)
    v_mfma_f32_16x16x32_bf16 v[140:143], a[204:207], v[20:23], v[140:143]
    v_mul_f32 v152, v152, v120
    v_mfma_f32_16x16x32_bf16 v[144:147], a[204:207], v[52:55], v[144:147]
    v_mul_f32 v153, v153, v120
    v_mfma_f32_16x16x32_bf16 v[148:151], a[204:207], v[84:87], v[148:151]
    v_mul_f32 v154, v154, v120
    ds_read_b64_tr_b16 a[228:229], v8 offset:8200
    ds_read_b64_tr_b16 a[230:231], v8 offset:8456
    s_waitcnt lgkmcnt(10)
    v_mfma_f32_16x16x32_bf16 v[128:131], a[208:211], v[24:27], v[128:131]
    v_mul_f32 v155, v155, v120
    v_mfma_f32_16x16x32_bf16 v[132:135], a[208:211], v[56:59], v[132:135]
    v_mul_f32 v164, v164, v120
    v_mfma_f32_16x16x32_bf16 v[136:139], a[208:211], v[88:91], v[136:139]
    v_mul_f32 v165, v165, v120
    ds_read_b64_tr_b16 a[232:233], v8 offset:10240
    ds_read_b64_tr_b16 a[234:235], v8 offset:10496
    s_waitcnt lgkmcnt(10)
    v_mfma_f32_16x16x32_bf16 v[140:143], a[212:215], v[24:27], v[140:143]
    v_mul_f32 v166, v166, v120
    v_mfma_f32_16x16x32_bf16 v[144:147], a[212:215], v[56:59], v[144:147]
    v_mul_f32 v167, v167, v120
    v_mfma_f32_16x16x32_bf16 v[148:151], a[212:215], v[88:91], v[148:151]
    v_cvt_pk_bf16_f32 v112, v152, v153
    ds_read_b64_tr_b16 a[236:237], v8 offset:10248
    ds_read_b64_tr_b16 a[238:239], v8 offset:10504
    s_waitcnt lgkmcnt(10)
    v_mfma_f32_16x16x32_bf16 v[128:131], a[216:219], v[28:31], v[128:131]
    v_cvt_pk_bf16_f32 v113, v154, v155
    v_mfma_f32_16x16x32_bf16 v[132:135], a[216:219], v[60:63], v[132:135]
    v_cvt_pk_bf16_f32 v114, v164, v165
    v_mfma_f32_16x16x32_bf16 v[136:139], a[216:219], v[92:95], v[136:139]
    v_cvt_pk_bf16_f32 v115, v166, v167
    ds_read_b64_tr_b16 a[192:193], v8 offset:12288
    ds_read_b64_tr_b16 a[194:195], v8 offset:12544
    s_waitcnt lgkmcnt(10)
    v_mfma_f32_16x16x32_bf16 v[140:143], a[220:223], v[28:31], v[140:143]
    buffer_store_dwordx4 v[112:115], v4, s[40:43], 0 offen offset:64
    v_mfma_f32_16x16x32_bf16 v[144:147], a[220:223], v[60:63], v[144:147]
    v_mul_f32 v156, v156, v121
    v_mfma_f32_16x16x32_bf16 v[148:151], a[220:223], v[92:95], v[148:151]
    v_mul_f32 v157, v157, v121
    ds_read_b64_tr_b16 a[196:197], v8 offset:12296
    ds_read_b64_tr_b16 a[198:199], v8 offset:12552
    s_waitcnt lgkmcnt(10)
    v_mfma_f32_16x16x32_bf16 v[128:131], a[224:227], v[32:35], v[128:131]
    v_mul_f32 v158, v158, v121
    v_mfma_f32_16x16x32_bf16 v[132:135], a[224:227], v[64:67], v[132:135]
    v_mul_f32 v159, v159, v121
    v_mfma_f32_16x16x32_bf16 v[136:139], a[224:227], v[96:99], v[136:139]
    v_mul_f32 v168, v168, v121
    ds_read_b64_tr_b16 a[200:201], v8 offset:14336
    ds_read_b64_tr_b16 a[202:203], v8 offset:14592
    s_waitcnt lgkmcnt(10)
    v_mfma_f32_16x16x32_bf16 v[140:143], a[228:231], v[32:35], v[140:143]
    v_mul_f32 v169, v169, v121
    v_mfma_f32_16x16x32_bf16 v[144:147], a[228:231], v[64:67], v[144:147]
    v_mul_f32 v170, v170, v121
    v_mfma_f32_16x16x32_bf16 v[148:151], a[228:231], v[96:99], v[148:151]
    v_mul_f32 v171, v171, v121
    ds_read_b64_tr_b16 a[204:205], v8 offset:14344
    ds_read_b64_tr_b16 a[206:207], v8 offset:14600
    s_waitcnt lgkmcnt(10)
    v_mfma_f32_16x16x32_bf16 v[128:131], a[232:235], v[36:39], v[128:131]
    v_cvt_pk_bf16_f32 v116, v156, v157
    v_mfma_f32_16x16x32_bf16 v[132:135], a[232:235], v[68:71], v[132:135]
    v_cvt_pk_bf16_f32 v117, v158, v159
    v_mfma_f32_16x16x32_bf16 v[136:139], a[232:235], v[100:103], v[136:139]
    v_cvt_pk_bf16_f32 v118, v168, v169
    s_barrier
    v_add_u32 v8, 147456, v12
    ds_read_b64_tr_b16 a[208:209], v8 offset:0
    ds_read_b64_tr_b16 a[210:211], v8 offset:256
    s_waitcnt lgkmcnt(10)
    v_mfma_f32_16x16x32_bf16 v[140:143], a[236:239], v[36:39], v[140:143]
    v_cvt_pk_bf16_f32 v119, v170, v171
    v_mfma_f32_16x16x32_bf16 v[144:147], a[236:239], v[68:71], v[144:147]
    buffer_store_dwordx4 v[116:119], v5, s[40:43], 0 offen offset:64
    v_mfma_f32_16x16x32_bf16 v[148:151], a[236:239], v[100:103], v[148:151]
    v_mul_f32 v160, v160, v122
    ds_read_b64_tr_b16 a[212:213], v8 offset:8
    ds_read_b64_tr_b16 a[214:215], v8 offset:264
    s_waitcnt lgkmcnt(10)
    v_mfma_f32_16x16x32_bf16 v[128:131], a[192:195], v[40:43], v[128:131]
    v_mul_f32 v161, v161, v122
    v_mfma_f32_16x16x32_bf16 v[132:135], a[192:195], v[72:75], v[132:135]
    v_mul_f32 v162, v162, v122
    v_mfma_f32_16x16x32_bf16 v[136:139], a[192:195], v[104:107], v[136:139]
    v_mul_f32 v163, v163, v122
    ds_read_b64_tr_b16 a[216:217], v8 offset:2048
    ds_read_b64_tr_b16 a[218:219], v8 offset:2304
    s_waitcnt lgkmcnt(10)
    v_mfma_f32_16x16x32_bf16 v[140:143], a[196:199], v[40:43], v[140:143]
    v_mul_f32 v172, v172, v122
    v_mfma_f32_16x16x32_bf16 v[144:147], a[196:199], v[72:75], v[144:147]
    v_mul_f32 v173, v173, v122
    v_mfma_f32_16x16x32_bf16 v[148:151], a[196:199], v[104:107], v[148:151]
    v_mul_f32 v174, v174, v122
    ds_read_b64_tr_b16 a[220:221], v8 offset:2056
    ds_read_b64_tr_b16 a[222:223], v8 offset:2312
    s_waitcnt lgkmcnt(10)
    v_mfma_f32_16x16x32_bf16 v[128:131], a[200:203], v[44:47], v[128:131]
    v_mul_f32 v175, v175, v122
    v_mfma_f32_16x16x32_bf16 v[132:135], a[200:203], v[76:79], v[132:135]
    v_cvt_pk_bf16_f32 v112, v160, v161
    v_mfma_f32_16x16x32_bf16 v[136:139], a[200:203], v[108:111], v[136:139]
    v_cvt_pk_bf16_f32 v113, v162, v163
    ds_read_b64_tr_b16 a[224:225], v8 offset:4096
    ds_read_b64_tr_b16 a[226:227], v8 offset:4352
    s_waitcnt lgkmcnt(10)
    v_mfma_f32_16x16x32_bf16 v[140:143], a[204:207], v[44:47], v[140:143]
    v_cvt_pk_bf16_f32 v114, v172, v173
    v_mfma_f32_16x16x32_bf16 v[144:147], a[204:207], v[76:79], v[144:147]
    v_cvt_pk_bf16_f32 v115, v174, v175
    v_mfma_f32_16x16x32_bf16 v[148:151], a[204:207], v[108:111], v[148:151]
    buffer_store_dwordx4 v[112:115], v6, s[40:43], 0 offen offset:64
    ds_read_b64_tr_b16 a[228:229], v8 offset:4104
    ds_read_b64_tr_b16 a[230:231], v8 offset:4360
    s_waitcnt lgkmcnt(10)
    v_mfma_f32_16x16x32_bf16 v[152:155], a[208:211], v[16:19], 0
    v_mfma_f32_16x16x32_bf16 v[156:159], a[208:211], v[48:51], 0
    v_mfma_f32_16x16x32_bf16 v[160:163], a[208:211], v[80:83], 0
    ds_read_b64_tr_b16 a[232:233], v8 offset:6144
    ds_read_b64_tr_b16 a[234:235], v8 offset:6400
    s_waitcnt lgkmcnt(10)
    v_mfma_f32_16x16x32_bf16 v[164:167], a[212:215], v[16:19], 0
    v_mfma_f32_16x16x32_bf16 v[168:171], a[212:215], v[48:51], 0
    v_mfma_f32_16x16x32_bf16 v[172:175], a[212:215], v[80:83], 0
    ds_read_b64_tr_b16 a[236:237], v8 offset:6152
    ds_read_b64_tr_b16 a[238:239], v8 offset:6408
    s_waitcnt lgkmcnt(10)
    v_mfma_f32_16x16x32_bf16 v[152:155], a[216:219], v[20:23], v[152:155]
    v_mfma_f32_16x16x32_bf16 v[156:159], a[216:219], v[52:55], v[156:159]
    v_mfma_f32_16x16x32_bf16 v[160:163], a[216:219], v[84:87], v[160:163]
    ds_read_b64_tr_b16 a[192:193], v8 offset:8192
    ds_read_b64_tr_b16 a[194:195], v8 offset:8448
    s_waitcnt lgkmcnt(10)
    v_mfma_f32_16x16x32_bf16 v[164:167], a[220:223], v[20:23], v[164:167]
    v_mul_f32 v128, v128, v120
    v_mfma_f32_16x16x32_bf16 v[168:171], a[220:223], v[52:55], v[168:171]
    v_mul_f32 v129, v129, v120
    v_mfma_f32_16x16x32_bf16 v[172:175], a[220:223], v[84:87], v[172:175]
    v_mul_f32 v130, v130, v120
    ds_read_b64_tr_b16 a[196:197], v8 offset:8200
    ds_read_b64_tr_b16 a[198:199], v8 offset:8456
    s_waitcnt lgkmcnt(10)
    v_mfma_f32_16x16x32_bf16 v[152:155], a[224:227], v[24:27], v[152:155]
    v_mul_f32 v131, v131, v120
    v_mfma_f32_16x16x32_bf16 v[156:159], a[224:227], v[56:59], v[156:159]
    v_mul_f32 v140, v140, v120
    v_mfma_f32_16x16x32_bf16 v[160:163], a[224:227], v[88:91], v[160:163]
    v_mul_f32 v141, v141, v120
    ds_read_b64_tr_b16 a[200:201], v8 offset:10240
    ds_read_b64_tr_b16 a[202:203], v8 offset:10496
    s_waitcnt lgkmcnt(10)
    v_mfma_f32_16x16x32_bf16 v[164:167], a[228:231], v[24:27], v[164:167]
    v_mul_f32 v142, v142, v120
    v_mfma_f32_16x16x32_bf16 v[168:171], a[228:231], v[56:59], v[168:171]
    v_mul_f32 v143, v143, v120
    v_mfma_f32_16x16x32_bf16 v[172:175], a[228:231], v[88:91], v[172:175]
    v_cvt_pk_bf16_f32 v112, v128, v129
    ds_read_b64_tr_b16 a[204:205], v8 offset:10248
    ds_read_b64_tr_b16 a[206:207], v8 offset:10504
    s_waitcnt lgkmcnt(10)
    v_mfma_f32_16x16x32_bf16 v[152:155], a[232:235], v[28:31], v[152:155]
    v_cvt_pk_bf16_f32 v113, v130, v131
    v_mfma_f32_16x16x32_bf16 v[156:159], a[232:235], v[60:63], v[156:159]
    v_cvt_pk_bf16_f32 v114, v140, v141
    v_mfma_f32_16x16x32_bf16 v[160:163], a[232:235], v[92:95], v[160:163]
    v_cvt_pk_bf16_f32 v115, v142, v143
    ds_read_b64_tr_b16 a[208:209], v8 offset:12288
    ds_read_b64_tr_b16 a[210:211], v8 offset:12544
    s_waitcnt lgkmcnt(10)
    v_mfma_f32_16x16x32_bf16 v[164:167], a[236:239], v[28:31], v[164:167]
    buffer_store_dwordx4 v[112:115], v4, s[40:43], 0 offen offset:128
    v_mfma_f32_16x16x32_bf16 v[168:171], a[236:239], v[60:63], v[168:171]
    v_mul_f32 v132, v132, v121
    v_mfma_f32_16x16x32_bf16 v[172:175], a[236:239], v[92:95], v[172:175]
    v_mul_f32 v133, v133, v121
    ds_read_b64_tr_b16 a[212:213], v8 offset:12296
    ds_read_b64_tr_b16 a[214:215], v8 offset:12552
    s_waitcnt lgkmcnt(10)
    v_mfma_f32_16x16x32_bf16 v[152:155], a[192:195], v[32:35], v[152:155]
    v_mul_f32 v134, v134, v121
    v_mfma_f32_16x16x32_bf16 v[156:159], a[192:195], v[64:67], v[156:159]
    v_mul_f32 v135, v135, v121
    v_mfma_f32_16x16x32_bf16 v[160:163], a[192:195], v[96:99], v[160:163]
    v_mul_f32 v144, v144, v121
    ds_read_b64_tr_b16 a[216:217], v8 offset:14336
    ds_read_b64_tr_b16 a[218:219], v8 offset:14592
    s_waitcnt lgkmcnt(10)
    v_mfma_f32_16x16x32_bf16 v[164:167], a[196:199], v[32:35], v[164:167]
    v_mul_f32 v145, v145, v121
    v_mfma_f32_16x16x32_bf16 v[168:171], a[196:199], v[64:67], v[168:171]
    v_mul_f32 v146, v146, v121
    v_mfma_f32_16x16x32_bf16 v[172:175], a[196:199], v[96:99], v[172:175]
    v_mul_f32 v147, v147, v121
    ds_read_b64_tr_b16 a[220:221], v8 offset:14344
    ds_read_b64_tr_b16 a[222:223], v8 offset:14600
    s_waitcnt lgkmcnt(10)
    v_mfma_f32_16x16x32_bf16 v[152:155], a[200:203], v[36:39], v[152:155]
    v_cvt_pk_bf16_f32 v116, v132, v133
    v_mfma_f32_16x16x32_bf16 v[156:159], a[200:203], v[68:71], v[156:159]
    v_cvt_pk_bf16_f32 v117, v134, v135
    v_mfma_f32_16x16x32_bf16 v[160:163], a[200:203], v[100:103], v[160:163]
    v_cvt_pk_bf16_f32 v118, v144, v145
    s_barrier
    v_add_u32 v8, 32768, v12
    ds_read_b64_tr_b16 a[224:225], v8 offset:0
    ds_read_b64_tr_b16 a[226:227], v8 offset:256
    s_waitcnt lgkmcnt(10)
    v_mfma_f32_16x16x32_bf16 v[164:167], a[204:207], v[36:39], v[164:167]
    v_cvt_pk_bf16_f32 v119, v146, v147
    v_mfma_f32_16x16x32_bf16 v[168:171], a[204:207], v[68:71], v[168:171]
    buffer_store_dwordx4 v[116:119], v5, s[40:43], 0 offen offset:128
    v_mfma_f32_16x16x32_bf16 v[172:175], a[204:207], v[100:103], v[172:175]
    v_mul_f32 v136, v136, v122
    ds_read_b64_tr_b16 a[228:229], v8 offset:8
    ds_read_b64_tr_b16 a[230:231], v8 offset:264
    s_waitcnt lgkmcnt(10)
    v_mfma_f32_16x16x32_bf16 v[152:155], a[208:211], v[40:43], v[152:155]
    v_mul_f32 v137, v137, v122
    v_mfma_f32_16x16x32_bf16 v[156:159], a[208:211], v[72:75], v[156:159]
    v_mul_f32 v138, v138, v122
    v_mfma_f32_16x16x32_bf16 v[160:163], a[208:211], v[104:107], v[160:163]
    v_mul_f32 v139, v139, v122
    ds_read_b64_tr_b16 a[232:233], v8 offset:2048
    ds_read_b64_tr_b16 a[234:235], v8 offset:2304
    s_waitcnt lgkmcnt(10)
    v_mfma_f32_16x16x32_bf16 v[164:167], a[212:215], v[40:43], v[164:167]
    v_mul_f32 v148, v148, v122
    v_mfma_f32_16x16x32_bf16 v[168:171], a[212:215], v[72:75], v[168:171]
    v_mul_f32 v149, v149, v122
    v_mfma_f32_16x16x32_bf16 v[172:175], a[212:215], v[104:107], v[172:175]
    v_mul_f32 v150, v150, v122
    ds_read_b64_tr_b16 a[236:237], v8 offset:2056
    ds_read_b64_tr_b16 a[238:239], v8 offset:2312
    s_waitcnt lgkmcnt(10)
    v_mfma_f32_16x16x32_bf16 v[152:155], a[216:219], v[44:47], v[152:155]
    v_mul_f32 v151, v151, v122
    v_mfma_f32_16x16x32_bf16 v[156:159], a[216:219], v[76:79], v[156:159]
    v_cvt_pk_bf16_f32 v112, v136, v137
    v_mfma_f32_16x16x32_bf16 v[160:163], a[216:219], v[108:111], v[160:163]
    v_cvt_pk_bf16_f32 v113, v138, v139
    ds_read_b64_tr_b16 a[192:193], v8 offset:4096
    ds_read_b64_tr_b16 a[194:195], v8 offset:4352
    s_waitcnt lgkmcnt(10)
    v_mfma_f32_16x16x32_bf16 v[164:167], a[220:223], v[44:47], v[164:167]
    v_cvt_pk_bf16_f32 v114, v148, v149
    v_mfma_f32_16x16x32_bf16 v[168:171], a[220:223], v[76:79], v[168:171]
    v_cvt_pk_bf16_f32 v115, v150, v151
    v_mfma_f32_16x16x32_bf16 v[172:175], a[220:223], v[108:111], v[172:175]
    buffer_store_dwordx4 v[112:115], v6, s[40:43], 0 offen offset:128
    ds_read_b64_tr_b16 a[196:197], v8 offset:4104
    ds_read_b64_tr_b16 a[198:199], v8 offset:4360
    s_waitcnt lgkmcnt(10)
    v_mfma_f32_16x16x32_bf16 v[128:131], a[224:227], v[16:19], 0
    v_mfma_f32_16x16x32_bf16 v[132:135], a[224:227], v[48:51], 0
    v_mfma_f32_16x16x32_bf16 v[136:139], a[224:227], v[80:83], 0
    ds_read_b64_tr_b16 a[200:201], v8 offset:6144
    ds_read_b64_tr_b16 a[202:203], v8 offset:6400
    s_waitcnt lgkmcnt(10)
    v_mfma_f32_16x16x32_bf16 v[140:143], a[228:231], v[16:19], 0
    v_mfma_f32_16x16x32_bf16 v[144:147], a[228:231], v[48:51], 0
    v_mfma_f32_16x16x32_bf16 v[148:151], a[228:231], v[80:83], 0
    ds_read_b64_tr_b16 a[204:205], v8 offset:6152
    ds_read_b64_tr_b16 a[206:207], v8 offset:6408
    s_waitcnt lgkmcnt(10)
    v_mfma_f32_16x16x32_bf16 v[128:131], a[232:235], v[20:23], v[128:131]
    v_mfma_f32_16x16x32_bf16 v[132:135], a[232:235], v[52:55], v[132:135]
    v_mfma_f32_16x16x32_bf16 v[136:139], a[232:235], v[84:87], v[136:139]
    ds_read_b64_tr_b16 a[208:209], v8 offset:8192
    ds_read_b64_tr_b16 a[210:211], v8 offset:8448
    s_waitcnt lgkmcnt(10)
    v_mfma_f32_16x16x32_bf16 v[140:143], a[236:239], v[20:23], v[140:143]
    v_mul_f32 v152, v152, v120
    v_mfma_f32_16x16x32_bf16 v[144:147], a[236:239], v[52:55], v[144:147]
    v_mul_f32 v153, v153, v120
    v_mfma_f32_16x16x32_bf16 v[148:151], a[236:239], v[84:87], v[148:151]
    v_mul_f32 v154, v154, v120
    ds_read_b64_tr_b16 a[212:213], v8 offset:8200
    ds_read_b64_tr_b16 a[214:215], v8 offset:8456
    s_waitcnt lgkmcnt(10)
    v_mfma_f32_16x16x32_bf16 v[128:131], a[192:195], v[24:27], v[128:131]
    v_mul_f32 v155, v155, v120
    v_mfma_f32_16x16x32_bf16 v[132:135], a[192:195], v[56:59], v[132:135]
    v_mul_f32 v164, v164, v120
    v_mfma_f32_16x16x32_bf16 v[136:139], a[192:195], v[88:91], v[136:139]
    v_mul_f32 v165, v165, v120
    ds_read_b64_tr_b16 a[216:217], v8 offset:10240
    ds_read_b64_tr_b16 a[218:219], v8 offset:10496
    s_waitcnt lgkmcnt(10)
    v_mfma_f32_16x16x32_bf16 v[140:143], a[196:199], v[24:27], v[140:143]
    v_mul_f32 v166, v166, v120
    v_mfma_f32_16x16x32_bf16 v[144:147], a[196:199], v[56:59], v[144:147]
    v_mul_f32 v167, v167, v120
    v_mfma_f32_16x16x32_bf16 v[148:151], a[196:199], v[88:91], v[148:151]
    v_cvt_pk_bf16_f32 v112, v152, v153
    ds_read_b64_tr_b16 a[220:221], v8 offset:10248
    ds_read_b64_tr_b16 a[222:223], v8 offset:10504
    s_waitcnt lgkmcnt(10)
    v_mfma_f32_16x16x32_bf16 v[128:131], a[200:203], v[28:31], v[128:131]
    v_cvt_pk_bf16_f32 v113, v154, v155
    v_mfma_f32_16x16x32_bf16 v[132:135], a[200:203], v[60:63], v[132:135]
    v_cvt_pk_bf16_f32 v114, v164, v165
    v_mfma_f32_16x16x32_bf16 v[136:139], a[200:203], v[92:95], v[136:139]
    v_cvt_pk_bf16_f32 v115, v166, v167
    ds_read_b64_tr_b16 a[224:225], v8 offset:12288
    ds_read_b64_tr_b16 a[226:227], v8 offset:12544
    s_waitcnt lgkmcnt(10)
    v_mfma_f32_16x16x32_bf16 v[140:143], a[204:207], v[28:31], v[140:143]
    buffer_store_dwordx4 v[112:115], v4, s[40:43], 0 offen offset:192
    v_mfma_f32_16x16x32_bf16 v[144:147], a[204:207], v[60:63], v[144:147]
    v_mul_f32 v156, v156, v121
    v_mfma_f32_16x16x32_bf16 v[148:151], a[204:207], v[92:95], v[148:151]
    v_mul_f32 v157, v157, v121
    ds_read_b64_tr_b16 a[228:229], v8 offset:12296
    ds_read_b64_tr_b16 a[230:231], v8 offset:12552
    s_waitcnt lgkmcnt(10)
    v_mfma_f32_16x16x32_bf16 v[128:131], a[208:211], v[32:35], v[128:131]
    v_mul_f32 v158, v158, v121
    v_mfma_f32_16x16x32_bf16 v[132:135], a[208:211], v[64:67], v[132:135]
    v_mul_f32 v159, v159, v121
    v_mfma_f32_16x16x32_bf16 v[136:139], a[208:211], v[96:99], v[136:139]
    v_mul_f32 v168, v168, v121
    ds_read_b64_tr_b16 a[232:233], v8 offset:14336
    ds_read_b64_tr_b16 a[234:235], v8 offset:14592
    s_waitcnt lgkmcnt(10)
    v_mfma_f32_16x16x32_bf16 v[140:143], a[212:215], v[32:35], v[140:143]
    v_mul_f32 v169, v169, v121
    v_mfma_f32_16x16x32_bf16 v[144:147], a[212:215], v[64:67], v[144:147]
    v_mul_f32 v170, v170, v121
    v_mfma_f32_16x16x32_bf16 v[148:151], a[212:215], v[96:99], v[148:151]
    v_mul_f32 v171, v171, v121
    ds_read_b64_tr_b16 a[236:237], v8 offset:14344
    ds_read_b64_tr_b16 a[238:239], v8 offset:14600
    s_waitcnt lgkmcnt(10)
    v_mfma_f32_16x16x32_bf16 v[128:131], a[216:219], v[36:39], v[128:131]
    v_cvt_pk_bf16_f32 v116, v156, v157
    v_mfma_f32_16x16x32_bf16 v[132:135], a[216:219], v[68:71], v[132:135]
    v_cvt_pk_bf16_f32 v117, v158, v159
    v_mfma_f32_16x16x32_bf16 v[136:139], a[216:219], v[100:103], v[136:139]
    v_cvt_pk_bf16_f32 v118, v168, v169
    s_barrier
    v_add_u32 v8, 49152, v12
    ds_read_b64_tr_b16 a[192:193], v8 offset:0
    ds_read_b64_tr_b16 a[194:195], v8 offset:256
    s_waitcnt lgkmcnt(10)
    v_mfma_f32_16x16x32_bf16 v[140:143], a[220:223], v[36:39], v[140:143]
    v_cvt_pk_bf16_f32 v119, v170, v171
    v_mfma_f32_16x16x32_bf16 v[144:147], a[220:223], v[68:71], v[144:147]
    buffer_store_dwordx4 v[116:119], v5, s[40:43], 0 offen offset:192
    v_mfma_f32_16x16x32_bf16 v[148:151], a[220:223], v[100:103], v[148:151]
    v_mul_f32 v160, v160, v122
    ds_read_b64_tr_b16 a[196:197], v8 offset:8
    ds_read_b64_tr_b16 a[198:199], v8 offset:264
    s_waitcnt lgkmcnt(10)
    v_mfma_f32_16x16x32_bf16 v[128:131], a[224:227], v[40:43], v[128:131]
    v_mul_f32 v161, v161, v122
    v_mfma_f32_16x16x32_bf16 v[132:135], a[224:227], v[72:75], v[132:135]
    v_mul_f32 v162, v162, v122
    v_mfma_f32_16x16x32_bf16 v[136:139], a[224:227], v[104:107], v[136:139]
    v_mul_f32 v163, v163, v122
    ds_read_b64_tr_b16 a[200:201], v8 offset:2048
    ds_read_b64_tr_b16 a[202:203], v8 offset:2304
    s_waitcnt lgkmcnt(10)
    v_mfma_f32_16x16x32_bf16 v[140:143], a[228:231], v[40:43], v[140:143]
    v_mul_f32 v172, v172, v122
    v_mfma_f32_16x16x32_bf16 v[144:147], a[228:231], v[72:75], v[144:147]
    v_mul_f32 v173, v173, v122
    v_mfma_f32_16x16x32_bf16 v[148:151], a[228:231], v[104:107], v[148:151]
    v_mul_f32 v174, v174, v122
    ds_read_b64_tr_b16 a[204:205], v8 offset:2056
    ds_read_b64_tr_b16 a[206:207], v8 offset:2312
    s_waitcnt lgkmcnt(10)
    v_mfma_f32_16x16x32_bf16 v[128:131], a[232:235], v[44:47], v[128:131]
    v_mul_f32 v175, v175, v122
    v_mfma_f32_16x16x32_bf16 v[132:135], a[232:235], v[76:79], v[132:135]
    v_cvt_pk_bf16_f32 v112, v160, v161
    v_mfma_f32_16x16x32_bf16 v[136:139], a[232:235], v[108:111], v[136:139]
    v_cvt_pk_bf16_f32 v113, v162, v163
    ds_read_b64_tr_b16 a[208:209], v8 offset:4096
    ds_read_b64_tr_b16 a[210:211], v8 offset:4352
    s_waitcnt lgkmcnt(10)
    v_mfma_f32_16x16x32_bf16 v[140:143], a[236:239], v[44:47], v[140:143]
    v_cvt_pk_bf16_f32 v114, v172, v173
    v_mfma_f32_16x16x32_bf16 v[144:147], a[236:239], v[76:79], v[144:147]
    v_cvt_pk_bf16_f32 v115, v174, v175
    v_mfma_f32_16x16x32_bf16 v[148:151], a[236:239], v[108:111], v[148:151]
    buffer_store_dwordx4 v[112:115], v6, s[40:43], 0 offen offset:192
    ds_read_b64_tr_b16 a[212:213], v8 offset:4104
    ds_read_b64_tr_b16 a[214:215], v8 offset:4360
    s_waitcnt lgkmcnt(10)
    v_mfma_f32_16x16x32_bf16 v[152:155], a[192:195], v[16:19], 0
    v_mfma_f32_16x16x32_bf16 v[156:159], a[192:195], v[48:51], 0
    v_mfma_f32_16x16x32_bf16 v[160:163], a[192:195], v[80:83], 0
    ds_read_b64_tr_b16 a[216:217], v8 offset:6144
    ds_read_b64_tr_b16 a[218:219], v8 offset:6400
    s_waitcnt lgkmcnt(10)
    v_mfma_f32_16x16x32_bf16 v[164:167], a[196:199], v[16:19], 0
    v_mfma_f32_16x16x32_bf16 v[168:171], a[196:199], v[48:51], 0
    v_mfma_f32_16x16x32_bf16 v[172:175], a[196:199], v[80:83], 0
    ds_read_b64_tr_b16 a[220:221], v8 offset:6152
    ds_read_b64_tr_b16 a[222:223], v8 offset:6408
    s_waitcnt lgkmcnt(10)
    v_mfma_f32_16x16x32_bf16 v[152:155], a[200:203], v[20:23], v[152:155]
    v_mfma_f32_16x16x32_bf16 v[156:159], a[200:203], v[52:55], v[156:159]
    v_mfma_f32_16x16x32_bf16 v[160:163], a[200:203], v[84:87], v[160:163]
    ds_read_b64_tr_b16 a[224:225], v8 offset:8192
    ds_read_b64_tr_b16 a[226:227], v8 offset:8448
    s_waitcnt lgkmcnt(10)
    v_mfma_f32_16x16x32_bf16 v[164:167], a[204:207], v[20:23], v[164:167]
    v_mul_f32 v128, v128, v120
    v_mfma_f32_16x16x32_bf16 v[168:171], a[204:207], v[52:55], v[168:171]
    v_mul_f32 v129, v129, v120
    v_mfma_f32_16x16x32_bf16 v[172:175], a[204:207], v[84:87], v[172:175]
    v_mul_f32 v130, v130, v120
    ds_read_b64_tr_b16 a[228:229], v8 offset:8200
    ds_read_b64_tr_b16 a[230:231], v8 offset:8456
    s_waitcnt lgkmcnt(10)
    v_mfma_f32_16x16x32_bf16 v[152:155], a[208:211], v[24:27], v[152:155]
    v_mul_f32 v131, v131, v120
    v_mfma_f32_16x16x32_bf16 v[156:159], a[208:211], v[56:59], v[156:159]
    v_mul_f32 v140, v140, v120
    v_mfma_f32_16x16x32_bf16 v[160:163], a[208:211], v[88:91], v[160:163]
    v_mul_f32 v141, v141, v120
    ds_read_b64_tr_b16 a[232:233], v8 offset:10240
    ds_read_b64_tr_b16 a[234:235], v8 offset:10496
    s_waitcnt lgkmcnt(10)
    v_mfma_f32_16x16x32_bf16 v[164:167], a[212:215], v[24:27], v[164:167]
    v_mul_f32 v142, v142, v120
    v_mfma_f32_16x16x32_bf16 v[168:171], a[212:215], v[56:59], v[168:171]
    v_mul_f32 v143, v143, v120
    v_mfma_f32_16x16x32_bf16 v[172:175], a[212:215], v[88:91], v[172:175]
    v_cvt_pk_bf16_f32 v112, v128, v129
    ds_read_b64_tr_b16 a[236:237], v8 offset:10248
    ds_read_b64_tr_b16 a[238:239], v8 offset:10504
    s_waitcnt lgkmcnt(10)
    v_mfma_f32_16x16x32_bf16 v[152:155], a[216:219], v[28:31], v[152:155]
    v_cvt_pk_bf16_f32 v113, v130, v131
    v_mfma_f32_16x16x32_bf16 v[156:159], a[216:219], v[60:63], v[156:159]
    v_cvt_pk_bf16_f32 v114, v140, v141
    v_mfma_f32_16x16x32_bf16 v[160:163], a[216:219], v[92:95], v[160:163]
    v_cvt_pk_bf16_f32 v115, v142, v143
    ds_read_b64_tr_b16 a[192:193], v8 offset:12288
    ds_read_b64_tr_b16 a[194:195], v8 offset:12544
    s_waitcnt lgkmcnt(10)
    v_mfma_f32_16x16x32_bf16 v[164:167], a[220:223], v[28:31], v[164:167]
    buffer_store_dwordx4 v[112:115], v4, s[40:43], 0 offen offset:256
    v_mfma_f32_16x16x32_bf16 v[168:171], a[220:223], v[60:63], v[168:171]
    v_mul_f32 v132, v132, v121
    v_mfma_f32_16x16x32_bf16 v[172:175], a[220:223], v[92:95], v[172:175]
    v_mul_f32 v133, v133, v121
    ds_read_b64_tr_b16 a[196:197], v8 offset:12296
    ds_read_b64_tr_b16 a[198:199], v8 offset:12552
    s_waitcnt lgkmcnt(10)
    v_mfma_f32_16x16x32_bf16 v[152:155], a[224:227], v[32:35], v[152:155]
    v_mul_f32 v134, v134, v121
    v_mfma_f32_16x16x32_bf16 v[156:159], a[224:227], v[64:67], v[156:159]
    v_mul_f32 v135, v135, v121
    v_mfma_f32_16x16x32_bf16 v[160:163], a[224:227], v[96:99], v[160:163]
    v_mul_f32 v144, v144, v121
    ds_read_b64_tr_b16 a[200:201], v8 offset:14336
    ds_read_b64_tr_b16 a[202:203], v8 offset:14592
    s_waitcnt lgkmcnt(10)
    v_mfma_f32_16x16x32_bf16 v[164:167], a[228:231], v[32:35], v[164:167]
    v_mul_f32 v145, v145, v121
    v_mfma_f32_16x16x32_bf16 v[168:171], a[228:231], v[64:67], v[168:171]
    v_mul_f32 v146, v146, v121
    v_mfma_f32_16x16x32_bf16 v[172:175], a[228:231], v[96:99], v[172:175]
    v_mul_f32 v147, v147, v121
    ds_read_b64_tr_b16 a[204:205], v8 offset:14344
    ds_read_b64_tr_b16 a[206:207], v8 offset:14600
    s_waitcnt lgkmcnt(10)
    v_mfma_f32_16x16x32_bf16 v[152:155], a[232:235], v[36:39], v[152:155]
    v_cvt_pk_bf16_f32 v116, v132, v133
    v_mfma_f32_16x16x32_bf16 v[156:159], a[232:235], v[68:71], v[156:159]
    v_cvt_pk_bf16_f32 v117, v134, v135
    v_mfma_f32_16x16x32_bf16 v[160:163], a[232:235], v[100:103], v[160:163]
    v_cvt_pk_bf16_f32 v118, v144, v145
    s_barrier
    v_add_u32 v8, 0, v12
    ds_read_b64_tr_b16 a[208:209], v8 offset:0
    ds_read_b64_tr_b16 a[210:211], v8 offset:256
    s_waitcnt lgkmcnt(10)
    v_mfma_f32_16x16x32_bf16 v[164:167], a[236:239], v[36:39], v[164:167]
    v_cvt_pk_bf16_f32 v119, v146, v147
    v_mfma_f32_16x16x32_bf16 v[168:171], a[236:239], v[68:71], v[168:171]
    buffer_store_dwordx4 v[116:119], v5, s[40:43], 0 offen offset:256
    v_mfma_f32_16x16x32_bf16 v[172:175], a[236:239], v[100:103], v[172:175]
    v_mul_f32 v136, v136, v122
    ds_read_b64_tr_b16 a[212:213], v8 offset:8
    ds_read_b64_tr_b16 a[214:215], v8 offset:264
    s_waitcnt lgkmcnt(10)
    v_mfma_f32_16x16x32_bf16 v[152:155], a[192:195], v[40:43], v[152:155]
    v_mul_f32 v137, v137, v122
    v_mfma_f32_16x16x32_bf16 v[156:159], a[192:195], v[72:75], v[156:159]
    v_mul_f32 v138, v138, v122
    v_mfma_f32_16x16x32_bf16 v[160:163], a[192:195], v[104:107], v[160:163]
    v_mul_f32 v139, v139, v122
    ds_read_b64_tr_b16 a[216:217], v8 offset:2048
    ds_read_b64_tr_b16 a[218:219], v8 offset:2304
    s_waitcnt lgkmcnt(10)
    v_mfma_f32_16x16x32_bf16 v[164:167], a[196:199], v[40:43], v[164:167]
    v_mul_f32 v148, v148, v122
    v_mfma_f32_16x16x32_bf16 v[168:171], a[196:199], v[72:75], v[168:171]
    v_mul_f32 v149, v149, v122
    v_mfma_f32_16x16x32_bf16 v[172:175], a[196:199], v[104:107], v[172:175]
    v_mul_f32 v150, v150, v122
    ds_read_b64_tr_b16 a[220:221], v8 offset:2056
    ds_read_b64_tr_b16 a[222:223], v8 offset:2312
    s_waitcnt lgkmcnt(10)
    v_mfma_f32_16x16x32_bf16 v[152:155], a[200:203], v[44:47], v[152:155]
    v_mul_f32 v151, v151, v122
    v_mfma_f32_16x16x32_bf16 v[156:159], a[200:203], v[76:79], v[156:159]
    v_cvt_pk_bf16_f32 v112, v136, v137
    v_mfma_f32_16x16x32_bf16 v[160:163], a[200:203], v[108:111], v[160:163]
    v_cvt_pk_bf16_f32 v113, v138, v139
    ds_read_b64_tr_b16 a[224:225], v8 offset:4096
    ds_read_b64_tr_b16 a[226:227], v8 offset:4352
    s_waitcnt lgkmcnt(10)
    v_mfma_f32_16x16x32_bf16 v[164:167], a[204:207], v[44:47], v[164:167]
    v_cvt_pk_bf16_f32 v114, v148, v149
    v_mfma_f32_16x16x32_bf16 v[168:171], a[204:207], v[76:79], v[168:171]
    v_cvt_pk_bf16_f32 v115, v150, v151
    v_mfma_f32_16x16x32_bf16 v[172:175], a[204:207], v[108:111], v[172:175]
    buffer_store_dwordx4 v[112:115], v6, s[40:43], 0 offen offset:256
    ds_read_b64_tr_b16 a[228:229], v8 offset:4104
    ds_read_b64_tr_b16 a[230:231], v8 offset:4360
    s_waitcnt lgkmcnt(10)
    v_mfma_f32_16x16x32_bf16 v[128:131], a[208:211], v[16:19], 0
    v_mfma_f32_16x16x32_bf16 v[132:135], a[208:211], v[48:51], 0
    v_mfma_f32_16x16x32_bf16 v[136:139], a[208:211], v[80:83], 0
    ds_read_b64_tr_b16 a[232:233], v8 offset:6144
    ds_read_b64_tr_b16 a[234:235], v8 offset:6400
    s_waitcnt lgkmcnt(10)
    v_mfma_f32_16x16x32_bf16 v[140:143], a[212:215], v[16:19], 0
    v_mfma_f32_16x16x32_bf16 v[144:147], a[212:215], v[48:51], 0
    v_mfma_f32_16x16x32_bf16 v[148:151], a[212:215], v[80:83], 0
    ds_read_b64_tr_b16 a[236:237], v8 offset:6152
    ds_read_b64_tr_b16 a[238:239], v8 offset:6408
    s_waitcnt lgkmcnt(10)
    v_mfma_f32_16x16x32_bf16 v[128:131], a[216:219], v[20:23], v[128:131]
    v_mfma_f32_16x16x32_bf16 v[132:135], a[216:219], v[52:55], v[132:135]
    v_mfma_f32_16x16x32_bf16 v[136:139], a[216:219], v[84:87], v[136:139]
    ds_read_b64_tr_b16 a[192:193], v8 offset:8192
    ds_read_b64_tr_b16 a[194:195], v8 offset:8448
    s_waitcnt lgkmcnt(10)
    v_mfma_f32_16x16x32_bf16 v[140:143], a[220:223], v[20:23], v[140:143]
    v_mul_f32 v152, v152, v120
    v_mfma_f32_16x16x32_bf16 v[144:147], a[220:223], v[52:55], v[144:147]
    v_mul_f32 v153, v153, v120
    v_mfma_f32_16x16x32_bf16 v[148:151], a[220:223], v[84:87], v[148:151]
    v_mul_f32 v154, v154, v120
    ds_read_b64_tr_b16 a[196:197], v8 offset:8200
    ds_read_b64_tr_b16 a[198:199], v8 offset:8456
    s_waitcnt lgkmcnt(10)
    v_mfma_f32_16x16x32_bf16 v[128:131], a[224:227], v[24:27], v[128:131]
    v_mul_f32 v155, v155, v120
    v_mfma_f32_16x16x32_bf16 v[132:135], a[224:227], v[56:59], v[132:135]
    v_mul_f32 v164, v164, v120
    v_mfma_f32_16x16x32_bf16 v[136:139], a[224:227], v[88:91], v[136:139]
    v_mul_f32 v165, v165, v120
    ds_read_b64_tr_b16 a[200:201], v8 offset:10240
    ds_read_b64_tr_b16 a[202:203], v8 offset:10496
    s_waitcnt lgkmcnt(10)
    v_mfma_f32_16x16x32_bf16 v[140:143], a[228:231], v[24:27], v[140:143]
    v_mul_f32 v166, v166, v120
    v_mfma_f32_16x16x32_bf16 v[144:147], a[228:231], v[56:59], v[144:147]
    v_mul_f32 v167, v167, v120
    v_mfma_f32_16x16x32_bf16 v[148:151], a[228:231], v[88:91], v[148:151]
    v_cvt_pk_bf16_f32 v112, v152, v153
    ds_read_b64_tr_b16 a[204:205], v8 offset:10248
    ds_read_b64_tr_b16 a[206:207], v8 offset:10504
    s_waitcnt lgkmcnt(10)
    v_mfma_f32_16x16x32_bf16 v[128:131], a[232:235], v[28:31], v[128:131]
    v_cvt_pk_bf16_f32 v113, v154, v155
    v_mfma_f32_16x16x32_bf16 v[132:135], a[232:235], v[60:63], v[132:135]
    v_cvt_pk_bf16_f32 v114, v164, v165
    v_mfma_f32_16x16x32_bf16 v[136:139], a[232:235], v[92:95], v[136:139]
    v_cvt_pk_bf16_f32 v115, v166, v167
    ds_read_b64_tr_b16 a[208:209], v8 offset:12288
    ds_read_b64_tr_b16 a[210:211], v8 offset:12544
    s_waitcnt lgkmcnt(10)
    v_mfma_f32_16x16x32_bf16 v[140:143], a[236:239], v[28:31], v[140:143]
    buffer_store_dwordx4 v[112:115], v4, s[40:43], 0 offen offset:320
    v_mfma_f32_16x16x32_bf16 v[144:147], a[236:239], v[60:63], v[144:147]
    v_mul_f32 v156, v156, v121
    v_mfma_f32_16x16x32_bf16 v[148:151], a[236:239], v[92:95], v[148:151]
    v_mul_f32 v157, v157, v121
    ds_read_b64_tr_b16 a[212:213], v8 offset:12296
    ds_read_b64_tr_b16 a[214:215], v8 offset:12552
    s_waitcnt lgkmcnt(10)
    v_mfma_f32_16x16x32_bf16 v[128:131], a[192:195], v[32:35], v[128:131]
    v_mul_f32 v158, v158, v121
    v_mfma_f32_16x16x32_bf16 v[132:135], a[192:195], v[64:67], v[132:135]
    v_mul_f32 v159, v159, v121
    v_mfma_f32_16x16x32_bf16 v[136:139], a[192:195], v[96:99], v[136:139]
    v_mul_f32 v168, v168, v121
    ds_read_b64_tr_b16 a[216:217], v8 offset:14336
    ds_read_b64_tr_b16 a[218:219], v8 offset:14592
    s_waitcnt lgkmcnt(10)
    v_mfma_f32_16x16x32_bf16 v[140:143], a[196:199], v[32:35], v[140:143]
    v_mul_f32 v169, v169, v121
    v_mfma_f32_16x16x32_bf16 v[144:147], a[196:199], v[64:67], v[144:147]
    v_mul_f32 v170, v170, v121
    v_mfma_f32_16x16x32_bf16 v[148:151], a[196:199], v[96:99], v[148:151]
    v_mul_f32 v171, v171, v121
    ds_read_b64_tr_b16 a[220:221], v8 offset:14344
    ds_read_b64_tr_b16 a[222:223], v8 offset:14600
    s_waitcnt lgkmcnt(10)
    v_mfma_f32_16x16x32_bf16 v[128:131], a[200:203], v[36:39], v[128:131]
    v_cvt_pk_bf16_f32 v116, v156, v157
    v_mfma_f32_16x16x32_bf16 v[132:135], a[200:203], v[68:71], v[132:135]
    v_cvt_pk_bf16_f32 v117, v158, v159
    v_mfma_f32_16x16x32_bf16 v[136:139], a[200:203], v[100:103], v[136:139]
    v_cvt_pk_bf16_f32 v118, v168, v169
    s_barrier
    v_add_u32 v8, 16384, v12
    ds_read_b64_tr_b16 a[224:225], v8 offset:0
    ds_read_b64_tr_b16 a[226:227], v8 offset:256
    s_waitcnt lgkmcnt(10)
    v_mfma_f32_16x16x32_bf16 v[140:143], a[204:207], v[36:39], v[140:143]
    v_cvt_pk_bf16_f32 v119, v170, v171
    v_mfma_f32_16x16x32_bf16 v[144:147], a[204:207], v[68:71], v[144:147]
    buffer_store_dwordx4 v[116:119], v5, s[40:43], 0 offen offset:320
    v_mfma_f32_16x16x32_bf16 v[148:151], a[204:207], v[100:103], v[148:151]
    v_mul_f32 v160, v160, v122
    ds_read_b64_tr_b16 a[228:229], v8 offset:8
    ds_read_b64_tr_b16 a[230:231], v8 offset:264
    s_waitcnt lgkmcnt(10)
    v_mfma_f32_16x16x32_bf16 v[128:131], a[208:211], v[40:43], v[128:131]
    v_mul_f32 v161, v161, v122
    v_mfma_f32_16x16x32_bf16 v[132:135], a[208:211], v[72:75], v[132:135]
    v_mul_f32 v162, v162, v122
    v_mfma_f32_16x16x32_bf16 v[136:139], a[208:211], v[104:107], v[136:139]
    v_mul_f32 v163, v163, v122
    ds_read_b64_tr_b16 a[232:233], v8 offset:2048
    ds_read_b64_tr_b16 a[234:235], v8 offset:2304
    s_waitcnt lgkmcnt(10)
    v_mfma_f32_16x16x32_bf16 v[140:143], a[212:215], v[40:43], v[140:143]
    v_mul_f32 v172, v172, v122
    v_mfma_f32_16x16x32_bf16 v[144:147], a[212:215], v[72:75], v[144:147]
    v_mul_f32 v173, v173, v122
    v_mfma_f32_16x16x32_bf16 v[148:151], a[212:215], v[104:107], v[148:151]
    v_mul_f32 v174, v174, v122
    ds_read_b64_tr_b16 a[236:237], v8 offset:2056
    ds_read_b64_tr_b16 a[238:239], v8 offset:2312
    s_waitcnt lgkmcnt(10)
    v_mfma_f32_16x16x32_bf16 v[128:131], a[216:219], v[44:47], v[128:131]
    v_mul_f32 v175, v175, v122
    v_mfma_f32_16x16x32_bf16 v[132:135], a[216:219], v[76:79], v[132:135]
    v_cvt_pk_bf16_f32 v112, v160, v161
    v_mfma_f32_16x16x32_bf16 v[136:139], a[216:219], v[108:111], v[136:139]
    v_cvt_pk_bf16_f32 v113, v162, v163
    ds_read_b64_tr_b16 a[192:193], v8 offset:4096
    ds_read_b64_tr_b16 a[194:195], v8 offset:4352
    s_waitcnt lgkmcnt(10)
    v_mfma_f32_16x16x32_bf16 v[140:143], a[220:223], v[44:47], v[140:143]
    v_cvt_pk_bf16_f32 v114, v172, v173
    v_mfma_f32_16x16x32_bf16 v[144:147], a[220:223], v[76:79], v[144:147]
    v_cvt_pk_bf16_f32 v115, v174, v175
    v_mfma_f32_16x16x32_bf16 v[148:151], a[220:223], v[108:111], v[148:151]
    buffer_store_dwordx4 v[112:115], v6, s[40:43], 0 offen offset:320
    ds_read_b64_tr_b16 a[196:197], v8 offset:4104
    ds_read_b64_tr_b16 a[198:199], v8 offset:4360
    s_waitcnt lgkmcnt(10)
    v_mfma_f32_16x16x32_bf16 v[152:155], a[224:227], v[16:19], 0
    v_mfma_f32_16x16x32_bf16 v[156:159], a[224:227], v[48:51], 0
    v_mfma_f32_16x16x32_bf16 v[160:163], a[224:227], v[80:83], 0
    ds_read_b64_tr_b16 a[200:201], v8 offset:6144
    ds_read_b64_tr_b16 a[202:203], v8 offset:6400
    s_waitcnt lgkmcnt(10)
    v_mfma_f32_16x16x32_bf16 v[164:167], a[228:231], v[16:19], 0
    v_mfma_f32_16x16x32_bf16 v[168:171], a[228:231], v[48:51], 0
    v_mfma_f32_16x16x32_bf16 v[172:175], a[228:231], v[80:83], 0
    ds_read_b64_tr_b16 a[204:205], v8 offset:6152
    ds_read_b64_tr_b16 a[206:207], v8 offset:6408
    s_waitcnt lgkmcnt(10)
    v_mfma_f32_16x16x32_bf16 v[152:155], a[232:235], v[20:23], v[152:155]
    v_mfma_f32_16x16x32_bf16 v[156:159], a[232:235], v[52:55], v[156:159]
    v_mfma_f32_16x16x32_bf16 v[160:163], a[232:235], v[84:87], v[160:163]
    ds_read_b64_tr_b16 a[208:209], v8 offset:8192
    ds_read_b64_tr_b16 a[210:211], v8 offset:8448
    s_waitcnt lgkmcnt(10)
    v_mfma_f32_16x16x32_bf16 v[164:167], a[236:239], v[20:23], v[164:167]
    v_mul_f32 v128, v128, v120
    v_mfma_f32_16x16x32_bf16 v[168:171], a[236:239], v[52:55], v[168:171]
    v_mul_f32 v129, v129, v120
    v_mfma_f32_16x16x32_bf16 v[172:175], a[236:239], v[84:87], v[172:175]
    v_mul_f32 v130, v130, v120
    ds_read_b64_tr_b16 a[212:213], v8 offset:8200
    ds_read_b64_tr_b16 a[214:215], v8 offset:8456
    s_waitcnt lgkmcnt(10)
    v_mfma_f32_16x16x32_bf16 v[152:155], a[192:195], v[24:27], v[152:155]
    v_mul_f32 v131, v131, v120
    v_mfma_f32_16x16x32_bf16 v[156:159], a[192:195], v[56:59], v[156:159]
    v_mul_f32 v140, v140, v120
    v_mfma_f32_16x16x32_bf16 v[160:163], a[192:195], v[88:91], v[160:163]
    v_mul_f32 v141, v141, v120
    ds_read_b64_tr_b16 a[216:217], v8 offset:10240
    ds_read_b64_tr_b16 a[218:219], v8 offset:10496
    s_waitcnt lgkmcnt(10)
    v_mfma_f32_16x16x32_bf16 v[164:167], a[196:199], v[24:27], v[164:167]
    v_mul_f32 v142, v142, v120
    v_mfma_f32_16x16x32_bf16 v[168:171], a[196:199], v[56:59], v[168:171]
    v_mul_f32 v143, v143, v120
    v_mfma_f32_16x16x32_bf16 v[172:175], a[196:199], v[88:91], v[172:175]
    v_cvt_pk_bf16_f32 v112, v128, v129
    ds_read_b64_tr_b16 a[220:221], v8 offset:10248
    ds_read_b64_tr_b16 a[222:223], v8 offset:10504
    s_waitcnt lgkmcnt(10)
    v_mfma_f32_16x16x32_bf16 v[152:155], a[200:203], v[28:31], v[152:155]
    v_cvt_pk_bf16_f32 v113, v130, v131
    v_mfma_f32_16x16x32_bf16 v[156:159], a[200:203], v[60:63], v[156:159]
    v_cvt_pk_bf16_f32 v114, v140, v141
    v_mfma_f32_16x16x32_bf16 v[160:163], a[200:203], v[92:95], v[160:163]
    v_cvt_pk_bf16_f32 v115, v142, v143
    ds_read_b64_tr_b16 a[224:225], v8 offset:12288
    ds_read_b64_tr_b16 a[226:227], v8 offset:12544
    s_waitcnt lgkmcnt(10)
    v_mfma_f32_16x16x32_bf16 v[164:167], a[204:207], v[28:31], v[164:167]
    buffer_store_dwordx4 v[112:115], v4, s[40:43], 0 offen offset:384
    v_mfma_f32_16x16x32_bf16 v[168:171], a[204:207], v[60:63], v[168:171]
    v_mul_f32 v132, v132, v121
    v_mfma_f32_16x16x32_bf16 v[172:175], a[204:207], v[92:95], v[172:175]
    v_mul_f32 v133, v133, v121
    ds_read_b64_tr_b16 a[228:229], v8 offset:12296
    ds_read_b64_tr_b16 a[230:231], v8 offset:12552
    s_waitcnt lgkmcnt(10)
    v_mfma_f32_16x16x32_bf16 v[152:155], a[208:211], v[32:35], v[152:155]
    v_mul_f32 v134, v134, v121
    v_mfma_f32_16x16x32_bf16 v[156:159], a[208:211], v[64:67], v[156:159]
    v_mul_f32 v135, v135, v121
    v_mfma_f32_16x16x32_bf16 v[160:163], a[208:211], v[96:99], v[160:163]
    v_mul_f32 v144, v144, v121
    ds_read_b64_tr_b16 a[232:233], v8 offset:14336
    ds_read_b64_tr_b16 a[234:235], v8 offset:14592
    s_waitcnt lgkmcnt(10)
    v_mfma_f32_16x16x32_bf16 v[164:167], a[212:215], v[32:35], v[164:167]
    v_mul_f32 v145, v145, v121
    v_mfma_f32_16x16x32_bf16 v[168:171], a[212:215], v[64:67], v[168:171]
    v_mul_f32 v146, v146, v121
    v_mfma_f32_16x16x32_bf16 v[172:175], a[212:215], v[96:99], v[172:175]
    v_mul_f32 v147, v147, v121
    ds_read_b64_tr_b16 a[236:237], v8 offset:14344
    ds_read_b64_tr_b16 a[238:239], v8 offset:14600
    s_waitcnt lgkmcnt(10)
    v_mfma_f32_16x16x32_bf16 v[152:155], a[216:219], v[36:39], v[152:155]
    v_cvt_pk_bf16_f32 v116, v132, v133
    v_mfma_f32_16x16x32_bf16 v[156:159], a[216:219], v[68:71], v[156:159]
    v_cvt_pk_bf16_f32 v117, v134, v135
    v_mfma_f32_16x16x32_bf16 v[160:163], a[216:219], v[100:103], v[160:163]
    v_cvt_pk_bf16_f32 v118, v144, v145
    s_barrier
    v_add_u32 v8, 65536, v12
    ds_read_b64_tr_b16 a[192:193], v8 offset:0
    ds_read_b64_tr_b16 a[194:195], v8 offset:256
    s_waitcnt lgkmcnt(10)
    v_mfma_f32_16x16x32_bf16 v[164:167], a[220:223], v[36:39], v[164:167]
    v_cvt_pk_bf16_f32 v119, v146, v147
    v_mfma_f32_16x16x32_bf16 v[168:171], a[220:223], v[68:71], v[168:171]
    buffer_store_dwordx4 v[116:119], v5, s[40:43], 0 offen offset:384
    v_mfma_f32_16x16x32_bf16 v[172:175], a[220:223], v[100:103], v[172:175]
    v_mul_f32 v136, v136, v122
    ds_read_b64_tr_b16 a[196:197], v8 offset:8
    ds_read_b64_tr_b16 a[198:199], v8 offset:264
    s_waitcnt lgkmcnt(10)
    v_mfma_f32_16x16x32_bf16 v[152:155], a[224:227], v[40:43], v[152:155]
    v_mul_f32 v137, v137, v122
    v_mfma_f32_16x16x32_bf16 v[156:159], a[224:227], v[72:75], v[156:159]
    v_mul_f32 v138, v138, v122
    v_mfma_f32_16x16x32_bf16 v[160:163], a[224:227], v[104:107], v[160:163]
    v_mul_f32 v139, v139, v122
    ds_read_b64_tr_b16 a[200:201], v8 offset:2048
    ds_read_b64_tr_b16 a[202:203], v8 offset:2304
    s_waitcnt lgkmcnt(10)
    v_mfma_f32_16x16x32_bf16 v[164:167], a[228:231], v[40:43], v[164:167]
    v_mul_f32 v148, v148, v122
    v_mfma_f32_16x16x32_bf16 v[168:171], a[228:231], v[72:75], v[168:171]
    v_mul_f32 v149, v149, v122
    v_mfma_f32_16x16x32_bf16 v[172:175], a[228:231], v[104:107], v[172:175]
    v_mul_f32 v150, v150, v122
    ds_read_b64_tr_b16 a[204:205], v8 offset:2056
    ds_read_b64_tr_b16 a[206:207], v8 offset:2312
    s_waitcnt lgkmcnt(10)
    v_mfma_f32_16x16x32_bf16 v[152:155], a[232:235], v[44:47], v[152:155]
    v_mul_f32 v151, v151, v122
    v_mfma_f32_16x16x32_bf16 v[156:159], a[232:235], v[76:79], v[156:159]
    v_cvt_pk_bf16_f32 v112, v136, v137
    v_mfma_f32_16x16x32_bf16 v[160:163], a[232:235], v[108:111], v[160:163]
    v_cvt_pk_bf16_f32 v113, v138, v139
    ds_read_b64_tr_b16 a[208:209], v8 offset:4096
    ds_read_b64_tr_b16 a[210:211], v8 offset:4352
    s_waitcnt lgkmcnt(10)
    v_mfma_f32_16x16x32_bf16 v[164:167], a[236:239], v[44:47], v[164:167]
    v_cvt_pk_bf16_f32 v114, v148, v149
    v_mfma_f32_16x16x32_bf16 v[168:171], a[236:239], v[76:79], v[168:171]
    v_cvt_pk_bf16_f32 v115, v150, v151
    v_mfma_f32_16x16x32_bf16 v[172:175], a[236:239], v[108:111], v[172:175]
    buffer_store_dwordx4 v[112:115], v6, s[40:43], 0 offen offset:384
    ds_read_b64_tr_b16 a[212:213], v8 offset:4104
    ds_read_b64_tr_b16 a[214:215], v8 offset:4360
    s_waitcnt lgkmcnt(10)
    v_mfma_f32_16x16x32_bf16 v[128:131], a[192:195], v[16:19], 0
    v_mfma_f32_16x16x32_bf16 v[132:135], a[192:195], v[48:51], 0
    v_mfma_f32_16x16x32_bf16 v[136:139], a[192:195], v[80:83], 0
    ds_read_b64_tr_b16 a[216:217], v8 offset:6144
    ds_read_b64_tr_b16 a[218:219], v8 offset:6400
    s_waitcnt lgkmcnt(10)
    v_mfma_f32_16x16x32_bf16 v[140:143], a[196:199], v[16:19], 0
    v_mfma_f32_16x16x32_bf16 v[144:147], a[196:199], v[48:51], 0
    v_mfma_f32_16x16x32_bf16 v[148:151], a[196:199], v[80:83], 0
    ds_read_b64_tr_b16 a[220:221], v8 offset:6152
    ds_read_b64_tr_b16 a[222:223], v8 offset:6408
    s_waitcnt lgkmcnt(10)
    v_mfma_f32_16x16x32_bf16 v[128:131], a[200:203], v[20:23], v[128:131]
    v_mfma_f32_16x16x32_bf16 v[132:135], a[200:203], v[52:55], v[132:135]
    v_mfma_f32_16x16x32_bf16 v[136:139], a[200:203], v[84:87], v[136:139]
    ds_read_b64_tr_b16 a[224:225], v8 offset:8192
    ds_read_b64_tr_b16 a[226:227], v8 offset:8448
    s_waitcnt lgkmcnt(10)
    v_mfma_f32_16x16x32_bf16 v[140:143], a[204:207], v[20:23], v[140:143]
    v_mul_f32 v152, v152, v120
    v_mfma_f32_16x16x32_bf16 v[144:147], a[204:207], v[52:55], v[144:147]
    v_mul_f32 v153, v153, v120
    v_mfma_f32_16x16x32_bf16 v[148:151], a[204:207], v[84:87], v[148:151]
    v_mul_f32 v154, v154, v120
    ds_read_b64_tr_b16 a[228:229], v8 offset:8200
    ds_read_b64_tr_b16 a[230:231], v8 offset:8456
    s_waitcnt lgkmcnt(10)
    v_mfma_f32_16x16x32_bf16 v[128:131], a[208:211], v[24:27], v[128:131]
    v_mul_f32 v155, v155, v120
    v_mfma_f32_16x16x32_bf16 v[132:135], a[208:211], v[56:59], v[132:135]
    v_mul_f32 v164, v164, v120
    v_mfma_f32_16x16x32_bf16 v[136:139], a[208:211], v[88:91], v[136:139]
    v_mul_f32 v165, v165, v120
    ds_read_b64_tr_b16 a[232:233], v8 offset:10240
    ds_read_b64_tr_b16 a[234:235], v8 offset:10496
    s_waitcnt lgkmcnt(10)
    v_mfma_f32_16x16x32_bf16 v[140:143], a[212:215], v[24:27], v[140:143]
    v_mul_f32 v166, v166, v120
    v_mfma_f32_16x16x32_bf16 v[144:147], a[212:215], v[56:59], v[144:147]
    v_mul_f32 v167, v167, v120
    v_mfma_f32_16x16x32_bf16 v[148:151], a[212:215], v[88:91], v[148:151]
    v_cvt_pk_bf16_f32 v112, v152, v153
    ds_read_b64_tr_b16 a[236:237], v8 offset:10248
    ds_read_b64_tr_b16 a[238:239], v8 offset:10504
    s_waitcnt lgkmcnt(10)
    v_mfma_f32_16x16x32_bf16 v[128:131], a[216:219], v[28:31], v[128:131]
    v_cvt_pk_bf16_f32 v113, v154, v155
    v_mfma_f32_16x16x32_bf16 v[132:135], a[216:219], v[60:63], v[132:135]
    v_cvt_pk_bf16_f32 v114, v164, v165
    v_mfma_f32_16x16x32_bf16 v[136:139], a[216:219], v[92:95], v[136:139]
    v_cvt_pk_bf16_f32 v115, v166, v167
    ds_read_b64_tr_b16 a[192:193], v8 offset:12288
    ds_read_b64_tr_b16 a[194:195], v8 offset:12544
    s_waitcnt lgkmcnt(10)
    v_mfma_f32_16x16x32_bf16 v[140:143], a[220:223], v[28:31], v[140:143]
    buffer_store_dwordx4 v[112:115], v4, s[40:43], 0 offen offset:448
    v_mfma_f32_16x16x32_bf16 v[144:147], a[220:223], v[60:63], v[144:147]
    v_mul_f32 v156, v156, v121
    v_mfma_f32_16x16x32_bf16 v[148:151], a[220:223], v[92:95], v[148:151]
    v_mul_f32 v157, v157, v121
    ds_read_b64_tr_b16 a[196:197], v8 offset:12296
    ds_read_b64_tr_b16 a[198:199], v8 offset:12552
    s_waitcnt lgkmcnt(10)
    v_mfma_f32_16x16x32_bf16 v[128:131], a[224:227], v[32:35], v[128:131]
    v_mul_f32 v158, v158, v121
    v_mfma_f32_16x16x32_bf16 v[132:135], a[224:227], v[64:67], v[132:135]
    v_mul_f32 v159, v159, v121
    v_mfma_f32_16x16x32_bf16 v[136:139], a[224:227], v[96:99], v[136:139]
    v_mul_f32 v168, v168, v121
    ds_read_b64_tr_b16 a[200:201], v8 offset:14336
    ds_read_b64_tr_b16 a[202:203], v8 offset:14592
    s_waitcnt lgkmcnt(10)
    v_mfma_f32_16x16x32_bf16 v[140:143], a[228:231], v[32:35], v[140:143]
    v_mul_f32 v169, v169, v121
    v_mfma_f32_16x16x32_bf16 v[144:147], a[228:231], v[64:67], v[144:147]
    v_mul_f32 v170, v170, v121
    v_mfma_f32_16x16x32_bf16 v[148:151], a[228:231], v[96:99], v[148:151]
    v_mul_f32 v171, v171, v121
    ds_read_b64_tr_b16 a[204:205], v8 offset:14344
    ds_read_b64_tr_b16 a[206:207], v8 offset:14600
    s_waitcnt lgkmcnt(10)
    v_mfma_f32_16x16x32_bf16 v[128:131], a[232:235], v[36:39], v[128:131]
    v_cvt_pk_bf16_f32 v116, v156, v157
    v_mfma_f32_16x16x32_bf16 v[132:135], a[232:235], v[68:71], v[132:135]
    v_cvt_pk_bf16_f32 v117, v158, v159
    v_mfma_f32_16x16x32_bf16 v[136:139], a[232:235], v[100:103], v[136:139]
    v_cvt_pk_bf16_f32 v118, v168, v169
    s_barrier
    v_add_u32 v8, 81920, v12
    ds_read_b64_tr_b16 a[208:209], v8 offset:0
    ds_read_b64_tr_b16 a[210:211], v8 offset:256
    s_waitcnt lgkmcnt(10)
    v_mfma_f32_16x16x32_bf16 v[140:143], a[236:239], v[36:39], v[140:143]
    v_cvt_pk_bf16_f32 v119, v170, v171
    v_mfma_f32_16x16x32_bf16 v[144:147], a[236:239], v[68:71], v[144:147]
    buffer_store_dwordx4 v[116:119], v5, s[40:43], 0 offen offset:448
    v_mfma_f32_16x16x32_bf16 v[148:151], a[236:239], v[100:103], v[148:151]
    v_mul_f32 v160, v160, v122
    ds_read_b64_tr_b16 a[212:213], v8 offset:8
    ds_read_b64_tr_b16 a[214:215], v8 offset:264
    s_waitcnt lgkmcnt(10)
    v_mfma_f32_16x16x32_bf16 v[128:131], a[192:195], v[40:43], v[128:131]
    v_mul_f32 v161, v161, v122
    v_mfma_f32_16x16x32_bf16 v[132:135], a[192:195], v[72:75], v[132:135]
    v_mul_f32 v162, v162, v122
    v_mfma_f32_16x16x32_bf16 v[136:139], a[192:195], v[104:107], v[136:139]
    v_mul_f32 v163, v163, v122
    ds_read_b64_tr_b16 a[216:217], v8 offset:2048
    ds_read_b64_tr_b16 a[218:219], v8 offset:2304
    s_waitcnt lgkmcnt(10)
    v_mfma_f32_16x16x32_bf16 v[140:143], a[196:199], v[40:43], v[140:143]
    v_mul_f32 v172, v172, v122
    v_mfma_f32_16x16x32_bf16 v[144:147], a[196:199], v[72:75], v[144:147]
    v_mul_f32 v173, v173, v122
    v_mfma_f32_16x16x32_bf16 v[148:151], a[196:199], v[104:107], v[148:151]
    v_mul_f32 v174, v174, v122
    ds_read_b64_tr_b16 a[220:221], v8 offset:2056
    ds_read_b64_tr_b16 a[222:223], v8 offset:2312
    s_waitcnt lgkmcnt(10)
    v_mfma_f32_16x16x32_bf16 v[128:131], a[200:203], v[44:47], v[128:131]
    v_mul_f32 v175, v175, v122
    v_mfma_f32_16x16x32_bf16 v[132:135], a[200:203], v[76:79], v[132:135]
    v_cvt_pk_bf16_f32 v112, v160, v161
    v_mfma_f32_16x16x32_bf16 v[136:139], a[200:203], v[108:111], v[136:139]
    v_cvt_pk_bf16_f32 v113, v162, v163
    ds_read_b64_tr_b16 a[224:225], v8 offset:4096
    ds_read_b64_tr_b16 a[226:227], v8 offset:4352
    s_waitcnt lgkmcnt(10)
    v_mfma_f32_16x16x32_bf16 v[140:143], a[204:207], v[44:47], v[140:143]
    v_cvt_pk_bf16_f32 v114, v172, v173
    v_mfma_f32_16x16x32_bf16 v[144:147], a[204:207], v[76:79], v[144:147]
    v_cvt_pk_bf16_f32 v115, v174, v175
    v_mfma_f32_16x16x32_bf16 v[148:151], a[204:207], v[108:111], v[148:151]
    buffer_store_dwordx4 v[112:115], v6, s[40:43], 0 offen offset:448
    ds_read_b64_tr_b16 a[228:229], v8 offset:4104
    ds_read_b64_tr_b16 a[230:231], v8 offset:4360
    s_waitcnt lgkmcnt(10)
    v_mfma_f32_16x16x32_bf16 v[152:155], a[208:211], v[16:19], 0
    v_mfma_f32_16x16x32_bf16 v[156:159], a[208:211], v[48:51], 0
    v_mfma_f32_16x16x32_bf16 v[160:163], a[208:211], v[80:83], 0
    ds_read_b64_tr_b16 a[232:233], v8 offset:6144
    ds_read_b64_tr_b16 a[234:235], v8 offset:6400
    s_waitcnt lgkmcnt(10)
    v_mfma_f32_16x16x32_bf16 v[164:167], a[212:215], v[16:19], 0
    v_mfma_f32_16x16x32_bf16 v[168:171], a[212:215], v[48:51], 0
    v_mfma_f32_16x16x32_bf16 v[172:175], a[212:215], v[80:83], 0
    ds_read_b64_tr_b16 a[236:237], v8 offset:6152
    ds_read_b64_tr_b16 a[238:239], v8 offset:6408
    s_waitcnt lgkmcnt(10)
    v_mfma_f32_16x16x32_bf16 v[152:155], a[216:219], v[20:23], v[152:155]
    v_mfma_f32_16x16x32_bf16 v[156:159], a[216:219], v[52:55], v[156:159]
    v_mfma_f32_16x16x32_bf16 v[160:163], a[216:219], v[84:87], v[160:163]
    ds_read_b64_tr_b16 a[192:193], v8 offset:8192
    ds_read_b64_tr_b16 a[194:195], v8 offset:8448
    s_waitcnt lgkmcnt(10)
    v_mfma_f32_16x16x32_bf16 v[164:167], a[220:223], v[20:23], v[164:167]
    v_mul_f32 v128, v128, v120
    v_mfma_f32_16x16x32_bf16 v[168:171], a[220:223], v[52:55], v[168:171]
    v_mul_f32 v129, v129, v120
    v_mfma_f32_16x16x32_bf16 v[172:175], a[220:223], v[84:87], v[172:175]
    v_mul_f32 v130, v130, v120
    ds_read_b64_tr_b16 a[196:197], v8 offset:8200
    ds_read_b64_tr_b16 a[198:199], v8 offset:8456
    s_waitcnt lgkmcnt(10)
    v_mfma_f32_16x16x32_bf16 v[152:155], a[224:227], v[24:27], v[152:155]
    v_mul_f32 v131, v131, v120
    v_mfma_f32_16x16x32_bf16 v[156:159], a[224:227], v[56:59], v[156:159]
    v_mul_f32 v140, v140, v120
    v_mfma_f32_16x16x32_bf16 v[160:163], a[224:227], v[88:91], v[160:163]
    v_mul_f32 v141, v141, v120
    ds_read_b64_tr_b16 a[200:201], v8 offset:10240
    ds_read_b64_tr_b16 a[202:203], v8 offset:10496
    s_waitcnt lgkmcnt(10)
    v_mfma_f32_16x16x32_bf16 v[164:167], a[228:231], v[24:27], v[164:167]
    v_mul_f32 v142, v142, v120
    v_mfma_f32_16x16x32_bf16 v[168:171], a[228:231], v[56:59], v[168:171]
    v_mul_f32 v143, v143, v120
    v_mfma_f32_16x16x32_bf16 v[172:175], a[228:231], v[88:91], v[172:175]
    v_cvt_pk_bf16_f32 v112, v128, v129
    ds_read_b64_tr_b16 a[204:205], v8 offset:10248
    ds_read_b64_tr_b16 a[206:207], v8 offset:10504
    s_waitcnt lgkmcnt(10)
    v_mfma_f32_16x16x32_bf16 v[152:155], a[232:235], v[28:31], v[152:155]
    v_cvt_pk_bf16_f32 v113, v130, v131
    v_mfma_f32_16x16x32_bf16 v[156:159], a[232:235], v[60:63], v[156:159]
    v_cvt_pk_bf16_f32 v114, v140, v141
    v_mfma_f32_16x16x32_bf16 v[160:163], a[232:235], v[92:95], v[160:163]
    v_cvt_pk_bf16_f32 v115, v142, v143
    ds_read_b64_tr_b16 a[208:209], v8 offset:12288
    ds_read_b64_tr_b16 a[210:211], v8 offset:12544
    s_waitcnt lgkmcnt(10)
    v_mfma_f32_16x16x32_bf16 v[164:167], a[236:239], v[28:31], v[164:167]
    buffer_store_dwordx4 v[112:115], v4, s[40:43], 0 offen offset:512
    v_mfma_f32_16x16x32_bf16 v[168:171], a[236:239], v[60:63], v[168:171]
    v_mul_f32 v132, v132, v121
    v_mfma_f32_16x16x32_bf16 v[172:175], a[236:239], v[92:95], v[172:175]
    v_mul_f32 v133, v133, v121
    ds_read_b64_tr_b16 a[212:213], v8 offset:12296
    ds_read_b64_tr_b16 a[214:215], v8 offset:12552
    s_waitcnt lgkmcnt(10)
    v_mfma_f32_16x16x32_bf16 v[152:155], a[192:195], v[32:35], v[152:155]
    v_mul_f32 v134, v134, v121
    v_mfma_f32_16x16x32_bf16 v[156:159], a[192:195], v[64:67], v[156:159]
    v_mul_f32 v135, v135, v121
    v_mfma_f32_16x16x32_bf16 v[160:163], a[192:195], v[96:99], v[160:163]
    v_mul_f32 v144, v144, v121
    ds_read_b64_tr_b16 a[216:217], v8 offset:14336
    ds_read_b64_tr_b16 a[218:219], v8 offset:14592
    s_waitcnt lgkmcnt(10)
    v_mfma_f32_16x16x32_bf16 v[164:167], a[196:199], v[32:35], v[164:167]
    v_mul_f32 v145, v145, v121
    v_mfma_f32_16x16x32_bf16 v[168:171], a[196:199], v[64:67], v[168:171]
    v_mul_f32 v146, v146, v121
    v_mfma_f32_16x16x32_bf16 v[172:175], a[196:199], v[96:99], v[172:175]
    v_mul_f32 v147, v147, v121
    ds_read_b64_tr_b16 a[220:221], v8 offset:14344
    ds_read_b64_tr_b16 a[222:223], v8 offset:14600
    s_waitcnt lgkmcnt(10)
    v_mfma_f32_16x16x32_bf16 v[152:155], a[200:203], v[36:39], v[152:155]
    v_cvt_pk_bf16_f32 v116, v132, v133
    v_mfma_f32_16x16x32_bf16 v[156:159], a[200:203], v[68:71], v[156:159]
    v_cvt_pk_bf16_f32 v117, v134, v135
    v_mfma_f32_16x16x32_bf16 v[160:163], a[200:203], v[100:103], v[160:163]
    v_cvt_pk_bf16_f32 v118, v144, v145
    s_barrier
    v_add_u32 v8, 98304, v12
    ds_read_b64_tr_b16 a[224:225], v8 offset:0
    ds_read_b64_tr_b16 a[226:227], v8 offset:256
    s_waitcnt lgkmcnt(10)
    v_mfma_f32_16x16x32_bf16 v[164:167], a[204:207], v[36:39], v[164:167]
    v_cvt_pk_bf16_f32 v119, v146, v147
    v_mfma_f32_16x16x32_bf16 v[168:171], a[204:207], v[68:71], v[168:171]
    buffer_store_dwordx4 v[116:119], v5, s[40:43], 0 offen offset:512
    v_mfma_f32_16x16x32_bf16 v[172:175], a[204:207], v[100:103], v[172:175]
    v_mul_f32 v136, v136, v122
    ds_read_b64_tr_b16 a[228:229], v8 offset:8
    ds_read_b64_tr_b16 a[230:231], v8 offset:264
    s_waitcnt lgkmcnt(10)
    v_mfma_f32_16x16x32_bf16 v[152:155], a[208:211], v[40:43], v[152:155]
    v_mul_f32 v137, v137, v122
    v_mfma_f32_16x16x32_bf16 v[156:159], a[208:211], v[72:75], v[156:159]
    v_mul_f32 v138, v138, v122
    v_mfma_f32_16x16x32_bf16 v[160:163], a[208:211], v[104:107], v[160:163]
    v_mul_f32 v139, v139, v122
    ds_read_b64_tr_b16 a[232:233], v8 offset:2048
    ds_read_b64_tr_b16 a[234:235], v8 offset:2304
    s_waitcnt lgkmcnt(10)
    v_mfma_f32_16x16x32_bf16 v[164:167], a[212:215], v[40:43], v[164:167]
    v_mul_f32 v148, v148, v122
    v_mfma_f32_16x16x32_bf16 v[168:171], a[212:215], v[72:75], v[168:171]
    v_mul_f32 v149, v149, v122
    v_mfma_f32_16x16x32_bf16 v[172:175], a[212:215], v[104:107], v[172:175]
    v_mul_f32 v150, v150, v122
    ds_read_b64_tr_b16 a[236:237], v8 offset:2056
    ds_read_b64_tr_b16 a[238:239], v8 offset:2312
    s_waitcnt lgkmcnt(10)
    v_mfma_f32_16x16x32_bf16 v[152:155], a[216:219], v[44:47], v[152:155]
    v_mul_f32 v151, v151, v122
    v_mfma_f32_16x16x32_bf16 v[156:159], a[216:219], v[76:79], v[156:159]
    v_cvt_pk_bf16_f32 v112, v136, v137
    v_mfma_f32_16x16x32_bf16 v[160:163], a[216:219], v[108:111], v[160:163]
    v_cvt_pk_bf16_f32 v113, v138, v139
    ds_read_b64_tr_b16 a[192:193], v8 offset:4096
    ds_read_b64_tr_b16 a[194:195], v8 offset:4352
    s_waitcnt lgkmcnt(10)
    v_mfma_f32_16x16x32_bf16 v[164:167], a[220:223], v[44:47], v[164:167]
    v_cvt_pk_bf16_f32 v114, v148, v149
    v_mfma_f32_16x16x32_bf16 v[168:171], a[220:223], v[76:79], v[168:171]
    v_cvt_pk_bf16_f32 v115, v150, v151
    v_mfma_f32_16x16x32_bf16 v[172:175], a[220:223], v[108:111], v[172:175]
    buffer_store_dwordx4 v[112:115], v6, s[40:43], 0 offen offset:512
    ds_read_b64_tr_b16 a[196:197], v8 offset:4104
    ds_read_b64_tr_b16 a[198:199], v8 offset:4360
    s_waitcnt lgkmcnt(10)
    v_mfma_f32_16x16x32_bf16 v[128:131], a[224:227], v[16:19], 0
    v_mfma_f32_16x16x32_bf16 v[132:135], a[224:227], v[48:51], 0
    v_mfma_f32_16x16x32_bf16 v[136:139], a[224:227], v[80:83], 0
    ds_read_b64_tr_b16 a[200:201], v8 offset:6144
    ds_read_b64_tr_b16 a[202:203], v8 offset:6400
    s_waitcnt lgkmcnt(10)
    v_mfma_f32_16x16x32_bf16 v[140:143], a[228:231], v[16:19], 0
    v_mfma_f32_16x16x32_bf16 v[144:147], a[228:231], v[48:51], 0
    v_mfma_f32_16x16x32_bf16 v[148:151], a[228:231], v[80:83], 0
    ds_read_b64_tr_b16 a[204:205], v8 offset:6152
    ds_read_b64_tr_b16 a[206:207], v8 offset:6408
    s_waitcnt lgkmcnt(10)
    v_mfma_f32_16x16x32_bf16 v[128:131], a[232:235], v[20:23], v[128:131]
    v_mfma_f32_16x16x32_bf16 v[132:135], a[232:235], v[52:55], v[132:135]
    v_mfma_f32_16x16x32_bf16 v[136:139], a[232:235], v[84:87], v[136:139]
    ds_read_b64_tr_b16 a[208:209], v8 offset:8192
    ds_read_b64_tr_b16 a[210:211], v8 offset:8448
    s_waitcnt lgkmcnt(10)
    v_mfma_f32_16x16x32_bf16 v[140:143], a[236:239], v[20:23], v[140:143]
    v_mul_f32 v152, v152, v120
    v_mfma_f32_16x16x32_bf16 v[144:147], a[236:239], v[52:55], v[144:147]
    v_mul_f32 v153, v153, v120
    v_mfma_f32_16x16x32_bf16 v[148:151], a[236:239], v[84:87], v[148:151]
    v_mul_f32 v154, v154, v120
    ds_read_b64_tr_b16 a[212:213], v8 offset:8200
    ds_read_b64_tr_b16 a[214:215], v8 offset:8456
    s_waitcnt lgkmcnt(10)
    v_mfma_f32_16x16x32_bf16 v[128:131], a[192:195], v[24:27], v[128:131]
    v_mul_f32 v155, v155, v120
    v_mfma_f32_16x16x32_bf16 v[132:135], a[192:195], v[56:59], v[132:135]
    v_mul_f32 v164, v164, v120
    v_mfma_f32_16x16x32_bf16 v[136:139], a[192:195], v[88:91], v[136:139]
    v_mul_f32 v165, v165, v120
    ds_read_b64_tr_b16 a[216:217], v8 offset:10240
    ds_read_b64_tr_b16 a[218:219], v8 offset:10496
    s_waitcnt lgkmcnt(10)
    v_mfma_f32_16x16x32_bf16 v[140:143], a[196:199], v[24:27], v[140:143]
    v_mul_f32 v166, v166, v120
    v_mfma_f32_16x16x32_bf16 v[144:147], a[196:199], v[56:59], v[144:147]
    v_mul_f32 v167, v167, v120
    v_mfma_f32_16x16x32_bf16 v[148:151], a[196:199], v[88:91], v[148:151]
    v_cvt_pk_bf16_f32 v112, v152, v153
    ds_read_b64_tr_b16 a[220:221], v8 offset:10248
    ds_read_b64_tr_b16 a[222:223], v8 offset:10504
    s_waitcnt lgkmcnt(10)
    v_mfma_f32_16x16x32_bf16 v[128:131], a[200:203], v[28:31], v[128:131]
    v_cvt_pk_bf16_f32 v113, v154, v155
    v_mfma_f32_16x16x32_bf16 v[132:135], a[200:203], v[60:63], v[132:135]
    v_cvt_pk_bf16_f32 v114, v164, v165
    v_mfma_f32_16x16x32_bf16 v[136:139], a[200:203], v[92:95], v[136:139]
    v_cvt_pk_bf16_f32 v115, v166, v167
    ds_read_b64_tr_b16 a[224:225], v8 offset:12288
    ds_read_b64_tr_b16 a[226:227], v8 offset:12544
    s_waitcnt lgkmcnt(10)
    v_mfma_f32_16x16x32_bf16 v[140:143], a[204:207], v[28:31], v[140:143]
    buffer_store_dwordx4 v[112:115], v4, s[40:43], 0 offen offset:576
    v_mfma_f32_16x16x32_bf16 v[144:147], a[204:207], v[60:63], v[144:147]
    v_mul_f32 v156, v156, v121
    v_mfma_f32_16x16x32_bf16 v[148:151], a[204:207], v[92:95], v[148:151]
    v_mul_f32 v157, v157, v121
    ds_read_b64_tr_b16 a[228:229], v8 offset:12296
    ds_read_b64_tr_b16 a[230:231], v8 offset:12552
    s_waitcnt lgkmcnt(10)
    v_mfma_f32_16x16x32_bf16 v[128:131], a[208:211], v[32:35], v[128:131]
    v_mul_f32 v158, v158, v121
    v_mfma_f32_16x16x32_bf16 v[132:135], a[208:211], v[64:67], v[132:135]
    v_mul_f32 v159, v159, v121
    v_mfma_f32_16x16x32_bf16 v[136:139], a[208:211], v[96:99], v[136:139]
    v_mul_f32 v168, v168, v121
    ds_read_b64_tr_b16 a[232:233], v8 offset:14336
    ds_read_b64_tr_b16 a[234:235], v8 offset:14592
    s_waitcnt lgkmcnt(10)
    v_mfma_f32_16x16x32_bf16 v[140:143], a[212:215], v[32:35], v[140:143]
    v_mul_f32 v169, v169, v121
    v_mfma_f32_16x16x32_bf16 v[144:147], a[212:215], v[64:67], v[144:147]
    v_mul_f32 v170, v170, v121
    v_mfma_f32_16x16x32_bf16 v[148:151], a[212:215], v[96:99], v[148:151]
    v_mul_f32 v171, v171, v121
    ds_read_b64_tr_b16 a[236:237], v8 offset:14344
    ds_read_b64_tr_b16 a[238:239], v8 offset:14600
    s_waitcnt lgkmcnt(10)
    v_mfma_f32_16x16x32_bf16 v[128:131], a[216:219], v[36:39], v[128:131]
    v_cvt_pk_bf16_f32 v116, v156, v157
    v_mfma_f32_16x16x32_bf16 v[132:135], a[216:219], v[68:71], v[132:135]
    v_cvt_pk_bf16_f32 v117, v158, v159
    v_mfma_f32_16x16x32_bf16 v[136:139], a[216:219], v[100:103], v[136:139]
    v_cvt_pk_bf16_f32 v118, v168, v169
    s_barrier
    v_add_u32 v8, 114688, v12
    ds_read_b64_tr_b16 a[192:193], v8 offset:0
    ds_read_b64_tr_b16 a[194:195], v8 offset:256
    s_waitcnt lgkmcnt(10)
    v_mfma_f32_16x16x32_bf16 v[140:143], a[220:223], v[36:39], v[140:143]
    v_cvt_pk_bf16_f32 v119, v170, v171
    v_mfma_f32_16x16x32_bf16 v[144:147], a[220:223], v[68:71], v[144:147]
    buffer_store_dwordx4 v[116:119], v5, s[40:43], 0 offen offset:576
    v_mfma_f32_16x16x32_bf16 v[148:151], a[220:223], v[100:103], v[148:151]
    v_mul_f32 v160, v160, v122
    ds_read_b64_tr_b16 a[196:197], v8 offset:8
    ds_read_b64_tr_b16 a[198:199], v8 offset:264
    s_waitcnt lgkmcnt(10)
    v_mfma_f32_16x16x32_bf16 v[128:131], a[224:227], v[40:43], v[128:131]
    v_mul_f32 v161, v161, v122
    v_mfma_f32_16x16x32_bf16 v[132:135], a[224:227], v[72:75], v[132:135]
    v_mul_f32 v162, v162, v122
    v_mfma_f32_16x16x32_bf16 v[136:139], a[224:227], v[104:107], v[136:139]
    v_mul_f32 v163, v163, v122
    ds_read_b64_tr_b16 a[200:201], v8 offset:2048
    ds_read_b64_tr_b16 a[202:203], v8 offset:2304
    s_waitcnt lgkmcnt(10)
    v_mfma_f32_16x16x32_bf16 v[140:143], a[228:231], v[40:43], v[140:143]
    v_mul_f32 v172, v172, v122
    v_mfma_f32_16x16x32_bf16 v[144:147], a[228:231], v[72:75], v[144:147]
    v_mul_f32 v173, v173, v122
    v_mfma_f32_16x16x32_bf16 v[148:151], a[228:231], v[104:107], v[148:151]
    v_mul_f32 v174, v174, v122
    ds_read_b64_tr_b16 a[204:205], v8 offset:2056
    ds_read_b64_tr_b16 a[206:207], v8 offset:2312
    s_waitcnt lgkmcnt(10)
    v_mfma_f32_16x16x32_bf16 v[128:131], a[232:235], v[44:47], v[128:131]
    v_mul_f32 v175, v175, v122
    v_mfma_f32_16x16x32_bf16 v[132:135], a[232:235], v[76:79], v[132:135]
    v_cvt_pk_bf16_f32 v112, v160, v161
    v_mfma_f32_16x16x32_bf16 v[136:139], a[232:235], v[108:111], v[136:139]
    v_cvt_pk_bf16_f32 v113, v162, v163
    ds_read_b64_tr_b16 a[208:209], v8 offset:4096
    ds_read_b64_tr_b16 a[210:211], v8 offset:4352
    s_waitcnt lgkmcnt(10)
    v_mfma_f32_16x16x32_bf16 v[140:143], a[236:239], v[44:47], v[140:143]
    v_cvt_pk_bf16_f32 v114, v172, v173
    v_mfma_f32_16x16x32_bf16 v[144:147], a[236:239], v[76:79], v[144:147]
    v_cvt_pk_bf16_f32 v115, v174, v175
    v_mfma_f32_16x16x32_bf16 v[148:151], a[236:239], v[108:111], v[148:151]
    buffer_store_dwordx4 v[112:115], v6, s[40:43], 0 offen offset:576
    ds_read_b64_tr_b16 a[212:213], v8 offset:4104
    ds_read_b64_tr_b16 a[214:215], v8 offset:4360
    s_waitcnt lgkmcnt(10)
    v_mfma_f32_16x16x32_bf16 v[152:155], a[192:195], v[16:19], 0
    v_mfma_f32_16x16x32_bf16 v[156:159], a[192:195], v[48:51], 0
    v_mfma_f32_16x16x32_bf16 v[160:163], a[192:195], v[80:83], 0
    ds_read_b64_tr_b16 a[216:217], v8 offset:6144
    ds_read_b64_tr_b16 a[218:219], v8 offset:6400
    s_waitcnt lgkmcnt(10)
    v_mfma_f32_16x16x32_bf16 v[164:167], a[196:199], v[16:19], 0
    v_mfma_f32_16x16x32_bf16 v[168:171], a[196:199], v[48:51], 0
    v_mfma_f32_16x16x32_bf16 v[172:175], a[196:199], v[80:83], 0
    ds_read_b64_tr_b16 a[220:221], v8 offset:6152
    ds_read_b64_tr_b16 a[222:223], v8 offset:6408
    s_waitcnt lgkmcnt(10)
    v_mfma_f32_16x16x32_bf16 v[152:155], a[200:203], v[20:23], v[152:155]
    v_mfma_f32_16x16x32_bf16 v[156:159], a[200:203], v[52:55], v[156:159]
    v_mfma_f32_16x16x32_bf16 v[160:163], a[200:203], v[84:87], v[160:163]
    ds_read_b64_tr_b16 a[224:225], v8 offset:8192
    ds_read_b64_tr_b16 a[226:227], v8 offset:8448
    s_waitcnt lgkmcnt(10)
    v_mfma_f32_16x16x32_bf16 v[164:167], a[204:207], v[20:23], v[164:167]
    v_mul_f32 v128, v128, v120
    v_mfma_f32_16x16x32_bf16 v[168:171], a[204:207], v[52:55], v[168:171]
    v_mul_f32 v129, v129, v120
    v_mfma_f32_16x16x32_bf16 v[172:175], a[204:207], v[84:87], v[172:175]
    v_mul_f32 v130, v130, v120
    ds_read_b64_tr_b16 a[228:229], v8 offset:8200
    ds_read_b64_tr_b16 a[230:231], v8 offset:8456
    s_waitcnt lgkmcnt(10)
    v_mfma_f32_16x16x32_bf16 v[152:155], a[208:211], v[24:27], v[152:155]
    v_mul_f32 v131, v131, v120
    v_mfma_f32_16x16x32_bf16 v[156:159], a[208:211], v[56:59], v[156:159]
    v_mul_f32 v140, v140, v120
    v_mfma_f32_16x16x32_bf16 v[160:163], a[208:211], v[88:91], v[160:163]
    v_mul_f32 v141, v141, v120
    ds_read_b64_tr_b16 a[232:233], v8 offset:10240
    ds_read_b64_tr_b16 a[234:235], v8 offset:10496
    s_waitcnt lgkmcnt(10)
    v_mfma_f32_16x16x32_bf16 v[164:167], a[212:215], v[24:27], v[164:167]
    v_mul_f32 v142, v142, v120
    v_mfma_f32_16x16x32_bf16 v[168:171], a[212:215], v[56:59], v[168:171]
    v_mul_f32 v143, v143, v120
    v_mfma_f32_16x16x32_bf16 v[172:175], a[212:215], v[88:91], v[172:175]
    v_cvt_pk_bf16_f32 v112, v128, v129
    ds_read_b64_tr_b16 a[236:237], v8 offset:10248
    ds_read_b64_tr_b16 a[238:239], v8 offset:10504
    s_waitcnt lgkmcnt(10)
    v_mfma_f32_16x16x32_bf16 v[152:155], a[216:219], v[28:31], v[152:155]
    v_cvt_pk_bf16_f32 v113, v130, v131
    v_mfma_f32_16x16x32_bf16 v[156:159], a[216:219], v[60:63], v[156:159]
    v_cvt_pk_bf16_f32 v114, v140, v141
    v_mfma_f32_16x16x32_bf16 v[160:163], a[216:219], v[92:95], v[160:163]
    v_cvt_pk_bf16_f32 v115, v142, v143
    ds_read_b64_tr_b16 a[192:193], v8 offset:12288
    ds_read_b64_tr_b16 a[194:195], v8 offset:12544
    s_waitcnt lgkmcnt(10)
    v_mfma_f32_16x16x32_bf16 v[164:167], a[220:223], v[28:31], v[164:167]
    buffer_store_dwordx4 v[112:115], v4, s[40:43], 0 offen offset:640
    v_mfma_f32_16x16x32_bf16 v[168:171], a[220:223], v[60:63], v[168:171]
    v_mul_f32 v132, v132, v121
    v_mfma_f32_16x16x32_bf16 v[172:175], a[220:223], v[92:95], v[172:175]
    v_mul_f32 v133, v133, v121
    ds_read_b64_tr_b16 a[196:197], v8 offset:12296
    ds_read_b64_tr_b16 a[198:199], v8 offset:12552
    s_waitcnt lgkmcnt(10)
    v_mfma_f32_16x16x32_bf16 v[152:155], a[224:227], v[32:35], v[152:155]
    v_mul_f32 v134, v134, v121
    v_mfma_f32_16x16x32_bf16 v[156:159], a[224:227], v[64:67], v[156:159]
    v_mul_f32 v135, v135, v121
    v_mfma_f32_16x16x32_bf16 v[160:163], a[224:227], v[96:99], v[160:163]
    v_mul_f32 v144, v144, v121
    ds_read_b64_tr_b16 a[200:201], v8 offset:14336
    ds_read_b64_tr_b16 a[202:203], v8 offset:14592
    s_waitcnt lgkmcnt(10)
    v_mfma_f32_16x16x32_bf16 v[164:167], a[228:231], v[32:35], v[164:167]
    v_mul_f32 v145, v145, v121
    v_mfma_f32_16x16x32_bf16 v[168:171], a[228:231], v[64:67], v[168:171]
    v_mul_f32 v146, v146, v121
    v_mfma_f32_16x16x32_bf16 v[172:175], a[228:231], v[96:99], v[172:175]
    v_mul_f32 v147, v147, v121
    ds_read_b64_tr_b16 a[204:205], v8 offset:14344
    ds_read_b64_tr_b16 a[206:207], v8 offset:14600
    s_waitcnt lgkmcnt(10)
    v_mfma_f32_16x16x32_bf16 v[152:155], a[232:235], v[36:39], v[152:155]
    v_cvt_pk_bf16_f32 v116, v132, v133
    v_mfma_f32_16x16x32_bf16 v[156:159], a[232:235], v[68:71], v[156:159]
    v_cvt_pk_bf16_f32 v117, v134, v135
    v_mfma_f32_16x16x32_bf16 v[160:163], a[232:235], v[100:103], v[160:163]
    v_cvt_pk_bf16_f32 v118, v144, v145
    s_barrier
    v_add_u32 v8, 131072, v12
    ds_read_b64_tr_b16 a[208:209], v8 offset:0
    ds_read_b64_tr_b16 a[210:211], v8 offset:256
    s_waitcnt lgkmcnt(10)
    v_mfma_f32_16x16x32_bf16 v[164:167], a[236:239], v[36:39], v[164:167]
    v_cvt_pk_bf16_f32 v119, v146, v147
    v_mfma_f32_16x16x32_bf16 v[168:171], a[236:239], v[68:71], v[168:171]
    buffer_store_dwordx4 v[116:119], v5, s[40:43], 0 offen offset:640
    v_mfma_f32_16x16x32_bf16 v[172:175], a[236:239], v[100:103], v[172:175]
    v_mul_f32 v136, v136, v122
    ds_read_b64_tr_b16 a[212:213], v8 offset:8
    ds_read_b64_tr_b16 a[214:215], v8 offset:264
    s_waitcnt lgkmcnt(10)
    v_mfma_f32_16x16x32_bf16 v[152:155], a[192:195], v[40:43], v[152:155]
    v_mul_f32 v137, v137, v122
    v_mfma_f32_16x16x32_bf16 v[156:159], a[192:195], v[72:75], v[156:159]
    v_mul_f32 v138, v138, v122
    v_mfma_f32_16x16x32_bf16 v[160:163], a[192:195], v[104:107], v[160:163]
    v_mul_f32 v139, v139, v122
    ds_read_b64_tr_b16 a[216:217], v8 offset:2048
    ds_read_b64_tr_b16 a[218:219], v8 offset:2304
    s_waitcnt lgkmcnt(10)
    v_mfma_f32_16x16x32_bf16 v[164:167], a[196:199], v[40:43], v[164:167]
    v_mul_f32 v148, v148, v122
    v_mfma_f32_16x16x32_bf16 v[168:171], a[196:199], v[72:75], v[168:171]
    v_mul_f32 v149, v149, v122
    v_mfma_f32_16x16x32_bf16 v[172:175], a[196:199], v[104:107], v[172:175]
    v_mul_f32 v150, v150, v122
    ds_read_b64_tr_b16 a[220:221], v8 offset:2056
    ds_read_b64_tr_b16 a[222:223], v8 offset:2312
    s_waitcnt lgkmcnt(10)
    v_mfma_f32_16x16x32_bf16 v[152:155], a[200:203], v[44:47], v[152:155]
    v_mul_f32 v151, v151, v122
    v_mfma_f32_16x16x32_bf16 v[156:159], a[200:203], v[76:79], v[156:159]
    v_cvt_pk_bf16_f32 v112, v136, v137
    v_mfma_f32_16x16x32_bf16 v[160:163], a[200:203], v[108:111], v[160:163]
    v_cvt_pk_bf16_f32 v113, v138, v139
    ds_read_b64_tr_b16 a[224:225], v8 offset:4096
    ds_read_b64_tr_b16 a[226:227], v8 offset:4352
    s_waitcnt lgkmcnt(10)
    v_mfma_f32_16x16x32_bf16 v[164:167], a[204:207], v[44:47], v[164:167]
    v_cvt_pk_bf16_f32 v114, v148, v149
    v_mfma_f32_16x16x32_bf16 v[168:171], a[204:207], v[76:79], v[168:171]
    v_cvt_pk_bf16_f32 v115, v150, v151
    v_mfma_f32_16x16x32_bf16 v[172:175], a[204:207], v[108:111], v[172:175]
    buffer_store_dwordx4 v[112:115], v6, s[40:43], 0 offen offset:640
    ds_read_b64_tr_b16 a[228:229], v8 offset:4104
    ds_read_b64_tr_b16 a[230:231], v8 offset:4360
    s_waitcnt lgkmcnt(10)
    v_mfma_f32_16x16x32_bf16 v[128:131], a[208:211], v[16:19], 0
    v_mfma_f32_16x16x32_bf16 v[132:135], a[208:211], v[48:51], 0
    v_mfma_f32_16x16x32_bf16 v[136:139], a[208:211], v[80:83], 0
    ds_read_b64_tr_b16 a[232:233], v8 offset:6144
    ds_read_b64_tr_b16 a[234:235], v8 offset:6400
    s_waitcnt lgkmcnt(10)
    v_mfma_f32_16x16x32_bf16 v[140:143], a[212:215], v[16:19], 0
    v_mfma_f32_16x16x32_bf16 v[144:147], a[212:215], v[48:51], 0
    v_mfma_f32_16x16x32_bf16 v[148:151], a[212:215], v[80:83], 0
    ds_read_b64_tr_b16 a[236:237], v8 offset:6152
    ds_read_b64_tr_b16 a[238:239], v8 offset:6408
    s_waitcnt lgkmcnt(10)
    v_mfma_f32_16x16x32_bf16 v[128:131], a[216:219], v[20:23], v[128:131]
    v_mfma_f32_16x16x32_bf16 v[132:135], a[216:219], v[52:55], v[132:135]
    v_mfma_f32_16x16x32_bf16 v[136:139], a[216:219], v[84:87], v[136:139]
    ds_read_b64_tr_b16 a[192:193], v8 offset:8192
    ds_read_b64_tr_b16 a[194:195], v8 offset:8448
    s_waitcnt lgkmcnt(10)
    v_mfma_f32_16x16x32_bf16 v[140:143], a[220:223], v[20:23], v[140:143]
    v_mul_f32 v152, v152, v120
    v_mfma_f32_16x16x32_bf16 v[144:147], a[220:223], v[52:55], v[144:147]
    v_mul_f32 v153, v153, v120
    v_mfma_f32_16x16x32_bf16 v[148:151], a[220:223], v[84:87], v[148:151]
    v_mul_f32 v154, v154, v120
    ds_read_b64_tr_b16 a[196:197], v8 offset:8200
    ds_read_b64_tr_b16 a[198:199], v8 offset:8456
    s_waitcnt lgkmcnt(10)
    v_mfma_f32_16x16x32_bf16 v[128:131], a[224:227], v[24:27], v[128:131]
    v_mul_f32 v155, v155, v120
    v_mfma_f32_16x16x32_bf16 v[132:135], a[224:227], v[56:59], v[132:135]
    v_mul_f32 v164, v164, v120
    v_mfma_f32_16x16x32_bf16 v[136:139], a[224:227], v[88:91], v[136:139]
    v_mul_f32 v165, v165, v120
    ds_read_b64_tr_b16 a[200:201], v8 offset:10240
    ds_read_b64_tr_b16 a[202:203], v8 offset:10496
    s_waitcnt lgkmcnt(10)
    v_mfma_f32_16x16x32_bf16 v[140:143], a[228:231], v[24:27], v[140:143]
    v_mul_f32 v166, v166, v120
    v_mfma_f32_16x16x32_bf16 v[144:147], a[228:231], v[56:59], v[144:147]
    v_mul_f32 v167, v167, v120
    v_mfma_f32_16x16x32_bf16 v[148:151], a[228:231], v[88:91], v[148:151]
    v_cvt_pk_bf16_f32 v112, v152, v153
    ds_read_b64_tr_b16 a[204:205], v8 offset:10248
    ds_read_b64_tr_b16 a[206:207], v8 offset:10504
    s_waitcnt lgkmcnt(10)
    v_mfma_f32_16x16x32_bf16 v[128:131], a[232:235], v[28:31], v[128:131]
    v_cvt_pk_bf16_f32 v113, v154, v155
    v_mfma_f32_16x16x32_bf16 v[132:135], a[232:235], v[60:63], v[132:135]
    v_cvt_pk_bf16_f32 v114, v164, v165
    v_mfma_f32_16x16x32_bf16 v[136:139], a[232:235], v[92:95], v[136:139]
    v_cvt_pk_bf16_f32 v115, v166, v167
    ds_read_b64_tr_b16 a[208:209], v8 offset:12288
    ds_read_b64_tr_b16 a[210:211], v8 offset:12544
    s_waitcnt lgkmcnt(10)
    v_mfma_f32_16x16x32_bf16 v[140:143], a[236:239], v[28:31], v[140:143]
    buffer_store_dwordx4 v[112:115], v4, s[40:43], 0 offen offset:704
    v_mfma_f32_16x16x32_bf16 v[144:147], a[236:239], v[60:63], v[144:147]
    v_mul_f32 v156, v156, v121
    v_mfma_f32_16x16x32_bf16 v[148:151], a[236:239], v[92:95], v[148:151]
    v_mul_f32 v157, v157, v121
    ds_read_b64_tr_b16 a[212:213], v8 offset:12296
    ds_read_b64_tr_b16 a[214:215], v8 offset:12552
    s_waitcnt lgkmcnt(10)
    v_mfma_f32_16x16x32_bf16 v[128:131], a[192:195], v[32:35], v[128:131]
    v_mul_f32 v158, v158, v121
    v_mfma_f32_16x16x32_bf16 v[132:135], a[192:195], v[64:67], v[132:135]
    v_mul_f32 v159, v159, v121
    v_mfma_f32_16x16x32_bf16 v[136:139], a[192:195], v[96:99], v[136:139]
    v_mul_f32 v168, v168, v121
    ds_read_b64_tr_b16 a[216:217], v8 offset:14336
    ds_read_b64_tr_b16 a[218:219], v8 offset:14592
    s_waitcnt lgkmcnt(10)
    v_mfma_f32_16x16x32_bf16 v[140:143], a[196:199], v[32:35], v[140:143]
    v_mul_f32 v169, v169, v121
    v_mfma_f32_16x16x32_bf16 v[144:147], a[196:199], v[64:67], v[144:147]
    v_mul_f32 v170, v170, v121
    v_mfma_f32_16x16x32_bf16 v[148:151], a[196:199], v[96:99], v[148:151]
    v_mul_f32 v171, v171, v121
    ds_read_b64_tr_b16 a[220:221], v8 offset:14344
    ds_read_b64_tr_b16 a[222:223], v8 offset:14600
    s_waitcnt lgkmcnt(10)
    v_mfma_f32_16x16x32_bf16 v[128:131], a[200:203], v[36:39], v[128:131]
    v_cvt_pk_bf16_f32 v116, v156, v157
    v_mfma_f32_16x16x32_bf16 v[132:135], a[200:203], v[68:71], v[132:135]
    v_cvt_pk_bf16_f32 v117, v158, v159
    v_mfma_f32_16x16x32_bf16 v[136:139], a[200:203], v[100:103], v[136:139]
    v_cvt_pk_bf16_f32 v118, v168, v169
    s_barrier
    v_add_u32 v8, 147456, v12
    ds_read_b64_tr_b16 a[224:225], v8 offset:0
    ds_read_b64_tr_b16 a[226:227], v8 offset:256
    s_waitcnt lgkmcnt(10)
    v_mfma_f32_16x16x32_bf16 v[140:143], a[204:207], v[36:39], v[140:143]
    v_cvt_pk_bf16_f32 v119, v170, v171
    v_mfma_f32_16x16x32_bf16 v[144:147], a[204:207], v[68:71], v[144:147]
    buffer_store_dwordx4 v[116:119], v5, s[40:43], 0 offen offset:704
    v_mfma_f32_16x16x32_bf16 v[148:151], a[204:207], v[100:103], v[148:151]
    v_mul_f32 v160, v160, v122
    ds_read_b64_tr_b16 a[228:229], v8 offset:8
    ds_read_b64_tr_b16 a[230:231], v8 offset:264
    s_waitcnt lgkmcnt(10)
    v_mfma_f32_16x16x32_bf16 v[128:131], a[208:211], v[40:43], v[128:131]
    v_mul_f32 v161, v161, v122
    v_mfma_f32_16x16x32_bf16 v[132:135], a[208:211], v[72:75], v[132:135]
    v_mul_f32 v162, v162, v122
    v_mfma_f32_16x16x32_bf16 v[136:139], a[208:211], v[104:107], v[136:139]
    v_mul_f32 v163, v163, v122
    ds_read_b64_tr_b16 a[232:233], v8 offset:2048
    ds_read_b64_tr_b16 a[234:235], v8 offset:2304
    s_waitcnt lgkmcnt(10)
    v_mfma_f32_16x16x32_bf16 v[140:143], a[212:215], v[40:43], v[140:143]
    v_mul_f32 v172, v172, v122
    v_mfma_f32_16x16x32_bf16 v[144:147], a[212:215], v[72:75], v[144:147]
    v_mul_f32 v173, v173, v122
    v_mfma_f32_16x16x32_bf16 v[148:151], a[212:215], v[104:107], v[148:151]
    v_mul_f32 v174, v174, v122
    ds_read_b64_tr_b16 a[236:237], v8 offset:2056
    ds_read_b64_tr_b16 a[238:239], v8 offset:2312
    s_waitcnt lgkmcnt(10)
    v_mfma_f32_16x16x32_bf16 v[128:131], a[216:219], v[44:47], v[128:131]
    v_mul_f32 v175, v175, v122
    v_mfma_f32_16x16x32_bf16 v[132:135], a[216:219], v[76:79], v[132:135]
    v_cvt_pk_bf16_f32 v112, v160, v161
    v_mfma_f32_16x16x32_bf16 v[136:139], a[216:219], v[108:111], v[136:139]
    v_cvt_pk_bf16_f32 v113, v162, v163
    ds_read_b64_tr_b16 a[192:193], v8 offset:4096
    ds_read_b64_tr_b16 a[194:195], v8 offset:4352
    s_waitcnt lgkmcnt(10)
    v_mfma_f32_16x16x32_bf16 v[140:143], a[220:223], v[44:47], v[140:143]
    v_cvt_pk_bf16_f32 v114, v172, v173
    v_mfma_f32_16x16x32_bf16 v[144:147], a[220:223], v[76:79], v[144:147]
    v_cvt_pk_bf16_f32 v115, v174, v175
    v_mfma_f32_16x16x32_bf16 v[148:151], a[220:223], v[108:111], v[148:151]
    buffer_store_dwordx4 v[112:115], v6, s[40:43], 0 offen offset:704
    ds_read_b64_tr_b16 a[196:197], v8 offset:4104
    ds_read_b64_tr_b16 a[198:199], v8 offset:4360
    s_waitcnt lgkmcnt(10)
    v_mfma_f32_16x16x32_bf16 v[152:155], a[224:227], v[16:19], 0
    v_mfma_f32_16x16x32_bf16 v[156:159], a[224:227], v[48:51], 0
    v_mfma_f32_16x16x32_bf16 v[160:163], a[224:227], v[80:83], 0
    ds_read_b64_tr_b16 a[200:201], v8 offset:6144
    ds_read_b64_tr_b16 a[202:203], v8 offset:6400
    s_waitcnt lgkmcnt(10)
    v_mfma_f32_16x16x32_bf16 v[164:167], a[228:231], v[16:19], 0
    v_mfma_f32_16x16x32_bf16 v[168:171], a[228:231], v[48:51], 0
    v_mfma_f32_16x16x32_bf16 v[172:175], a[228:231], v[80:83], 0
    ds_read_b64_tr_b16 a[204:205], v8 offset:6152
    ds_read_b64_tr_b16 a[206:207], v8 offset:6408
    s_waitcnt lgkmcnt(10)
    v_mfma_f32_16x16x32_bf16 v[152:155], a[232:235], v[20:23], v[152:155]
    v_mfma_f32_16x16x32_bf16 v[156:159], a[232:235], v[52:55], v[156:159]
    v_mfma_f32_16x16x32_bf16 v[160:163], a[232:235], v[84:87], v[160:163]
    ds_read_b64_tr_b16 a[208:209], v8 offset:8192
    ds_read_b64_tr_b16 a[210:211], v8 offset:8448
    s_waitcnt lgkmcnt(10)
    v_mfma_f32_16x16x32_bf16 v[164:167], a[236:239], v[20:23], v[164:167]
    v_mul_f32 v128, v128, v120
    v_mfma_f32_16x16x32_bf16 v[168:171], a[236:239], v[52:55], v[168:171]
    v_mul_f32 v129, v129, v120
    v_mfma_f32_16x16x32_bf16 v[172:175], a[236:239], v[84:87], v[172:175]
    v_mul_f32 v130, v130, v120
    ds_read_b64_tr_b16 a[212:213], v8 offset:8200
    ds_read_b64_tr_b16 a[214:215], v8 offset:8456
    s_waitcnt lgkmcnt(10)
    v_mfma_f32_16x16x32_bf16 v[152:155], a[192:195], v[24:27], v[152:155]
    v_mul_f32 v131, v131, v120
    v_mfma_f32_16x16x32_bf16 v[156:159], a[192:195], v[56:59], v[156:159]
    v_mul_f32 v140, v140, v120
    v_mfma_f32_16x16x32_bf16 v[160:163], a[192:195], v[88:91], v[160:163]
    v_mul_f32 v141, v141, v120
    ds_read_b64_tr_b16 a[216:217], v8 offset:10240
    ds_read_b64_tr_b16 a[218:219], v8 offset:10496
    s_waitcnt lgkmcnt(10)
    v_mfma_f32_16x16x32_bf16 v[164:167], a[196:199], v[24:27], v[164:167]
    v_mul_f32 v142, v142, v120
    v_mfma_f32_16x16x32_bf16 v[168:171], a[196:199], v[56:59], v[168:171]
    v_mul_f32 v143, v143, v120
    v_mfma_f32_16x16x32_bf16 v[172:175], a[196:199], v[88:91], v[172:175]
    v_cvt_pk_bf16_f32 v112, v128, v129
    ds_read_b64_tr_b16 a[220:221], v8 offset:10248
    ds_read_b64_tr_b16 a[222:223], v8 offset:10504
    s_waitcnt lgkmcnt(10)
    v_mfma_f32_16x16x32_bf16 v[152:155], a[200:203], v[28:31], v[152:155]
    v_cvt_pk_bf16_f32 v113, v130, v131
    v_mfma_f32_16x16x32_bf16 v[156:159], a[200:203], v[60:63], v[156:159]
    v_cvt_pk_bf16_f32 v114, v140, v141
    v_mfma_f32_16x16x32_bf16 v[160:163], a[200:203], v[92:95], v[160:163]
    v_cvt_pk_bf16_f32 v115, v142, v143
    ds_read_b64_tr_b16 a[224:225], v8 offset:12288
    ds_read_b64_tr_b16 a[226:227], v8 offset:12544
    s_waitcnt lgkmcnt(10)
    v_mfma_f32_16x16x32_bf16 v[164:167], a[204:207], v[28:31], v[164:167]
    buffer_store_dwordx4 v[112:115], v4, s[40:43], 0 offen offset:768
    v_mfma_f32_16x16x32_bf16 v[168:171], a[204:207], v[60:63], v[168:171]
    v_mul_f32 v132, v132, v121
    v_mfma_f32_16x16x32_bf16 v[172:175], a[204:207], v[92:95], v[172:175]
    v_mul_f32 v133, v133, v121
    ds_read_b64_tr_b16 a[228:229], v8 offset:12296
    ds_read_b64_tr_b16 a[230:231], v8 offset:12552
    s_waitcnt lgkmcnt(10)
    v_mfma_f32_16x16x32_bf16 v[152:155], a[208:211], v[32:35], v[152:155]
    v_mul_f32 v134, v134, v121
    v_mfma_f32_16x16x32_bf16 v[156:159], a[208:211], v[64:67], v[156:159]
    v_mul_f32 v135, v135, v121
    v_mfma_f32_16x16x32_bf16 v[160:163], a[208:211], v[96:99], v[160:163]
    v_mul_f32 v144, v144, v121
    ds_read_b64_tr_b16 a[232:233], v8 offset:14336
    ds_read_b64_tr_b16 a[234:235], v8 offset:14592
    s_waitcnt lgkmcnt(10)
    v_mfma_f32_16x16x32_bf16 v[164:167], a[212:215], v[32:35], v[164:167]
    v_mul_f32 v145, v145, v121
    v_mfma_f32_16x16x32_bf16 v[168:171], a[212:215], v[64:67], v[168:171]
    v_mul_f32 v146, v146, v121
    v_mfma_f32_16x16x32_bf16 v[172:175], a[212:215], v[96:99], v[172:175]
    v_mul_f32 v147, v147, v121
    ds_read_b64_tr_b16 a[236:237], v8 offset:14344
    ds_read_b64_tr_b16 a[238:239], v8 offset:14600
    s_waitcnt lgkmcnt(10)
    v_mfma_f32_16x16x32_bf16 v[152:155], a[216:219], v[36:39], v[152:155]
    v_cvt_pk_bf16_f32 v116, v132, v133
    v_mfma_f32_16x16x32_bf16 v[156:159], a[216:219], v[68:71], v[156:159]
    v_cvt_pk_bf16_f32 v117, v134, v135
    v_mfma_f32_16x16x32_bf16 v[160:163], a[216:219], v[100:103], v[160:163]
    v_cvt_pk_bf16_f32 v118, v144, v145
    s_waitcnt lgkmcnt(8)
    v_mfma_f32_16x16x32_bf16 v[164:167], a[220:223], v[36:39], v[164:167]
    v_cvt_pk_bf16_f32 v119, v146, v147
    v_mfma_f32_16x16x32_bf16 v[168:171], a[220:223], v[68:71], v[168:171]
    buffer_store_dwordx4 v[116:119], v5, s[40:43], 0 offen offset:768
    v_mfma_f32_16x16x32_bf16 v[172:175], a[220:223], v[100:103], v[172:175]
    v_mul_f32 v136, v136, v122
    s_waitcnt lgkmcnt(6)
    v_mfma_f32_16x16x32_bf16 v[152:155], a[224:227], v[40:43], v[152:155]
    v_mul_f32 v137, v137, v122
    v_mfma_f32_16x16x32_bf16 v[156:159], a[224:227], v[72:75], v[156:159]
    v_mul_f32 v138, v138, v122
    v_mfma_f32_16x16x32_bf16 v[160:163], a[224:227], v[104:107], v[160:163]
    v_mul_f32 v139, v139, v122
    s_waitcnt lgkmcnt(4)
    v_mfma_f32_16x16x32_bf16 v[164:167], a[228:231], v[40:43], v[164:167]
    v_mul_f32 v148, v148, v122
    v_mfma_f32_16x16x32_bf16 v[168:171], a[228:231], v[72:75], v[168:171]
    v_mul_f32 v149, v149, v122
    v_mfma_f32_16x16x32_bf16 v[172:175], a[228:231], v[104:107], v[172:175]
    v_mul_f32 v150, v150, v122
    s_waitcnt lgkmcnt(2)
    v_mfma_f32_16x16x32_bf16 v[152:155], a[232:235], v[44:47], v[152:155]
    v_mul_f32 v151, v151, v122
    v_mfma_f32_16x16x32_bf16 v[156:159], a[232:235], v[76:79], v[156:159]
    v_cvt_pk_bf16_f32 v112, v136, v137
    v_mfma_f32_16x16x32_bf16 v[160:163], a[232:235], v[108:111], v[160:163]
    v_cvt_pk_bf16_f32 v113, v138, v139
    s_waitcnt lgkmcnt(0)
    v_mfma_f32_16x16x32_bf16 v[164:167], a[236:239], v[44:47], v[164:167]
    v_cvt_pk_bf16_f32 v114, v148, v149
    v_mfma_f32_16x16x32_bf16 v[168:171], a[236:239], v[76:79], v[168:171]
    v_cvt_pk_bf16_f32 v115, v150, v151
    v_mfma_f32_16x16x32_bf16 v[172:175], a[236:239], v[108:111], v[172:175]
    buffer_store_dwordx4 v[112:115], v6, s[40:43], 0 offen offset:768
    s_nop 7
    s_nop 1
    v_mul_f32 v152, v152, v120
    v_mul_f32 v153, v153, v120
    v_mul_f32 v154, v154, v120
    v_mul_f32 v155, v155, v120
    v_mul_f32 v164, v164, v120
    v_mul_f32 v165, v165, v120
    v_mul_f32 v166, v166, v120
    v_mul_f32 v167, v167, v120
    v_cvt_pk_bf16_f32 v112, v152, v153
    v_cvt_pk_bf16_f32 v113, v154, v155
    v_cvt_pk_bf16_f32 v114, v164, v165
    v_cvt_pk_bf16_f32 v115, v166, v167
    buffer_store_dwordx4 v[112:115], v4, s[40:43], 0 offen offset:832
    v_mul_f32 v156, v156, v121
    v_mul_f32 v157, v157, v121
    v_mul_f32 v158, v158, v121
    v_mul_f32 v159, v159, v121
    v_mul_f32 v168, v168, v121
    v_mul_f32 v169, v169, v121
    v_mul_f32 v170, v170, v121
    v_mul_f32 v171, v171, v121
    v_cvt_pk_bf16_f32 v116, v156, v157
    v_cvt_pk_bf16_f32 v117, v158, v159
    v_cvt_pk_bf16_f32 v118, v168, v169
    v_cvt_pk_bf16_f32 v119, v170, v171
    buffer_store_dwordx4 v[116:119], v5, s[40:43], 0 offen offset:832
    v_mul_f32 v160, v160, v122
    v_mul_f32 v161, v161, v122
    v_mul_f32 v162, v162, v122
    v_mul_f32 v163, v163, v122
    v_mul_f32 v172, v172, v122
    v_mul_f32 v173, v173, v122
    v_mul_f32 v174, v174, v122
    v_mul_f32 v175, v175, v122
    v_cvt_pk_bf16_f32 v112, v160, v161
    v_cvt_pk_bf16_f32 v113, v162, v163
    v_cvt_pk_bf16_f32 v114, v172, v173
    v_cvt_pk_bf16_f32 v115, v174, v175
    buffer_store_dwordx4 v[112:115], v6, s[40:43], 0 offen offset:832
    s_waitcnt vmcnt(0)
    s_branch L1_end
L1_loader:
    s_getpc_b64 s[70:71]
L1_pc:
    s_sub_u32 s70, s70, L1_pc-attn_kernel
    s_subb_u32 s71, s71, 0
    s_lshr_b32 s72, s2, 3
    s_cmp_ge_u32 s72, 21
    s_cbranch_scc1 L1_nopf
    s_lshl_b32 s72, s72, 12
    v_lshl_add_u32 v40, v0, 6, s72
    v_mov_b32 v41, s71
    v_add_co_u32 v42, vcc, s70, v40
    s_nop 1
    v_addc_co_u32 v43, vcc, 0, v41, vcc
    global_load_dword v44, v[42:43], off
L1_nopf:
    s_lshr_b32 s48, s2, 4
    s_add_u32 s48, s48, s2
    v_lshrrev_b32 v1, 5, v0
    v_and_b32 v2, 31, v0
    v_add_u32 v3, 0, v1
    v_xor_b32 v3, v3, v2
    v_lshlrev_b32 v3, 4, v3
    v_lshl_add_u32 v8, v1, 9, v3
    v_add_u32 v3, 2, v1
    v_xor_b32 v3, v3, v2
    v_lshlrev_b32 v3, 4, v3
    v_lshl_add_u32 v9, v1, 9, v3
    v_add_u32 v3, 4, v1
    v_xor_b32 v3, v3, v2
    v_lshlrev_b32 v3, 4, v3
    v_lshl_add_u32 v10, v1, 9, v3
    v_add_u32 v3, 6, v1
    v_xor_b32 v3, v3, v2
    v_lshlrev_b32 v3, 4, v3
    v_lshl_add_u32 v11, v1, 9, v3
    v_add_u32 v3, 8, v1
    v_xor_b32 v3, v3, v2
    v_lshlrev_b32 v3, 4, v3
    v_lshl_add_u32 v12, v1, 9, v3
    v_add_u32 v3, 10, v1
    v_xor_b32 v3, v3, v2
    v_lshlrev_b32 v3, 4, v3
    v_lshl_add_u32 v13, v1, 9, v3
    v_add_u32 v3, 12, v1
    v_xor_b32 v3, v3, v2
    v_lshlrev_b32 v3, 4, v3
    v_lshl_add_u32 v14, v1, 9, v3
    v_add_u32 v3, 14, v1
    v_xor_b32 v3, v3, v2
    v_lshlrev_b32 v3, 4, v3
    v_lshl_add_u32 v15, v1, 9, v3
    v_add_u32 v3, 0, v1
    v_lshlrev_b32 v3, 2, v3
    v_xor_b32 v3, v3, v2
    v_lshlrev_b32 v3, 4, v3
    v_lshl_add_u32 v16, v1, 9, v3
    v_lshl_add_u32 v18, v1, 13, v3
    v_add_u32 v3, 2, v1
    v_lshlrev_b32 v3, 2, v3
    v_xor_b32 v3, v3, v2
    v_lshlrev_b32 v3, 4, v3
    v_lshl_add_u32 v17, v1, 9, v3
    v_lshl_add_u32 v19, v1, 13, v3
    v_lshrrev_b32 v3, 2, v0
    v_mul_u32_u24 v3, 896, v3
    v_and_b32 v4, 3, v0
    v_lshl_add_u32 v20, v4, 4, v3
    s_mov_b32 m0, 0
    s_mov_b32 s47, 0
    buffer_load_dwordx4 v18, s[36:39], s47 offen lds
    s_mov_b32 m0, 1024
    s_mov_b32 s47, 16384
    buffer_load_dwordx4 v19, s[36:39], s47 offen lds
    s_mov_b32 m0, 2048
    s_mov_b32 s47, 32768
    buffer_load_dwordx4 v18, s[36:39], s47 offen lds
    s_mov_b32 m0, 3072
    s_mov_b32 s47, 49152
    buffer_load_dwordx4 v19, s[36:39], s47 offen lds
    s_mov_b32 m0, 4096
    s_mov_b32 s47, 65536
    buffer_load_dwordx4 v18, s[36:39], s47 offen lds
    s_mov_b32 m0, 5120
    s_mov_b32 s47, 81920
    buffer_load_dwordx4 v19, s[36:39], s47 offen lds
    s_mov_b32 m0, 6144
    s_mov_b32 s47, 98304
    buffer_load_dwordx4 v18, s[36:39], s47 offen lds
    s_mov_b32 m0, 7168
    s_mov_b32 s47, 114688
    buffer_load_dwordx4 v19, s[36:39], s47 offen lds
    s_mov_b32 m0, 8192
    s_mov_b32 s47, 131072
    buffer_load_dwordx4 v18, s[36:39], s47 offen lds
    s_mov_b32 m0, 9216
    s_mov_b32 s47, 147456
    buffer_load_dwordx4 v19, s[36:39], s47 offen lds
    s_mov_b32 m0, 10240
    s_mov_b32 s47, 163840
    buffer_load_dwordx4 v18, s[36:39], s47 offen lds
    s_mov_b32 m0, 11264
    s_mov_b32 s47, 180224
    buffer_load_dwordx4 v19, s[36:39], s47 offen lds
    s_mov_b32 m0, 12288
    s_mov_b32 s47, 196608
    buffer_load_dwordx4 v18, s[36:39], s47 offen lds
    s_mov_b32 m0, 13312
    s_mov_b32 s47, 212992
    buffer_load_dwordx4 v19, s[36:39], s47 offen lds
    s_mov_b32 m0, 14336
    s_mov_b32 s47, 229376
    buffer_load_dwordx4 v18, s[36:39], s47 offen lds
    s_mov_b32 m0, 15360
    s_mov_b32 s47, 245760
    buffer_load_dwordx4 v19, s[36:39], s47 offen lds
    s_mov_b32 m0, 16384
    s_mov_b32 s47, 262144
    buffer_load_dwordx4 v18, s[36:39], s47 offen lds
    s_mov_b32 m0, 17408
    s_mov_b32 s47, 278528
    buffer_load_dwordx4 v19, s[36:39], s47 offen lds
    s_mov_b32 m0, 18432
    s_mov_b32 s47, 294912
    buffer_load_dwordx4 v18, s[36:39], s47 offen lds
    s_mov_b32 m0, 19456
    s_mov_b32 s47, 311296
    buffer_load_dwordx4 v19, s[36:39], s47 offen lds
    s_mov_b32 m0, 20480
    s_mov_b32 s47, 327680
    buffer_load_dwordx4 v18, s[36:39], s47 offen lds
    s_mov_b32 m0, 21504
    s_mov_b32 s47, 344064
    buffer_load_dwordx4 v19, s[36:39], s47 offen lds
    s_mov_b32 m0, 22528
    s_mov_b32 s47, 360448
    buffer_load_dwordx4 v18, s[36:39], s47 offen lds
    s_mov_b32 m0, 23552
    s_mov_b32 s47, 376832
    buffer_load_dwordx4 v19, s[36:39], s47 offen lds
    s_mov_b32 m0, 24576
    s_mov_b32 s47, 393216
    buffer_load_dwordx4 v18, s[36:39], s47 offen lds
    s_mov_b32 m0, 25600
    s_mov_b32 s47, 409600
    buffer_load_dwordx4 v19, s[36:39], s47 offen lds
    s_mov_b32 m0, 26624
    s_mov_b32 s47, 425984
    buffer_load_dwordx4 v18, s[36:39], s47 offen lds
    s_mov_b32 m0, 27648
    s_mov_b32 s47, 442368
    buffer_load_dwordx4 v19, s[36:39], s47 offen lds
    s_mov_b32 m0, 28672
    s_mov_b32 s47, 458752
    buffer_load_dwordx4 v18, s[36:39], s47 offen lds
    s_mov_b32 m0, 29696
    s_mov_b32 s47, 475136
    buffer_load_dwordx4 v19, s[36:39], s47 offen lds
    s_mov_b32 m0, 30720
    s_mov_b32 s47, 491520
    buffer_load_dwordx4 v18, s[36:39], s47 offen lds
    s_mov_b32 m0, 31744
    s_mov_b32 s47, 507904
    buffer_load_dwordx4 v19, s[36:39], s47 offen lds
    s_mov_b32 m0, 32768
    s_mov_b32 s47, 524288
    buffer_load_dwordx4 v18, s[36:39], s47 offen lds
    s_mov_b32 m0, 33792
    s_mov_b32 s47, 540672
    buffer_load_dwordx4 v19, s[36:39], s47 offen lds
    s_mov_b32 m0, 34816
    s_mov_b32 s47, 557056
    buffer_load_dwordx4 v18, s[36:39], s47 offen lds
    s_mov_b32 m0, 35840
    s_mov_b32 s47, 573440
    buffer_load_dwordx4 v19, s[36:39], s47 offen lds
    s_mov_b32 m0, 36864
    s_mov_b32 s47, 589824
    buffer_load_dwordx4 v18, s[36:39], s47 offen lds
    s_mov_b32 m0, 37888
    s_mov_b32 s47, 606208
    buffer_load_dwordx4 v19, s[36:39], s47 offen lds
    s_mov_b32 m0, 38912
    s_mov_b32 s47, 622592
    buffer_load_dwordx4 v18, s[36:39], s47 offen lds
    s_mov_b32 m0, 39936
    s_mov_b32 s47, 638976
    buffer_load_dwordx4 v19, s[36:39], s47 offen lds
    s_mov_b32 m0, 40960
    s_mov_b32 s47, 655360
    buffer_load_dwordx4 v18, s[36:39], s47 offen lds
    s_mov_b32 m0, 41984
    s_mov_b32 s47, 671744
    buffer_load_dwordx4 v19, s[36:39], s47 offen lds
    s_mov_b32 m0, 43008
    s_mov_b32 s47, 688128
    buffer_load_dwordx4 v18, s[36:39], s47 offen lds
    s_mov_b32 m0, 44032
    s_mov_b32 s47, 704512
    buffer_load_dwordx4 v19, s[36:39], s47 offen lds
    s_mov_b32 m0, 45056
    s_mov_b32 s47, 720896
    buffer_load_dwordx4 v18, s[36:39], s47 offen lds
    s_mov_b32 m0, 46080
    s_mov_b32 s47, 737280
    buffer_load_dwordx4 v19, s[36:39], s47 offen lds
    s_mov_b32 m0, 47104
    s_mov_b32 s47, 753664
    buffer_load_dwordx4 v18, s[36:39], s47 offen lds
    s_mov_b32 m0, 48128
    s_mov_b32 s47, 770048
    buffer_load_dwordx4 v19, s[36:39], s47 offen lds
    s_mov_b32 m0, 49152
    s_mov_b32 s47, 786432
    buffer_load_dwordx4 v18, s[36:39], s47 offen lds
    s_mov_b32 m0, 50176
    s_mov_b32 s47, 802816
    buffer_load_dwordx4 v19, s[36:39], s47 offen lds
    s_mov_b32 m0, 51200
    s_mov_b32 s47, 819200
    buffer_load_dwordx4 v18, s[36:39], s47 offen lds
    s_mov_b32 m0, 52224
    s_mov_b32 s47, 835584
    buffer_load_dwordx4 v19, s[36:39], s47 offen lds
    s_mov_b32 m0, 53248
    s_mov_b32 s47, 851968
    buffer_load_dwordx4 v18, s[36:39], s47 offen lds
    s_mov_b32 m0, 54272
    s_mov_b32 s47, 868352
    buffer_load_dwordx4 v19, s[36:39], s47 offen lds
    s_mov_b32 m0, 55296
    s_mov_b32 s47, 884736
    buffer_load_dwordx4 v18, s[36:39], s47 offen lds
    s_mov_b32 m0, 56320
    s_mov_b32 s47, 901120
    buffer_load_dwordx4 v19, s[36:39], s47 offen lds
    s_mov_b32 m0, 57344
    s_mov_b32 s47, 917504
    buffer_load_dwordx4 v18, s[36:39], s47 offen lds
    s_mov_b32 m0, 58368
    s_mov_b32 s47, 933888
    buffer_load_dwordx4 v19, s[36:39], s47 offen lds
    s_mov_b32 m0, 59392
    s_mov_b32 s47, 950272
    buffer_load_dwordx4 v18, s[36:39], s47 offen lds
    s_mov_b32 m0, 60416
    s_mov_b32 s47, 966656
    buffer_load_dwordx4 v19, s[36:39], s47 offen lds
    s_mov_b32 m0, 61440
    s_mov_b32 s47, 983040
    buffer_load_dwordx4 v18, s[36:39], s47 offen lds
    s_mov_b32 m0, 62464
    s_mov_b32 s47, 999424
    buffer_load_dwordx4 v19, s[36:39], s47 offen lds
    s_mov_b32 m0, 63488
    s_mov_b32 s47, 1015808
    buffer_load_dwordx4 v18, s[36:39], s47 offen lds
    s_mov_b32 m0, 64512
    s_mov_b32 s47, 1032192
    buffer_load_dwordx4 v19, s[36:39], s47 offen lds
    s_waitcnt vmcnt(48)
    s_barrier
    s_waitcnt vmcnt(32)
    s_barrier
    s_waitcnt vmcnt(16)
    s_barrier
    s_mov_b32 m0, 0
    s_mov_b32 s47, 1048576
    buffer_load_dwordx4 v18, s[36:39], s47 offen lds
    s_mov_b32 m0, 1024
    s_mov_b32 s47, 1064960
    buffer_load_dwordx4 v19, s[36:39], s47 offen lds
    s_mov_b32 m0, 2048
    s_mov_b32 s47, 1081344
    buffer_load_dwordx4 v18, s[36:39], s47 offen lds
    s_mov_b32 m0, 3072
    s_mov_b32 s47, 1097728
    buffer_load_dwordx4 v19, s[36:39], s47 offen lds
    s_mov_b32 m0, 4096
    s_mov_b32 s47, 1114112
    buffer_load_dwordx4 v18, s[36:39], s47 offen lds
    s_mov_b32 m0, 5120
    s_mov_b32 s47, 1130496
    buffer_load_dwordx4 v19, s[36:39], s47 offen lds
    s_mov_b32 m0, 6144
    s_mov_b32 s47, 1146880
    buffer_load_dwordx4 v18, s[36:39], s47 offen lds
    s_mov_b32 m0, 7168
    s_mov_b32 s47, 1163264
    buffer_load_dwordx4 v19, s[36:39], s47 offen lds
    s_mov_b32 m0, 8192
    s_mov_b32 s47, 1179648
    buffer_load_dwordx4 v18, s[36:39], s47 offen lds
    s_mov_b32 m0, 9216
    s_mov_b32 s47, 1196032
    buffer_load_dwordx4 v19, s[36:39], s47 offen lds
    s_mov_b32 m0, 10240
    s_mov_b32 s47, 1212416
    buffer_load_dwordx4 v18, s[36:39], s47 offen lds
    s_mov_b32 m0, 11264
    s_mov_b32 s47, 1228800
    buffer_load_dwordx4 v19, s[36:39], s47 offen lds
    s_mov_b32 m0, 12288
    s_mov_b32 s47, 1245184
    buffer_load_dwordx4 v18, s[36:39], s47 offen lds
    s_mov_b32 m0, 13312
    s_mov_b32 s47, 1261568
    buffer_load_dwordx4 v19, s[36:39], s47 offen lds
    s_mov_b32 m0, 14336
    s_mov_b32 s47, 1277952
    buffer_load_dwordx4 v18, s[36:39], s47 offen lds
    s_mov_b32 m0, 15360
    s_mov_b32 s47, 1294336
    buffer_load_dwordx4 v19, s[36:39], s47 offen lds
    s_waitcnt vmcnt(16)
    s_barrier
    s_mov_b32 m0, 16384
    s_mov_b32 s47, 1310720
    buffer_load_dwordx4 v18, s[36:39], s47 offen lds
    s_mov_b32 m0, 17408
    s_mov_b32 s47, 1327104
    buffer_load_dwordx4 v19, s[36:39], s47 offen lds
    s_mov_b32 m0, 18432
    s_mov_b32 s47, 1343488
    buffer_load_dwordx4 v18, s[36:39], s47 offen lds
    s_mov_b32 m0, 19456
    s_mov_b32 s47, 1359872
    buffer_load_dwordx4 v19, s[36:39], s47 offen lds
    s_mov_b32 m0, 20480
    s_mov_b32 s47, 1376256
    buffer_load_dwordx4 v18, s[36:39], s47 offen lds
    s_mov_b32 m0, 21504
    s_mov_b32 s47, 1392640
    buffer_load_dwordx4 v19, s[36:39], s47 offen lds
    s_mov_b32 m0, 22528
    s_mov_b32 s47, 1409024
    buffer_load_dwordx4 v18, s[36:39], s47 offen lds
    s_mov_b32 m0, 23552
    s_mov_b32 s47, 1425408
    buffer_load_dwordx4 v19, s[36:39], s47 offen lds
    s_mov_b32 m0, 24576
    s_mov_b32 s47, 1441792
    buffer_load_dwordx4 v18, s[36:39], s47 offen lds
    s_mov_b32 m0, 25600
    s_mov_b32 s47, 1458176
    buffer_load_dwordx4 v19, s[36:39], s47 offen lds
    s_mov_b32 m0, 26624
    s_mov_b32 s47, 1474560
    buffer_load_dwordx4 v18, s[36:39], s47 offen lds
    s_mov_b32 m0, 27648
    s_mov_b32 s47, 1490944
    buffer_load_dwordx4 v19, s[36:39], s47 offen lds
    s_mov_b32 m0, 28672
    s_mov_b32 s47, 1507328
    buffer_load_dwordx4 v18, s[36:39], s47 offen lds
    s_mov_b32 m0, 29696
    s_mov_b32 s47, 1523712
    buffer_load_dwordx4 v19, s[36:39], s47 offen lds
    s_mov_b32 m0, 30720
    s_mov_b32 s47, 1540096
    buffer_load_dwordx4 v18, s[36:39], s47 offen lds
    s_mov_b32 m0, 31744
    s_mov_b32 s47, 1556480
    buffer_load_dwordx4 v19, s[36:39], s47 offen lds
    s_waitcnt vmcnt(16)
    s_barrier
    s_mov_b32 m0, 32768
    s_mov_b32 s47, 1572864
    buffer_load_dwordx4 v18, s[36:39], s47 offen lds
    s_mov_b32 m0, 33792
    s_mov_b32 s47, 1589248
    buffer_load_dwordx4 v19, s[36:39], s47 offen lds
    s_mov_b32 m0, 34816
    s_mov_b32 s47, 1605632
    buffer_load_dwordx4 v18, s[36:39], s47 offen lds
    s_mov_b32 m0, 35840
    s_mov_b32 s47, 1622016
    buffer_load_dwordx4 v19, s[36:39], s47 offen lds
    s_mov_b32 m0, 36864
    s_mov_b32 s47, 1638400
    buffer_load_dwordx4 v18, s[36:39], s47 offen lds
    s_mov_b32 m0, 37888
    s_mov_b32 s47, 1654784
    buffer_load_dwordx4 v19, s[36:39], s47 offen lds
    s_mov_b32 m0, 38912
    s_mov_b32 s47, 1671168
    buffer_load_dwordx4 v18, s[36:39], s47 offen lds
    s_mov_b32 m0, 39936
    s_mov_b32 s47, 1687552
    buffer_load_dwordx4 v19, s[36:39], s47 offen lds
    s_mov_b32 m0, 40960
    s_mov_b32 s47, 1703936
    buffer_load_dwordx4 v18, s[36:39], s47 offen lds
    s_mov_b32 m0, 41984
    s_mov_b32 s47, 1720320
    buffer_load_dwordx4 v19, s[36:39], s47 offen lds
    s_mov_b32 m0, 43008
    s_mov_b32 s47, 1736704
    buffer_load_dwordx4 v18, s[36:39], s47 offen lds
    s_mov_b32 m0, 44032
    s_mov_b32 s47, 1753088
    buffer_load_dwordx4 v19, s[36:39], s47 offen lds
    s_mov_b32 m0, 45056
    s_mov_b32 s47, 1769472
    buffer_load_dwordx4 v18, s[36:39], s47 offen lds
    s_mov_b32 m0, 46080
    s_mov_b32 s47, 1785856
    buffer_load_dwordx4 v19, s[36:39], s47 offen lds
    s_mov_b32 m0, 47104
    s_mov_b32 s47, 1802240
    buffer_load_dwordx4 v18, s[36:39], s47 offen lds
    s_mov_b32 m0, 48128
    s_mov_b32 s47, 1818624
    buffer_load_dwordx4 v19, s[36:39], s47 offen lds
    s_waitcnt vmcnt(16)
    s_barrier
    s_mov_b32 m0, 49152
    s_mov_b32 s47, 1835008
    buffer_load_dwordx4 v18, s[36:39], s47 offen lds
    s_mov_b32 m0, 50176
    s_mov_b32 s47, 1851392
    buffer_load_dwordx4 v19, s[36:39], s47 offen lds
    s_mov_b32 m0, 51200
    s_mov_b32 s47, 1867776
    buffer_load_dwordx4 v18, s[36:39], s47 offen lds
    s_mov_b32 m0, 52224
    s_mov_b32 s47, 1884160
    buffer_load_dwordx4 v19, s[36:39], s47 offen lds
    s_mov_b32 m0, 53248
    s_mov_b32 s47, 1900544
    buffer_load_dwordx4 v18, s[36:39], s47 offen lds
    s_mov_b32 m0, 54272
    s_mov_b32 s47, 1916928
    buffer_load_dwordx4 v19, s[36:39], s47 offen lds
    s_mov_b32 m0, 55296
    s_mov_b32 s47, 1933312
    buffer_load_dwordx4 v18, s[36:39], s47 offen lds
    s_mov_b32 m0, 56320
    s_mov_b32 s47, 1949696
    buffer_load_dwordx4 v19, s[36:39], s47 offen lds
    s_mov_b32 m0, 57344
    s_mov_b32 s47, 1966080
    buffer_load_dwordx4 v18, s[36:39], s47 offen lds
    s_mov_b32 m0, 58368
    s_mov_b32 s47, 1982464
    buffer_load_dwordx4 v19, s[36:39], s47 offen lds
    s_mov_b32 m0, 59392
    s_mov_b32 s47, 1998848
    buffer_load_dwordx4 v18, s[36:39], s47 offen lds
    s_mov_b32 m0, 60416
    s_mov_b32 s47, 2015232
    buffer_load_dwordx4 v19, s[36:39], s47 offen lds
    s_mov_b32 m0, 61440
    s_mov_b32 s47, 2031616
    buffer_load_dwordx4 v18, s[36:39], s47 offen lds
    s_mov_b32 m0, 62464
    s_mov_b32 s47, 2048000
    buffer_load_dwordx4 v19, s[36:39], s47 offen lds
    s_mov_b32 m0, 63488
    s_mov_b32 s47, 2064384
    buffer_load_dwordx4 v18, s[36:39], s47 offen lds
    s_mov_b32 m0, 64512
    s_mov_b32 s47, 2080768
    buffer_load_dwordx4 v19, s[36:39], s47 offen lds
    s_waitcnt vmcnt(16)
    s_barrier
    s_mov_b32 m0, 0
    s_mov_b32 s47, 2097152
    buffer_load_dwordx4 v18, s[36:39], s47 offen lds
    s_mov_b32 m0, 1024
    s_mov_b32 s47, 2113536
    buffer_load_dwordx4 v19, s[36:39], s47 offen lds
    s_mov_b32 m0, 2048
    s_mov_b32 s47, 2129920
    buffer_load_dwordx4 v18, s[36:39], s47 offen lds
    s_mov_b32 m0, 3072
    s_mov_b32 s47, 2146304
    buffer_load_dwordx4 v19, s[36:39], s47 offen lds
    s_mov_b32 m0, 4096
    s_mov_b32 s47, 2162688
    buffer_load_dwordx4 v18, s[36:39], s47 offen lds
    s_mov_b32 m0, 5120
    s_mov_b32 s47, 2179072
    buffer_load_dwordx4 v19, s[36:39], s47 offen lds
    s_mov_b32 m0, 6144
    s_mov_b32 s47, 2195456
    buffer_load_dwordx4 v18, s[36:39], s47 offen lds
    s_mov_b32 m0, 7168
    s_mov_b32 s47, 2211840
    buffer_load_dwordx4 v19, s[36:39], s47 offen lds
    s_mov_b32 m0, 8192
    s_mov_b32 s47, 2228224
    buffer_load_dwordx4 v18, s[36:39], s47 offen lds
    s_mov_b32 m0, 9216
    s_mov_b32 s47, 2244608
    buffer_load_dwordx4 v19, s[36:39], s47 offen lds
    s_mov_b32 m0, 10240
    s_mov_b32 s47, 2260992
    buffer_load_dwordx4 v18, s[36:39], s47 offen lds
    s_mov_b32 m0, 11264
    s_mov_b32 s47, 2277376
    buffer_load_dwordx4 v19, s[36:39], s47 offen lds
    s_mov_b32 m0, 12288
    s_mov_b32 s47, 2293760
    buffer_load_dwordx4 v18, s[36:39], s47 offen lds
    s_mov_b32 m0, 13312
    s_mov_b32 s47, 2310144
    buffer_load_dwordx4 v19, s[36:39], s47 offen lds
    s_mov_b32 m0, 14336
    s_mov_b32 s47, 2326528
    buffer_load_dwordx4 v18, s[36:39], s47 offen lds
    s_mov_b32 m0, 15360
    s_mov_b32 s47, 2342912
    buffer_load_dwordx4 v19, s[36:39], s47 offen lds
    s_waitcnt vmcnt(16)
    s_barrier
    s_mov_b32 m0, 16384
    s_mov_b32 s47, 2359296
    buffer_load_dwordx4 v18, s[36:39], s47 offen lds
    s_mov_b32 m0, 17408
    s_mov_b32 s47, 2375680
    buffer_load_dwordx4 v19, s[36:39], s47 offen lds
    s_mov_b32 m0, 18432
    s_mov_b32 s47, 2392064
    buffer_load_dwordx4 v18, s[36:39], s47 offen lds
    s_mov_b32 m0, 19456
    s_mov_b32 s47, 2408448
    buffer_load_dwordx4 v19, s[36:39], s47 offen lds
    s_mov_b32 m0, 20480
    s_mov_b32 s47, 2424832
    buffer_load_dwordx4 v18, s[36:39], s47 offen lds
    s_mov_b32 m0, 21504
    s_mov_b32 s47, 2441216
    buffer_load_dwordx4 v19, s[36:39], s47 offen lds
    s_mov_b32 m0, 22528
    s_mov_b32 s47, 2457600
    buffer_load_dwordx4 v18, s[36:39], s47 offen lds
    s_mov_b32 m0, 23552
    s_mov_b32 s47, 2473984
    buffer_load_dwordx4 v19, s[36:39], s47 offen lds
    s_mov_b32 m0, 24576
    s_mov_b32 s47, 2490368
    buffer_load_dwordx4 v18, s[36:39], s47 offen lds
    s_mov_b32 m0, 25600
    s_mov_b32 s47, 2506752
    buffer_load_dwordx4 v19, s[36:39], s47 offen lds
    s_mov_b32 m0, 26624
    s_mov_b32 s47, 2523136
    buffer_load_dwordx4 v18, s[36:39], s47 offen lds
    s_mov_b32 m0, 27648
    s_mov_b32 s47, 2539520
    buffer_load_dwordx4 v19, s[36:39], s47 offen lds
    s_mov_b32 m0, 28672
    s_mov_b32 s47, 2555904
    buffer_load_dwordx4 v18, s[36:39], s47 offen lds
    s_mov_b32 m0, 29696
    s_mov_b32 s47, 2572288
    buffer_load_dwordx4 v19, s[36:39], s47 offen lds
    s_mov_b32 m0, 30720
    s_mov_b32 s47, 2588672
    buffer_load_dwordx4 v18, s[36:39], s47 offen lds
    s_mov_b32 m0, 31744
    s_mov_b32 s47, 2605056
    buffer_load_dwordx4 v19, s[36:39], s47 offen lds
    s_waitcnt vmcnt(16)
    s_barrier
    s_mov_b32 m0, 32768
    s_mov_b32 s47, 2621440
    buffer_load_dwordx4 v18, s[36:39], s47 offen lds
    s_mov_b32 m0, 33792
    s_mov_b32 s47, 2637824
    buffer_load_dwordx4 v19, s[36:39], s47 offen lds
    s_mov_b32 m0, 34816
    s_mov_b32 s47, 2654208
    buffer_load_dwordx4 v18, s[36:39], s47 offen lds
    s_mov_b32 m0, 35840
    s_mov_b32 s47, 2670592
    buffer_load_dwordx4 v19, s[36:39], s47 offen lds
    s_mov_b32 m0, 36864
    s_mov_b32 s47, 2686976
    buffer_load_dwordx4 v18, s[36:39], s47 offen lds
    s_mov_b32 m0, 37888
    s_mov_b32 s47, 2703360
    buffer_load_dwordx4 v19, s[36:39], s47 offen lds
    s_mov_b32 m0, 38912
    s_mov_b32 s47, 2719744
    buffer_load_dwordx4 v18, s[36:39], s47 offen lds
    s_mov_b32 m0, 39936
    s_mov_b32 s47, 2736128
    buffer_load_dwordx4 v19, s[36:39], s47 offen lds
    s_mov_b32 m0, 40960
    s_mov_b32 s47, 2752512
    buffer_load_dwordx4 v18, s[36:39], s47 offen lds
    s_mov_b32 m0, 41984
    s_mov_b32 s47, 2768896
    buffer_load_dwordx4 v19, s[36:39], s47 offen lds
    s_mov_b32 m0, 43008
    s_mov_b32 s47, 2785280
    buffer_load_dwordx4 v18, s[36:39], s47 offen lds
    s_mov_b32 m0, 44032
    s_mov_b32 s47, 2801664
    buffer_load_dwordx4 v19, s[36:39], s47 offen lds
    s_mov_b32 m0, 45056
    s_mov_b32 s47, 2818048
    buffer_load_dwordx4 v18, s[36:39], s47 offen lds
    s_mov_b32 m0, 46080
    s_mov_b32 s47, 2834432
    buffer_load_dwordx4 v19, s[36:39], s47 offen lds
    s_mov_b32 m0, 47104
    s_mov_b32 s47, 2850816
    buffer_load_dwordx4 v18, s[36:39], s47 offen lds
    s_mov_b32 m0, 48128
    s_mov_b32 s47, 2867200
    buffer_load_dwordx4 v19, s[36:39], s47 offen lds
    s_waitcnt vmcnt(16)
    s_barrier
    s_mov_b32 m0, 49152
    s_mov_b32 s47, 2883584
    buffer_load_dwordx4 v18, s[36:39], s47 offen lds
    s_mov_b32 m0, 50176
    s_mov_b32 s47, 2899968
    buffer_load_dwordx4 v19, s[36:39], s47 offen lds
    s_mov_b32 m0, 51200
    s_mov_b32 s47, 2916352
    buffer_load_dwordx4 v18, s[36:39], s47 offen lds
    s_mov_b32 m0, 52224
    s_mov_b32 s47, 2932736
    buffer_load_dwordx4 v19, s[36:39], s47 offen lds
    s_mov_b32 m0, 53248
    s_mov_b32 s47, 2949120
    buffer_load_dwordx4 v18, s[36:39], s47 offen lds
    s_mov_b32 m0, 54272
    s_mov_b32 s47, 2965504
    buffer_load_dwordx4 v19, s[36:39], s47 offen lds
    s_mov_b32 m0, 55296
    s_mov_b32 s47, 2981888
    buffer_load_dwordx4 v18, s[36:39], s47 offen lds
    s_mov_b32 m0, 56320
    s_mov_b32 s47, 2998272
    buffer_load_dwordx4 v19, s[36:39], s47 offen lds
    s_mov_b32 m0, 57344
    s_mov_b32 s47, 3014656
    buffer_load_dwordx4 v18, s[36:39], s47 offen lds
    s_mov_b32 m0, 58368
    s_mov_b32 s47, 3031040
    buffer_load_dwordx4 v19, s[36:39], s47 offen lds
    s_mov_b32 m0, 59392
    s_mov_b32 s47, 3047424
    buffer_load_dwordx4 v18, s[36:39], s47 offen lds
    s_mov_b32 m0, 60416
    s_mov_b32 s47, 3063808
    buffer_load_dwordx4 v19, s[36:39], s47 offen lds
    s_mov_b32 m0, 61440
    s_mov_b32 s47, 3080192
    buffer_load_dwordx4 v18, s[36:39], s47 offen lds
    s_mov_b32 m0, 62464
    s_mov_b32 s47, 3096576
    buffer_load_dwordx4 v19, s[36:39], s47 offen lds
    s_mov_b32 m0, 63488
    s_mov_b32 s47, 3112960
    buffer_load_dwordx4 v18, s[36:39], s47 offen lds
    s_mov_b32 m0, 64512
    s_mov_b32 s47, 3129344
    buffer_load_dwordx4 v19, s[36:39], s47 offen lds
    s_waitcnt vmcnt(16)
    s_barrier
    s_mov_b32 m0, 0
    s_mov_b32 s47, 3145728
    buffer_load_dwordx4 v18, s[36:39], s47 offen lds
    s_mov_b32 m0, 1024
    s_mov_b32 s47, 3162112
    buffer_load_dwordx4 v19, s[36:39], s47 offen lds
    s_mov_b32 m0, 2048
    s_mov_b32 s47, 3178496
    buffer_load_dwordx4 v18, s[36:39], s47 offen lds
    s_mov_b32 m0, 3072
    s_mov_b32 s47, 3194880
    buffer_load_dwordx4 v19, s[36:39], s47 offen lds
    s_mov_b32 m0, 4096
    s_mov_b32 s47, 3211264
    buffer_load_dwordx4 v18, s[36:39], s47 offen lds
    s_mov_b32 m0, 5120
    s_mov_b32 s47, 3227648
    buffer_load_dwordx4 v19, s[36:39], s47 offen lds
    s_mov_b32 m0, 6144
    s_mov_b32 s47, 3244032
    buffer_load_dwordx4 v18, s[36:39], s47 offen lds
    s_mov_b32 m0, 7168
    s_mov_b32 s47, 3260416
    buffer_load_dwordx4 v19, s[36:39], s47 offen lds
    s_mov_b32 m0, 8192
    s_mov_b32 s47, 3276800
    buffer_load_dwordx4 v18, s[36:39], s47 offen lds
    s_mov_b32 m0, 9216
    s_mov_b32 s47, 3293184
    buffer_load_dwordx4 v19, s[36:39], s47 offen lds
    s_mov_b32 m0, 10240
    s_mov_b32 s47, 3309568
    buffer_load_dwordx4 v18, s[36:39], s47 offen lds
    s_mov_b32 m0, 11264
    s_mov_b32 s47, 3325952
    buffer_load_dwordx4 v19, s[36:39], s47 offen lds
    s_mov_b32 m0, 12288
    s_mov_b32 s47, 3342336
    buffer_load_dwordx4 v18, s[36:39], s47 offen lds
    s_mov_b32 m0, 13312
    s_mov_b32 s47, 3358720
    buffer_load_dwordx4 v19, s[36:39], s47 offen lds
    s_mov_b32 m0, 14336
    s_mov_b32 s47, 3375104
    buffer_load_dwordx4 v18, s[36:39], s47 offen lds
    s_mov_b32 m0, 15360
    s_mov_b32 s47, 3391488
    buffer_load_dwordx4 v19, s[36:39], s47 offen lds
    s_waitcnt vmcnt(16)
    s_barrier
    s_mov_b32 m0, 16384
    s_mov_b32 s47, 3407872
    buffer_load_dwordx4 v18, s[36:39], s47 offen lds
    s_mov_b32 m0, 17408
    s_mov_b32 s47, 3424256
    buffer_load_dwordx4 v19, s[36:39], s47 offen lds
    s_mov_b32 m0, 18432
    s_mov_b32 s47, 3440640
    buffer_load_dwordx4 v18, s[36:39], s47 offen lds
    s_mov_b32 m0, 19456
    s_mov_b32 s47, 3457024
    buffer_load_dwordx4 v19, s[36:39], s47 offen lds
    s_mov_b32 m0, 20480
    s_mov_b32 s47, 3473408
    buffer_load_dwordx4 v18, s[36:39], s47 offen lds
    s_mov_b32 m0, 21504
    s_mov_b32 s47, 3489792
    buffer_load_dwordx4 v19, s[36:39], s47 offen lds
    s_mov_b32 m0, 22528
    s_mov_b32 s47, 3506176
    buffer_load_dwordx4 v18, s[36:39], s47 offen lds
    s_mov_b32 m0, 23552
    s_mov_b32 s47, 3522560
    buffer_load_dwordx4 v19, s[36:39], s47 offen lds
    s_mov_b32 m0, 24576
    s_mov_b32 s47, 3538944
    buffer_load_dwordx4 v18, s[36:39], s47 offen lds
    s_mov_b32 m0, 25600
    s_mov_b32 s47, 3555328
    buffer_load_dwordx4 v19, s[36:39], s47 offen lds
    s_mov_b32 m0, 26624
    s_mov_b32 s47, 3571712
    buffer_load_dwordx4 v18, s[36:39], s47 offen lds
    s_mov_b32 m0, 27648
    s_mov_b32 s47, 3588096
    buffer_load_dwordx4 v19, s[36:39], s47 offen lds
    s_mov_b32 m0, 28672
    s_mov_b32 s47, 3604480
    buffer_load_dwordx4 v18, s[36:39], s47 offen lds
    s_mov_b32 m0, 29696
    s_mov_b32 s47, 3620864
    buffer_load_dwordx4 v19, s[36:39], s47 offen lds
    s_mov_b32 m0, 30720
    s_mov_b32 s47, 3637248
    buffer_load_dwordx4 v18, s[36:39], s47 offen lds
    s_mov_b32 m0, 31744
    s_mov_b32 s47, 3653632
    buffer_load_dwordx4 v19, s[36:39], s47 offen lds
    s_waitcnt vmcnt(16)
    s_barrier
    s_mov_b32 m0, 32768
    s_add_u32 s49, s48, 6
    s_and_b32 s49, s49, 15
    s_lshl_b32 s49, s49, 14
    s_add_u32 s47, s49, 0
    buffer_load_dwordx4 v8, s[28:31], s47 offen nt lds
    s_mov_b32 m0, 33792
    s_add_u32 s47, s49, 1024
    buffer_load_dwordx4 v9, s[28:31], s47 offen nt lds
    s_mov_b32 m0, 34816
    s_add_u32 s47, s49, 2048
    buffer_load_dwordx4 v8, s[28:31], s47 offen nt lds
    s_mov_b32 m0, 35840
    s_add_u32 s47, s49, 3072
    buffer_load_dwordx4 v9, s[28:31], s47 offen nt lds
    s_mov_b32 m0, 36864
    s_add_u32 s47, s49, 4096
    buffer_load_dwordx4 v10, s[28:31], s47 offen nt lds
    s_mov_b32 m0, 37888
    s_add_u32 s47, s49, 5120
    buffer_load_dwordx4 v11, s[28:31], s47 offen nt lds
    s_mov_b32 m0, 38912
    s_add_u32 s47, s49, 6144
    buffer_load_dwordx4 v10, s[28:31], s47 offen nt lds
    s_mov_b32 m0, 39936
    s_add_u32 s47, s49, 7168
    buffer_load_dwordx4 v11, s[28:31], s47 offen nt lds
    s_mov_b32 m0, 40960
    s_add_u32 s47, s49, 8192
    buffer_load_dwordx4 v12, s[28:31], s47 offen nt lds
    s_mov_b32 m0, 41984
    s_add_u32 s47, s49, 9216
    buffer_load_dwordx4 v13, s[28:31], s47 offen nt lds
    s_mov_b32 m0, 43008
    s_add_u32 s47, s49, 10240
    buffer_load_dwordx4 v12, s[28:31], s47 offen nt lds
    s_mov_b32 m0, 44032
    s_add_u32 s47, s49, 11264
    buffer_load_dwordx4 v13, s[28:31], s47 offen nt lds
    s_mov_b32 m0, 45056
    s_add_u32 s47, s49, 12288
    buffer_load_dwordx4 v14, s[28:31], s47 offen nt lds
    s_mov_b32 m0, 46080
    s_add_u32 s47, s49, 13312
    buffer_load_dwordx4 v15, s[28:31], s47 offen nt lds
    s_mov_b32 m0, 47104
    s_add_u32 s47, s49, 14336
    buffer_load_dwordx4 v14, s[28:31], s47 offen nt lds
    s_mov_b32 m0, 48128
    s_add_u32 s47, s49, 15360
    buffer_load_dwordx4 v15, s[28:31], s47 offen nt lds
    s_waitcnt vmcnt(16)
    s_barrier
    s_mov_b32 m0, 49152
    s_add_u32 s49, s48, 7
    s_and_b32 s49, s49, 15
    s_lshl_b32 s49, s49, 14
    s_add_u32 s47, s49, 0
    buffer_load_dwordx4 v8, s[28:31], s47 offen nt lds
    s_mov_b32 m0, 50176
    s_add_u32 s47, s49, 1024
    buffer_load_dwordx4 v9, s[28:31], s47 offen nt lds
    s_mov_b32 m0, 51200
    s_add_u32 s47, s49, 2048
    buffer_load_dwordx4 v8, s[28:31], s47 offen nt lds
    s_mov_b32 m0, 52224
    s_add_u32 s47, s49, 3072
    buffer_load_dwordx4 v9, s[28:31], s47 offen nt lds
    s_mov_b32 m0, 53248
    s_add_u32 s47, s49, 4096
    buffer_load_dwordx4 v10, s[28:31], s47 offen nt lds
    s_mov_b32 m0, 54272
    s_add_u32 s47, s49, 5120
    buffer_load_dwordx4 v11, s[28:31], s47 offen nt lds
    s_mov_b32 m0, 55296
    s_add_u32 s47, s49, 6144
    buffer_load_dwordx4 v10, s[28:31], s47 offen nt lds
    s_mov_b32 m0, 56320
    s_add_u32 s47, s49, 7168
    buffer_load_dwordx4 v11, s[28:31], s47 offen nt lds
    s_mov_b32 m0, 57344
    s_add_u32 s47, s49, 8192
    buffer_load_dwordx4 v12, s[28:31], s47 offen nt lds
    s_mov_b32 m0, 58368
    s_add_u32 s47, s49, 9216
    buffer_load_dwordx4 v13, s[28:31], s47 offen nt lds
    s_mov_b32 m0, 59392
    s_add_u32 s47, s49, 10240
    buffer_load_dwordx4 v12, s[28:31], s47 offen nt lds
    s_mov_b32 m0, 60416
    s_add_u32 s47, s49, 11264
    buffer_load_dwordx4 v13, s[28:31], s47 offen nt lds
    s_mov_b32 m0, 61440
    s_add_u32 s47, s49, 12288
    buffer_load_dwordx4 v14, s[28:31], s47 offen nt lds
    s_mov_b32 m0, 62464
    s_add_u32 s47, s49, 13312
    buffer_load_dwordx4 v15, s[28:31], s47 offen nt lds
    s_mov_b32 m0, 63488
    s_add_u32 s47, s49, 14336
    buffer_load_dwordx4 v14, s[28:31], s47 offen nt lds
    s_mov_b32 m0, 64512
    s_add_u32 s47, s49, 15360
    buffer_load_dwordx4 v15, s[28:31], s47 offen nt lds
    s_barrier
    s_mov_b32 m0, 0
    s_add_u32 s49, s48, 8
    s_and_b32 s49, s49, 15
    s_lshl_b32 s49, s49, 14
    s_add_u32 s47, s49, 0
    buffer_load_dwordx4 v8, s[28:31], s47 offen nt lds
    s_mov_b32 m0, 1024
    s_add_u32 s47, s49, 1024
    buffer_load_dwordx4 v9, s[28:31], s47 offen nt lds
    s_mov_b32 m0, 2048
    s_add_u32 s47, s49, 2048
    buffer_load_dwordx4 v8, s[28:31], s47 offen nt lds
    s_mov_b32 m0, 3072
    s_add_u32 s47, s49, 3072
    buffer_load_dwordx4 v9, s[28:31], s47 offen nt lds
    s_mov_b32 m0, 4096
    s_add_u32 s47, s49, 4096
    buffer_load_dwordx4 v10, s[28:31], s47 offen nt lds
    s_mov_b32 m0, 5120
    s_add_u32 s47, s49, 5120
    buffer_load_dwordx4 v11, s[28:31], s47 offen nt lds
    s_mov_b32 m0, 6144
    s_add_u32 s47, s49, 6144
    buffer_load_dwordx4 v10, s[28:31], s47 offen nt lds
    s_mov_b32 m0, 7168
    s_add_u32 s47, s49, 7168
    buffer_load_dwordx4 v11, s[28:31], s47 offen nt lds
    s_mov_b32 m0, 8192
    s_add_u32 s47, s49, 8192
    buffer_load_dwordx4 v12, s[28:31], s47 offen nt lds
    s_mov_b32 m0, 9216
    s_add_u32 s47, s49, 9216
    buffer_load_dwordx4 v13, s[28:31], s47 offen nt lds
    s_mov_b32 m0, 10240
    s_add_u32 s47, s49, 10240
    buffer_load_dwordx4 v12, s[28:31], s47 offen nt lds
    s_mov_b32 m0, 11264
    s_add_u32 s47, s49, 11264
    buffer_load_dwordx4 v13, s[28:31], s47 offen nt lds
    s_mov_b32 m0, 12288
    s_add_u32 s47, s49, 12288
    buffer_load_dwordx4 v14, s[28:31], s47 offen nt lds
    s_mov_b32 m0, 13312
    s_add_u32 s47, s49, 13312
    buffer_load_dwordx4 v15, s[28:31], s47 offen nt lds
    s_mov_b32 m0, 14336
    s_add_u32 s47, s49, 14336
    buffer_load_dwordx4 v14, s[28:31], s47 offen nt lds
    s_mov_b32 m0, 15360
    s_add_u32 s47, s49, 15360
    buffer_load_dwordx4 v15, s[28:31], s47 offen nt lds
    s_barrier
    s_mov_b32 m0, 16384
    s_add_u32 s49, s48, 9
    s_and_b32 s49, s49, 15
    s_lshl_b32 s49, s49, 14
    s_add_u32 s47, s49, 0
    buffer_load_dwordx4 v8, s[28:31], s47 offen nt lds
    s_mov_b32 m0, 17408
    s_add_u32 s47, s49, 1024
    buffer_load_dwordx4 v9, s[28:31], s47 offen nt lds
    s_mov_b32 m0, 18432
    s_add_u32 s47, s49, 2048
    buffer_load_dwordx4 v8, s[28:31], s47 offen nt lds
    s_mov_b32 m0, 19456
    s_add_u32 s47, s49, 3072
    buffer_load_dwordx4 v9, s[28:31], s47 offen nt lds
    s_mov_b32 m0, 20480
    s_add_u32 s47, s49, 4096
    buffer_load_dwordx4 v10, s[28:31], s47 offen nt lds
    s_mov_b32 m0, 21504
    s_add_u32 s47, s49, 5120
    buffer_load_dwordx4 v11, s[28:31], s47 offen nt lds
    s_mov_b32 m0, 22528
    s_add_u32 s47, s49, 6144
    buffer_load_dwordx4 v10, s[28:31], s47 offen nt lds
    s_mov_b32 m0, 23552
    s_add_u32 s47, s49, 7168
    buffer_load_dwordx4 v11, s[28:31], s47 offen nt lds
    s_mov_b32 m0, 24576
    s_add_u32 s47, s49, 8192
    buffer_load_dwordx4 v12, s[28:31], s47 offen nt lds
    s_mov_b32 m0, 25600
    s_add_u32 s47, s49, 9216
    buffer_load_dwordx4 v13, s[28:31], s47 offen nt lds
    s_mov_b32 m0, 26624
    s_add_u32 s47, s49, 10240
    buffer_load_dwordx4 v12, s[28:31], s47 offen nt lds
    s_mov_b32 m0, 27648
    s_add_u32 s47, s49, 11264
    buffer_load_dwordx4 v13, s[28:31], s47 offen nt lds
    s_mov_b32 m0, 28672
    s_add_u32 s47, s49, 12288
    buffer_load_dwordx4 v14, s[28:31], s47 offen nt lds
    s_mov_b32 m0, 29696
    s_add_u32 s47, s49, 13312
    buffer_load_dwordx4 v15, s[28:31], s47 offen nt lds
    s_mov_b32 m0, 30720
    s_add_u32 s47, s49, 14336
    buffer_load_dwordx4 v14, s[28:31], s47 offen nt lds
    s_mov_b32 m0, 31744
    s_add_u32 s47, s49, 15360
    buffer_load_dwordx4 v15, s[28:31], s47 offen nt lds
    s_barrier
    s_barrier
    s_barrier
    s_barrier
    s_waitcnt vmcnt(48)
    s_barrier
    s_mov_b32 m0, 65536
    s_add_u32 s49, s48, 10
    s_and_b32 s49, s49, 15
    s_lshl_b32 s49, s49, 14
    s_add_u32 s47, s49, 0
    buffer_load_dwordx4 v8, s[28:31], s47 offen nt lds
    s_mov_b32 m0, 66560
    s_add_u32 s47, s49, 1024
    buffer_load_dwordx4 v9, s[28:31], s47 offen nt lds
    s_mov_b32 m0, 67584
    s_add_u32 s47, s49, 2048
    buffer_load_dwordx4 v8, s[28:31], s47 offen nt lds
    s_mov_b32 m0, 68608
    s_add_u32 s47, s49, 3072
    buffer_load_dwordx4 v9, s[28:31], s47 offen nt lds
    s_mov_b32 m0, 69632
    s_add_u32 s47, s49, 4096
    buffer_load_dwordx4 v10, s[28:31], s47 offen nt lds
    s_mov_b32 m0, 70656
    s_add_u32 s47, s49, 5120
    buffer_load_dwordx4 v11, s[28:31], s47 offen nt lds
    s_mov_b32 m0, 71680
    s_add_u32 s47, s49, 6144
    buffer_load_dwordx4 v10, s[28:31], s47 offen nt lds
    s_mov_b32 m0, 72704
    s_add_u32 s47, s49, 7168
    buffer_load_dwordx4 v11, s[28:31], s47 offen nt lds
    s_mov_b32 m0, 73728
    s_add_u32 s47, s49, 8192
    buffer_load_dwordx4 v12, s[28:31], s47 offen nt lds
    s_mov_b32 m0, 74752
    s_add_u32 s47, s49, 9216
    buffer_load_dwordx4 v13, s[28:31], s47 offen nt lds
    s_mov_b32 m0, 75776
    s_add_u32 s47, s49, 10240
    buffer_load_dwordx4 v12, s[28:31], s47 offen nt lds
    s_mov_b32 m0, 76800
    s_add_u32 s47, s49, 11264
    buffer_load_dwordx4 v13, s[28:31], s47 offen nt lds
    s_mov_b32 m0, 77824
    s_add_u32 s47, s49, 12288
    buffer_load_dwordx4 v14, s[28:31], s47 offen nt lds
    s_mov_b32 m0, 78848
    s_add_u32 s47, s49, 13312
    buffer_load_dwordx4 v15, s[28:31], s47 offen nt lds
    s_mov_b32 m0, 79872
    s_add_u32 s47, s49, 14336
    buffer_load_dwordx4 v14, s[28:31], s47 offen nt lds
    s_mov_b32 m0, 80896
    s_add_u32 s47, s49, 15360
    buffer_load_dwordx4 v15, s[28:31], s47 offen nt lds
    s_waitcnt vmcnt(48)
    s_barrier
    s_mov_b32 m0, 81920
    s_add_u32 s49, s48, 11
    s_and_b32 s49, s49, 15
    s_lshl_b32 s49, s49, 14
    s_add_u32 s47, s49, 0
    buffer_load_dwordx4 v8, s[28:31], s47 offen nt lds
    s_mov_b32 m0, 82944
    s_add_u32 s47, s49, 1024
    buffer_load_dwordx4 v9, s[28:31], s47 offen nt lds
    s_mov_b32 m0, 83968
    s_add_u32 s47, s49, 2048
    buffer_load_dwordx4 v8, s[28:31], s47 offen nt lds
    s_mov_b32 m0, 84992
    s_add_u32 s47, s49, 3072
    buffer_load_dwordx4 v9, s[28:31], s47 offen nt lds
    s_mov_b32 m0, 86016
    s_add_u32 s47, s49, 4096
    buffer_load_dwordx4 v10, s[28:31], s47 offen nt lds
    s_mov_b32 m0, 87040
    s_add_u32 s47, s49, 5120
    buffer_load_dwordx4 v11, s[28:31], s47 offen nt lds
    s_mov_b32 m0, 88064
    s_add_u32 s47, s49, 6144
    buffer_load_dwordx4 v10, s[28:31], s47 offen nt lds
    s_mov_b32 m0, 89088
    s_add_u32 s47, s49, 7168
    buffer_load_dwordx4 v11, s[28:31], s47 offen nt lds
    s_mov_b32 m0, 90112
    s_add_u32 s47, s49, 8192
    buffer_load_dwordx4 v12, s[28:31], s47 offen nt lds
    s_mov_b32 m0, 91136
    s_add_u32 s47, s49, 9216
    buffer_load_dwordx4 v13, s[28:31], s47 offen nt lds
    s_mov_b32 m0, 92160
    s_add_u32 s47, s49, 10240
    buffer_load_dwordx4 v12, s[28:31], s47 offen nt lds
    s_mov_b32 m0, 93184
    s_add_u32 s47, s49, 11264
    buffer_load_dwordx4 v13, s[28:31], s47 offen nt lds
    s_mov_b32 m0, 94208
    s_add_u32 s47, s49, 12288
    buffer_load_dwordx4 v14, s[28:31], s47 offen nt lds
    s_mov_b32 m0, 95232
    s_add_u32 s47, s49, 13312
    buffer_load_dwordx4 v15, s[28:31], s47 offen nt lds
    s_mov_b32 m0, 96256
    s_add_u32 s47, s49, 14336
    buffer_load_dwordx4 v14, s[28:31], s47 offen nt lds
    s_mov_b32 m0, 97280
    s_add_u32 s47, s49, 15360
    buffer_load_dwordx4 v15, s[28:31], s47 offen nt lds
    s_waitcnt vmcnt(48)
    s_barrier
    s_mov_b32 m0, 98304
    s_add_u32 s49, s48, 12
    s_and_b32 s49, s49, 15
    s_lshl_b32 s49, s49, 14
    s_add_u32 s47, s49, 0
    buffer_load_dwordx4 v8, s[28:31], s47 offen nt lds
    s_mov_b32 m0, 99328
    s_add_u32 s47, s49, 1024
    buffer_load_dwordx4 v9, s[28:31], s47 offen nt lds
    s_mov_b32 m0, 100352
    s_add_u32 s47, s49, 2048
    buffer_load_dwordx4 v8, s[28:31], s47 offen nt lds
    s_mov_b32 m0, 101376
    s_add_u32 s47, s49, 3072
    buffer_load_dwordx4 v9, s[28:31], s47 offen nt lds
    s_mov_b32 m0, 102400
    s_add_u32 s47, s49, 4096
    buffer_load_dwordx4 v10, s[28:31], s47 offen nt lds
    s_mov_b32 m0, 103424
    s_add_u32 s47, s49, 5120
    buffer_load_dwordx4 v11, s[28:31], s47 offen nt lds
    s_mov_b32 m0, 104448
    s_add_u32 s47, s49, 6144
    buffer_load_dwordx4 v10, s[28:31], s47 offen nt lds
    s_mov_b32 m0, 105472
    s_add_u32 s47, s49, 7168
    buffer_load_dwordx4 v11, s[28:31], s47 offen nt lds
    s_mov_b32 m0, 106496
    s_add_u32 s47, s49, 8192
    buffer_load_dwordx4 v12, s[28:31], s47 offen nt lds
    s_mov_b32 m0, 107520
    s_add_u32 s47, s49, 9216
    buffer_load_dwordx4 v13, s[28:31], s47 offen nt lds
    s_mov_b32 m0, 108544
    s_add_u32 s47, s49, 10240
    buffer_load_dwordx4 v12, s[28:31], s47 offen nt lds
    s_mov_b32 m0, 109568
    s_add_u32 s47, s49, 11264
    buffer_load_dwordx4 v13, s[28:31], s47 offen nt lds
    s_mov_b32 m0, 110592
    s_add_u32 s47, s49, 12288
    buffer_load_dwordx4 v14, s[28:31], s47 offen nt lds
    s_mov_b32 m0, 111616
    s_add_u32 s47, s49, 13312
    buffer_load_dwordx4 v15, s[28:31], s47 offen nt lds
    s_mov_b32 m0, 112640
    s_add_u32 s47, s49, 14336
    buffer_load_dwordx4 v14, s[28:31], s47 offen nt lds
    s_mov_b32 m0, 113664
    s_add_u32 s47, s49, 15360
    buffer_load_dwordx4 v15, s[28:31], s47 offen nt lds
    s_waitcnt vmcnt(48)
    s_barrier
    s_mov_b32 m0, 114688
    s_add_u32 s49, s48, 13
    s_and_b32 s49, s49, 15
    s_lshl_b32 s49, s49, 14
    s_add_u32 s47, s49, 0
    buffer_load_dwordx4 v8, s[28:31], s47 offen nt lds
    s_mov_b32 m0, 115712
    s_add_u32 s47, s49, 1024
    buffer_load_dwordx4 v9, s[28:31], s47 offen nt lds
    s_mov_b32 m0, 116736
    s_add_u32 s47, s49, 2048
    buffer_load_dwordx4 v8, s[28:31], s47 offen nt lds
    s_mov_b32 m0, 117760
    s_add_u32 s47, s49, 3072
    buffer_load_dwordx4 v9, s[28:31], s47 offen nt lds
    s_mov_b32 m0, 118784
    s_add_u32 s47, s49, 4096
    buffer_load_dwordx4 v10, s[28:31], s47 offen nt lds
    s_mov_b32 m0, 119808
    s_add_u32 s47, s49, 5120
    buffer_load_dwordx4 v11, s[28:31], s47 offen nt lds
    s_mov_b32 m0, 120832
    s_add_u32 s47, s49, 6144
    buffer_load_dwordx4 v10, s[28:31], s47 offen nt lds
    s_mov_b32 m0, 121856
    s_add_u32 s47, s49, 7168
    buffer_load_dwordx4 v11, s[28:31], s47 offen nt lds
    s_mov_b32 m0, 122880
    s_add_u32 s47, s49, 8192
    buffer_load_dwordx4 v12, s[28:31], s47 offen nt lds
    s_mov_b32 m0, 123904
    s_add_u32 s47, s49, 9216
    buffer_load_dwordx4 v13, s[28:31], s47 offen nt lds
    s_mov_b32 m0, 124928
    s_add_u32 s47, s49, 10240
    buffer_load_dwordx4 v12, s[28:31], s47 offen nt lds
    s_mov_b32 m0, 125952
    s_add_u32 s47, s49, 11264
    buffer_load_dwordx4 v13, s[28:31], s47 offen nt lds
    s_mov_b32 m0, 126976
    s_add_u32 s47, s49, 12288
    buffer_load_dwordx4 v14, s[28:31], s47 offen nt lds
    s_mov_b32 m0, 128000
    s_add_u32 s47, s49, 13312
    buffer_load_dwordx4 v15, s[28:31], s47 offen nt lds
    s_mov_b32 m0, 129024
    s_add_u32 s47, s49, 14336
    buffer_load_dwordx4 v14, s[28:31], s47 offen nt lds
    s_mov_b32 m0, 130048
    s_add_u32 s47, s49, 15360
    buffer_load_dwordx4 v15, s[28:31], s47 offen nt lds
    s_waitcnt vmcnt(48)
    s_barrier
    s_mov_b32 m0, 131072
    s_add_u32 s49, s48, 14
    s_and_b32 s49, s49, 15
    s_lshl_b32 s49, s49, 14
    s_add_u32 s47, s49, 0
    buffer_load_dwordx4 v8, s[28:31], s47 offen nt lds
    s_mov_b32 m0, 132096
    s_add_u32 s47, s49, 1024
    buffer_load_dwordx4 v9, s[28:31], s47 offen nt lds
    s_mov_b32 m0, 133120
    s_add_u32 s47, s49, 2048
    buffer_load_dwordx4 v8, s[28:31], s47 offen nt lds
    s_mov_b32 m0, 134144
    s_add_u32 s47, s49, 3072
    buffer_load_dwordx4 v9, s[28:31], s47 offen nt lds
    s_mov_b32 m0, 135168
    s_add_u32 s47, s49, 4096
    buffer_load_dwordx4 v10, s[28:31], s47 offen nt lds
    s_mov_b32 m0, 136192
    s_add_u32 s47, s49, 5120
    buffer_load_dwordx4 v11, s[28:31], s47 offen nt lds
    s_mov_b32 m0, 137216
    s_add_u32 s47, s49, 6144
    buffer_load_dwordx4 v10, s[28:31], s47 offen nt lds
    s_mov_b32 m0, 138240
    s_add_u32 s47, s49, 7168
    buffer_load_dwordx4 v11, s[28:31], s47 offen nt lds
    s_mov_b32 m0, 139264
    s_add_u32 s47, s49, 8192
    buffer_load_dwordx4 v12, s[28:31], s47 offen nt lds
    s_mov_b32 m0, 140288
    s_add_u32 s47, s49, 9216
    buffer_load_dwordx4 v13, s[28:31], s47 offen nt lds
    s_mov_b32 m0, 141312
    s_add_u32 s47, s49, 10240
    buffer_load_dwordx4 v12, s[28:31], s47 offen nt lds
    s_mov_b32 m0, 142336
    s_add_u32 s47, s49, 11264
    buffer_load_dwordx4 v13, s[28:31], s47 offen nt lds
    s_mov_b32 m0, 143360
    s_add_u32 s47, s49, 12288
    buffer_load_dwordx4 v14, s[28:31], s47 offen nt lds
    s_mov_b32 m0, 144384
    s_add_u32 s47, s49, 13312
    buffer_load_dwordx4 v15, s[28:31], s47 offen nt lds
    s_mov_b32 m0, 145408
    s_add_u32 s47, s49, 14336
    buffer_load_dwordx4 v14, s[28:31], s47 offen nt lds
    s_mov_b32 m0, 146432
    s_add_u32 s47, s49, 15360
    buffer_load_dwordx4 v15, s[28:31], s47 offen nt lds
    s_waitcnt vmcnt(48)
    s_barrier
    s_mov_b32 m0, 147456
    s_add_u32 s49, s48, 15
    s_and_b32 s49, s49, 15
    s_lshl_b32 s49, s49, 14
    s_add_u32 s47, s49, 0
    buffer_load_dwordx4 v8, s[28:31], s47 offen nt lds
    s_mov_b32 m0, 148480
    s_add_u32 s47, s49, 1024
    buffer_load_dwordx4 v9, s[28:31], s47 offen nt lds
    s_mov_b32 m0, 149504
    s_add_u32 s47, s49, 2048
    buffer_load_dwordx4 v8, s[28:31], s47 offen nt lds
    s_mov_b32 m0, 150528
    s_add_u32 s47, s49, 3072
    buffer_load_dwordx4 v9, s[28:31], s47 offen nt lds
    s_mov_b32 m0, 151552
    s_add_u32 s47, s49, 4096
    buffer_load_dwordx4 v10, s[28:31], s47 offen nt lds
    s_mov_b32 m0, 152576
    s_add_u32 s47, s49, 5120
    buffer_load_dwordx4 v11, s[28:31], s47 offen nt lds
    s_mov_b32 m0, 153600
    s_add_u32 s47, s49, 6144
    buffer_load_dwordx4 v10, s[28:31], s47 offen nt lds
    s_mov_b32 m0, 154624
    s_add_u32 s47, s49, 7168
    buffer_load_dwordx4 v11, s[28:31], s47 offen nt lds
    s_mov_b32 m0, 155648
    s_add_u32 s47, s49, 8192
    buffer_load_dwordx4 v12, s[28:31], s47 offen nt lds
    s_mov_b32 m0, 156672
    s_add_u32 s47, s49, 9216
    buffer_load_dwordx4 v13, s[28:31], s47 offen nt lds
    s_mov_b32 m0, 157696
    s_add_u32 s47, s49, 10240
    buffer_load_dwordx4 v12, s[28:31], s47 offen nt lds
    s_mov_b32 m0, 158720
    s_add_u32 s47, s49, 11264
    buffer_load_dwordx4 v13, s[28:31], s47 offen nt lds
    s_mov_b32 m0, 159744
    s_add_u32 s47, s49, 12288
    buffer_load_dwordx4 v14, s[28:31], s47 offen nt lds
    s_mov_b32 m0, 160768
    s_add_u32 s47, s49, 13312
    buffer_load_dwordx4 v15, s[28:31], s47 offen nt lds
    s_mov_b32 m0, 161792
    s_add_u32 s47, s49, 14336
    buffer_load_dwordx4 v14, s[28:31], s47 offen nt lds
    s_mov_b32 m0, 162816
    s_add_u32 s47, s49, 15360
    buffer_load_dwordx4 v15, s[28:31], s47 offen nt lds
    s_waitcnt vmcnt(48)
    s_barrier
    s_mov_b32 m0, 32768
    s_add_u32 s49, s48, 0
    s_and_b32 s49, s49, 15
    s_lshl_b32 s49, s49, 14
    s_add_u32 s47, s49, 0
    buffer_load_dwordx4 v16, s[32:35], s47 offen nt lds
    s_mov_b32 m0, 33792
    s_add_u32 s47, s49, 1024
    buffer_load_dwordx4 v17, s[32:35], s47 offen nt lds
    s_mov_b32 m0, 34816
    s_add_u32 s47, s49, 2048
    buffer_load_dwordx4 v16, s[32:35], s47 offen nt lds
    s_mov_b32 m0, 35840
    s_add_u32 s47, s49, 3072
    buffer_load_dwordx4 v17, s[32:35], s47 offen nt lds
    s_mov_b32 m0, 36864
    s_add_u32 s47, s49, 4096
    buffer_load_dwordx4 v16, s[32:35], s47 offen nt lds
    s_mov_b32 m0, 37888
    s_add_u32 s47, s49, 5120
    buffer_load_dwordx4 v17, s[32:35], s47 offen nt lds
    s_mov_b32 m0, 38912
    s_add_u32 s47, s49, 6144
    buffer_load_dwordx4 v16, s[32:35], s47 offen nt lds
    s_mov_b32 m0, 39936
    s_add_u32 s47, s49, 7168
    buffer_load_dwordx4 v17, s[32:35], s47 offen nt lds
    s_mov_b32 m0, 40960
    s_add_u32 s47, s49, 8192
    buffer_load_dwordx4 v16, s[32:35], s47 offen nt lds
    s_mov_b32 m0, 41984
    s_add_u32 s47, s49, 9216
    buffer_load_dwordx4 v17, s[32:35], s47 offen nt lds
    s_mov_b32 m0, 43008
    s_add_u32 s47, s49, 10240
    buffer_load_dwordx4 v16, s[32:35], s47 offen nt lds
    s_mov_b32 m0, 44032
    s_add_u32 s47, s49, 11264
    buffer_load_dwordx4 v17, s[32:35], s47 offen nt lds
    s_mov_b32 m0, 45056
    s_add_u32 s47, s49, 12288
    buffer_load_dwordx4 v16, s[32:35], s47 offen nt lds
    s_mov_b32 m0, 46080
    s_add_u32 s47, s49, 13312
    buffer_load_dwordx4 v17, s[32:35], s47 offen nt lds
    s_mov_b32 m0, 47104
    s_add_u32 s47, s49, 14336
    buffer_load_dwordx4 v16, s[32:35], s47 offen nt lds
    s_mov_b32 m0, 48128
    s_add_u32 s47, s49, 15360
    buffer_load_dwordx4 v17, s[32:35], s47 offen nt lds
    s_waitcnt vmcnt(48)
    s_barrier
    s_mov_b32 m0, 49152
    s_add_u32 s49, s48, 1
    s_and_b32 s49, s49, 15
    s_lshl_b32 s49, s49, 14
    s_add_u32 s47, s49, 0
    buffer_load_dwordx4 v16, s[32:35], s47 offen nt lds
    s_mov_b32 m0, 50176
    s_add_u32 s47, s49, 1024
    buffer_load_dwordx4 v17, s[32:35], s47 offen nt lds
    s_mov_b32 m0, 51200
    s_add_u32 s47, s49, 2048
    buffer_load_dwordx4 v16, s[32:35], s47 offen nt lds
    s_mov_b32 m0, 52224
    s_add_u32 s47, s49, 3072
    buffer_load_dwordx4 v17, s[32:35], s47 offen nt lds
    s_mov_b32 m0, 53248
    s_add_u32 s47, s49, 4096
    buffer_load_dwordx4 v16, s[32:35], s47 offen nt lds
    s_mov_b32 m0, 54272
    s_add_u32 s47, s49, 5120
    buffer_load_dwordx4 v17, s[32:35], s47 offen nt lds
    s_mov_b32 m0, 55296
    s_add_u32 s47, s49, 6144
    buffer_load_dwordx4 v16, s[32:35], s47 offen nt lds
    s_mov_b32 m0, 56320
    s_add_u32 s47, s49, 7168
    buffer_load_dwordx4 v17, s[32:35], s47 offen nt lds
    s_mov_b32 m0, 57344
    s_add_u32 s47, s49, 8192
    buffer_load_dwordx4 v16, s[32:35], s47 offen nt lds
    s_mov_b32 m0, 58368
    s_add_u32 s47, s49, 9216
    buffer_load_dwordx4 v17, s[32:35], s47 offen nt lds
    s_mov_b32 m0, 59392
    s_add_u32 s47, s49, 10240
    buffer_load_dwordx4 v16, s[32:35], s47 offen nt lds
    s_mov_b32 m0, 60416
    s_add_u32 s47, s49, 11264
    buffer_load_dwordx4 v17, s[32:35], s47 offen nt lds
    s_mov_b32 m0, 61440
    s_add_u32 s47, s49, 12288
    buffer_load_dwordx4 v16, s[32:35], s47 offen nt lds
    s_mov_b32 m0, 62464
    s_add_u32 s47, s49, 13312
    buffer_load_dwordx4 v17, s[32:35], s47 offen nt lds
    s_mov_b32 m0, 63488
    s_add_u32 s47, s49, 14336
    buffer_load_dwordx4 v16, s[32:35], s47 offen nt lds
    s_mov_b32 m0, 64512
    s_add_u32 s47, s49, 15360
    buffer_load_dwordx4 v17, s[32:35], s47 offen nt lds
    s_waitcnt vmcnt(48)
    s_barrier
    s_mov_b32 m0, 0
    s_add_u32 s49, s48, 2
    s_and_b32 s49, s49, 15
    s_lshl_b32 s49, s49, 14
    s_add_u32 s47, s49, 0
    buffer_load_dwordx4 v16, s[32:35], s47 offen nt lds
    s_mov_b32 m0, 1024
    s_add_u32 s47, s49, 1024
    buffer_load_dwordx4 v17, s[32:35], s47 offen nt lds
    s_mov_b32 m0, 2048
    s_add_u32 s47, s49, 2048
    buffer_load_dwordx4 v16, s[32:35], s47 offen nt lds
    s_mov_b32 m0, 3072
    s_add_u32 s47, s49, 3072
    buffer_load_dwordx4 v17, s[32:35], s47 offen nt lds
    s_mov_b32 m0, 4096
    s_add_u32 s47, s49, 4096
    buffer_load_dwordx4 v16, s[32:35], s47 offen nt lds
    s_mov_b32 m0, 5120
    s_add_u32 s47, s49, 5120
    buffer_load_dwordx4 v17, s[32:35], s47 offen nt lds
    s_mov_b32 m0, 6144
    s_add_u32 s47, s49, 6144
    buffer_load_dwordx4 v16, s[32:35], s47 offen nt lds
    s_mov_b32 m0, 7168
    s_add_u32 s47, s49, 7168
    buffer_load_dwordx4 v17, s[32:35], s47 offen nt lds
    s_mov_b32 m0, 8192
    s_add_u32 s47, s49, 8192
    buffer_load_dwordx4 v16, s[32:35], s47 offen nt lds
    s_mov_b32 m0, 9216
    s_add_u32 s47, s49, 9216
    buffer_load_dwordx4 v17, s[32:35], s47 offen nt lds
    s_mov_b32 m0, 10240
    s_add_u32 s47, s49, 10240
    buffer_load_dwordx4 v16, s[32:35], s47 offen nt lds
    s_mov_b32 m0, 11264
    s_add_u32 s47, s49, 11264
    buffer_load_dwordx4 v17, s[32:35], s47 offen nt lds
    s_mov_b32 m0, 12288
    s_add_u32 s47, s49, 12288
    buffer_load_dwordx4 v16, s[32:35], s47 offen nt lds
    s_mov_b32 m0, 13312
    s_add_u32 s47, s49, 13312
    buffer_load_dwordx4 v17, s[32:35], s47 offen nt lds
    s_mov_b32 m0, 14336
    s_add_u32 s47, s49, 14336
    buffer_load_dwordx4 v16, s[32:35], s47 offen nt lds
    s_mov_b32 m0, 15360
    s_add_u32 s47, s49, 15360
    buffer_load_dwordx4 v17, s[32:35], s47 offen nt lds
    s_waitcnt vmcnt(48)
    s_barrier
    s_mov_b32 m0, 16384
    s_add_u32 s49, s48, 3
    s_and_b32 s49, s49, 15
    s_lshl_b32 s49, s49, 14
    s_add_u32 s47, s49, 0
    buffer_load_dwordx4 v16, s[32:35], s47 offen nt lds
    s_mov_b32 m0, 17408
    s_add_u32 s47, s49, 1024
    buffer_load_dwordx4 v17, s[32:35], s47 offen nt lds
    s_mov_b32 m0, 18432
    s_add_u32 s47, s49, 2048
    buffer_load_dwordx4 v16, s[32:35], s47 offen nt lds
    s_mov_b32 m0, 19456
    s_add_u32 s47, s49, 3072
    buffer_load_dwordx4 v17, s[32:35], s47 offen nt lds
    s_mov_b32 m0, 20480
    s_add_u32 s47, s49, 4096
    buffer_load_dwordx4 v16, s[32:35], s47 offen nt lds
    s_mov_b32 m0, 21504
    s_add_u32 s47, s49, 5120
    buffer_load_dwordx4 v17, s[32:35], s47 offen nt lds
    s_mov_b32 m0, 22528
    s_add_u32 s47, s49, 6144
    buffer_load_dwordx4 v16, s[32:35], s47 offen nt lds
    s_mov_b32 m0, 23552
    s_add_u32 s47, s49, 7168
    buffer_load_dwordx4 v17, s[32:35], s47 offen nt lds
    s_mov_b32 m0, 24576
    s_add_u32 s47, s49, 8192
    buffer_load_dwordx4 v16, s[32:35], s47 offen nt lds
    s_mov_b32 m0, 25600
    s_add_u32 s47, s49, 9216
    buffer_load_dwordx4 v17, s[32:35], s47 offen nt lds
    s_mov_b32 m0, 26624
    s_add_u32 s47, s49, 10240
    buffer_load_dwordx4 v16, s[32:35], s47 offen nt lds
    s_mov_b32 m0, 27648
    s_add_u32 s47, s49, 11264
    buffer_load_dwordx4 v17, s[32:35], s47 offen nt lds
    s_mov_b32 m0, 28672
    s_add_u32 s47, s49, 12288
    buffer_load_dwordx4 v16, s[32:35], s47 offen nt lds
    s_mov_b32 m0, 29696
    s_add_u32 s47, s49, 13312
    buffer_load_dwordx4 v17, s[32:35], s47 offen nt lds
    s_mov_b32 m0, 30720
    s_add_u32 s47, s49, 14336
    buffer_load_dwordx4 v16, s[32:35], s47 offen nt lds
    s_mov_b32 m0, 31744
    s_add_u32 s47, s49, 15360
    buffer_load_dwordx4 v17, s[32:35], s47 offen nt lds
    s_waitcnt vmcnt(48)
    s_barrier
    s_mov_b32 m0, 65536
    s_add_u32 s49, s48, 4
    s_and_b32 s49, s49, 15
    s_lshl_b32 s49, s49, 14
    s_add_u32 s47, s49, 0
    buffer_load_dwordx4 v16, s[32:35], s47 offen nt lds
    s_mov_b32 m0, 66560
    s_add_u32 s47, s49, 1024
    buffer_load_dwordx4 v17, s[32:35], s47 offen nt lds
    s_mov_b32 m0, 67584
    s_add_u32 s47, s49, 2048
    buffer_load_dwordx4 v16, s[32:35], s47 offen nt lds
    s_mov_b32 m0, 68608
    s_add_u32 s47, s49, 3072
    buffer_load_dwordx4 v17, s[32:35], s47 offen nt lds
    s_mov_b32 m0, 69632
    s_add_u32 s47, s49, 4096
    buffer_load_dwordx4 v16, s[32:35], s47 offen nt lds
    s_mov_b32 m0, 70656
    s_add_u32 s47, s49, 5120
    buffer_load_dwordx4 v17, s[32:35], s47 offen nt lds
    s_mov_b32 m0, 71680
    s_add_u32 s47, s49, 6144
    buffer_load_dwordx4 v16, s[32:35], s47 offen nt lds
    s_mov_b32 m0, 72704
    s_add_u32 s47, s49, 7168
    buffer_load_dwordx4 v17, s[32:35], s47 offen nt lds
    s_mov_b32 m0, 73728
    s_add_u32 s47, s49, 8192
    buffer_load_dwordx4 v16, s[32:35], s47 offen nt lds
    s_mov_b32 m0, 74752
    s_add_u32 s47, s49, 9216
    buffer_load_dwordx4 v17, s[32:35], s47 offen nt lds
    s_mov_b32 m0, 75776
    s_add_u32 s47, s49, 10240
    buffer_load_dwordx4 v16, s[32:35], s47 offen nt lds
    s_mov_b32 m0, 76800
    s_add_u32 s47, s49, 11264
    buffer_load_dwordx4 v17, s[32:35], s47 offen nt lds
    s_mov_b32 m0, 77824
    s_add_u32 s47, s49, 12288
    buffer_load_dwordx4 v16, s[32:35], s47 offen nt lds
    s_mov_b32 m0, 78848
    s_add_u32 s47, s49, 13312
    buffer_load_dwordx4 v17, s[32:35], s47 offen nt lds
    s_mov_b32 m0, 79872
    s_add_u32 s47, s49, 14336
    buffer_load_dwordx4 v16, s[32:35], s47 offen nt lds
    s_mov_b32 m0, 80896
    s_add_u32 s47, s49, 15360
    buffer_load_dwordx4 v17, s[32:35], s47 offen nt lds
    s_waitcnt vmcnt(48)
    s_barrier
    s_mov_b32 m0, 81920
    s_add_u32 s49, s48, 5
    s_and_b32 s49, s49, 15
    s_lshl_b32 s49, s49, 14
    s_add_u32 s47, s49, 0
    buffer_load_dwordx4 v16, s[32:35], s47 offen nt lds
    s_mov_b32 m0, 82944
    s_add_u32 s47, s49, 1024
    buffer_load_dwordx4 v17, s[32:35], s47 offen nt lds
    s_mov_b32 m0, 83968
    s_add_u32 s47, s49, 2048
    buffer_load_dwordx4 v16, s[32:35], s47 offen nt lds
    s_mov_b32 m0, 84992
    s_add_u32 s47, s49, 3072
    buffer_load_dwordx4 v17, s[32:35], s47 offen nt lds
    s_mov_b32 m0, 86016
    s_add_u32 s47, s49, 4096
    buffer_load_dwordx4 v16, s[32:35], s47 offen nt lds
    s_mov_b32 m0, 87040
    s_add_u32 s47, s49, 5120
    buffer_load_dwordx4 v17, s[32:35], s47 offen nt lds
    s_mov_b32 m0, 88064
    s_add_u32 s47, s49, 6144
    buffer_load_dwordx4 v16, s[32:35], s47 offen nt lds
    s_mov_b32 m0, 89088
    s_add_u32 s47, s49, 7168
    buffer_load_dwordx4 v17, s[32:35], s47 offen nt lds
    s_mov_b32 m0, 90112
    s_add_u32 s47, s49, 8192
    buffer_load_dwordx4 v16, s[32:35], s47 offen nt lds
    s_mov_b32 m0, 91136
    s_add_u32 s47, s49, 9216
    buffer_load_dwordx4 v17, s[32:35], s47 offen nt lds
    s_mov_b32 m0, 92160
    s_add_u32 s47, s49, 10240
    buffer_load_dwordx4 v16, s[32:35], s47 offen nt lds
    s_mov_b32 m0, 93184
    s_add_u32 s47, s49, 11264
    buffer_load_dwordx4 v17, s[32:35], s47 offen nt lds
    s_mov_b32 m0, 94208
    s_add_u32 s47, s49, 12288
    buffer_load_dwordx4 v16, s[32:35], s47 offen nt lds
    s_mov_b32 m0, 95232
    s_add_u32 s47, s49, 13312
    buffer_load_dwordx4 v17, s[32:35], s47 offen nt lds
    s_mov_b32 m0, 96256
    s_add_u32 s47, s49, 14336
    buffer_load_dwordx4 v16, s[32:35], s47 offen nt lds
    s_mov_b32 m0, 97280
    s_add_u32 s47, s49, 15360
    buffer_load_dwordx4 v17, s[32:35], s47 offen nt lds
    s_waitcnt vmcnt(48)
    s_barrier
    s_mov_b32 m0, 98304
    s_add_u32 s49, s48, 6
    s_and_b32 s49, s49, 15
    s_lshl_b32 s49, s49, 14
    s_add_u32 s47, s49, 0
    buffer_load_dwordx4 v16, s[32:35], s47 offen nt lds
    s_mov_b32 m0, 99328
    s_add_u32 s47, s49, 1024
    buffer_load_dwordx4 v17, s[32:35], s47 offen nt lds
    s_mov_b32 m0, 100352
    s_add_u32 s47, s49, 2048
    buffer_load_dwordx4 v16, s[32:35], s47 offen nt lds
    s_mov_b32 m0, 101376
    s_add_u32 s47, s49, 3072
    buffer_load_dwordx4 v17, s[32:35], s47 offen nt lds
    s_mov_b32 m0, 102400
    s_add_u32 s47, s49, 4096
    buffer_load_dwordx4 v16, s[32:35], s47 offen nt lds
    s_mov_b32 m0, 103424
    s_add_u32 s47, s49, 5120
    buffer_load_dwordx4 v17, s[32:35], s47 offen nt lds
    s_mov_b32 m0, 104448
    s_add_u32 s47, s49, 6144
    buffer_load_dwordx4 v16, s[32:35], s47 offen nt lds
    s_mov_b32 m0, 105472
    s_add_u32 s47, s49, 7168
    buffer_load_dwordx4 v17, s[32:35], s47 offen nt lds
    s_mov_b32 m0, 106496
    s_add_u32 s47, s49, 8192
    buffer_load_dwordx4 v16, s[32:35], s47 offen nt lds
    s_mov_b32 m0, 107520
    s_add_u32 s47, s49, 9216
    buffer_load_dwordx4 v17, s[32:35], s47 offen nt lds
    s_mov_b32 m0, 108544
    s_add_u32 s47, s49, 10240
    buffer_load_dwordx4 v16, s[32:35], s47 offen nt lds
    s_mov_b32 m0, 109568
    s_add_u32 s47, s49, 11264
    buffer_load_dwordx4 v17, s[32:35], s47 offen nt lds
    s_mov_b32 m0, 110592
    s_add_u32 s47, s49, 12288
    buffer_load_dwordx4 v16, s[32:35], s47 offen nt lds
    s_mov_b32 m0, 111616
    s_add_u32 s47, s49, 13312
    buffer_load_dwordx4 v17, s[32:35], s47 offen nt lds
    s_mov_b32 m0, 112640
    s_add_u32 s47, s49, 14336
    buffer_load_dwordx4 v16, s[32:35], s47 offen nt lds
    s_mov_b32 m0, 113664
    s_add_u32 s47, s49, 15360
    buffer_load_dwordx4 v17, s[32:35], s47 offen nt lds
    s_waitcnt vmcnt(48)
    s_barrier
    s_mov_b32 m0, 114688
    s_add_u32 s49, s48, 7
    s_and_b32 s49, s49, 15
    s_lshl_b32 s49, s49, 14
    s_add_u32 s47, s49, 0
    buffer_load_dwordx4 v16, s[32:35], s47 offen nt lds
    s_mov_b32 m0, 115712
    s_add_u32 s47, s49, 1024
    buffer_load_dwordx4 v17, s[32:35], s47 offen nt lds
    s_mov_b32 m0, 116736
    s_add_u32 s47, s49, 2048
    buffer_load_dwordx4 v16, s[32:35], s47 offen nt lds
    s_mov_b32 m0, 117760
    s_add_u32 s47, s49, 3072
    buffer_load_dwordx4 v17, s[32:35], s47 offen nt lds
    s_mov_b32 m0, 118784
    s_add_u32 s47, s49, 4096
    buffer_load_dwordx4 v16, s[32:35], s47 offen nt lds
    s_mov_b32 m0, 119808
    s_add_u32 s47, s49, 5120
    buffer_load_dwordx4 v17, s[32:35], s47 offen nt lds
    s_mov_b32 m0, 120832
    s_add_u32 s47, s49, 6144
    buffer_load_dwordx4 v16, s[32:35], s47 offen nt lds
    s_mov_b32 m0, 121856
    s_add_u32 s47, s49, 7168
    buffer_load_dwordx4 v17, s[32:35], s47 offen nt lds
    s_mov_b32 m0, 122880
    s_add_u32 s47, s49, 8192
    buffer_load_dwordx4 v16, s[32:35], s47 offen nt lds
    s_mov_b32 m0, 123904
    s_add_u32 s47, s49, 9216
    buffer_load_dwordx4 v17, s[32:35], s47 offen nt lds
    s_mov_b32 m0, 124928
    s_add_u32 s47, s49, 10240
    buffer_load_dwordx4 v16, s[32:35], s47 offen nt lds
    s_mov_b32 m0, 125952
    s_add_u32 s47, s49, 11264
    buffer_load_dwordx4 v17, s[32:35], s47 offen nt lds
    s_mov_b32 m0, 126976
    s_add_u32 s47, s49, 12288
    buffer_load_dwordx4 v16, s[32:35], s47 offen nt lds
    s_mov_b32 m0, 128000
    s_add_u32 s47, s49, 13312
    buffer_load_dwordx4 v17, s[32:35], s47 offen nt lds
    s_mov_b32 m0, 129024
    s_add_u32 s47, s49, 14336
    buffer_load_dwordx4 v16, s[32:35], s47 offen nt lds
    s_mov_b32 m0, 130048
    s_add_u32 s47, s49, 15360
    buffer_load_dwordx4 v17, s[32:35], s47 offen nt lds
    s_waitcnt vmcnt(48)
    s_barrier
    s_mov_b32 m0, 131072
    s_add_u32 s49, s48, 8
    s_and_b32 s49, s49, 15
    s_lshl_b32 s49, s49, 14
    s_add_u32 s47, s49, 0
    buffer_load_dwordx4 v16, s[32:35], s47 offen nt lds
    s_mov_b32 m0, 132096
    s_add_u32 s47, s49, 1024
    buffer_load_dwordx4 v17, s[32:35], s47 offen nt lds
    s_mov_b32 m0, 133120
    s_add_u32 s47, s49, 2048
    buffer_load_dwordx4 v16, s[32:35], s47 offen nt lds
    s_mov_b32 m0, 134144
    s_add_u32 s47, s49, 3072
    buffer_load_dwordx4 v17, s[32:35], s47 offen nt lds
    s_mov_b32 m0, 135168
    s_add_u32 s47, s49, 4096
    buffer_load_dwordx4 v16, s[32:35], s47 offen nt lds
    s_mov_b32 m0, 136192
    s_add_u32 s47, s49, 5120
    buffer_load_dwordx4 v17, s[32:35], s47 offen nt lds
    s_mov_b32 m0, 137216
    s_add_u32 s47, s49, 6144
    buffer_load_dwordx4 v16, s[32:35], s47 offen nt lds
    s_mov_b32 m0, 138240
    s_add_u32 s47, s49, 7168
    buffer_load_dwordx4 v17, s[32:35], s47 offen nt lds
    s_mov_b32 m0, 139264
    s_add_u32 s47, s49, 8192
    buffer_load_dwordx4 v16, s[32:35], s47 offen nt lds
    s_mov_b32 m0, 140288
    s_add_u32 s47, s49, 9216
    buffer_load_dwordx4 v17, s[32:35], s47 offen nt lds
    s_mov_b32 m0, 141312
    s_add_u32 s47, s49, 10240
    buffer_load_dwordx4 v16, s[32:35], s47 offen nt lds
    s_mov_b32 m0, 142336
    s_add_u32 s47, s49, 11264
    buffer_load_dwordx4 v17, s[32:35], s47 offen nt lds
    s_mov_b32 m0, 143360
    s_add_u32 s47, s49, 12288
    buffer_load_dwordx4 v16, s[32:35], s47 offen nt lds
    s_mov_b32 m0, 144384
    s_add_u32 s47, s49, 13312
    buffer_load_dwordx4 v17, s[32:35], s47 offen nt lds
    s_mov_b32 m0, 145408
    s_add_u32 s47, s49, 14336
    buffer_load_dwordx4 v16, s[32:35], s47 offen nt lds
    s_mov_b32 m0, 146432
    s_add_u32 s47, s49, 15360
    buffer_load_dwordx4 v17, s[32:35], s47 offen nt lds
    s_waitcnt vmcnt(48)
    s_barrier
    s_mov_b32 m0, 147456
    s_add_u32 s49, s48, 9
    s_and_b32 s49, s49, 15
    s_lshl_b32 s49, s49, 14
    s_add_u32 s47, s49, 0
    buffer_load_dwordx4 v16, s[32:35], s47 offen nt lds
    s_mov_b32 m0, 148480
    s_add_u32 s47, s49, 1024
    buffer_load_dwordx4 v17, s[32:35], s47 offen nt lds
    s_mov_b32 m0, 149504
    s_add_u32 s47, s49, 2048
    buffer_load_dwordx4 v16, s[32:35], s47 offen nt lds
    s_mov_b32 m0, 150528
    s_add_u32 s47, s49, 3072
    buffer_load_dwordx4 v17, s[32:35], s47 offen nt lds
    s_mov_b32 m0, 151552
    s_add_u32 s47, s49, 4096
    buffer_load_dwordx4 v16, s[32:35], s47 offen nt lds
    s_mov_b32 m0, 152576
    s_add_u32 s47, s49, 5120
    buffer_load_dwordx4 v17, s[32:35], s47 offen nt lds
    s_mov_b32 m0, 153600
    s_add_u32 s47, s49, 6144
    buffer_load_dwordx4 v16, s[32:35], s47 offen nt lds
    s_mov_b32 m0, 154624
    s_add_u32 s47, s49, 7168
    buffer_load_dwordx4 v17, s[32:35], s47 offen nt lds
    s_mov_b32 m0, 155648
    s_add_u32 s47, s49, 8192
    buffer_load_dwordx4 v16, s[32:35], s47 offen nt lds
    s_mov_b32 m0, 156672
    s_add_u32 s47, s49, 9216
    buffer_load_dwordx4 v17, s[32:35], s47 offen nt lds
    s_mov_b32 m0, 157696
    s_add_u32 s47, s49, 10240
    buffer_load_dwordx4 v16, s[32:35], s47 offen nt lds
    s_mov_b32 m0, 158720
    s_add_u32 s47, s49, 11264
    buffer_load_dwordx4 v17, s[32:35], s47 offen nt lds
    s_mov_b32 m0, 159744
    s_add_u32 s47, s49, 12288
    buffer_load_dwordx4 v16, s[32:35], s47 offen nt lds
    s_mov_b32 m0, 160768
    s_add_u32 s47, s49, 13312
    buffer_load_dwordx4 v17, s[32:35], s47 offen nt lds
    s_mov_b32 m0, 161792
    s_add_u32 s47, s49, 14336
    buffer_load_dwordx4 v16, s[32:35], s47 offen nt lds
    s_mov_b32 m0, 162816
    s_add_u32 s47, s49, 15360
    buffer_load_dwordx4 v17, s[32:35], s47 offen nt lds
    s_waitcnt vmcnt(48)
    s_barrier
    s_mov_b32 m0, 32768
    s_add_u32 s49, s48, 10
    s_and_b32 s49, s49, 15
    s_lshl_b32 s49, s49, 14
    s_add_u32 s47, s49, 0
    buffer_load_dwordx4 v16, s[32:35], s47 offen nt lds
    s_mov_b32 m0, 33792
    s_add_u32 s47, s49, 1024
    buffer_load_dwordx4 v17, s[32:35], s47 offen nt lds
    s_mov_b32 m0, 34816
    s_add_u32 s47, s49, 2048
    buffer_load_dwordx4 v16, s[32:35], s47 offen nt lds
    s_mov_b32 m0, 35840
    s_add_u32 s47, s49, 3072
    buffer_load_dwordx4 v17, s[32:35], s47 offen nt lds
    s_mov_b32 m0, 36864
    s_add_u32 s47, s49, 4096
    buffer_load_dwordx4 v16, s[32:35], s47 offen nt lds
    s_mov_b32 m0, 37888
    s_add_u32 s47, s49, 5120
    buffer_load_dwordx4 v17, s[32:35], s47 offen nt lds
    s_mov_b32 m0, 38912
    s_add_u32 s47, s49, 6144
    buffer_load_dwordx4 v16, s[32:35], s47 offen nt lds
    s_mov_b32 m0, 39936
    s_add_u32 s47, s49, 7168
    buffer_load_dwordx4 v17, s[32:35], s47 offen nt lds
    s_mov_b32 m0, 40960
    s_add_u32 s47, s49, 8192
    buffer_load_dwordx4 v16, s[32:35], s47 offen nt lds
    s_mov_b32 m0, 41984
    s_add_u32 s47, s49, 9216
    buffer_load_dwordx4 v17, s[32:35], s47 offen nt lds
    s_mov_b32 m0, 43008
    s_add_u32 s47, s49, 10240
    buffer_load_dwordx4 v16, s[32:35], s47 offen nt lds
    s_mov_b32 m0, 44032
    s_add_u32 s47, s49, 11264
    buffer_load_dwordx4 v17, s[32:35], s47 offen nt lds
    s_mov_b32 m0, 45056
    s_add_u32 s47, s49, 12288
    buffer_load_dwordx4 v16, s[32:35], s47 offen nt lds
    s_mov_b32 m0, 46080
    s_add_u32 s47, s49, 13312
    buffer_load_dwordx4 v17, s[32:35], s47 offen nt lds
    s_mov_b32 m0, 47104
    s_add_u32 s47, s49, 14336
    buffer_load_dwordx4 v16, s[32:35], s47 offen nt lds
    s_mov_b32 m0, 48128
    s_add_u32 s47, s49, 15360
    buffer_load_dwordx4 v17, s[32:35], s47 offen nt lds
    s_waitcnt vmcnt(48)
    s_barrier
    s_mov_b32 m0, 49152
    s_add_u32 s49, s48, 11
    s_and_b32 s49, s49, 15
    s_lshl_b32 s49, s49, 14
    s_add_u32 s47, s49, 0
    buffer_load_dwordx4 v16, s[32:35], s47 offen nt lds
    s_mov_b32 m0, 50176
    s_add_u32 s47, s49, 1024
    buffer_load_dwordx4 v17, s[32:35], s47 offen nt lds
    s_mov_b32 m0, 51200
    s_add_u32 s47, s49, 2048
    buffer_load_dwordx4 v16, s[32:35], s47 offen nt lds
    s_mov_b32 m0, 52224
    s_add_u32 s47, s49, 3072
    buffer_load_dwordx4 v17, s[32:35], s47 offen nt lds
    s_mov_b32 m0, 53248
    s_add_u32 s47, s49, 4096
    buffer_load_dwordx4 v16, s[32:35], s47 offen nt lds
    s_mov_b32 m0, 54272
    s_add_u32 s47, s49, 5120
    buffer_load_dwordx4 v17, s[32:35], s47 offen nt lds
    s_mov_b32 m0, 55296
    s_add_u32 s47, s49, 6144
    buffer_load_dwordx4 v16, s[32:35], s47 offen nt lds
    s_mov_b32 m0, 56320
    s_add_u32 s47, s49, 7168
    buffer_load_dwordx4 v17, s[32:35], s47 offen nt lds
    s_mov_b32 m0, 57344
    s_add_u32 s47, s49, 8192
    buffer_load_dwordx4 v16, s[32:35], s47 offen nt lds
    s_mov_b32 m0, 58368
    s_add_u32 s47, s49, 9216
    buffer_load_dwordx4 v17, s[32:35], s47 offen nt lds
    s_mov_b32 m0, 59392
    s_add_u32 s47, s49, 10240
    buffer_load_dwordx4 v16, s[32:35], s47 offen nt lds
    s_mov_b32 m0, 60416
    s_add_u32 s47, s49, 11264
    buffer_load_dwordx4 v17, s[32:35], s47 offen nt lds
    s_mov_b32 m0, 61440
    s_add_u32 s47, s49, 12288
    buffer_load_dwordx4 v16, s[32:35], s47 offen nt lds
    s_mov_b32 m0, 62464
    s_add_u32 s47, s49, 13312
    buffer_load_dwordx4 v17, s[32:35], s47 offen nt lds
    s_mov_b32 m0, 63488
    s_add_u32 s47, s49, 14336
    buffer_load_dwordx4 v16, s[32:35], s47 offen nt lds
    s_mov_b32 m0, 64512
    s_add_u32 s47, s49, 15360
    buffer_load_dwordx4 v17, s[32:35], s47 offen nt lds
    s_waitcnt vmcnt(48)
    s_barrier
    s_mov_b32 m0, 0
    s_add_u32 s49, s48, 12
    s_and_b32 s49, s49, 15
    s_lshl_b32 s49, s49, 14
    s_add_u32 s47, s49, 0
    buffer_load_dwordx4 v16, s[32:35], s47 offen nt lds
    s_mov_b32 m0, 1024
    s_add_u32 s47, s49, 1024
    buffer_load_dwordx4 v17, s[32:35], s47 offen nt lds
    s_mov_b32 m0, 2048
    s_add_u32 s47, s49, 2048
    buffer_load_dwordx4 v16, s[32:35], s47 offen nt lds
    s_mov_b32 m0, 3072
    s_add_u32 s47, s49, 3072
    buffer_load_dwordx4 v17, s[32:35], s47 offen nt lds
    s_mov_b32 m0, 4096
    s_add_u32 s47, s49, 4096
    buffer_load_dwordx4 v16, s[32:35], s47 offen nt lds
    s_mov_b32 m0, 5120
    s_add_u32 s47, s49, 5120
    buffer_load_dwordx4 v17, s[32:35], s47 offen nt lds
    s_mov_b32 m0, 6144
    s_add_u32 s47, s49, 6144
    buffer_load_dwordx4 v16, s[32:35], s47 offen nt lds
    s_mov_b32 m0, 7168
    s_add_u32 s47, s49, 7168
    buffer_load_dwordx4 v17, s[32:35], s47 offen nt lds
    s_mov_b32 m0, 8192
    s_add_u32 s47, s49, 8192
    buffer_load_dwordx4 v16, s[32:35], s47 offen nt lds
    s_mov_b32 m0, 9216
    s_add_u32 s47, s49, 9216
    buffer_load_dwordx4 v17, s[32:35], s47 offen nt lds
    s_mov_b32 m0, 10240
    s_add_u32 s47, s49, 10240
    buffer_load_dwordx4 v16, s[32:35], s47 offen nt lds
    s_mov_b32 m0, 11264
    s_add_u32 s47, s49, 11264
    buffer_load_dwordx4 v17, s[32:35], s47 offen nt lds
    s_mov_b32 m0, 12288
    s_add_u32 s47, s49, 12288
    buffer_load_dwordx4 v16, s[32:35], s47 offen nt lds
    s_mov_b32 m0, 13312
    s_add_u32 s47, s49, 13312
    buffer_load_dwordx4 v17, s[32:35], s47 offen nt lds
    s_mov_b32 m0, 14336
    s_add_u32 s47, s49, 14336
    buffer_load_dwordx4 v16, s[32:35], s47 offen nt lds
    s_mov_b32 m0, 15360
    s_add_u32 s47, s49, 15360
    buffer_load_dwordx4 v17, s[32:35], s47 offen nt lds
    s_waitcnt vmcnt(48)
    s_barrier
    s_mov_b32 m0, 16384
    s_add_u32 s49, s48, 13
    s_and_b32 s49, s49, 15
    s_lshl_b32 s49, s49, 14
    s_add_u32 s47, s49, 0
    buffer_load_dwordx4 v16, s[32:35], s47 offen nt lds
    s_mov_b32 m0, 17408
    s_add_u32 s47, s49, 1024
    buffer_load_dwordx4 v17, s[32:35], s47 offen nt lds
    s_mov_b32 m0, 18432
    s_add_u32 s47, s49, 2048
    buffer_load_dwordx4 v16, s[32:35], s47 offen nt lds
    s_mov_b32 m0, 19456
    s_add_u32 s47, s49, 3072
    buffer_load_dwordx4 v17, s[32:35], s47 offen nt lds
    s_mov_b32 m0, 20480
    s_add_u32 s47, s49, 4096
    buffer_load_dwordx4 v16, s[32:35], s47 offen nt lds
    s_mov_b32 m0, 21504
    s_add_u32 s47, s49, 5120
    buffer_load_dwordx4 v17, s[32:35], s47 offen nt lds
    s_mov_b32 m0, 22528
    s_add_u32 s47, s49, 6144
    buffer_load_dwordx4 v16, s[32:35], s47 offen nt lds
    s_mov_b32 m0, 23552
    s_add_u32 s47, s49, 7168
    buffer_load_dwordx4 v17, s[32:35], s47 offen nt lds
    s_mov_b32 m0, 24576
    s_add_u32 s47, s49, 8192
    buffer_load_dwordx4 v16, s[32:35], s47 offen nt lds
    s_mov_b32 m0, 25600
    s_add_u32 s47, s49, 9216
    buffer_load_dwordx4 v17, s[32:35], s47 offen nt lds
    s_mov_b32 m0, 26624
    s_add_u32 s47, s49, 10240
    buffer_load_dwordx4 v16, s[32:35], s47 offen nt lds
    s_mov_b32 m0, 27648
    s_add_u32 s47, s49, 11264
    buffer_load_dwordx4 v17, s[32:35], s47 offen nt lds
    s_mov_b32 m0, 28672
    s_add_u32 s47, s49, 12288
    buffer_load_dwordx4 v16, s[32:35], s47 offen nt lds
    s_mov_b32 m0, 29696
    s_add_u32 s47, s49, 13312
    buffer_load_dwordx4 v17, s[32:35], s47 offen nt lds
    s_mov_b32 m0, 30720
    s_add_u32 s47, s49, 14336
    buffer_load_dwordx4 v16, s[32:35], s47 offen nt lds
    s_mov_b32 m0, 31744
    s_add_u32 s47, s49, 15360
    buffer_load_dwordx4 v17, s[32:35], s47 offen nt lds
    s_waitcnt vmcnt(48)
    s_barrier
    s_mov_b32 m0, 65536
    s_add_u32 s49, s48, 14
    s_and_b32 s49, s49, 15
    s_lshl_b32 s49, s49, 14
    s_add_u32 s47, s49, 0
    buffer_load_dwordx4 v16, s[32:35], s47 offen nt lds
    s_mov_b32 m0, 66560
    s_add_u32 s47, s49, 1024
    buffer_load_dwordx4 v17, s[32:35], s47 offen nt lds
    s_mov_b32 m0, 67584
    s_add_u32 s47, s49, 2048
    buffer_load_dwordx4 v16, s[32:35], s47 offen nt lds
    s_mov_b32 m0, 68608
    s_add_u32 s47, s49, 3072
    buffer_load_dwordx4 v17, s[32:35], s47 offen nt lds
    s_mov_b32 m0, 69632
    s_add_u32 s47, s49, 4096
    buffer_load_dwordx4 v16, s[32:35], s47 offen nt lds
    s_mov_b32 m0, 70656
    s_add_u32 s47, s49, 5120
    buffer_load_dwordx4 v17, s[32:35], s47 offen nt lds
    s_mov_b32 m0, 71680
    s_add_u32 s47, s49, 6144
    buffer_load_dwordx4 v16, s[32:35], s47 offen nt lds
    s_mov_b32 m0, 72704
    s_add_u32 s47, s49, 7168
    buffer_load_dwordx4 v17, s[32:35], s47 offen nt lds
    s_mov_b32 m0, 73728
    s_add_u32 s47, s49, 8192
    buffer_load_dwordx4 v16, s[32:35], s47 offen nt lds
    s_mov_b32 m0, 74752
    s_add_u32 s47, s49, 9216
    buffer_load_dwordx4 v17, s[32:35], s47 offen nt lds
    s_mov_b32 m0, 75776
    s_add_u32 s47, s49, 10240
    buffer_load_dwordx4 v16, s[32:35], s47 offen nt lds
    s_mov_b32 m0, 76800
    s_add_u32 s47, s49, 11264
    buffer_load_dwordx4 v17, s[32:35], s47 offen nt lds
    s_mov_b32 m0, 77824
    s_add_u32 s47, s49, 12288
    buffer_load_dwordx4 v16, s[32:35], s47 offen nt lds
    s_mov_b32 m0, 78848
    s_add_u32 s47, s49, 13312
    buffer_load_dwordx4 v17, s[32:35], s47 offen nt lds
    s_mov_b32 m0, 79872
    s_add_u32 s47, s49, 14336
    buffer_load_dwordx4 v16, s[32:35], s47 offen nt lds
    s_mov_b32 m0, 80896
    s_add_u32 s47, s49, 15360
    buffer_load_dwordx4 v17, s[32:35], s47 offen nt lds
    s_waitcnt vmcnt(48)
    s_barrier
    s_mov_b32 m0, 81920
    s_add_u32 s49, s48, 15
    s_and_b32 s49, s49, 15
    s_lshl_b32 s49, s49, 14
    s_add_u32 s47, s49, 0
    buffer_load_dwordx4 v16, s[32:35], s47 offen nt lds
    s_mov_b32 m0, 82944
    s_add_u32 s47, s49, 1024
    buffer_load_dwordx4 v17, s[32:35], s47 offen nt lds
    s_mov_b32 m0, 83968
    s_add_u32 s47, s49, 2048
    buffer_load_dwordx4 v16, s[32:35], s47 offen nt lds
    s_mov_b32 m0, 84992
    s_add_u32 s47, s49, 3072
    buffer_load_dwordx4 v17, s[32:35], s47 offen nt lds
    s_mov_b32 m0, 86016
    s_add_u32 s47, s49, 4096
    buffer_load_dwordx4 v16, s[32:35], s47 offen nt lds
    s_mov_b32 m0, 87040
    s_add_u32 s47, s49, 5120
    buffer_load_dwordx4 v17, s[32:35], s47 offen nt lds
    s_mov_b32 m0, 88064
    s_add_u32 s47, s49, 6144
    buffer_load_dwordx4 v16, s[32:35], s47 offen nt lds
    s_mov_b32 m0, 89088
    s_add_u32 s47, s49, 7168
    buffer_load_dwordx4 v17, s[32:35], s47 offen nt lds
    s_mov_b32 m0, 90112
    s_add_u32 s47, s49, 8192
    buffer_load_dwordx4 v16, s[32:35], s47 offen nt lds
    s_mov_b32 m0, 91136
    s_add_u32 s47, s49, 9216
    buffer_load_dwordx4 v17, s[32:35], s47 offen nt lds
    s_mov_b32 m0, 92160
    s_add_u32 s47, s49, 10240
    buffer_load_dwordx4 v16, s[32:35], s47 offen nt lds
    s_mov_b32 m0, 93184
    s_add_u32 s47, s49, 11264
    buffer_load_dwordx4 v17, s[32:35], s47 offen nt lds
    s_mov_b32 m0, 94208
    s_add_u32 s47, s49, 12288
    buffer_load_dwordx4 v16, s[32:35], s47 offen nt lds
    s_mov_b32 m0, 95232
    s_add_u32 s47, s49, 13312
    buffer_load_dwordx4 v17, s[32:35], s47 offen nt lds
    s_mov_b32 m0, 96256
    s_add_u32 s47, s49, 14336
    buffer_load_dwordx4 v16, s[32:35], s47 offen nt lds
    s_mov_b32 m0, 97280
    s_add_u32 s47, s49, 15360
    buffer_load_dwordx4 v17, s[32:35], s47 offen nt lds
    s_waitcnt vmcnt(48)
    s_barrier
    s_mov_b32 m0, 98304
    s_mov_b32 s47, 0
    buffer_load_dwordx4 v20, s[64:67], s47 offen lds
    s_mov_b32 m0, 99328
    s_mov_b32 s47, 14336
    buffer_load_dwordx4 v20, s[64:67], s47 offen lds
    s_mov_b32 m0, 100352
    s_mov_b32 s47, 28672
    buffer_load_dwordx4 v20, s[64:67], s47 offen lds
    s_mov_b32 m0, 101376
    s_mov_b32 s47, 43008
    buffer_load_dwordx4 v20, s[64:67], s47 offen lds
    s_mov_b32 m0, 102400
    s_mov_b32 s47, 57344
    buffer_load_dwordx4 v20, s[64:67], s47 offen lds
    s_mov_b32 m0, 103424
    s_mov_b32 s47, 71680
    buffer_load_dwordx4 v20, s[64:67], s47 offen lds
    s_mov_b32 m0, 104448
    s_mov_b32 s47, 86016
    buffer_load_dwordx4 v20, s[64:67], s47 offen lds
    s_mov_b32 m0, 105472
    s_mov_b32 s47, 100352
    buffer_load_dwordx4 v20, s[64:67], s47 offen lds
    s_mov_b32 m0, 106496
    s_mov_b32 s47, 114688
    buffer_load_dwordx4 v20, s[64:67], s47 offen lds
    s_mov_b32 m0, 107520
    s_mov_b32 s47, 129024
    buffer_load_dwordx4 v20, s[64:67], s47 offen lds
    s_mov_b32 m0, 108544
    s_mov_b32 s47, 143360
    buffer_load_dwordx4 v20, s[64:67], s47 offen lds
    s_mov_b32 m0, 109568
    s_mov_b32 s47, 157696
    buffer_load_dwordx4 v20, s[64:67], s47 offen lds
    s_mov_b32 m0, 110592
    s_mov_b32 s47, 172032
    buffer_load_dwordx4 v20, s[64:67], s47 offen lds
    s_mov_b32 m0, 111616
    s_mov_b32 s47, 186368
    buffer_load_dwordx4 v20, s[64:67], s47 offen lds
    s_mov_b32 m0, 112640
    s_mov_b32 s47, 200704
    buffer_load_dwordx4 v20, s[64:67], s47 offen lds
    s_mov_b32 m0, 113664
    s_mov_b32 s47, 215040
    buffer_load_dwordx4 v20, s[64:67], s47 offen lds
    s_waitcnt vmcnt(48)
    s_barrier
    s_mov_b32 m0, 114688
    s_mov_b32 s47, 64
    buffer_load_dwordx4 v20, s[64:67], s47 offen lds
    s_mov_b32 m0, 115712
    s_mov_b32 s47, 14400
    buffer_load_dwordx4 v20, s[64:67], s47 offen lds
    s_mov_b32 m0, 116736
    s_mov_b32 s47, 28736
    buffer_load_dwordx4 v20, s[64:67], s47 offen lds
    s_mov_b32 m0, 117760
    s_mov_b32 s47, 43072
    buffer_load_dwordx4 v20, s[64:67], s47 offen lds
    s_mov_b32 m0, 118784
    s_mov_b32 s47, 57408
    buffer_load_dwordx4 v20, s[64:67], s47 offen lds
    s_mov_b32 m0, 119808
    s_mov_b32 s47, 71744
    buffer_load_dwordx4 v20, s[64:67], s47 offen lds
    s_mov_b32 m0, 120832
    s_mov_b32 s47, 86080
    buffer_load_dwordx4 v20, s[64:67], s47 offen lds
    s_mov_b32 m0, 121856
    s_mov_b32 s47, 100416
    buffer_load_dwordx4 v20, s[64:67], s47 offen lds
    s_mov_b32 m0, 122880
    s_mov_b32 s47, 114752
    buffer_load_dwordx4 v20, s[64:67], s47 offen lds
    s_mov_b32 m0, 123904
    s_mov_b32 s47, 129088
    buffer_load_dwordx4 v20, s[64:67], s47 offen lds
    s_mov_b32 m0, 124928
    s_mov_b32 s47, 143424
    buffer_load_dwordx4 v20, s[64:67], s47 offen lds
    s_mov_b32 m0, 125952
    s_mov_b32 s47, 157760
    buffer_load_dwordx4 v20, s[64:67], s47 offen lds
    s_mov_b32 m0, 126976
    s_mov_b32 s47, 172096
    buffer_load_dwordx4 v20, s[64:67], s47 offen lds
    s_mov_b32 m0, 128000
    s_mov_b32 s47, 186432
    buffer_load_dwordx4 v20, s[64:67], s47 offen lds
    s_mov_b32 m0, 129024
    s_mov_b32 s47, 200768
    buffer_load_dwordx4 v20, s[64:67], s47 offen lds
    s_mov_b32 m0, 130048
    s_mov_b32 s47, 215104
    buffer_load_dwordx4 v20, s[64:67], s47 offen lds
    s_waitcnt vmcnt(48)
    s_barrier
    s_mov_b32 m0, 131072
    s_mov_b32 s47, 128
    buffer_load_dwordx4 v20, s[64:67], s47 offen lds
    s_mov_b32 m0, 132096
    s_mov_b32 s47, 14464
    buffer_load_dwordx4 v20, s[64:67], s47 offen lds
    s_mov_b32 m0, 133120
    s_mov_b32 s47, 28800
    buffer_load_dwordx4 v20, s[64:67], s47 offen lds
    s_mov_b32 m0, 134144
    s_mov_b32 s47, 43136
    buffer_load_dwordx4 v20, s[64:67], s47 offen lds
    s_mov_b32 m0, 135168
    s_mov_b32 s47, 57472
    buffer_load_dwordx4 v20, s[64:67], s47 offen lds
    s_mov_b32 m0, 136192
    s_mov_b32 s47, 71808
    buffer_load_dwordx4 v20, s[64:67], s47 offen lds
    s_mov_b32 m0, 137216
    s_mov_b32 s47, 86144
    buffer_load_dwordx4 v20, s[64:67], s47 offen lds
    s_mov_b32 m0, 138240
    s_mov_b32 s47, 100480
    buffer_load_dwordx4 v20, s[64:67], s47 offen lds
    s_mov_b32 m0, 139264
    s_mov_b32 s47, 114816
    buffer_load_dwordx4 v20, s[64:67], s47 offen lds
    s_mov_b32 m0, 140288
    s_mov_b32 s47, 129152
    buffer_load_dwordx4 v20, s[64:67], s47 offen lds
    s_mov_b32 m0, 141312
    s_mov_b32 s47, 143488
    buffer_load_dwordx4 v20, s[64:67], s47 offen lds
    s_mov_b32 m0, 142336
    s_mov_b32 s47, 157824
    buffer_load_dwordx4 v20, s[64:67], s47 offen lds
    s_mov_b32 m0, 143360
    s_mov_b32 s47, 172160
    buffer_load_dwordx4 v20, s[64:67], s47 offen lds
    s_mov_b32 m0, 144384
    s_mov_b32 s47, 186496
    buffer_load_dwordx4 v20, s[64:67], s47 offen lds
    s_mov_b32 m0, 145408
    s_mov_b32 s47, 200832
    buffer_load_dwordx4 v20, s[64:67], s47 offen lds
    s_mov_b32 m0, 146432
    s_mov_b32 s47, 215168
    buffer_load_dwordx4 v20, s[64:67], s47 offen lds
    s_waitcnt vmcnt(48)
    s_barrier
    s_mov_b32 m0, 147456
    s_mov_b32 s47, 192
    buffer_load_dwordx4 v20, s[64:67], s47 offen lds
    s_mov_b32 m0, 148480
    s_mov_b32 s47, 14528
    buffer_load_dwordx4 v20, s[64:67], s47 offen lds
    s_mov_b32 m0, 149504
    s_mov_b32 s47, 28864
    buffer_load_dwordx4 v20, s[64:67], s47 offen lds
    s_mov_b32 m0, 150528
    s_mov_b32 s47, 43200
    buffer_load_dwordx4 v20, s[64:67], s47 offen lds
    s_mov_b32 m0, 151552
    s_mov_b32 s47, 57536
    buffer_load_dwordx4 v20, s[64:67], s47 offen lds
    s_mov_b32 m0, 152576
    s_mov_b32 s47, 71872
    buffer_load_dwordx4 v20, s[64:67], s47 offen lds
    s_mov_b32 m0, 153600
    s_mov_b32 s47, 86208
    buffer_load_dwordx4 v20, s[64:67], s47 offen lds
    s_mov_b32 m0, 154624
    s_mov_b32 s47, 100544
    buffer_load_dwordx4 v20, s[64:67], s47 offen lds
    s_mov_b32 m0, 155648
    s_mov_b32 s47, 114880
    buffer_load_dwordx4 v20, s[64:67], s47 offen lds
    s_mov_b32 m0, 156672
    s_mov_b32 s47, 129216
    buffer_load_dwordx4 v20, s[64:67], s47 offen lds
    s_mov_b32 m0, 157696
    s_mov_b32 s47, 143552
    buffer_load_dwordx4 v20, s[64:67], s47 offen lds
    s_mov_b32 m0, 158720
    s_mov_b32 s47, 157888
    buffer_load_dwordx4 v20, s[64:67], s47 offen lds
    s_mov_b32 m0, 159744
    s_mov_b32 s47, 172224
    buffer_load_dwordx4 v20, s[64:67], s47 offen lds
    s_mov_b32 m0, 160768
    s_mov_b32 s47, 186560
    buffer_load_dwordx4 v20, s[64:67], s47 offen lds
    s_mov_b32 m0, 161792
    s_mov_b32 s47, 200896
    buffer_load_dwordx4 v20, s[64:67], s47 offen lds
    s_mov_b32 m0, 162816
    s_mov_b32 s47, 215232
    buffer_load_dwordx4 v20, s[64:67], s47 offen lds
    s_waitcnt vmcnt(48)
    s_barrier
    s_mov_b32 m0, 32768
    s_mov_b32 s47, 256
    buffer_load_dwordx4 v20, s[64:67], s47 offen lds
    s_mov_b32 m0, 33792
    s_mov_b32 s47, 14592
    buffer_load_dwordx4 v20, s[64:67], s47 offen lds
    s_mov_b32 m0, 34816
    s_mov_b32 s47, 28928
    buffer_load_dwordx4 v20, s[64:67], s47 offen lds
    s_mov_b32 m0, 35840
    s_mov_b32 s47, 43264
    buffer_load_dwordx4 v20, s[64:67], s47 offen lds
    s_mov_b32 m0, 36864
    s_mov_b32 s47, 57600
    buffer_load_dwordx4 v20, s[64:67], s47 offen lds
    s_mov_b32 m0, 37888
    s_mov_b32 s47, 71936
    buffer_load_dwordx4 v20, s[64:67], s47 offen lds
    s_mov_b32 m0, 38912
    s_mov_b32 s47, 86272
    buffer_load_dwordx4 v20, s[64:67], s47 offen lds
    s_mov_b32 m0, 39936
    s_mov_b32 s47, 100608
    buffer_load_dwordx4 v20, s[64:67], s47 offen lds
    s_mov_b32 m0, 40960
    s_mov_b32 s47, 114944
    buffer_load_dwordx4 v20, s[64:67], s47 offen lds
    s_mov_b32 m0, 41984
    s_mov_b32 s47, 129280
    buffer_load_dwordx4 v20, s[64:67], s47 offen lds
    s_mov_b32 m0, 43008
    s_mov_b32 s47, 143616
    buffer_load_dwordx4 v20, s[64:67], s47 offen lds
    s_mov_b32 m0, 44032
    s_mov_b32 s47, 157952
    buffer_load_dwordx4 v20, s[64:67], s47 offen lds
    s_mov_b32 m0, 45056
    s_mov_b32 s47, 172288
    buffer_load_dwordx4 v20, s[64:67], s47 offen lds
    s_mov_b32 m0, 46080
    s_mov_b32 s47, 186624
    buffer_load_dwordx4 v20, s[64:67], s47 offen lds
    s_mov_b32 m0, 47104
    s_mov_b32 s47, 200960
    buffer_load_dwordx4 v20, s[64:67], s47 offen lds
    s_mov_b32 m0, 48128
    s_mov_b32 s47, 215296
    buffer_load_dwordx4 v20, s[64:67], s47 offen lds
    s_waitcnt vmcnt(48)
    s_barrier
    s_mov_b32 m0, 49152
    s_mov_b32 s47, 320
    buffer_load_dwordx4 v20, s[64:67], s47 offen lds
    s_mov_b32 m0, 50176
    s_mov_b32 s47, 14656
    buffer_load_dwordx4 v20, s[64:67], s47 offen lds
    s_mov_b32 m0, 51200
    s_mov_b32 s47, 28992
    buffer_load_dwordx4 v20, s[64:67], s47 offen lds
    s_mov_b32 m0, 52224
    s_mov_b32 s47, 43328
    buffer_load_dwordx4 v20, s[64:67], s47 offen lds
    s_mov_b32 m0, 53248
    s_mov_b32 s47, 57664
    buffer_load_dwordx4 v20, s[64:67], s47 offen lds
    s_mov_b32 m0, 54272
    s_mov_b32 s47, 72000
    buffer_load_dwordx4 v20, s[64:67], s47 offen lds
    s_mov_b32 m0, 55296
    s_mov_b32 s47, 86336
    buffer_load_dwordx4 v20, s[64:67], s47 offen lds
    s_mov_b32 m0, 56320
    s_mov_b32 s47, 100672
    buffer_load_dwordx4 v20, s[64:67], s47 offen lds
    s_mov_b32 m0, 57344
    s_mov_b32 s47, 115008
    buffer_load_dwordx4 v20, s[64:67], s47 offen lds
    s_mov_b32 m0, 58368
    s_mov_b32 s47, 129344
    buffer_load_dwordx4 v20, s[64:67], s47 offen lds
    s_mov_b32 m0, 59392
    s_mov_b32 s47, 143680
    buffer_load_dwordx4 v20, s[64:67], s47 offen lds
    s_mov_b32 m0, 60416
    s_mov_b32 s47, 158016
    buffer_load_dwordx4 v20, s[64:67], s47 offen lds
    s_mov_b32 m0, 61440
    s_mov_b32 s47, 172352
    buffer_load_dwordx4 v20, s[64:67], s47 offen lds
    s_mov_b32 m0, 62464
    s_mov_b32 s47, 186688
    buffer_load_dwordx4 v20, s[64:67], s47 offen lds
    s_mov_b32 m0, 63488
    s_mov_b32 s47, 201024
    buffer_load_dwordx4 v20, s[64:67], s47 offen lds
    s_mov_b32 m0, 64512
    s_mov_b32 s47, 215360
    buffer_load_dwordx4 v20, s[64:67], s47 offen lds
    s_waitcnt vmcnt(48)
    s_barrier
    s_mov_b32 m0, 0
    s_mov_b32 s47, 384
    buffer_load_dwordx4 v20, s[64:67], s47 offen lds
    s_mov_b32 m0, 1024
    s_mov_b32 s47, 14720
    buffer_load_dwordx4 v20, s[64:67], s47 offen lds
    s_mov_b32 m0, 2048
    s_mov_b32 s47, 29056
    buffer_load_dwordx4 v20, s[64:67], s47 offen lds
    s_mov_b32 m0, 3072
    s_mov_b32 s47, 43392
    buffer_load_dwordx4 v20, s[64:67], s47 offen lds
    s_mov_b32 m0, 4096
    s_mov_b32 s47, 57728
    buffer_load_dwordx4 v20, s[64:67], s47 offen lds
    s_mov_b32 m0, 5120
    s_mov_b32 s47, 72064
    buffer_load_dwordx4 v20, s[64:67], s47 offen lds
    s_mov_b32 m0, 6144
    s_mov_b32 s47, 86400
    buffer_load_dwordx4 v20, s[64:67], s47 offen lds
    s_mov_b32 m0, 7168
    s_mov_b32 s47, 100736
    buffer_load_dwordx4 v20, s[64:67], s47 offen lds
    s_mov_b32 m0, 8192
    s_mov_b32 s47, 115072
    buffer_load_dwordx4 v20, s[64:67], s47 offen lds
    s_mov_b32 m0, 9216
    s_mov_b32 s47, 129408
    buffer_load_dwordx4 v20, s[64:67], s47 offen lds
    s_mov_b32 m0, 10240
    s_mov_b32 s47, 143744
    buffer_load_dwordx4 v20, s[64:67], s47 offen lds
    s_mov_b32 m0, 11264
    s_mov_b32 s47, 158080
    buffer_load_dwordx4 v20, s[64:67], s47 offen lds
    s_mov_b32 m0, 12288
    s_mov_b32 s47, 172416
    buffer_load_dwordx4 v20, s[64:67], s47 offen lds
    s_mov_b32 m0, 13312
    s_mov_b32 s47, 186752
    buffer_load_dwordx4 v20, s[64:67], s47 offen lds
    s_mov_b32 m0, 14336
    s_mov_b32 s47, 201088
    buffer_load_dwordx4 v20, s[64:67], s47 offen lds
    s_mov_b32 m0, 15360
    s_mov_b32 s47, 215424
    buffer_load_dwordx4 v20, s[64:67], s47 offen lds
    s_waitcnt vmcnt(48)
    s_barrier
    s_mov_b32 m0, 16384
    s_mov_b32 s47, 448
    buffer_load_dwordx4 v20, s[64:67], s47 offen lds
    s_mov_b32 m0, 17408
    s_mov_b32 s47, 14784
    buffer_load_dwordx4 v20, s[64:67], s47 offen lds
    s_mov_b32 m0, 18432
    s_mov_b32 s47, 29120
    buffer_load_dwordx4 v20, s[64:67], s47 offen lds
    s_mov_b32 m0, 19456
    s_mov_b32 s47, 43456
    buffer_load_dwordx4 v20, s[64:67], s47 offen lds
    s_mov_b32 m0, 20480
    s_mov_b32 s47, 57792
    buffer_load_dwordx4 v20, s[64:67], s47 offen lds
    s_mov_b32 m0, 21504
    s_mov_b32 s47, 72128
    buffer_load_dwordx4 v20, s[64:67], s47 offen lds
    s_mov_b32 m0, 22528
    s_mov_b32 s47, 86464
    buffer_load_dwordx4 v20, s[64:67], s47 offen lds
    s_mov_b32 m0, 23552
    s_mov_b32 s47, 100800
    buffer_load_dwordx4 v20, s[64:67], s47 offen lds
    s_mov_b32 m0, 24576
    s_mov_b32 s47, 115136
    buffer_load_dwordx4 v20, s[64:67], s47 offen lds
    s_mov_b32 m0, 25600
    s_mov_b32 s47, 129472
    buffer_load_dwordx4 v20, s[64:67], s47 offen lds
    s_mov_b32 m0, 26624
    s_mov_b32 s47, 143808
    buffer_load_dwordx4 v20, s[64:67], s47 offen lds
    s_mov_b32 m0, 27648
    s_mov_b32 s47, 158144
    buffer_load_dwordx4 v20, s[64:67], s47 offen lds
    s_mov_b32 m0, 28672
    s_mov_b32 s47, 172480
    buffer_load_dwordx4 v20, s[64:67], s47 offen lds
    s_mov_b32 m0, 29696
    s_mov_b32 s47, 186816
    buffer_load_dwordx4 v20, s[64:67], s47 offen lds
    s_mov_b32 m0, 30720
    s_mov_b32 s47, 201152
    buffer_load_dwordx4 v20, s[64:67], s47 offen lds
    s_mov_b32 m0, 31744
    s_mov_b32 s47, 215488
    buffer_load_dwordx4 v20, s[64:67], s47 offen lds
    s_waitcnt vmcnt(48)
    s_barrier
    s_mov_b32 m0, 65536
    s_mov_b32 s47, 512
    buffer_load_dwordx4 v20, s[64:67], s47 offen lds
    s_mov_b32 m0, 66560
    s_mov_b32 s47, 14848
    buffer_load_dwordx4 v20, s[64:67], s47 offen lds
    s_mov_b32 m0, 67584
    s_mov_b32 s47, 29184
    buffer_load_dwordx4 v20, s[64:67], s47 offen lds
    s_mov_b32 m0, 68608
    s_mov_b32 s47, 43520
    buffer_load_dwordx4 v20, s[64:67], s47 offen lds
    s_mov_b32 m0, 69632
    s_mov_b32 s47, 57856
    buffer_load_dwordx4 v20, s[64:67], s47 offen lds
    s_mov_b32 m0, 70656
    s_mov_b32 s47, 72192
    buffer_load_dwordx4 v20, s[64:67], s47 offen lds
    s_mov_b32 m0, 71680
    s_mov_b32 s47, 86528
    buffer_load_dwordx4 v20, s[64:67], s47 offen lds
    s_mov_b32 m0, 72704
    s_mov_b32 s47, 100864
    buffer_load_dwordx4 v20, s[64:67], s47 offen lds
    s_mov_b32 m0, 73728
    s_mov_b32 s47, 115200
    buffer_load_dwordx4 v20, s[64:67], s47 offen lds
    s_mov_b32 m0, 74752
    s_mov_b32 s47, 129536
    buffer_load_dwordx4 v20, s[64:67], s47 offen lds
    s_mov_b32 m0, 75776
    s_mov_b32 s47, 143872
    buffer_load_dwordx4 v20, s[64:67], s47 offen lds
    s_mov_b32 m0, 76800
    s_mov_b32 s47, 158208
    buffer_load_dwordx4 v20, s[64:67], s47 offen lds
    s_mov_b32 m0, 77824
    s_mov_b32 s47, 172544
    buffer_load_dwordx4 v20, s[64:67], s47 offen lds
    s_mov_b32 m0, 78848
    s_mov_b32 s47, 186880
    buffer_load_dwordx4 v20, s[64:67], s47 offen lds
    s_mov_b32 m0, 79872
    s_mov_b32 s47, 201216
    buffer_load_dwordx4 v20, s[64:67], s47 offen lds
    s_mov_b32 m0, 80896
    s_mov_b32 s47, 215552
    buffer_load_dwordx4 v20, s[64:67], s47 offen lds
    s_waitcnt vmcnt(48)
    s_barrier
    s_mov_b32 m0, 81920
    s_mov_b32 s47, 576
    buffer_load_dwordx4 v20, s[64:67], s47 offen lds
    s_mov_b32 m0, 82944
    s_mov_b32 s47, 14912
    buffer_load_dwordx4 v20, s[64:67], s47 offen lds
    s_mov_b32 m0, 83968
    s_mov_b32 s47, 29248
    buffer_load_dwordx4 v20, s[64:67], s47 offen lds
    s_mov_b32 m0, 84992
    s_mov_b32 s47, 43584
    buffer_load_dwordx4 v20, s[64:67], s47 offen lds
    s_mov_b32 m0, 86016
    s_mov_b32 s47, 57920
    buffer_load_dwordx4 v20, s[64:67], s47 offen lds
    s_mov_b32 m0, 87040
    s_mov_b32 s47, 72256
    buffer_load_dwordx4 v20, s[64:67], s47 offen lds
    s_mov_b32 m0, 88064
    s_mov_b32 s47, 86592
    buffer_load_dwordx4 v20, s[64:67], s47 offen lds
    s_mov_b32 m0, 89088
    s_mov_b32 s47, 100928
    buffer_load_dwordx4 v20, s[64:67], s47 offen lds
    s_mov_b32 m0, 90112
    s_mov_b32 s47, 115264
    buffer_load_dwordx4 v20, s[64:67], s47 offen lds
    s_mov_b32 m0, 91136
    s_mov_b32 s47, 129600
    buffer_load_dwordx4 v20, s[64:67], s47 offen lds
    s_mov_b32 m0, 92160
    s_mov_b32 s47, 143936
    buffer_load_dwordx4 v20, s[64:67], s47 offen lds
    s_mov_b32 m0, 93184
    s_mov_b32 s47, 158272
    buffer_load_dwordx4 v20, s[64:67], s47 offen lds
    s_mov_b32 m0, 94208
    s_mov_b32 s47, 172608
    buffer_load_dwordx4 v20, s[64:67], s47 offen lds
    s_mov_b32 m0, 95232
    s_mov_b32 s47, 186944
    buffer_load_dwordx4 v20, s[64:67], s47 offen lds
    s_mov_b32 m0, 96256
    s_mov_b32 s47, 201280
    buffer_load_dwordx4 v20, s[64:67], s47 offen lds
    s_mov_b32 m0, 97280
    s_mov_b32 s47, 215616
    buffer_load_dwordx4 v20, s[64:67], s47 offen lds
    s_waitcnt vmcnt(48)
    s_barrier
    s_mov_b32 m0, 98304
    s_mov_b32 s47, 640
    buffer_load_dwordx4 v20, s[64:67], s47 offen lds
    s_mov_b32 m0, 99328
    s_mov_b32 s47, 14976
    buffer_load_dwordx4 v20, s[64:67], s47 offen lds
    s_mov_b32 m0, 100352
    s_mov_b32 s47, 29312
    buffer_load_dwordx4 v20, s[64:67], s47 offen lds
    s_mov_b32 m0, 101376
    s_mov_b32 s47, 43648
    buffer_load_dwordx4 v20, s[64:67], s47 offen lds
    s_mov_b32 m0, 102400
    s_mov_b32 s47, 57984
    buffer_load_dwordx4 v20, s[64:67], s47 offen lds
    s_mov_b32 m0, 103424
    s_mov_b32 s47, 72320
    buffer_load_dwordx4 v20, s[64:67], s47 offen lds
    s_mov_b32 m0, 104448
    s_mov_b32 s47, 86656
    buffer_load_dwordx4 v20, s[64:67], s47 offen lds
    s_mov_b32 m0, 105472
    s_mov_b32 s47, 100992
    buffer_load_dwordx4 v20, s[64:67], s47 offen lds
    s_mov_b32 m0, 106496
    s_mov_b32 s47, 115328
    buffer_load_dwordx4 v20, s[64:67], s47 offen lds
    s_mov_b32 m0, 107520
    s_mov_b32 s47, 129664
    buffer_load_dwordx4 v20, s[64:67], s47 offen lds
    s_mov_b32 m0, 108544
    s_mov_b32 s47, 144000
    buffer_load_dwordx4 v20, s[64:67], s47 offen lds
    s_mov_b32 m0, 109568
    s_mov_b32 s47, 158336
    buffer_load_dwordx4 v20, s[64:67], s47 offen lds
    s_mov_b32 m0, 110592
    s_mov_b32 s47, 172672
    buffer_load_dwordx4 v20, s[64:67], s47 offen lds
    s_mov_b32 m0, 111616
    s_mov_b32 s47, 187008
    buffer_load_dwordx4 v20, s[64:67], s47 offen lds
    s_mov_b32 m0, 112640
    s_mov_b32 s47, 201344
    buffer_load_dwordx4 v20, s[64:67], s47 offen lds
    s_mov_b32 m0, 113664
    s_mov_b32 s47, 215680
    buffer_load_dwordx4 v20, s[64:67], s47 offen lds
    s_waitcnt vmcnt(48)
    s_barrier
    s_mov_b32 m0, 114688
    s_mov_b32 s47, 704
    buffer_load_dwordx4 v20, s[64:67], s47 offen lds
    s_mov_b32 m0, 115712
    s_mov_b32 s47, 15040
    buffer_load_dwordx4 v20, s[64:67], s47 offen lds
    s_mov_b32 m0, 116736
    s_mov_b32 s47, 29376
    buffer_load_dwordx4 v20, s[64:67], s47 offen lds
    s_mov_b32 m0, 117760
    s_mov_b32 s47, 43712
    buffer_load_dwordx4 v20, s[64:67], s47 offen lds
    s_mov_b32 m0, 118784
    s_mov_b32 s47, 58048
    buffer_load_dwordx4 v20, s[64:67], s47 offen lds
    s_mov_b32 m0, 119808
    s_mov_b32 s47, 72384
    buffer_load_dwordx4 v20, s[64:67], s47 offen lds
    s_mov_b32 m0, 120832
    s_mov_b32 s47, 86720
    buffer_load_dwordx4 v20, s[64:67], s47 offen lds
    s_mov_b32 m0, 121856
    s_mov_b32 s47, 101056
    buffer_load_dwordx4 v20, s[64:67], s47 offen lds
    s_mov_b32 m0, 122880
    s_mov_b32 s47, 115392
    buffer_load_dwordx4 v20, s[64:67], s47 offen lds
    s_mov_b32 m0, 123904
    s_mov_b32 s47, 129728
    buffer_load_dwordx4 v20, s[64:67], s47 offen lds
    s_mov_b32 m0, 124928
    s_mov_b32 s47, 144064
    buffer_load_dwordx4 v20, s[64:67], s47 offen lds
    s_mov_b32 m0, 125952
    s_mov_b32 s47, 158400
    buffer_load_dwordx4 v20, s[64:67], s47 offen lds
    s_mov_b32 m0, 126976
    s_mov_b32 s47, 172736
    buffer_load_dwordx4 v20, s[64:67], s47 offen lds
    s_mov_b32 m0, 128000
    s_mov_b32 s47, 187072
    buffer_load_dwordx4 v20, s[64:67], s47 offen lds
    s_mov_b32 m0, 129024
    s_mov_b32 s47, 201408
    buffer_load_dwordx4 v20, s[64:67], s47 offen lds
    s_mov_b32 m0, 130048
    s_mov_b32 s47, 215744
    buffer_load_dwordx4 v20, s[64:67], s47 offen lds
    s_waitcnt vmcnt(48)
    s_barrier
    s_mov_b32 m0, 131072
    s_mov_b32 s47, 768
    buffer_load_dwordx4 v20, s[64:67], s47 offen lds
    s_mov_b32 m0, 132096
    s_mov_b32 s47, 15104
    buffer_load_dwordx4 v20, s[64:67], s47 offen lds
    s_mov_b32 m0, 133120
    s_mov_b32 s47, 29440
    buffer_load_dwordx4 v20, s[64:67], s47 offen lds
    s_mov_b32 m0, 134144
    s_mov_b32 s47, 43776
    buffer_load_dwordx4 v20, s[64:67], s47 offen lds
    s_mov_b32 m0, 135168
    s_mov_b32 s47, 58112
    buffer_load_dwordx4 v20, s[64:67], s47 offen lds
    s_mov_b32 m0, 136192
    s_mov_b32 s47, 72448
    buffer_load_dwordx4 v20, s[64:67], s47 offen lds
    s_mov_b32 m0, 137216
    s_mov_b32 s47, 86784
    buffer_load_dwordx4 v20, s[64:67], s47 offen lds
    s_mov_b32 m0, 138240
    s_mov_b32 s47, 101120
    buffer_load_dwordx4 v20, s[64:67], s47 offen lds
    s_mov_b32 m0, 139264
    s_mov_b32 s47, 115456
    buffer_load_dwordx4 v20, s[64:67], s47 offen lds
    s_mov_b32 m0, 140288
    s_mov_b32 s47, 129792
    buffer_load_dwordx4 v20, s[64:67], s47 offen lds
    s_mov_b32 m0, 141312
    s_mov_b32 s47, 144128
    buffer_load_dwordx4 v20, s[64:67], s47 offen lds
    s_mov_b32 m0, 142336
    s_mov_b32 s47, 158464
    buffer_load_dwordx4 v20, s[64:67], s47 offen lds
    s_mov_b32 m0, 143360
    s_mov_b32 s47, 172800
    buffer_load_dwordx4 v20, s[64:67], s47 offen lds
    s_mov_b32 m0, 144384
    s_mov_b32 s47, 187136
    buffer_load_dwordx4 v20, s[64:67], s47 offen lds
    s_mov_b32 m0, 145408
    s_mov_b32 s47, 201472
    buffer_load_dwordx4 v20, s[64:67], s47 offen lds
    s_mov_b32 m0, 146432
    s_mov_b32 s47, 215808
    buffer_load_dwordx4 v20, s[64:67], s47 offen lds
    s_waitcnt vmcnt(48)
    s_barrier
    s_mov_b32 m0, 147456
    s_mov_b32 s47, 832
    buffer_load_dwordx4 v20, s[64:67], s47 offen lds
    s_mov_b32 m0, 148480
    s_mov_b32 s47, 15168
    buffer_load_dwordx4 v20, s[64:67], s47 offen lds
    s_mov_b32 m0, 149504
    s_mov_b32 s47, 29504
    buffer_load_dwordx4 v20, s[64:67], s47 offen lds
    s_mov_b32 m0, 150528
    s_mov_b32 s47, 43840
    buffer_load_dwordx4 v20, s[64:67], s47 offen lds
    s_mov_b32 m0, 151552
    s_mov_b32 s47, 58176
    buffer_load_dwordx4 v20, s[64:67], s47 offen lds
    s_mov_b32 m0, 152576
    s_mov_b32 s47, 72512
    buffer_load_dwordx4 v20, s[64:67], s47 offen lds
    s_mov_b32 m0, 153600
    s_mov_b32 s47, 86848
    buffer_load_dwordx4 v20, s[64:67], s47 offen lds
    s_mov_b32 m0, 154624
    s_mov_b32 s47, 101184
    buffer_load_dwordx4 v20, s[64:67], s47 offen lds
    s_mov_b32 m0, 155648
    s_mov_b32 s47, 115520
    buffer_load_dwordx4 v20, s[64:67], s47 offen lds
    s_mov_b32 m0, 156672
    s_mov_b32 s47, 129856
    buffer_load_dwordx4 v20, s[64:67], s47 offen lds
    s_mov_b32 m0, 157696
    s_mov_b32 s47, 144192
    buffer_load_dwordx4 v20, s[64:67], s47 offen lds
    s_mov_b32 m0, 158720
    s_mov_b32 s47, 158528
    buffer_load_dwordx4 v20, s[64:67], s47 offen lds
    s_mov_b32 m0, 159744
    s_mov_b32 s47, 172864
    buffer_load_dwordx4 v20, s[64:67], s47 offen lds
    s_mov_b32 m0, 160768
    s_mov_b32 s47, 187200
    buffer_load_dwordx4 v20, s[64:67], s47 offen lds
    s_mov_b32 m0, 161792
    s_mov_b32 s47, 201536
    buffer_load_dwordx4 v20, s[64:67], s47 offen lds
    s_mov_b32 m0, 162816
    s_mov_b32 s47, 215872
    buffer_load_dwordx4 v20, s[64:67], s47 offen lds
    s_waitcnt vmcnt(48)
    s_barrier
    s_waitcnt vmcnt(32)
    s_barrier
    s_waitcnt vmcnt(16)
    s_barrier
    s_waitcnt vmcnt(0)
    s_barrier
L1_end:
    s_endpgm
.section .rodata,"a"
.p2align 6
.amdhsa_kernel attn_kernel
  .amdhsa_next_free_vgpr 512
  .amdhsa_next_free_sgpr 102
  .amdhsa_accum_offset 256
  .amdhsa_group_segment_fixed_size 0
  .amdhsa_kernarg_size 104
  .amdhsa_user_sgpr_count 2
  .amdhsa_user_sgpr_kernarg_segment_ptr 1
  .amdhsa_system_sgpr_workgroup_id_x 1
.end_amdhsa_kernel
.text
    .globl reduce_kernel
    .p2align 8
    .type reduce_kernel,@function
reduce_kernel:
    s_cmp_ge_u32 s2, 504
    s_cbranch_scc1 L2_end
    s_load_dwordx2 s[14:15], s[0:1], 80
    s_load_dwordx2 s[16:17], s[0:1], 96
    s_lshl_b32 s3, s2, 8
    v_add_u32 v1, s3, v0
    v_lshrrev_b32 v2, 7, v1
    v_mul_u32_u24 v2, 1041, v2
    v_lshrrev_b32 v2, 16, v2
    v_mul_u32_u24 v3, 8064, v2
    v_sub_u32 v3, v1, v3
    s_mov_b32 s4, 2064384
    v_mul_lo_u32 v4, v2, s4
    v_lshl_add_u32 v4, v3, 4, v4
    s_waitcnt lgkmcnt(0)
    s_mov_b32 s20, s16
    s_mov_b32 s21, s17
    s_mov_b32 s22, 33030144
    s_mov_b32 s23, 0x20000
    s_mov_b32 s24, s14
    s_mov_b32 s25, s15
    s_mov_b32 s26, 2064384
    s_mov_b32 s27, 0x20000
    s_mov_b32 s5, 0
    buffer_load_dwordx4 v[16:19], v4, s[20:23], s5 offen
    s_mov_b32 s5, 129024
    buffer_load_dwordx4 v[20:23], v4, s[20:23], s5 offen
    s_mov_b32 s5, 258048
    buffer_load_dwordx4 v[24:27], v4, s[20:23], s5 offen
    s_mov_b32 s5, 387072
    buffer_load_dwordx4 v[28:31], v4, s[20:23], s5 offen
    s_mov_b32 s5, 516096
    buffer_load_dwordx4 v[32:35], v4, s[20:23], s5 offen
    s_mov_b32 s5, 645120
    buffer_load_dwordx4 v[36:39], v4, s[20:23], s5 offen
    s_mov_b32 s5, 774144
    buffer_load_dwordx4 v[40:43], v4, s[20:23], s5 offen
    s_mov_b32 s5, 903168
    buffer_load_dwordx4 v[44:47], v4, s[20:23], s5 offen
    s_mov_b32 s5, 1032192
    buffer_load_dwordx4 v[48:51], v4, s[20:23], s5 offen
    s_mov_b32 s5, 1161216
    buffer_load_dwordx4 v[52:55], v4, s[20:23], s5 offen
    s_mov_b32 s5, 1290240
    buffer_load_dwordx4 v[56:59], v4, s[20:23], s5 offen
    s_mov_b32 s5, 1419264
    buffer_load_dwordx4 v[60:63], v4, s[20:23], s5 offen
    s_mov_b32 s5, 1548288
    buffer_load_dwordx4 v[64:67], v4, s[20:23], s5 offen
    s_mov_b32 s5, 1677312
    buffer_load_dwordx4 v[68:71], v4, s[20:23], s5 offen
    s_mov_b32 s5, 1806336
    buffer_load_dwordx4 v[72:75], v4, s[20:23], s5 offen
    s_mov_b32 s5, 1935360
    buffer_load_dwordx4 v[76:79], v4, s[20:23], s5 offen
    v_lshrrev_b32 v5, 3, v3
    v_mul_u32_u24 v5, 9363, v5
    v_lshrrev_b32 v5, 16, v5
    v_mul_u32_u24 v6, 56, v5
    v_sub_u32 v6, v3, v6
    v_and_b32 v7, 7, v2
    v_mul_u32_u24 v7, 144, v7
    v_add_u32 v7, v7, v5
    v_mul_u32_u24 v7, 1792, v7
    v_lshrrev_b32 v8, 3, v2
    v_mul_u32_u24 v8, 896, v8
    v_add_u32 v7, v7, v8
    v_lshl_add_u32 v7, v6, 4, v7
    v_mov_b32 v8, 0
    v_mov_b32 v9, 0
    v_mov_b32 v10, 0
    v_mov_b32 v11, 0
    v_mov_b32 v12, 0
    v_mov_b32 v13, 0
    v_mov_b32 v14, 0
    v_mov_b32 v15, 0
    s_waitcnt vmcnt(15)
    v_lshlrev_b32 v80, 16, v16
    v_and_b32 v81, 0xffff0000, v16
    v_add_f32 v8, v8, v80
    v_add_f32 v9, v9, v81
    v_lshlrev_b32 v80, 16, v17
    v_and_b32 v81, 0xffff0000, v17
    v_add_f32 v10, v10, v80
    v_add_f32 v11, v11, v81
    v_lshlrev_b32 v80, 16, v18
    v_and_b32 v81, 0xffff0000, v18
    v_add_f32 v12, v12, v80
    v_add_f32 v13, v13, v81
    v_lshlrev_b32 v80, 16, v19
    v_and_b32 v81, 0xffff0000, v19
    v_add_f32 v14, v14, v80
    v_add_f32 v15, v15, v81
    s_waitcnt vmcnt(14)
    v_lshlrev_b32 v80, 16, v20
    v_and_b32 v81, 0xffff0000, v20
    v_add_f32 v8, v8, v80
    v_add_f32 v9, v9, v81
    v_lshlrev_b32 v80, 16, v21
    v_and_b32 v81, 0xffff0000, v21
    v_add_f32 v10, v10, v80
    v_add_f32 v11, v11, v81
    v_lshlrev_b32 v80, 16, v22
    v_and_b32 v81, 0xffff0000, v22
    v_add_f32 v12, v12, v80
    v_add_f32 v13, v13, v81
    v_lshlrev_b32 v80, 16, v23
    v_and_b32 v81, 0xffff0000, v23
    v_add_f32 v14, v14, v80
    v_add_f32 v15, v15, v81
    s_waitcnt vmcnt(13)
    v_lshlrev_b32 v80, 16, v24
    v_and_b32 v81, 0xffff0000, v24
    v_add_f32 v8, v8, v80
    v_add_f32 v9, v9, v81
    v_lshlrev_b32 v80, 16, v25
    v_and_b32 v81, 0xffff0000, v25
    v_add_f32 v10, v10, v80
    v_add_f32 v11, v11, v81
    v_lshlrev_b32 v80, 16, v26
    v_and_b32 v81, 0xffff0000, v26
    v_add_f32 v12, v12, v80
    v_add_f32 v13, v13, v81
    v_lshlrev_b32 v80, 16, v27
    v_and_b32 v81, 0xffff0000, v27
    v_add_f32 v14, v14, v80
    v_add_f32 v15, v15, v81
    s_waitcnt vmcnt(12)
    v_lshlrev_b32 v80, 16, v28
    v_and_b32 v81, 0xffff0000, v28
    v_add_f32 v8, v8, v80
    v_add_f32 v9, v9, v81
    v_lshlrev_b32 v80, 16, v29
    v_and_b32 v81, 0xffff0000, v29
    v_add_f32 v10, v10, v80
    v_add_f32 v11, v11, v81
    v_lshlrev_b32 v80, 16, v30
    v_and_b32 v81, 0xffff0000, v30
    v_add_f32 v12, v12, v80
    v_add_f32 v13, v13, v81
    v_lshlrev_b32 v80, 16, v31
    v_and_b32 v81, 0xffff0000, v31
    v_add_f32 v14, v14, v80
    v_add_f32 v15, v15, v81
    s_waitcnt vmcnt(11)
    v_lshlrev_b32 v80, 16, v32
    v_and_b32 v81, 0xffff0000, v32
    v_add_f32 v8, v8, v80
    v_add_f32 v9, v9, v81
    v_lshlrev_b32 v80, 16, v33
    v_and_b32 v81, 0xffff0000, v33
    v_add_f32 v10, v10, v80
    v_add_f32 v11, v11, v81
    v_lshlrev_b32 v80, 16, v34
    v_and_b32 v81, 0xffff0000, v34
    v_add_f32 v12, v12, v80
    v_add_f32 v13, v13, v81
    v_lshlrev_b32 v80, 16, v35
    v_and_b32 v81, 0xffff0000, v35
    v_add_f32 v14, v14, v80
    v_add_f32 v15, v15, v81
    s_waitcnt vmcnt(10)
    v_lshlrev_b32 v80, 16, v36
    v_and_b32 v81, 0xffff0000, v36
    v_add_f32 v8, v8, v80
    v_add_f32 v9, v9, v81
    v_lshlrev_b32 v80, 16, v37
    v_and_b32 v81, 0xffff0000, v37
    v_add_f32 v10, v10, v80
    v_add_f32 v11, v11, v81
    v_lshlrev_b32 v80, 16, v38
    v_and_b32 v81, 0xffff0000, v38
    v_add_f32 v12, v12, v80
    v_add_f32 v13, v13, v81
    v_lshlrev_b32 v80, 16, v39
    v_and_b32 v81, 0xffff0000, v39
    v_add_f32 v14, v14, v80
    v_add_f32 v15, v15, v81
    s_waitcnt vmcnt(9)
    v_lshlrev_b32 v80, 16, v40
    v_and_b32 v81, 0xffff0000, v40
    v_add_f32 v8, v8, v80
    v_add_f32 v9, v9, v81
    v_lshlrev_b32 v80, 16, v41
    v_and_b32 v81, 0xffff0000, v41
    v_add_f32 v10, v10, v80
    v_add_f32 v11, v11, v81
    v_lshlrev_b32 v80, 16, v42
    v_and_b32 v81, 0xffff0000, v42
    v_add_f32 v12, v12, v80
    v_add_f32 v13, v13, v81
    v_lshlrev_b32 v80, 16, v43
    v_and_b32 v81, 0xffff0000, v43
    v_add_f32 v14, v14, v80
    v_add_f32 v15, v15, v81
    s_waitcnt vmcnt(8)
    v_lshlrev_b32 v80, 16, v44
    v_and_b32 v81, 0xffff0000, v44
    v_add_f32 v8, v8, v80
    v_add_f32 v9, v9, v81
    v_lshlrev_b32 v80, 16, v45
    v_and_b32 v81, 0xffff0000, v45
    v_add_f32 v10, v10, v80
    v_add_f32 v11, v11, v81
    v_lshlrev_b32 v80, 16, v46
    v_and_b32 v81, 0xffff0000, v46
    v_add_f32 v12, v12, v80
    v_add_f32 v13, v13, v81
    v_lshlrev_b32 v80, 16, v47
    v_and_b32 v81, 0xffff0000, v47
    v_add_f32 v14, v14, v80
    v_add_f32 v15, v15, v81
    s_waitcnt vmcnt(7)
    v_lshlrev_b32 v80, 16, v48
    v_and_b32 v81, 0xffff0000, v48
    v_add_f32 v8, v8, v80
    v_add_f32 v9, v9, v81
    v_lshlrev_b32 v80, 16, v49
    v_and_b32 v81, 0xffff0000, v49
    v_add_f32 v10, v10, v80
    v_add_f32 v11, v11, v81
    v_lshlrev_b32 v80, 16, v50
    v_and_b32 v81, 0xffff0000, v50
    v_add_f32 v12, v12, v80
    v_add_f32 v13, v13, v81
    v_lshlrev_b32 v80, 16, v51
    v_and_b32 v81, 0xffff0000, v51
    v_add_f32 v14, v14, v80
    v_add_f32 v15, v15, v81
    s_waitcnt vmcnt(6)
    v_lshlrev_b32 v80, 16, v52
    v_and_b32 v81, 0xffff0000, v52
    v_add_f32 v8, v8, v80
    v_add_f32 v9, v9, v81
    v_lshlrev_b32 v80, 16, v53
    v_and_b32 v81, 0xffff0000, v53
    v_add_f32 v10, v10, v80
    v_add_f32 v11, v11, v81
    v_lshlrev_b32 v80, 16, v54
    v_and_b32 v81, 0xffff0000, v54
    v_add_f32 v12, v12, v80
    v_add_f32 v13, v13, v81
    v_lshlrev_b32 v80, 16, v55
    v_and_b32 v81, 0xffff0000, v55
    v_add_f32 v14, v14, v80
    v_add_f32 v15, v15, v81
    s_waitcnt vmcnt(5)
    v_lshlrev_b32 v80, 16, v56
    v_and_b32 v81, 0xffff0000, v56
    v_add_f32 v8, v8, v80
    v_add_f32 v9, v9, v81
    v_lshlrev_b32 v80, 16, v57
    v_and_b32 v81, 0xffff0000, v57
    v_add_f32 v10, v10, v80
    v_add_f32 v11, v11, v81
    v_lshlrev_b32 v80, 16, v58
    v_and_b32 v81, 0xffff0000, v58
    v_add_f32 v12, v12, v80
    v_add_f32 v13, v13, v81
    v_lshlrev_b32 v80, 16, v59
    v_and_b32 v81, 0xffff0000, v59
    v_add_f32 v14, v14, v80
    v_add_f32 v15, v15, v81
    s_waitcnt vmcnt(4)
    v_lshlrev_b32 v80, 16, v60
    v_and_b32 v81, 0xffff0000, v60
    v_add_f32 v8, v8, v80
    v_add_f32 v9, v9, v81
    v_lshlrev_b32 v80, 16, v61
    v_and_b32 v81, 0xffff0000, v61
    v_add_f32 v10, v10, v80
    v_add_f32 v11, v11, v81
    v_lshlrev_b32 v80, 16, v62
    v_and_b32 v81, 0xffff0000, v62
    v_add_f32 v12, v12, v80
    v_add_f32 v13, v13, v81
    v_lshlrev_b32 v80, 16, v63
    v_and_b32 v81, 0xffff0000, v63
    v_add_f32 v14, v14, v80
    v_add_f32 v15, v15, v81
    s_waitcnt vmcnt(3)
    v_lshlrev_b32 v80, 16, v64
    v_and_b32 v81, 0xffff0000, v64
    v_add_f32 v8, v8, v80
    v_add_f32 v9, v9, v81
    v_lshlrev_b32 v80, 16, v65
    v_and_b32 v81, 0xffff0000, v65
    v_add_f32 v10, v10, v80
    v_add_f32 v11, v11, v81
    v_lshlrev_b32 v80, 16, v66
    v_and_b32 v81, 0xffff0000, v66
    v_add_f32 v12, v12, v80
    v_add_f32 v13, v13, v81
    v_lshlrev_b32 v80, 16, v67
    v_and_b32 v81, 0xffff0000, v67
    v_add_f32 v14, v14, v80
    v_add_f32 v15, v15, v81
    s_waitcnt vmcnt(2)
    v_lshlrev_b32 v80, 16, v68
    v_and_b32 v81, 0xffff0000, v68
    v_add_f32 v8, v8, v80
    v_add_f32 v9, v9, v81
    v_lshlrev_b32 v80, 16, v69
    v_and_b32 v81, 0xffff0000, v69
    v_add_f32 v10, v10, v80
    v_add_f32 v11, v11, v81
    v_lshlrev_b32 v80, 16, v70
    v_and_b32 v81, 0xffff0000, v70
    v_add_f32 v12, v12, v80
    v_add_f32 v13, v13, v81
    v_lshlrev_b32 v80, 16, v71
    v_and_b32 v81, 0xffff0000, v71
    v_add_f32 v14, v14, v80
    v_add_f32 v15, v15, v81
    s_waitcnt vmcnt(1)
    v_lshlrev_b32 v80, 16, v72
    v_and_b32 v81, 0xffff0000, v72
    v_add_f32 v8, v8, v80
    v_add_f32 v9, v9, v81
    v_lshlrev_b32 v80, 16, v73
    v_and_b32 v81, 0xffff0000, v73
    v_add_f32 v10, v10, v80
    v_add_f32 v11, v11, v81
    v_lshlrev_b32 v80, 16, v74
    v_and_b32 v81, 0xffff0000, v74
    v_add_f32 v12, v12, v80
    v_add_f32 v13, v13, v81
    v_lshlrev_b32 v80, 16, v75
    v_and_b32 v81, 0xffff0000, v75
    v_add_f32 v14, v14, v80
    v_add_f32 v15, v15, v81
    s_waitcnt vmcnt(0)
    v_lshlrev_b32 v80, 16, v76
    v_and_b32 v81, 0xffff0000, v76
    v_add_f32 v8, v8, v80
    v_add_f32 v9, v9, v81
    v_lshlrev_b32 v80, 16, v77
    v_and_b32 v81, 0xffff0000, v77
    v_add_f32 v10, v10, v80
    v_add_f32 v11, v11, v81
    v_lshlrev_b32 v80, 16, v78
    v_and_b32 v81, 0xffff0000, v78
    v_add_f32 v12, v12, v80
    v_add_f32 v13, v13, v81
    v_lshlrev_b32 v80, 16, v79
    v_and_b32 v81, 0xffff0000, v79
    v_add_f32 v14, v14, v80
    v_add_f32 v15, v15, v81
    v_cvt_pk_bf16_f32 v84, v8, v9
    v_cvt_pk_bf16_f32 v85, v10, v11
    v_cvt_pk_bf16_f32 v86, v12, v13
    v_cvt_pk_bf16_f32 v87, v14, v15
    buffer_store_dwordx4 v[84:87], v7, s[24:27], 0 offen
    s_waitcnt vmcnt(0)
L2_end:
    s_endpgm
.section .rodata,"a"
.p2align 6
.amdhsa_kernel reduce_kernel
  .amdhsa_next_free_vgpr 88
  .amdhsa_next_free_sgpr 102
  .amdhsa_accum_offset 88
  .amdhsa_group_segment_fixed_size 0
  .amdhsa_kernarg_size 104
  .amdhsa_user_sgpr_count 2
  .amdhsa_user_sgpr_kernarg_segment_ptr 1
  .amdhsa_system_sgpr_workgroup_id_x 1
.end_amdhsa_kernel
.text
```
